```python
import torch

def _softmax(x, axis=-1):
    return torch.softmax(x, dim=axis)
def _gelu(x):
    return torch.nn.functional.gelu(x, approximate="tanh")
def _silu(x):
    return torch.nn.functional.silu(x)
def _sigmoid(x):
    return torch.sigmoid(x)
def _layernorm(x, axis=-1, eps=1e-5):
    m = x.mean(dim=axis, keepdim=True)
    v = x.var(dim=axis, keepdim=True, unbiased=False)
    return (x - m) / torch.sqrt(v + eps)
def _scatter_add(tgt, idx, src, axis=0):
    return tgt.clone().index_add_(axis, idx, src)
def _segment_sum(src, seg, n):
    out = torch.zeros((n,) + src.shape[1:], dtype=src.dtype)
    return out.index_add_(0, seg, src)
def _pad(x, pw):
    flat = tuple(v for pair in reversed(pw) for v in pair)
    return torch.nn.functional.pad(x, flat)

kernel_name = 'sequential_preLN__spectral_fnet__swiglu_ffn__prompt'

def setup_inputs():

    _w = (lambda a: (lambda t: t.to(torch.bfloat16) if t.is_floating_point() else t)(torch.as_tensor(a)))
    def _A_setup():
        B, S, D = 1, 2048, 1024
        ns = torch.arange(S)[:, None] * torch.arange(S)[None, :]
        nd = torch.arange(D)[:, None] * torch.arange(D)[None, :]
        Ws_re = torch.cos(-2.0 * torch.pi * ns / S).to(float)
        Ws_im = torch.sin(-2.0 * torch.pi * ns / S).to(float)
        Wd_re = torch.cos(-2.0 * torch.pi * nd / D).to(float)
        Wd_im = torch.sin(-2.0 * torch.pi * nd / D).to(float)
        return {
            "x": _w((lambda *s: torch.randn(*s, dtype=torch.bfloat16) * 0.05)(B, S, D)),
            "dft_seq_re": _w(Ws_re),
            "dft_seq_im": _w(Ws_im),
            "dft_hid_re": _w(Wd_re),
            "dft_hid_im": _w(Wd_im),
        }
    _A_in = _A_setup()

    def _B_setup():
        B, S, D, F = 1, 2048, 1024, 3584
        return {
            "x": _w((lambda *s: torch.randn(*s, dtype=torch.bfloat16) * 0.05)(B, S, D)),
            "w_gate": _w((lambda *s: torch.randn(*s, dtype=torch.bfloat16) * 0.2)(D, F)),
            "w_up": _w((lambda *s: torch.randn(*s, dtype=torch.bfloat16) * 0.2)(D, F)),
            "w_down": _w((lambda *s: torch.randn(*s, dtype=torch.bfloat16) * 0.2)(F, D)),
        }
    _B_in = _B_setup()

    return {
        "A_x": _A_in["x"],
        "A_dft_seq_re": _A_in["dft_seq_re"],
        "A_dft_seq_im": _A_in["dft_seq_im"],
        "A_dft_hid_re": _A_in["dft_hid_re"],
        "A_dft_hid_im": _A_in["dft_hid_im"],
        "B_x": _B_in["x"],
        "B_w_gate": _B_in["w_gate"],
        "B_w_up": _B_in["w_up"],
        "B_w_down": _B_in["w_down"],
    }

def reference(A_x, A_dft_seq_re, A_dft_seq_im, A_dft_hid_re, A_dft_hid_im, B_x, B_w_gate, B_w_up, B_w_down):
    def _A_ref(x, dft_seq_re, dft_seq_im, dft_hid_re, dft_hid_im):
        a = torch.einsum("bsd,ed->bse", x, dft_hid_re)
        b = torch.einsum("bsd,ed->bse", x, dft_hid_im)
        y = torch.einsum("ts,bse->bte", dft_seq_re, a) - torch.einsum("ts,bse->bte", dft_seq_im, b)
        return y

    def _B_ref(x, w_gate, w_up, w_down):
        g = _silu(x @ w_gate)
        u = x @ w_up
        return (g * u) @ w_down

    x = A_x
    h = x + _A_ref(_layernorm(x, axis=-1), A_dft_seq_re, A_dft_seq_im, A_dft_hid_re, A_dft_hid_im)
    h2 = h + _B_ref(_layernorm(h, axis=-1), B_w_gate, B_w_up, B_w_down)
    return h2
```

```asm
; @launch kernel=k1_kernel grid=(256,1,1) block=(512,1,1) lds=34880
; @launch kernel=k2_kernel grid=(256,1,1) block=(256,1,1) lds=92160
; @launch kernel=g34_kernel grid=(256,1,1) block=(256,1,1) lds=151552
.amdgcn_target "amdgcn-amd-amdhsa--gfx950"
.text
.globl k1_kernel
.p2align 8
.type k1_kernel,@function
k1_kernel:
    s_cmp_ge_u32 s2, 256
    s_cbranch_scc1 k1_kernel_end
    s_load_dwordx2 s[36:37], s[0:1], 0
    s_load_dwordx4 s[52:55], s[0:1], 8
    s_load_dwordx2 s[40:41], s[0:1], 88
    s_load_dwordx4 s[56:59], s[0:1], 48
    s_getpc_b64 s[4:5]
k1_kernel_pc:
    s_lshr_b32 s6, s2, 3
    s_lshl_b32 s6, s6, 3
    v_lshrrev_b32 v161, 6, v0
    v_add_u32 v161, s6, v161
    v_and_b32 v161, 15, v161
    v_lshlrev_b32 v161, 6, v161
    v_and_or_b32 v161, v0, 63, v161
    v_lshlrev_b32 v161, 7, v161
    v_min_u32 v161, ((k1_kernel_end - k1_kernel_pc) / 4) * 4 - 4, v161
    global_load_dword v160, v161, s[4:5]
    v_lshrrev_b32 v1, 6, v0
    v_and_b32 v0, 63, v0
    v_readfirstlane_b32 s24, v1
    v_lshlrev_b32 v1, 4, v0
    s_lshl_b32 s25, s24, 8
    s_add_u32 s25, s25, s2
    s_lshl_b32 s26, s25, 11
    s_and_b32 s27, s2, 7
    s_lshl_b32 s27, s27, 8
    s_and_b32 s28, s2, 0xf8
    s_add_u32 s27, s27, s28
    s_add_u32 s27, s27, s24
    s_lshr_b32 s28, s27, 4
    s_lshl_b32 s28, s28, 4
    v_and_b32 v2, 15, v0
    v_add_u32 v144, s28, v2
    v_lshrrev_b32 v145, 8, v144
    v_and_b32 v144, 255, v144
    v_lshl_add_u32 v144, v144, 3, v145
    v_lshrrev_b32 v145, 4, v0
    s_waitcnt lgkmcnt(0)
    s_mov_b32 s8, s36
    s_and_b32 s9, s37, 0xffff
    s_mov_b32 s10, 0x400000
    s_mov_b32 s11, 0x00020000
    buffer_load_dwordx4 v[4:7], v1, s[8:11], s26 offen
    buffer_load_dwordx4 v[8:11], v1, s[8:11], s26 offen offset:1024
    s_mov_b32 s12, s40
    s_and_b32 s13, s41, 0xffff
    s_mov_b32 s14, 0x400000
    s_mov_b32 s15, 0x00020000
    s_add_u32 s16, s40, 0x600000
    s_addc_u32 s17, s41, 0
    s_and_b32 s17, s17, 0xffff
    s_mov_b32 s18, 0x12000
    s_mov_b32 s19, 0x00020000
    s_add_u32 s20, s40, 0x620000
    s_addc_u32 s21, s41, 0
    s_and_b32 s21, s21, 0xffff
    s_mov_b32 s22, 0x2000
    s_mov_b32 s23, 0x00020000
    s_add_u32 s48, s40, 0x400000
    s_addc_u32 s49, s41, 0
    s_and_b32 s49, s49, 0xffff
    s_mov_b32 s50, 0x200000
    s_mov_b32 s51, 0x00020000
    v_cvt_f32_u32 v144, v144
    v_mul_f32 v144, 0x3a000000, v144
    s_and_b32 s28, s27, 7
    s_lshl_b32 s28, s28, 5
    v_lshl_add_u32 v146, v145, 2, s28
    v_cvt_f32_u32 v146, v146
    s_bitcmp1_b32 s27, 3
    s_cselect_b32 s28, 0x3e800000, 0
    v_add_f32 v147, 0x0, v146
    v_fma_f32 v147, v147, v144, s28
    v_fract_f32 v147, v147
    v_cos_f32 v148, v147
    v_add_f32 v147, 0x3f800000, v146
    v_fma_f32 v147, v147, v144, s28
    v_fract_f32 v147, v147
    v_cos_f32 v149, v147
    v_add_f32 v147, 0x40000000, v146
    v_fma_f32 v147, v147, v144, s28
    v_fract_f32 v147, v147
    v_cos_f32 v150, v147
    v_add_f32 v147, 0x40400000, v146
    v_fma_f32 v147, v147, v144, s28
    v_fract_f32 v147, v147
    v_cos_f32 v151, v147
    s_nop 0
    v_cvt_pk_f16_f32 v12, v148, v149
    v_cvt_pk_f16_f32 v13, v150, v151
    v_add_f32 v147, 0x41800000, v146
    v_fma_f32 v147, v147, v144, s28
    v_fract_f32 v147, v147
    v_cos_f32 v148, v147
    v_add_f32 v147, 0x41880000, v146
    v_fma_f32 v147, v147, v144, s28
    v_fract_f32 v147, v147
    v_cos_f32 v149, v147
    v_add_f32 v147, 0x41900000, v146
    v_fma_f32 v147, v147, v144, s28
    v_fract_f32 v147, v147
    v_cos_f32 v150, v147
    v_add_f32 v147, 0x41980000, v146
    v_fma_f32 v147, v147, v144, s28
    v_fract_f32 v147, v147
    v_cos_f32 v151, v147
    s_nop 0
    v_cvt_pk_f16_f32 v14, v148, v149
    v_cvt_pk_f16_f32 v15, v150, v151
    s_lshl_b32 s28, s27, 10
    buffer_store_dwordx4 v[12:15], v1, s[48:51], s28 offen
    v_cvt_f32_u32 v146, v2
    v_lshlrev_b32 v145, 2, v145
    v_cvt_f32_u32 v147, v145
    v_add_f32 v148, 0x0, v146
    v_mul_f32 v149, 0x3a800000, v148
    v_mul_f32 v148, 0x3d000000, v148
    v_add_f32 v150, 0x0, v147
    v_mul_f32 v151, v150, v148
    v_mul_f32 v150, v150, v149
    v_fract_f32 v151, v151
    v_cos_f32 v152, v151
    v_sin_f32 v154, v151
    v_cos_f32 v56, v150
    v_sin_f32 v72, v150
    v_add_f32 v150, 0x3f800000, v147
    v_mul_f32 v151, v150, v148
    v_mul_f32 v150, v150, v149
    v_fract_f32 v151, v151
    v_cos_f32 v153, v151
    v_sin_f32 v155, v151
    v_cos_f32 v57, v150
    v_sin_f32 v73, v150
    v_cvt_pk_f16_f32 v32, v152, v153
    v_cvt_pk_f16_f32 v48, v154, v155
    v_xor_b32 v40, 0x80008000, v48
    v_add_f32 v150, 0x40000000, v147
    v_mul_f32 v151, v150, v148
    v_mul_f32 v150, v150, v149
    v_fract_f32 v151, v151
    v_cos_f32 v152, v151
    v_sin_f32 v154, v151
    v_cos_f32 v58, v150
    v_sin_f32 v74, v150
    v_add_f32 v150, 0x40400000, v147
    v_mul_f32 v151, v150, v148
    v_mul_f32 v150, v150, v149
    v_fract_f32 v151, v151
    v_cos_f32 v153, v151
    v_sin_f32 v155, v151
    v_cos_f32 v59, v150
    v_sin_f32 v75, v150
    v_cvt_pk_f16_f32 v33, v152, v153
    v_cvt_pk_f16_f32 v49, v154, v155
    v_xor_b32 v41, 0x80008000, v49
    v_add_f32 v150, 0x41800000, v147
    v_mul_f32 v151, v150, v148
    v_mul_f32 v150, v150, v149
    v_fract_f32 v151, v151
    v_cos_f32 v152, v151
    v_sin_f32 v154, v151
    v_cos_f32 v64, v150
    v_sin_f32 v80, v150
    v_add_f32 v150, 0x41880000, v147
    v_mul_f32 v151, v150, v148
    v_mul_f32 v150, v150, v149
    v_fract_f32 v151, v151
    v_cos_f32 v153, v151
    v_sin_f32 v155, v151
    v_cos_f32 v65, v150
    v_sin_f32 v81, v150
    v_cvt_pk_f16_f32 v34, v152, v153
    v_cvt_pk_f16_f32 v50, v154, v155
    v_xor_b32 v42, 0x80008000, v50
    v_add_f32 v150, 0x41900000, v147
    v_mul_f32 v151, v150, v148
    v_mul_f32 v150, v150, v149
    v_fract_f32 v151, v151
    v_cos_f32 v152, v151
    v_sin_f32 v154, v151
    v_cos_f32 v66, v150
    v_sin_f32 v82, v150
    v_add_f32 v150, 0x41980000, v147
    v_mul_f32 v151, v150, v148
    v_mul_f32 v150, v150, v149
    v_fract_f32 v151, v151
    v_cos_f32 v153, v151
    v_sin_f32 v155, v151
    v_cos_f32 v67, v150
    v_sin_f32 v83, v150
    v_cvt_pk_f16_f32 v35, v152, v153
    v_cvt_pk_f16_f32 v51, v154, v155
    v_xor_b32 v43, 0x80008000, v51
    v_add_f32 v148, 0x41800000, v146
    v_mul_f32 v149, 0x3a800000, v148
    v_mul_f32 v148, 0x3d000000, v148
    v_add_f32 v150, 0x0, v147
    v_mul_f32 v151, v150, v148
    v_mul_f32 v150, v150, v149
    v_fract_f32 v151, v151
    v_cos_f32 v152, v151
    v_sin_f32 v154, v151
    v_cos_f32 v60, v150
    v_sin_f32 v76, v150
    v_add_f32 v150, 0x3f800000, v147
    v_mul_f32 v151, v150, v148
    v_mul_f32 v150, v150, v149
    v_fract_f32 v151, v151
    v_cos_f32 v153, v151
    v_sin_f32 v155, v151
    v_cos_f32 v61, v150
    v_sin_f32 v77, v150
    v_cvt_pk_f16_f32 v36, v152, v153
    v_cvt_pk_f16_f32 v52, v154, v155
    v_xor_b32 v44, 0x80008000, v52
    v_add_f32 v150, 0x40000000, v147
    v_mul_f32 v151, v150, v148
    v_mul_f32 v150, v150, v149
    v_fract_f32 v151, v151
    v_cos_f32 v152, v151
    v_sin_f32 v154, v151
    v_cos_f32 v62, v150
    v_sin_f32 v78, v150
    v_add_f32 v150, 0x40400000, v147
    v_mul_f32 v151, v150, v148
    v_mul_f32 v150, v150, v149
    v_fract_f32 v151, v151
    v_cos_f32 v153, v151
    v_sin_f32 v155, v151
    v_cos_f32 v63, v150
    v_sin_f32 v79, v150
    v_cvt_pk_f16_f32 v37, v152, v153
    v_cvt_pk_f16_f32 v53, v154, v155
    v_xor_b32 v45, 0x80008000, v53
    v_add_f32 v150, 0x41800000, v147
    v_mul_f32 v151, v150, v148
    v_mul_f32 v150, v150, v149
    v_fract_f32 v151, v151
    v_cos_f32 v152, v151
    v_sin_f32 v154, v151
    v_cos_f32 v68, v150
    v_sin_f32 v84, v150
    v_add_f32 v150, 0x41880000, v147
    v_mul_f32 v151, v150, v148
    v_mul_f32 v150, v150, v149
    v_fract_f32 v151, v151
    v_cos_f32 v153, v151
    v_sin_f32 v155, v151
    v_cos_f32 v69, v150
    v_sin_f32 v85, v150
    v_cvt_pk_f16_f32 v38, v152, v153
    v_cvt_pk_f16_f32 v54, v154, v155
    v_xor_b32 v46, 0x80008000, v54
    v_add_f32 v150, 0x41900000, v147
    v_mul_f32 v151, v150, v148
    v_mul_f32 v150, v150, v149
    v_fract_f32 v151, v151
    v_cos_f32 v152, v151
    v_sin_f32 v154, v151
    v_cos_f32 v70, v150
    v_sin_f32 v86, v150
    v_add_f32 v150, 0x41980000, v147
    v_mul_f32 v151, v150, v148
    v_mul_f32 v150, v150, v149
    v_fract_f32 v151, v151
    v_cos_f32 v153, v151
    v_sin_f32 v155, v151
    v_cos_f32 v71, v150
    v_sin_f32 v87, v150
    v_cvt_pk_f16_f32 v39, v152, v153
    v_cvt_pk_f16_f32 v55, v154, v155
    v_xor_b32 v47, 0x80008000, v55
    s_lshl_b32 s29, s24, 11
    s_add_u32 s29, s29, 18432
    v_add_u32 v156, s29, v1
    v_lshrrev_b32 v157, 2, v0
    v_lshlrev_b32 v157, 6, v157
    v_and_b32 v158, 3, v0
    v_lshl_add_u32 v157, v158, 3, v157
    v_add_u32 v157, s29, v157
    v_mul_u32_u24 v158, 144, v2
    v_lshl_add_u32 v158, v145, 2, v158
    s_mul_i32 s30, s24, 2304
    v_add_u32 v158, s30, v158
    s_and_b32 s30, s24, 1
    s_lshl_b32 s31, s30, 6
    v_and_b32 v152, 31, v0
    v_lshrrev_b32 v153, 5, v0
    v_lshl_add_u32 v154, v152, 1, v153
    v_add_u32 v154, s31, v154
    v_lshrrev_b32 v155, 3, v154
    v_add_u32 v154, v154, v155
    v_lshlrev_b32 v159, 4, v154
    v_lshrrev_b32 v154, 3, v152
    v_lshlrev_b32 v154, 16, v154
    v_and_b32 v155, 7, v0
    v_lshl_add_u32 v154, v155, 4, v154
    v_lshl_add_u32 v154, v153, 15, v154
    s_lshl_b32 s34, s30, 2
    v_lshrrev_b32 v164, 3, v152
    v_add_u32 v164, s34, v164
    v_cmp_eq_u32 vcc, 0, v164
    v_lshlrev_b32 v164, 10, v164
    v_lshl_add_u32 v164, v153, 9, v164
    v_add_u32 v164, 7168, v164
    v_mov_b32 v151, 0x40000000
    v_cndmask_b32 v164, v164, v151, vcc
    v_cmp_ne_u32 vcc, 0, v155
    s_lshl_b32 s30, s30, 18
    v_add_u32 v3, s30, v154
    v_cndmask_b32 v164, v164, v151, vcc
    s_lshr_b32 s32, s2, 5
    s_lshl_b32 s32, s32, 6
    s_bfe_u32 s31, s2, 0x20002
    s_lshl_b32 s31, s31, 4
    s_add_u32 s32, s32, s31
    s_bfe_u32 s31, s2, 0x10004
    s_lshl_b32 s31, s31, 3
    s_add_u32 s32, s32, s31
    s_and_b32 s31, s2, 3
    s_lshl_b32 s31, s31, 1
    s_add_u32 s32, s32, s31
    s_and_b32 s26, s2, 0xc0
    s_and_b32 s31, s2, 7
    s_lshl_b32 s31, s31, 3
    s_add_u32 s26, s26, s31
    s_bfe_u32 s31, s2, 0x30003
    s_add_u32 s26, s26, s31
    s_lshl_b32 s26, s26, 7
    s_and_b32 s31, s25, 7
    s_lshl_b32 s31, s31, 8
    s_lshr_b32 s33, s25, 3
    s_add_u32 s33, s33, s31
    s_lshl_b32 s33, s33, 2
    s_lshr_b32 s35, s2, 3
    s_lshl_b32 s35, s35, 3
    s_add_u32 s35, s35, s24
    s_bitcmp1_b32 s35, 7
    s_cselect_b32 s64, s58, s56
    s_cselect_b32 s65, s59, s57
    s_and_b32 s65, s65, 0xffff
    s_mov_b32 s66, 7340032
    s_mov_b32 s67, 0x00020000
    s_and_b32 s60, s35, 127
    s_mul_i32 s60, s60, 28672
    s_and_b32 s61, s2, 7
    s_mul_i32 s61, s61, 896
    s_add_u32 s60, s60, s61
    v_mul_u32_u24 v162, 9363, v0
    v_lshrrev_b32 v162, 16, v162
    v_mul_u32_u24 v162, 6272, v162
    v_lshl_add_u32 v162, v0, 7, v162
    v_cmp_lt_u32 vcc, 27, v0
    v_mov_b32 v163, 0x40000000
    s_nop 0
    v_cndmask_b32 v162, v162, v163, vcc
    s_getpc_b64 s[62:63]
k1_pc2:
    s_add_u32 s62, s62, k1_kernel_end - k1_pc2
    s_addc_u32 s63, s63, 0
    s_min_u32 s61, s35, (code_end - k1_kernel_end) / 8192 - 1
    s_lshl_b32 s61, s61, 13
    v_lshlrev_b32 v163, 7, v0
    v_add_u32 v163, s61, v163
    global_load_dword v160, v163, s[62:63]
    buffer_load_dword v160, v162, s[64:67], s60 offen
    s_waitcnt vmcnt(3)
    v_readfirstlane_b32 s30, v4
    v_lshlrev_b32 v16, 16, v4
    v_and_b32 v17, 0xffff0000, v4
    v_lshlrev_b32 v18, 16, v5
    v_and_b32 v19, 0xffff0000, v5
    v_lshlrev_b32 v20, 16, v6
    v_and_b32 v21, 0xffff0000, v6
    v_lshlrev_b32 v22, 16, v7
    v_and_b32 v23, 0xffff0000, v7
    v_lshlrev_b32 v24, 16, v8
    v_and_b32 v25, 0xffff0000, v8
    v_lshlrev_b32 v26, 16, v9
    v_and_b32 v27, 0xffff0000, v9
    v_lshlrev_b32 v28, 16, v10
    v_and_b32 v29, 0xffff0000, v10
    v_lshlrev_b32 v30, 16, v11
    v_and_b32 v31, 0xffff0000, v11
    s_lshl_b32 s30, s30, 16
    v_subrev_f32 v16, s30, v16
    v_subrev_f32 v17, s30, v17
    v_subrev_f32 v18, s30, v18
    v_subrev_f32 v19, s30, v19
    v_subrev_f32 v20, s30, v20
    v_subrev_f32 v21, s30, v21
    v_subrev_f32 v22, s30, v22
    v_subrev_f32 v23, s30, v23
    v_subrev_f32 v24, s30, v24
    v_subrev_f32 v25, s30, v25
    v_subrev_f32 v26, s30, v26
    v_subrev_f32 v27, s30, v27
    v_subrev_f32 v28, s30, v28
    v_subrev_f32 v29, s30, v29
    v_subrev_f32 v30, s30, v30
    v_subrev_f32 v31, s30, v31
    v_add_f32 v144, v16, v18
    v_mul_f32 v146, v16, v16
    v_add_f32 v145, v17, v19
    v_mul_f32 v147, v17, v17
    v_fmac_f32 v146, v18, v18
    v_fmac_f32 v147, v19, v19
    v_add_f32 v144, v144, v20
    v_add_f32 v145, v145, v21
    v_fmac_f32 v146, v20, v20
    v_fmac_f32 v147, v21, v21
    v_add_f32 v144, v144, v22
    v_add_f32 v145, v145, v23
    v_fmac_f32 v146, v22, v22
    v_fmac_f32 v147, v23, v23
    v_add_f32 v144, v144, v24
    v_add_f32 v145, v145, v25
    v_fmac_f32 v146, v24, v24
    v_fmac_f32 v147, v25, v25
    v_add_f32 v144, v144, v26
    v_add_f32 v145, v145, v27
    v_fmac_f32 v146, v26, v26
    v_fmac_f32 v147, v27, v27
    v_add_f32 v144, v144, v28
    v_add_f32 v145, v145, v29
    v_fmac_f32 v146, v28, v28
    v_fmac_f32 v147, v29, v29
    v_add_f32 v144, v144, v30
    v_add_f32 v145, v145, v31
    v_fmac_f32 v146, v30, v30
    v_fmac_f32 v147, v31, v31
    v_sub_f32 v152, v144, v145
    v_add_f32 v144, v144, v145
    v_add_f32 v146, v146, v147
    v_add_f32_dpp v152, v152, v152 row_ror:8 row_mask:0xf bank_mask:0xf
    v_add_f32_dpp v144, v144, v144 row_ror:8 row_mask:0xf bank_mask:0xf
    v_add_f32_dpp v146, v146, v146 row_ror:8 row_mask:0xf bank_mask:0xf
    v_add_f32_dpp v152, v152, v152 row_ror:4 row_mask:0xf bank_mask:0xf
    v_add_f32_dpp v144, v144, v144 row_ror:4 row_mask:0xf bank_mask:0xf
    v_add_f32_dpp v146, v146, v146 row_ror:4 row_mask:0xf bank_mask:0xf
    v_add_f32_dpp v152, v152, v152 row_ror:2 row_mask:0xf bank_mask:0xf
    v_add_f32_dpp v144, v144, v144 row_ror:2 row_mask:0xf bank_mask:0xf
    v_add_f32_dpp v146, v146, v146 row_ror:2 row_mask:0xf bank_mask:0xf
    v_add_f32_dpp v152, v152, v152 row_ror:1 row_mask:0xf bank_mask:0xf
    v_add_f32_dpp v144, v144, v144 row_ror:1 row_mask:0xf bank_mask:0xf
    v_add_f32_dpp v146, v146, v146 row_ror:1 row_mask:0xf bank_mask:0xf
    v_mov_b32 v153, v152
    v_mov_b32 v145, v144
    v_mov_b32 v147, v146
    v_permlane32_swap_b32 v152, v153
    v_permlane32_swap_b32 v144, v145
    v_permlane32_swap_b32 v146, v147
    v_add_f32 v152, v152, v153
    v_add_f32 v144, v144, v145
    v_add_f32 v146, v146, v147
    v_mov_b32 v153, v152
    v_mov_b32 v145, v144
    v_mov_b32 v147, v146
    v_permlane16_swap_b32 v152, v153
    v_permlane16_swap_b32 v144, v145
    v_permlane16_swap_b32 v146, v147
    v_add_f32 v152, v152, v153
    v_add_f32 v144, v144, v145
    v_add_f32 v146, v146, v147
    v_mul_f32 v144, 0x3a800000, v144
    v_mul_f32 v146, 0x3a800000, v146
    v_fma_f32 v146, -v144, v144, v146
    v_max_f32 v146, 0, v146
    v_add_f32 v146, 0x3727c5ac, v146
    v_rsq_f32 v147, v146
    v_add_f32 v148, s30, v144
    v_mul_f32 v145, v144, v147
    v_mul_f32 v152, v152, v147
    v_fma_f32 v16, v16, v147, -v145
    v_fma_f32 v17, v17, v147, -v145
    v_fma_f32 v18, v18, v147, -v145
    v_fma_f32 v19, v19, v147, -v145
    v_fma_f32 v20, v20, v147, -v145
    v_fma_f32 v21, v21, v147, -v145
    v_fma_f32 v22, v22, v147, -v145
    v_fma_f32 v23, v23, v147, -v145
    v_fma_f32 v24, v24, v147, -v145
    v_fma_f32 v25, v25, v147, -v145
    v_fma_f32 v26, v26, v147, -v145
    v_fma_f32 v27, v27, v147, -v145
    v_fma_f32 v28, v28, v147, -v145
    v_fma_f32 v29, v29, v147, -v145
    v_fma_f32 v30, v30, v147, -v145
    v_fma_f32 v31, v31, v147, -v145
    v_cvt_pk_f16_f32 v4, v16, v17
    v_cvt_pk_f16_f32 v5, v18, v19
    v_cvt_pk_f16_f32 v6, v20, v21
    v_cvt_pk_f16_f32 v7, v22, v23
    v_cvt_pk_f16_f32 v8, v24, v25
    v_cvt_pk_f16_f32 v9, v26, v27
    v_cvt_pk_f16_f32 v10, v28, v29
    v_cvt_pk_f16_f32 v11, v30, v31
    ds_write_b128 v156, v[4:7]
    ds_write_b128 v156, v[8:11] offset:1024
    v_mov_b32 v149, 0
    buffer_store_dword v148, v149, s[20:23], s33 offen
    s_add_u32 s68, s40, 0x628000
    s_addc_u32 s69, s41, 0
    s_and_b32 s69, s69, 0xffff
    s_mov_b32 s70, 0x2000
    s_mov_b32 s71, 0x00020000
    s_lshl_b32 s33, s25, 2
    buffer_store_dword v149, v149, s[68:71], s33 offen
    v_readfirstlane_b32 s30, v16
    s_lshl_b32 s31, s24, 2
    s_add_u32 s31, s31, 34816
    s_waitcnt lgkmcnt(0)
    ds_read_b64_tr_b16 v[88:89], v157 offset:0
    ds_read_b64_tr_b16 v[90:91], v157 offset:1024
    ds_read_b64_tr_b16 v[92:93], v157 offset:32
    ds_read_b64_tr_b16 v[94:95], v157 offset:1056
    v_mov_b32 v150, s31
    v_mov_b32 v151, s30
    ds_write_b32 v150, v151
    ds_write_b32 v150, v152 offset:32
    s_waitcnt lgkmcnt(0)
    v_mfma_f32_16x16x32_f16 v[96:99], v[88:91], v[32:35], 0
    v_mfma_f32_16x16x32_f16 v[100:103], v[88:91], v[40:43], 0
    v_mfma_f32_16x16x32_f16 v[112:115], v[92:95], v[32:35], 0
    v_mfma_f32_16x16x32_f16 v[116:119], v[92:95], v[40:43], 0
    v_mfma_f32_16x16x32_f16 v[104:107], v[88:91], v[36:39], 0
    v_mfma_f32_16x16x32_f16 v[108:111], v[88:91], v[44:47], 0
    v_mfma_f32_16x16x32_f16 v[120:123], v[92:95], v[36:39], 0
    v_mfma_f32_16x16x32_f16 v[124:127], v[92:95], v[44:47], 0
    s_nop 3
    v_mul_f32 v144, v96, v56
    v_mul_f32 v148, v100, v56
    v_fmac_f32 v144, v100, v72
    v_fma_f32 v148, -v96, v72, v148
    v_mul_f32 v145, v97, v57
    v_mul_f32 v149, v101, v57
    v_fmac_f32 v145, v101, v73
    v_fma_f32 v149, -v97, v73, v149
    v_mul_f32 v146, v98, v58
    v_mul_f32 v150, v102, v58
    v_fmac_f32 v146, v102, v74
    v_fma_f32 v150, -v98, v74, v150
    v_mul_f32 v147, v99, v59
    v_mul_f32 v151, v103, v59
    v_fmac_f32 v147, v103, v75
    v_fma_f32 v151, -v99, v75, v151
    v_cvt_pk_f16_f32 v128, v144, v145
    v_cvt_pk_f16_f32 v129, v146, v147
    v_cvt_pk_f16_f32 v132, v148, v149
    v_cvt_pk_f16_f32 v133, v150, v151
    v_mul_f32 v144, v112, v64
    v_mul_f32 v148, v116, v64
    v_fmac_f32 v144, v116, v80
    v_fma_f32 v148, -v112, v80, v148
    v_mul_f32 v145, v113, v65
    v_mul_f32 v149, v117, v65
    v_fmac_f32 v145, v117, v81
    v_fma_f32 v149, -v113, v81, v149
    v_mul_f32 v146, v114, v66
    v_mul_f32 v150, v118, v66
    v_fmac_f32 v146, v118, v82
    v_fma_f32 v150, -v114, v82, v150
    v_mul_f32 v147, v115, v67
    v_mul_f32 v151, v119, v67
    v_fmac_f32 v147, v119, v83
    v_fma_f32 v151, -v115, v83, v151
    v_cvt_pk_f16_f32 v130, v144, v145
    v_cvt_pk_f16_f32 v131, v146, v147
    v_cvt_pk_f16_f32 v134, v148, v149
    v_cvt_pk_f16_f32 v135, v150, v151
    s_nop 1
    v_mfma_f32_16x16x32_f16 v[16:19], v[128:131], v[32:35], 0
    v_mfma_f32_16x16x32_f16 v[16:19], v[132:135], v[48:51], v[16:19]
    v_mfma_f32_16x16x32_f16 v[20:23], v[128:131], v[40:43], 0
    v_mfma_f32_16x16x32_f16 v[20:23], v[132:135], v[32:35], v[20:23]
    v_mul_f32 v144, v104, v60
    v_mul_f32 v148, v108, v60
    v_fmac_f32 v144, v108, v76
    v_fma_f32 v148, -v104, v76, v148
    v_mul_f32 v145, v105, v61
    v_mul_f32 v149, v109, v61
    v_fmac_f32 v145, v109, v77
    v_fma_f32 v149, -v105, v77, v149
    v_mul_f32 v146, v106, v62
    v_mul_f32 v150, v110, v62
    v_fmac_f32 v146, v110, v78
    v_fma_f32 v150, -v106, v78, v150
    v_mul_f32 v147, v107, v63
    v_mul_f32 v151, v111, v63
    v_fmac_f32 v147, v111, v79
    v_fma_f32 v151, -v107, v79, v151
    v_cvt_pk_f16_f32 v136, v144, v145
    v_cvt_pk_f16_f32 v137, v146, v147
    v_cvt_pk_f16_f32 v140, v148, v149
    v_cvt_pk_f16_f32 v141, v150, v151
    v_mul_f32 v144, v120, v68
    v_mul_f32 v148, v124, v68
    v_fmac_f32 v144, v124, v84
    v_fma_f32 v148, -v120, v84, v148
    v_mul_f32 v145, v121, v69
    v_mul_f32 v149, v125, v69
    v_fmac_f32 v145, v125, v85
    v_fma_f32 v149, -v121, v85, v149
    v_mul_f32 v146, v122, v70
    v_mul_f32 v150, v126, v70
    v_fmac_f32 v146, v126, v86
    v_fma_f32 v150, -v122, v86, v150
    v_mul_f32 v147, v123, v71
    v_mul_f32 v151, v127, v71
    v_fmac_f32 v147, v127, v87
    v_fma_f32 v151, -v123, v87, v151
    v_cvt_pk_f16_f32 v138, v144, v145
    v_cvt_pk_f16_f32 v139, v146, v147
    v_cvt_pk_f16_f32 v142, v148, v149
    v_cvt_pk_f16_f32 v143, v150, v151
    s_nop 1
    v_mfma_f32_16x16x32_f16 v[96:99], v[136:139], v[32:35], 0
    v_mfma_f32_16x16x32_f16 v[96:99], v[140:143], v[48:51], v[96:99]
    v_mfma_f32_16x16x32_f16 v[100:103], v[136:139], v[40:43], 0
    v_mfma_f32_16x16x32_f16 v[100:103], v[140:143], v[32:35], v[100:103]
    v_cvt_pk_f16_f32 v4, v16, v17
    v_cvt_pk_f16_f32 v5, v18, v19
    v_cvt_pk_f16_f32 v6, v20, v21
    v_cvt_pk_f16_f32 v7, v22, v23
    ds_write_b128 v158, v[4:7] offset:0
    s_nop 5
    v_cvt_pk_f16_f32 v88, v96, v97
    v_cvt_pk_f16_f32 v89, v98, v99
    v_cvt_pk_f16_f32 v90, v100, v101
    v_cvt_pk_f16_f32 v91, v102, v103
    ds_write_b128 v158, v[88:91] offset:64
    s_waitcnt lgkmcnt(0)
    s_barrier
    s_cmp_gt_u32 s24, 4
    s_cbranch_scc1 k1_kernel_done
    s_cmp_eq_u32 s24, 4
    s_cbranch_scc1 k1_kernel_vec
    ds_read_b128 v[16:19], v159 offset:0
    ds_read_b128 v[32:35], v159 offset:9216
    ds_read_b128 v[24:27], v159 offset:4608
    ds_read_b128 v[40:43], v159 offset:13824
    ds_read_b128 v[20:23], v159 offset:2304
    ds_read_b128 v[36:39], v159 offset:11520
    ds_read_b128 v[28:31], v159 offset:6912
    ds_read_b128 v[44:47], v159 offset:16128
    s_cmp_ge_u32 s24, 2
    s_cbranch_scc1 k1_kernel_odd
    s_waitcnt lgkmcnt(6)
    v_pk_add_f16 v16, v16, v32
    v_pk_add_f16 v17, v17, v33
    v_pk_add_f16 v18, v18, v34
    v_pk_add_f16 v19, v19, v35
    s_waitcnt lgkmcnt(4)
    v_pk_add_f16 v24, v24, v40
    v_pk_add_f16 v25, v25, v41
    v_pk_add_f16 v26, v26, v42
    v_pk_add_f16 v27, v27, v43
    s_waitcnt lgkmcnt(2)
    v_pk_add_f16 v20, v20, v36
    v_pk_add_f16 v21, v21, v37
    v_pk_add_f16 v22, v22, v38
    v_pk_add_f16 v23, v23, v39
    s_waitcnt lgkmcnt(0)
    v_pk_add_f16 v28, v28, v44
    v_pk_add_f16 v29, v29, v45
    v_pk_add_f16 v30, v30, v46
    v_pk_add_f16 v31, v31, v47
    v_pk_add_f16 v48, v16, v24
    v_pk_add_f16 v52, v16, v24 neg_lo:[0,1] neg_hi:[0,1]
    v_pk_add_f16 v56, v20, v28
    v_pk_add_f16 v60, v20, v28 neg_lo:[0,1] neg_hi:[0,1]
    v_pk_add_f16 v50, v18, v26
    v_pk_add_f16 v54, v18, v26 neg_lo:[0,1] neg_hi:[0,1]
    v_pk_add_f16 v58, v22, v30
    v_pk_add_f16 v62, v22, v30 neg_lo:[0,1] neg_hi:[0,1]
    v_pk_add_f16 v49, v17, v25
    v_pk_add_f16 v53, v17, v25 neg_lo:[0,1] neg_hi:[0,1]
    v_pk_add_f16 v57, v21, v29
    v_pk_add_f16 v61, v21, v29 neg_lo:[0,1] neg_hi:[0,1]
    v_pk_add_f16 v51, v19, v27
    v_pk_add_f16 v55, v19, v27 neg_lo:[0,1] neg_hi:[0,1]
    v_pk_add_f16 v59, v23, v31
    v_pk_add_f16 v63, v23, v31 neg_lo:[0,1] neg_hi:[0,1]
    v_pk_add_f16 v64, v48, v56
    v_pk_add_f16 v66, v50, v58 neg_lo:[1,1] neg_hi:[1,1]
    v_pk_add_f16 v65, v49, v57
    v_pk_add_f16 v67, v51, v59 neg_lo:[1,1] neg_hi:[1,1]
    s_add_u32 s30, s26, 0x0
    s_add_u32 s33, s32, 0x0
    v_permlane32_swap_b32 v64, v66
    v_permlane32_swap_b32 v65, v67
    buffer_store_dwordx4 v[64:67], v3, s[12:15], s30 offen sc1
    buffer_store_short v64, v164, s[16:19], s33 offen
    v_pk_add_f16 v68, v52, v62
    v_pk_add_f16 v70, v60, v54 neg_lo:[0,1] neg_hi:[0,1]
    v_pk_add_f16 v69, v53, v63
    v_pk_add_f16 v71, v61, v55 neg_lo:[0,1] neg_hi:[0,1]
    s_add_u32 s30, s26, 0x100000
    s_add_u32 s33, s32, 0x4000
    v_permlane32_swap_b32 v68, v70
    v_permlane32_swap_b32 v69, v71
    buffer_store_dwordx4 v[68:71], v3, s[12:15], s30 offen sc1
    buffer_store_short v68, v164, s[16:19], s33 offen
    v_pk_add_f16 v72, v48, v56 neg_lo:[0,1] neg_hi:[0,1]
    v_pk_add_f16 v74, v58, v50 neg_lo:[0,1] neg_hi:[0,1]
    v_pk_add_f16 v73, v49, v57 neg_lo:[0,1] neg_hi:[0,1]
    v_pk_add_f16 v75, v59, v51 neg_lo:[0,1] neg_hi:[0,1]
    s_add_u32 s30, s26, 0x200000
    s_add_u32 s33, s32, 0x8000
    v_permlane32_swap_b32 v72, v74
    v_permlane32_swap_b32 v73, v75
    buffer_store_dwordx4 v[72:75], v3, s[12:15], s30 offen sc1
    buffer_store_short v72, v164, s[16:19], s33 offen
    v_pk_add_f16 v76, v52, v62 neg_lo:[0,1] neg_hi:[0,1]
    v_pk_add_f16 v78, v54, v60 neg_lo:[1,1] neg_hi:[1,1]
    v_pk_add_f16 v77, v53, v63 neg_lo:[0,1] neg_hi:[0,1]
    v_pk_add_f16 v79, v55, v61 neg_lo:[1,1] neg_hi:[1,1]
    s_add_u32 s30, s26, 0x300000
    s_add_u32 s33, s32, 0xc000
    v_permlane32_swap_b32 v76, v78
    v_permlane32_swap_b32 v77, v79
    buffer_store_dwordx4 v[76:79], v3, s[12:15], s30 offen sc1
    buffer_store_short v76, v164, s[16:19], s33 offen
    s_branch k1_kernel_done
k1_kernel_vec:
    v_bfe_u32 v30, v0, 4, 1
    v_lshlrev_b32 v16, 5, v30
    v_add_u32 v16, 34816, v16
    ds_read_b128 v[20:23], v16
    ds_read_b128 v[24:27], v16 offset:16
    v_and_b32 v17, 7, v0
    v_cvt_f32_u32 v18, v17
    v_mul_f32 v18, 0x3e000000, v18
    v_bfe_u32 v19, v0, 3, 1
    v_cvt_f32_u32 v28, v19
    v_mul_f32 v28, 0xbe800000, v28
    v_mov_b32 v29, 0
    v_mov_b32 v31, 0x0
    v_fma_f32 v32, v18, v31, v28
    v_fract_f32 v32, v32
    v_cos_f32 v32, v32
    v_mov_b32 v31, 0x3f800000
    v_fma_f32 v33, v18, v31, v28
    v_fract_f32 v33, v33
    v_cos_f32 v33, v33
    v_mov_b32 v31, 0x40000000
    v_fma_f32 v34, v18, v31, v28
    v_fract_f32 v34, v34
    v_cos_f32 v34, v34
    v_mov_b32 v31, 0x40400000
    v_fma_f32 v35, v18, v31, v28
    v_fract_f32 v35, v35
    v_cos_f32 v35, v35
    v_mov_b32 v31, 0x40800000
    v_fma_f32 v36, v18, v31, v28
    v_fract_f32 v36, v36
    v_cos_f32 v36, v36
    v_mov_b32 v31, 0x40a00000
    v_fma_f32 v37, v18, v31, v28
    v_fract_f32 v37, v37
    v_cos_f32 v37, v37
    v_mov_b32 v31, 0x40c00000
    v_fma_f32 v38, v18, v31, v28
    v_fract_f32 v38, v38
    v_cos_f32 v38, v38
    v_mov_b32 v31, 0x40e00000
    v_fma_f32 v39, v18, v31, v28
    v_fract_f32 v39, v39
    v_cos_f32 v39, v39
    s_waitcnt lgkmcnt(0)
    v_fmac_f32 v29, v32, v20
    v_fmac_f32 v29, v33, v21
    v_fmac_f32 v29, v34, v22
    v_fmac_f32 v29, v35, v23
    v_fmac_f32 v29, v36, v24
    v_fmac_f32 v29, v37, v25
    v_fmac_f32 v29, v38, v26
    v_fmac_f32 v29, v39, v27
    v_cvt_pk_f16_f32 v29, v29, v29
    v_lshlrev_b32 v16, 10, v17
    v_lshlrev_b32 v17, 13, v17
    v_add_u32 v17, 15360, v17
    v_cmp_eq_u32 vcc, 0, v30
    s_nop 1
    v_cndmask_b32 v17, v17, v16, vcc
    v_lshl_add_u32 v17, v19, 9, v17
    buffer_store_short v29, v17, s[16:19], s32 offen
    s_branch k1_kernel_done
k1_kernel_odd:
    s_mov_b32 s29, 0x39a839a8
    s_waitcnt lgkmcnt(6)
    v_pk_add_f16 v16, v16, v32 neg_lo:[0,1] neg_hi:[0,1]
    v_pk_add_f16 v17, v17, v33 neg_lo:[0,1] neg_hi:[0,1]
    v_pk_add_f16 v18, v18, v34 neg_lo:[0,1] neg_hi:[0,1]
    v_pk_add_f16 v19, v19, v35 neg_lo:[0,1] neg_hi:[0,1]
    s_waitcnt lgkmcnt(4)
    v_pk_add_f16 v24, v24, v40 neg_lo:[0,1] neg_hi:[0,1]
    v_pk_add_f16 v25, v25, v41 neg_lo:[0,1] neg_hi:[0,1]
    v_pk_add_f16 v26, v26, v42 neg_lo:[0,1] neg_hi:[0,1]
    v_pk_add_f16 v27, v27, v43 neg_lo:[0,1] neg_hi:[0,1]
    s_waitcnt lgkmcnt(2)
    v_pk_add_f16 v20, v20, v36 neg_lo:[0,1] neg_hi:[0,1]
    v_pk_add_f16 v21, v21, v37 neg_lo:[0,1] neg_hi:[0,1]
    v_pk_add_f16 v22, v22, v38 neg_lo:[0,1] neg_hi:[0,1]
    v_pk_add_f16 v23, v23, v39 neg_lo:[0,1] neg_hi:[0,1]
    v_pk_add_f16 v36, v20, v22
    v_pk_add_f16 v38, v22, v20 neg_lo:[0,1] neg_hi:[0,1]
    v_pk_add_f16 v37, v21, v23
    v_pk_add_f16 v39, v23, v21 neg_lo:[0,1] neg_hi:[0,1]
    v_pk_mul_f16 v36, v36, s29
    v_pk_mul_f16 v37, v37, s29
    v_pk_mul_f16 v38, v38, s29
    v_pk_mul_f16 v39, v39, s29
    s_waitcnt lgkmcnt(0)
    v_pk_add_f16 v28, v28, v44 neg_lo:[0,1] neg_hi:[0,1]
    v_pk_add_f16 v29, v29, v45 neg_lo:[0,1] neg_hi:[0,1]
    v_pk_add_f16 v30, v30, v46 neg_lo:[0,1] neg_hi:[0,1]
    v_pk_add_f16 v31, v31, v47 neg_lo:[0,1] neg_hi:[0,1]
    v_pk_add_f16 v44, v28, v30
    v_pk_add_f16 v46, v30, v28 neg_lo:[0,1] neg_hi:[0,1]
    v_pk_add_f16 v45, v29, v31
    v_pk_add_f16 v47, v31, v29 neg_lo:[0,1] neg_hi:[0,1]
    v_pk_mul_f16 v44, v44, s29
    v_pk_mul_f16 v45, v45, s29
    v_pk_mul_f16 v46, v46, s29
    v_pk_mul_f16 v47, v47, s29
    v_pk_add_f16 v48, v16, v26
    v_pk_add_f16 v52, v16, v26 neg_lo:[0,1] neg_hi:[0,1]
    v_pk_add_f16 v56, v36, v46
    v_pk_add_f16 v60, v36, v46 neg_lo:[0,1] neg_hi:[0,1]
    v_pk_add_f16 v50, v18, v24 neg_lo:[0,1] neg_hi:[0,1]
    v_pk_add_f16 v54, v18, v24
    v_pk_add_f16 v58, v38, v44 neg_lo:[0,1] neg_hi:[0,1]
    v_pk_add_f16 v62, v38, v44
    v_pk_add_f16 v49, v17, v27
    v_pk_add_f16 v53, v17, v27 neg_lo:[0,1] neg_hi:[0,1]
    v_pk_add_f16 v57, v37, v47
    v_pk_add_f16 v61, v37, v47 neg_lo:[0,1] neg_hi:[0,1]
    v_pk_add_f16 v51, v19, v25 neg_lo:[0,1] neg_hi:[0,1]
    v_pk_add_f16 v55, v19, v25
    v_pk_add_f16 v59, v39, v45 neg_lo:[0,1] neg_hi:[0,1]
    v_pk_add_f16 v63, v39, v45
    v_pk_add_f16 v64, v48, v56
    v_pk_add_f16 v66, v50, v58 neg_lo:[1,1] neg_hi:[1,1]
    v_pk_add_f16 v65, v49, v57
    v_pk_add_f16 v67, v51, v59 neg_lo:[1,1] neg_hi:[1,1]
    s_add_u32 s30, s26, 0x80000
    s_add_u32 s33, s32, 0x2000
    v_permlane32_swap_b32 v64, v66
    v_permlane32_swap_b32 v65, v67
    buffer_store_dwordx4 v[64:67], v3, s[12:15], s30 offen sc1
    buffer_store_short v64, v164, s[16:19], s33 offen
    v_pk_add_f16 v68, v52, v62
    v_pk_add_f16 v70, v60, v54 neg_lo:[0,1] neg_hi:[0,1]
    v_pk_add_f16 v69, v53, v63
    v_pk_add_f16 v71, v61, v55 neg_lo:[0,1] neg_hi:[0,1]
    s_add_u32 s30, s26, 0x180000
    s_add_u32 s33, s32, 0x6000
    v_permlane32_swap_b32 v68, v70
    v_permlane32_swap_b32 v69, v71
    buffer_store_dwordx4 v[68:71], v3, s[12:15], s30 offen sc1
    buffer_store_short v68, v164, s[16:19], s33 offen
    v_pk_add_f16 v72, v48, v56 neg_lo:[0,1] neg_hi:[0,1]
    v_pk_add_f16 v74, v58, v50 neg_lo:[0,1] neg_hi:[0,1]
    v_pk_add_f16 v73, v49, v57 neg_lo:[0,1] neg_hi:[0,1]
    v_pk_add_f16 v75, v59, v51 neg_lo:[0,1] neg_hi:[0,1]
    s_add_u32 s30, s26, 0x280000
    s_add_u32 s33, s32, 0xa000
    v_permlane32_swap_b32 v72, v74
    v_permlane32_swap_b32 v73, v75
    buffer_store_dwordx4 v[72:75], v3, s[12:15], s30 offen sc1
    buffer_store_short v72, v164, s[16:19], s33 offen
    v_pk_add_f16 v76, v52, v62 neg_lo:[0,1] neg_hi:[0,1]
    v_pk_add_f16 v78, v54, v60 neg_lo:[1,1] neg_hi:[1,1]
    v_pk_add_f16 v77, v53, v63 neg_lo:[0,1] neg_hi:[0,1]
    v_pk_add_f16 v79, v55, v61 neg_lo:[1,1] neg_hi:[1,1]
    s_add_u32 s30, s26, 0x380000
    s_add_u32 s33, s32, 0xe000
    v_permlane32_swap_b32 v76, v78
    v_permlane32_swap_b32 v77, v79
    buffer_store_dwordx4 v[76:79], v3, s[12:15], s30 offen sc1
    buffer_store_short v76, v164, s[16:19], s33 offen
k1_kernel_done:
k1_kernel_end:
    s_endpgm
.globl k2_kernel
.p2align 8
.type k2_kernel,@function
k2_kernel:
    s_cmp_ge_u32 s2, 256
    s_cbranch_scc1 k2_kernel_end
    s_getpc_b64 s[4:5]
k2_kernel_pc:
    s_lshr_b32 s6, s2, 3
    s_lshl_b32 s6, s6, 2
    v_lshrrev_b32 v28, 6, v0
    v_add_u32 v28, s6, v28
    v_and_b32 v28, 15, v28
    v_lshlrev_b32 v28, 6, v28
    v_and_or_b32 v28, v0, 63, v28
    v_lshlrev_b32 v28, 7, v28
    v_min_u32 v28, ((k2_kernel_end - k2_kernel_pc) / 4) * 4 - 4, v28
    global_load_dword v30, v28, s[4:5]
    s_load_dwordx2 s[36:37], s[0:1], 0
    s_load_dwordx2 s[40:41], s[0:1], 88
    v_lshrrev_b32 v1, 6, v0
    v_and_b32 v0, 63, v0
    v_readfirstlane_b32 s24, v1
    s_and_b32 s34, s2, 7
    s_bfe_u32 s33, s2, 0x30003
    s_lshr_b32 s31, s2, 6
    s_lshl_b32 s42, s34, 4
    s_lshl_b32 s31, s31, 2
    s_add_u32 s42, s42, s31
    s_add_u32 s42, s42, s24
    s_lshl_b32 s43, s42, 14
    v_lshlrev_b32 v1, 4, v0
    v_add_u32 v2, s43, v1
    s_mul_i32 s28, s24, 4224
    s_lshl_b32 s31, s34, 3
    s_add_u32 s31, s31, s33
    s_lshl_b32 s25, s31, 16
    s_lshl_b32 s47, s31, 10
    s_add_u32 s47, s47, 7168
    s_lshl_b32 s31, s24, 12
    s_add_u32 s25, s25, s31
    s_lshl_b32 s45, s24, 11
    s_add_u32 s45, s45, 67584
    s_lshl_b32 s46, s34, 10
    s_waitcnt lgkmcnt(0)
    s_mov_b32 s12, s40
    s_and_b32 s13, s41, 0xffff
    s_mov_b32 s14, 0x400000
    s_mov_b32 s15, 0x00020000
    s_add_u32 s8, s40, 0x400000
    s_addc_u32 s9, s41, 0
    s_and_b32 s9, s9, 0xffff
    s_mov_b32 s10, 0x200000
    s_mov_b32 s11, 0x00020000
    s_add_u32 s60, s40, 0x600000
    s_addc_u32 s61, s41, 0
    s_and_b32 s61, s61, 0xffff
    s_mov_b32 s62, 0x12000
    s_mov_b32 s63, 0x00020000
    s_mov_b32 s26, 0
    s_mov_b32 m0, s45
    s_nop 0
    buffer_load_dwordx4 v1, s[60:63], s46 offen lds
    buffer_load_dwordx4 v1, s[60:63], s47 offen offset:1024 lds
    s_add_u32 m0, s28, 0
    s_nop 0
    buffer_load_dwordx4 v1, s[12:15], s25 offen offset:0 lds
    s_add_u32 m0, s28, 32
    s_nop 0
    buffer_load_dwordx4 v1, s[12:15], s25 offen offset:1024 lds
    s_add_u32 m0, s28, 64
    s_nop 0
    buffer_load_dwordx4 v1, s[12:15], s25 offen offset:2048 lds
    s_add_u32 m0, s28, 96
    s_nop 0
    buffer_load_dwordx4 v1, s[12:15], s25 offen offset:3072 lds
    s_add_u32 s25, s25, 16384
    buffer_load_dwordx4 a[0:3], v2, s[8:11], s26 offen offset:0
    buffer_load_dwordx4 a[4:7], v2, s[8:11], s26 offen offset:1024
    buffer_load_dwordx4 a[8:11], v2, s[8:11], s26 offen offset:2048
    buffer_load_dwordx4 a[12:15], v2, s[8:11], s26 offen offset:3072
    s_add_u32 s26, s26, 4096
    s_add_u32 m0, s28, 16896
    s_nop 0
    buffer_load_dwordx4 v1, s[12:15], s25 offen offset:0 lds
    s_add_u32 m0, s28, 16928
    s_nop 0
    buffer_load_dwordx4 v1, s[12:15], s25 offen offset:1024 lds
    s_add_u32 m0, s28, 16960
    s_nop 0
    buffer_load_dwordx4 v1, s[12:15], s25 offen offset:2048 lds
    s_add_u32 m0, s28, 16992
    s_nop 0
    buffer_load_dwordx4 v1, s[12:15], s25 offen offset:3072 lds
    s_add_u32 s25, s25, 16384
    buffer_load_dwordx4 a[16:19], v2, s[8:11], s26 offen offset:0
    buffer_load_dwordx4 a[20:23], v2, s[8:11], s26 offen offset:1024
    buffer_load_dwordx4 a[24:27], v2, s[8:11], s26 offen offset:2048
    buffer_load_dwordx4 a[28:31], v2, s[8:11], s26 offen offset:3072
    s_add_u32 s26, s26, 4096
    s_add_u32 m0, s28, 33792
    s_nop 0
    buffer_load_dwordx4 v1, s[12:15], s25 offen offset:0 lds
    v_bfe_u32 v20, v0, 2, 3
    v_mul_u32_u24 v20, 1056, v20
    v_lshrrev_b32 v21, 5, v0
    v_lshl_add_u32 v20, v21, 7, v20
    v_and_b32 v21, 3, v0
    v_lshl_add_u32 v13, v21, 3, v20
    v_add_u32 v14, 50688, v13
    v_lshrrev_b32 v20, 4, v0
    v_lshlrev_b32 v20, 4, v20
    v_and_b32 v21, 1, v0
    v_lshl_add_u32 v20, v21, 10, v20
    v_add_u32 v31, s45, v20
    v_and_b32 v20, 15, v0
    v_lshlrev_b32 v22, 4, v20
    s_lshl_b32 s31, s42, 4
    v_add_u32 v23, s31, v20
    v_lshlrev_b32 v23, 2, v23
    s_and_b32 s65, s42, 15
    s_lshl_b32 s65, s65, 7
    s_add_u32 s65, s65, s34
    s_sub_u32 s66, 2048, s65
    v_lshlrev_b32 v24, 3, v20
    v_sub_u32 v24, s66, v24
    v_and_b32 v24, 0x7ff, v24
    v_and_b32 v25, 7, v24
    v_lshrrev_b32 v24, 3, v24
    v_lshl_add_u32 v24, v25, 8, v24
    v_lshlrev_b32 v3, 2, v24
    v_lshrrev_b32 v25, 4, v24
    v_and_b32 v24, 15, v24
    v_lshlrev_b32 v24, 4, v24
    v_lshl_add_u32 v17, v25, 10, v24
    v_lshl_add_u32 v16, v25, 15, v24
    v_lshrrev_b32 v25, 4, v0
    v_xor_b32 v25, 3, v25
    v_lshl_add_u32 v16, v25, 8, v16
    v_lshrrev_b32 v24, 4, v0
    v_and_b32 v25, 7, v0
    v_xor_b32 v24, v24, v25
    v_lshlrev_b32 v24, 4, v24
    v_and_b32 v25, 0x38, v0
    s_lshl_b32 s67, s33, 7
    s_sub_u32 s68, 1920, s67
    v_add_u32 v26, s65, v25
    v_and_b32 v26, 0x7ff, v26
    v_lshl_add_u32 v26, v26, 11, v24
    v_add_u32 v4, s67, v26
    v_add_u32 v26, s65, v25
    v_add_u32 v26, 64, v26
    v_and_b32 v26, 0x7ff, v26
    v_lshl_add_u32 v26, v26, 11, v24
    v_xor_b32 v26, 64, v26
    v_add_u32 v5, s67, v26
    v_sub_u32 v26, s66, v25
    v_and_b32 v26, 0x7ff, v26
    v_lshl_add_u32 v26, v26, 11, v24
    v_add_u32 v6, s68, v26
    v_sub_u32 v26, s66, v25
    v_add_u32 v26, -64, v26
    v_and_b32 v26, 0x7ff, v26
    v_lshl_add_u32 v26, v26, 11, v24
    v_xor_b32 v26, 64, v26
    v_add_u32 v7, s68, v26
    s_lshl_b32 s64, s24, 12
    s_add_u32 s64, s64, 75776
    v_lshlrev_b32 v21, 7, v20
    v_add_u32 v21, s64, v21
    v_bfe_u32 v24, v0, 4, 1
    v_lshl_add_u32 v21, v24, 3, v21
    v_lshrrev_b32 v24, 5, v0
    v_lshrrev_b32 v25, 1, v20
    v_xor_b32 v24, v24, v25
    v_xor_b32 v25, 0, v24
    v_lshl_add_u32 v8, v25, 4, v21
    v_xor_b32 v25, 2, v24
    v_lshl_add_u32 v9, v25, 4, v21
    v_xor_b32 v25, 4, v24
    v_lshl_add_u32 v10, v25, 4, v21
    v_xor_b32 v25, 6, v24
    v_lshl_add_u32 v11, v25, 4, v21
    v_add_u32 v12, 16, v0
    v_and_b32 v12, 63, v12
    v_lshlrev_b32 v12, 2, v12
    s_add_u32 s20, s40, 0x640000
    s_addc_u32 s21, s41, 0
    s_and_b32 s21, s21, 0xffff
    s_mov_b32 s22, 0x20000
    s_mov_b32 s23, 0x00020000
    s_add_u32 s16, s40, 0x800000
    s_addc_u32 s17, s41, 0
    s_and_b32 s17, s17, 0xffff
    s_mov_b32 s18, 0x400000
    s_mov_b32 s19, 0x00020000
    s_mov_b32 s48, s36
    s_and_b32 s49, s37, 0xffff
    s_mov_b32 s50, 0x400000
    s_mov_b32 s51, 0x00020000
    s_add_u32 s52, s40, 0x622000
    s_addc_u32 s53, s41, 0
    s_and_b32 s53, s53, 0xffff
    s_mov_b32 s54, 0x2000
    s_mov_b32 s55, 0x00020000
    s_add_u32 s56, s40, 0x620000
    s_addc_u32 s57, s41, 0
    s_and_b32 s57, s57, 0xffff
    s_mov_b32 s58, 0x2000
    s_mov_b32 s59, 0x00020000
    s_lshl_b32 s44, s42, 15
    s_lshl_b32 s31, s33, 11
    s_add_u32 s44, s44, s31
    s_sub_u32 s69, 30720, s31
    s_lshr_b32 s31, s33, 2
    s_lshl_b32 s45, s31, 8
    s_and_b32 s31, s33, 3
    s_lshl_b32 s31, s31, 2
    s_add_u32 s45, s45, s31
    s_sub_u32 s71, 15, s33
    s_lshr_b32 s31, s71, 2
    s_lshl_b32 s70, s31, 8
    s_and_b32 s31, s71, 3
    s_lshl_b32 s31, s31, 2
    s_add_u32 s70, s70, s31
    s_lshl_b32 s31, s42, 10
    s_add_u32 s45, s45, s31
    v_cmp_lt_u32 s[38:39], 47, v0
    s_waitcnt vmcnt(13)
    s_barrier
    s_waitcnt vmcnt(17)
    ds_read_b128 a[80:83], v31 offset:0
    ds_read_b128 a[84:87], v31 offset:64
    ds_read_b128 a[88:91], v31 offset:128
    ds_read_b64_tr_b16 a[64:65], v13 offset:0
    ds_read_b64_tr_b16 a[66:67], v13 offset:256
    ds_read_b64_tr_b16 a[68:69], v13 offset:32
    ds_read_b64_tr_b16 a[70:71], v13 offset:288
    ds_read_b64_tr_b16 a[72:73], v13 offset:64
    ds_read_b64_tr_b16 a[74:75], v13 offset:320
    s_waitcnt vmcnt(12)
    s_waitcnt lgkmcnt(8)
    v_mfma_f32_16x16x32_f16 v[56:59], a[80:83], a[0:3], 0
    ds_read_b128 a[92:95], v31 offset:192
    s_waitcnt lgkmcnt(5)
    v_mfma_f32_16x16x32_f16 v[64:67], a[64:67], a[0:3], 0
    ds_read_b64_tr_b16 a[76:77], v13 offset:96
    ds_read_b64_tr_b16 a[78:79], v13 offset:352
    s_waitcnt lgkmcnt(5)
    v_mfma_f32_16x16x32_f16 v[68:71], a[68:71], a[0:3], 0
    ds_read_b64_tr_b16 a[64:65], v13 offset:512
    ds_read_b64_tr_b16 a[66:67], v13 offset:768
    s_add_u32 m0, s64, 0
    s_nop 0
    buffer_load_dwordx4 v4, s[48:51], 0 offen lds
    s_waitcnt lgkmcnt(5)
    v_mfma_f32_16x16x32_f16 v[72:75], a[72:75], a[0:3], 0
    ds_read_b64_tr_b16 a[68:69], v13 offset:544
    ds_read_b64_tr_b16 a[70:71], v13 offset:800
    s_add_u32 m0, s64, 1024
    s_nop 0
    buffer_load_dwordx4 v5, s[48:51], 0 offen lds
    s_waitcnt lgkmcnt(4)
    v_mfma_f32_16x16x32_f16 v[76:79], a[76:79], a[0:3], 0
    ds_read_b64_tr_b16 a[72:73], v13 offset:576
    ds_read_b64_tr_b16 a[74:75], v13 offset:832
    s_waitcnt vmcnt(13)
    s_waitcnt lgkmcnt(15)
    v_mfma_f32_16x16x32_f16 v[56:59], a[84:87], a[4:7], v[56:59]
    ds_read_b128 a[80:83], v31 offset:256
    s_waitcnt lgkmcnt(5)
    v_mfma_f32_16x16x32_f16 v[64:67], a[64:67], a[4:7], v[64:67]
    ds_read_b64_tr_b16 a[76:77], v13 offset:608
    ds_read_b64_tr_b16 a[78:79], v13 offset:864
    s_add_u32 m0, s64, 2048
    s_nop 0
    buffer_load_dwordx4 v6, s[48:51], 0 offen lds
    s_waitcnt lgkmcnt(5)
    v_mfma_f32_16x16x32_f16 v[68:71], a[68:71], a[4:7], v[68:71]
    ds_read_b64_tr_b16 a[64:65], v13 offset:8448
    ds_read_b64_tr_b16 a[66:67], v13 offset:8704
    s_add_u32 m0, s64, 3072
    s_nop 0
    buffer_load_dwordx4 v7, s[48:51], 0 offen lds
    s_waitcnt lgkmcnt(5)
    v_mfma_f32_16x16x32_f16 v[72:75], a[72:75], a[4:7], v[72:75]
    ds_read_b64_tr_b16 a[68:69], v13 offset:8480
    ds_read_b64_tr_b16 a[70:71], v13 offset:8736
    s_waitcnt lgkmcnt(4)
    v_mfma_f32_16x16x32_f16 v[76:79], a[76:79], a[4:7], v[76:79]
    ds_read_b64_tr_b16 a[72:73], v13 offset:8512
    ds_read_b64_tr_b16 a[74:75], v13 offset:8768
    buffer_load_dword v18, v23, s[56:59], 0 offen
    s_waitcnt vmcnt(15)
    s_waitcnt lgkmcnt(15)
    v_mfma_f32_16x16x32_f16 v[56:59], a[88:91], a[8:11], v[56:59]
    ds_read_b128 a[84:87], v31 offset:320
    s_waitcnt lgkmcnt(5)
    v_mfma_f32_16x16x32_f16 v[64:67], a[64:67], a[8:11], v[64:67]
    ds_read_b64_tr_b16 a[76:77], v13 offset:8544
    ds_read_b64_tr_b16 a[78:79], v13 offset:8800
    buffer_load_dword v19, v3, s[56:59], 0 offen
    s_waitcnt lgkmcnt(5)
    v_mfma_f32_16x16x32_f16 v[68:71], a[68:71], a[8:11], v[68:71]
    ds_read_b64_tr_b16 a[64:65], v13 offset:8960
    ds_read_b64_tr_b16 a[66:67], v13 offset:9216
    s_waitcnt lgkmcnt(5)
    v_mfma_f32_16x16x32_f16 v[72:75], a[72:75], a[8:11], v[72:75]
    ds_read_b64_tr_b16 a[68:69], v13 offset:8992
    ds_read_b64_tr_b16 a[70:71], v13 offset:9248
    s_add_u32 m0, s28, 33824
    s_nop 0
    buffer_load_dwordx4 v1, s[12:15], s25 offen offset:1024 lds
    s_waitcnt lgkmcnt(4)
    v_mfma_f32_16x16x32_f16 v[76:79], a[76:79], a[8:11], v[76:79]
    ds_read_b64_tr_b16 a[72:73], v13 offset:9024
    ds_read_b64_tr_b16 a[74:75], v13 offset:9280
    s_add_u32 m0, s28, 33856
    s_nop 0
    buffer_load_dwordx4 v1, s[12:15], s25 offen offset:2048 lds
    s_waitcnt vmcnt(17)
    s_waitcnt lgkmcnt(15)
    v_mfma_f32_16x16x32_f16 v[56:59], a[92:95], a[12:15], v[56:59]
    ds_read_b128 a[88:91], v31 offset:384
    s_waitcnt lgkmcnt(5)
    v_mfma_f32_16x16x32_f16 v[64:67], a[64:67], a[12:15], v[64:67]
    ds_read_b64_tr_b16 a[76:77], v13 offset:9056
    ds_read_b64_tr_b16 a[78:79], v13 offset:9312
    s_add_u32 m0, s28, 33888
    s_nop 0
    buffer_load_dwordx4 v1, s[12:15], s25 offen offset:3072 lds
    s_add_u32 s25, s25, 16384
    s_waitcnt lgkmcnt(5)
    v_mfma_f32_16x16x32_f16 v[68:71], a[68:71], a[12:15], v[68:71]
    s_waitcnt vmcnt(14)
    s_barrier
    ds_read_b64_tr_b16 a[64:65], v13 offset:16896
    ds_read_b64_tr_b16 a[66:67], v13 offset:17152
    s_waitcnt lgkmcnt(5)
    v_mfma_f32_16x16x32_f16 v[72:75], a[72:75], a[12:15], v[72:75]
    ds_read_b64_tr_b16 a[68:69], v13 offset:16928
    ds_read_b64_tr_b16 a[70:71], v13 offset:17184
    buffer_load_dwordx4 a[32:35], v2, s[8:11], s26 offen offset:0
    s_waitcnt lgkmcnt(4)
    v_mfma_f32_16x16x32_f16 v[76:79], a[76:79], a[12:15], v[76:79]
    ds_read_b64_tr_b16 a[72:73], v13 offset:16960
    ds_read_b64_tr_b16 a[74:75], v13 offset:17216
    buffer_load_dwordx4 a[36:39], v2, s[8:11], s26 offen offset:1024
    s_waitcnt vmcnt(15)
    s_waitcnt lgkmcnt(15)
    v_mfma_f32_16x16x32_f16 v[56:59], a[80:83], a[16:19], v[56:59]
    ds_read_b128 a[92:95], v31 offset:448
    s_waitcnt lgkmcnt(5)
    v_mfma_f32_16x16x32_f16 v[64:67], a[64:67], a[16:19], v[64:67]
    ds_read_b64_tr_b16 a[76:77], v13 offset:16992
    ds_read_b64_tr_b16 a[78:79], v13 offset:17248
    s_waitcnt lgkmcnt(5)
    v_mfma_f32_16x16x32_f16 v[68:71], a[68:71], a[16:19], v[68:71]
    ds_read_b64_tr_b16 a[64:65], v13 offset:17408
    ds_read_b64_tr_b16 a[66:67], v13 offset:17664
    buffer_load_dwordx4 a[40:43], v2, s[8:11], s26 offen offset:2048
    s_waitcnt lgkmcnt(5)
    v_mfma_f32_16x16x32_f16 v[72:75], a[72:75], a[16:19], v[72:75]
    ds_read_b64_tr_b16 a[68:69], v13 offset:17440
    ds_read_b64_tr_b16 a[70:71], v13 offset:17696
    buffer_load_dwordx4 a[44:47], v2, s[8:11], s26 offen offset:3072
    s_add_u32 s26, s26, 4096
    s_waitcnt lgkmcnt(4)
    v_mfma_f32_16x16x32_f16 v[76:79], a[76:79], a[16:19], v[76:79]
    ds_read_b64_tr_b16 a[72:73], v13 offset:17472
    ds_read_b64_tr_b16 a[74:75], v13 offset:17728
    s_waitcnt vmcnt(16)
    s_waitcnt lgkmcnt(15)
    v_mfma_f32_16x16x32_f16 v[56:59], a[84:87], a[20:23], v[56:59]
    ds_read_b128 a[80:83], v31 offset:512
    s_waitcnt lgkmcnt(5)
    v_mfma_f32_16x16x32_f16 v[64:67], a[64:67], a[20:23], v[64:67]
    ds_read_b64_tr_b16 a[76:77], v13 offset:17504
    ds_read_b64_tr_b16 a[78:79], v13 offset:17760
    s_add_u32 m0, s28, 50688
    s_nop 0
    buffer_load_dwordx4 v1, s[12:15], s25 offen offset:0 lds
    s_waitcnt lgkmcnt(5)
    v_mfma_f32_16x16x32_f16 v[68:71], a[68:71], a[20:23], v[68:71]
    ds_read_b64_tr_b16 a[64:65], v13 offset:25344
    ds_read_b64_tr_b16 a[66:67], v13 offset:25600
    s_add_u32 m0, s28, 50720
    s_nop 0
    buffer_load_dwordx4 v1, s[12:15], s25 offen offset:1024 lds
    s_waitcnt lgkmcnt(5)
    v_mfma_f32_16x16x32_f16 v[72:75], a[72:75], a[20:23], v[72:75]
    ds_read_b64_tr_b16 a[68:69], v13 offset:25376
    ds_read_b64_tr_b16 a[70:71], v13 offset:25632
    s_add_u32 m0, s28, 50752
    s_nop 0
    buffer_load_dwordx4 v1, s[12:15], s25 offen offset:2048 lds
    s_waitcnt lgkmcnt(4)
    v_mfma_f32_16x16x32_f16 v[76:79], a[76:79], a[20:23], v[76:79]
    ds_read_b64_tr_b16 a[72:73], v13 offset:25408
    ds_read_b64_tr_b16 a[74:75], v13 offset:25664
    s_waitcnt vmcnt(18)
    s_waitcnt lgkmcnt(15)
    v_mfma_f32_16x16x32_f16 v[56:59], a[88:91], a[24:27], v[56:59]
    ds_read_b128 a[84:87], v31 offset:576
    s_waitcnt lgkmcnt(5)
    v_mfma_f32_16x16x32_f16 v[64:67], a[64:67], a[24:27], v[64:67]
    ds_read_b64_tr_b16 a[76:77], v13 offset:25440
    ds_read_b64_tr_b16 a[78:79], v13 offset:25696
    s_add_u32 m0, s28, 50784
    s_nop 0
    buffer_load_dwordx4 v1, s[12:15], s25 offen offset:3072 lds
    s_waitcnt lgkmcnt(5)
    v_mfma_f32_16x16x32_f16 v[68:71], a[68:71], a[24:27], v[68:71]
    ds_read_b64_tr_b16 a[64:65], v13 offset:25856
    ds_read_b64_tr_b16 a[66:67], v13 offset:26112
    buffer_load_dwordx4 a[48:51], v2, s[8:11], s26 offen offset:0
    s_waitcnt lgkmcnt(5)
    v_mfma_f32_16x16x32_f16 v[72:75], a[72:75], a[24:27], v[72:75]
    ds_read_b64_tr_b16 a[68:69], v13 offset:25888
    ds_read_b64_tr_b16 a[70:71], v13 offset:26144
    s_waitcnt lgkmcnt(4)
    v_mfma_f32_16x16x32_f16 v[76:79], a[76:79], a[24:27], v[76:79]
    ds_read_b64_tr_b16 a[72:73], v13 offset:25920
    ds_read_b64_tr_b16 a[74:75], v13 offset:26176
    buffer_load_dwordx4 a[52:55], v2, s[8:11], s26 offen offset:1024
    s_waitcnt vmcnt(20)
    s_waitcnt lgkmcnt(15)
    v_mfma_f32_16x16x32_f16 v[56:59], a[92:95], a[28:31], v[56:59]
    ds_read_b128 a[88:91], v31 offset:640
    s_waitcnt lgkmcnt(5)
    v_mfma_f32_16x16x32_f16 v[64:67], a[64:67], a[28:31], v[64:67]
    ds_read_b64_tr_b16 a[76:77], v13 offset:25952
    ds_read_b64_tr_b16 a[78:79], v13 offset:26208
    buffer_load_dwordx4 a[56:59], v2, s[8:11], s26 offen offset:2048
    s_waitcnt lgkmcnt(5)
    v_mfma_f32_16x16x32_f16 v[68:71], a[68:71], a[28:31], v[68:71]
    s_waitcnt vmcnt(11)
    s_barrier
    ds_read_b64_tr_b16 a[64:65], v13 offset:33792
    ds_read_b64_tr_b16 a[66:67], v13 offset:34048
    s_waitcnt lgkmcnt(5)
    v_mfma_f32_16x16x32_f16 v[72:75], a[72:75], a[28:31], v[72:75]
    ds_read_b64_tr_b16 a[68:69], v13 offset:33824
    ds_read_b64_tr_b16 a[70:71], v13 offset:34080
    buffer_load_dwordx4 a[60:63], v2, s[8:11], s26 offen offset:3072
    s_add_u32 s26, s26, 4096
    s_waitcnt lgkmcnt(4)
    v_mfma_f32_16x16x32_f16 v[76:79], a[76:79], a[28:31], v[76:79]
    ds_read_b64_tr_b16 a[72:73], v13 offset:33856
    ds_read_b64_tr_b16 a[74:75], v13 offset:34112
    s_waitcnt vmcnt(11)
    s_waitcnt lgkmcnt(15)
    v_mfma_f32_16x16x32_f16 v[56:59], a[80:83], a[32:35], v[56:59]
    ds_read_b128 a[92:95], v31 offset:704
    s_waitcnt lgkmcnt(5)
    v_mfma_f32_16x16x32_f16 v[64:67], a[64:67], a[32:35], v[64:67]
    ds_read_b64_tr_b16 a[76:77], v13 offset:33888
    ds_read_b64_tr_b16 a[78:79], v13 offset:34144
    s_waitcnt lgkmcnt(5)
    v_mfma_f32_16x16x32_f16 v[68:71], a[68:71], a[32:35], v[68:71]
    ds_read_b64_tr_b16 a[64:65], v13 offset:34304
    ds_read_b64_tr_b16 a[66:67], v13 offset:34560
    s_waitcnt lgkmcnt(5)
    v_mfma_f32_16x16x32_f16 v[72:75], a[72:75], a[32:35], v[72:75]
    ds_read_b64_tr_b16 a[68:69], v13 offset:34336
    ds_read_b64_tr_b16 a[70:71], v13 offset:34592
    s_waitcnt lgkmcnt(4)
    v_mfma_f32_16x16x32_f16 v[76:79], a[76:79], a[32:35], v[76:79]
    ds_read_b64_tr_b16 a[72:73], v13 offset:34368
    ds_read_b64_tr_b16 a[74:75], v13 offset:34624
    s_waitcnt vmcnt(10)
    s_waitcnt lgkmcnt(15)
    v_mfma_f32_16x16x32_f16 v[56:59], a[84:87], a[36:39], v[56:59]
    ds_read_b128 a[80:83], v31 offset:768
    s_waitcnt lgkmcnt(5)
    v_mfma_f32_16x16x32_f16 v[64:67], a[64:67], a[36:39], v[64:67]
    ds_read_b64_tr_b16 a[76:77], v13 offset:34400
    ds_read_b64_tr_b16 a[78:79], v13 offset:34656
    s_waitcnt lgkmcnt(5)
    v_mfma_f32_16x16x32_f16 v[68:71], a[68:71], a[36:39], v[68:71]
    ds_read_b64_tr_b16 a[64:65], v13 offset:42240
    ds_read_b64_tr_b16 a[66:67], v13 offset:42496
    s_waitcnt lgkmcnt(5)
    v_mfma_f32_16x16x32_f16 v[72:75], a[72:75], a[36:39], v[72:75]
    ds_read_b64_tr_b16 a[68:69], v13 offset:42272
    ds_read_b64_tr_b16 a[70:71], v13 offset:42528
    s_waitcnt lgkmcnt(4)
    v_mfma_f32_16x16x32_f16 v[76:79], a[76:79], a[36:39], v[76:79]
    ds_read_b64_tr_b16 a[72:73], v13 offset:42304
    ds_read_b64_tr_b16 a[74:75], v13 offset:42560
    s_waitcnt vmcnt(9)
    s_waitcnt lgkmcnt(15)
    v_mfma_f32_16x16x32_f16 v[56:59], a[88:91], a[40:43], v[56:59]
    ds_read_b128 a[84:87], v31 offset:832
    s_waitcnt lgkmcnt(5)
    v_mfma_f32_16x16x32_f16 v[64:67], a[64:67], a[40:43], v[64:67]
    ds_read_b64_tr_b16 a[76:77], v13 offset:42336
    ds_read_b64_tr_b16 a[78:79], v13 offset:42592
    s_waitcnt lgkmcnt(5)
    v_mfma_f32_16x16x32_f16 v[68:71], a[68:71], a[40:43], v[68:71]
    ds_read_b64_tr_b16 a[64:65], v13 offset:42752
    ds_read_b64_tr_b16 a[66:67], v13 offset:43008
    s_waitcnt lgkmcnt(5)
    v_mfma_f32_16x16x32_f16 v[72:75], a[72:75], a[40:43], v[72:75]
    ds_read_b64_tr_b16 a[68:69], v13 offset:42784
    ds_read_b64_tr_b16 a[70:71], v13 offset:43040
    s_waitcnt lgkmcnt(4)
    v_mfma_f32_16x16x32_f16 v[76:79], a[76:79], a[40:43], v[76:79]
    ds_read_b64_tr_b16 a[72:73], v13 offset:42816
    ds_read_b64_tr_b16 a[74:75], v13 offset:43072
    s_waitcnt vmcnt(8)
    s_waitcnt lgkmcnt(15)
    v_mfma_f32_16x16x32_f16 v[56:59], a[92:95], a[44:47], v[56:59]
    ds_read_b128 a[88:91], v31 offset:896
    s_waitcnt lgkmcnt(5)
    v_mfma_f32_16x16x32_f16 v[64:67], a[64:67], a[44:47], v[64:67]
    ds_read_b64_tr_b16 a[76:77], v13 offset:42848
    ds_read_b64_tr_b16 a[78:79], v13 offset:43104
    s_waitcnt lgkmcnt(5)
    v_mfma_f32_16x16x32_f16 v[68:71], a[68:71], a[44:47], v[68:71]
    s_waitcnt vmcnt(4)
    s_barrier
    ds_read_b64_tr_b16 a[64:65], v14 offset:0
    ds_read_b64_tr_b16 a[66:67], v14 offset:256
    s_waitcnt lgkmcnt(5)
    v_mfma_f32_16x16x32_f16 v[72:75], a[72:75], a[44:47], v[72:75]
    ds_read_b64_tr_b16 a[68:69], v14 offset:32
    ds_read_b64_tr_b16 a[70:71], v14 offset:288
    s_waitcnt lgkmcnt(4)
    v_mfma_f32_16x16x32_f16 v[76:79], a[76:79], a[44:47], v[76:79]
    ds_read_b64_tr_b16 a[72:73], v14 offset:64
    ds_read_b64_tr_b16 a[74:75], v14 offset:320
    s_waitcnt vmcnt(3)
    s_waitcnt lgkmcnt(15)
    v_mfma_f32_16x16x32_f16 v[56:59], a[80:83], a[48:51], v[56:59]
    ds_read_b128 a[92:95], v31 offset:960
    s_waitcnt lgkmcnt(5)
    v_mfma_f32_16x16x32_f16 v[64:67], a[64:67], a[48:51], v[64:67]
    ds_read_b64_tr_b16 a[76:77], v14 offset:96
    ds_read_b64_tr_b16 a[78:79], v14 offset:352
    s_waitcnt lgkmcnt(5)
    v_mfma_f32_16x16x32_f16 v[68:71], a[68:71], a[48:51], v[68:71]
    ds_read_b64_tr_b16 a[64:65], v14 offset:512
    ds_read_b64_tr_b16 a[66:67], v14 offset:768
    s_waitcnt lgkmcnt(5)
    v_mfma_f32_16x16x32_f16 v[72:75], a[72:75], a[48:51], v[72:75]
    ds_read_b64_tr_b16 a[68:69], v14 offset:544
    ds_read_b64_tr_b16 a[70:71], v14 offset:800
    s_waitcnt lgkmcnt(4)
    v_mfma_f32_16x16x32_f16 v[76:79], a[76:79], a[48:51], v[76:79]
    ds_read_b64_tr_b16 a[72:73], v14 offset:576
    ds_read_b64_tr_b16 a[74:75], v14 offset:832
    s_waitcnt vmcnt(2)
    s_waitcnt lgkmcnt(15)
    v_mfma_f32_16x16x32_f16 v[56:59], a[84:87], a[52:55], v[56:59]
    s_waitcnt lgkmcnt(4)
    v_mfma_f32_16x16x32_f16 v[64:67], a[64:67], a[52:55], v[64:67]
    ds_read_b64_tr_b16 a[76:77], v14 offset:608
    ds_read_b64_tr_b16 a[78:79], v14 offset:864
    s_waitcnt lgkmcnt(4)
    v_mfma_f32_16x16x32_f16 v[68:71], a[68:71], a[52:55], v[68:71]
    ds_read_b64_tr_b16 a[64:65], v14 offset:8448
    ds_read_b64_tr_b16 a[66:67], v14 offset:8704
    s_waitcnt lgkmcnt(4)
    v_mfma_f32_16x16x32_f16 v[72:75], a[72:75], a[52:55], v[72:75]
    ds_read_b64_tr_b16 a[68:69], v14 offset:8480
    ds_read_b64_tr_b16 a[70:71], v14 offset:8736
    s_waitcnt lgkmcnt(4)
    v_mfma_f32_16x16x32_f16 v[76:79], a[76:79], a[52:55], v[76:79]
    ds_read_b64_tr_b16 a[72:73], v14 offset:8512
    ds_read_b64_tr_b16 a[74:75], v14 offset:8768
    s_waitcnt vmcnt(1)
    s_waitcnt lgkmcnt(15)
    v_mfma_f32_16x16x32_f16 v[56:59], a[88:91], a[56:59], v[56:59]
    s_waitcnt lgkmcnt(4)
    v_mfma_f32_16x16x32_f16 v[64:67], a[64:67], a[56:59], v[64:67]
    ds_read_b64_tr_b16 a[76:77], v14 offset:8544
    ds_read_b64_tr_b16 a[78:79], v14 offset:8800
    s_waitcnt lgkmcnt(4)
    v_mfma_f32_16x16x32_f16 v[68:71], a[68:71], a[56:59], v[68:71]
    ds_read_b64_tr_b16 a[64:65], v14 offset:8960
    ds_read_b64_tr_b16 a[66:67], v14 offset:9216
    s_waitcnt lgkmcnt(4)
    v_mfma_f32_16x16x32_f16 v[72:75], a[72:75], a[56:59], v[72:75]
    ds_read_b64_tr_b16 a[68:69], v14 offset:8992
    ds_read_b64_tr_b16 a[70:71], v14 offset:9248
    s_waitcnt lgkmcnt(4)
    v_mfma_f32_16x16x32_f16 v[76:79], a[76:79], a[56:59], v[76:79]
    ds_read_b64_tr_b16 a[72:73], v14 offset:9024
    ds_read_b64_tr_b16 a[74:75], v14 offset:9280
    s_waitcnt vmcnt(0)
    s_waitcnt lgkmcnt(15)
    v_mfma_f32_16x16x32_f16 v[56:59], a[92:95], a[60:63], v[56:59]
    s_waitcnt lgkmcnt(4)
    v_mfma_f32_16x16x32_f16 v[64:67], a[64:67], a[60:63], v[64:67]
    ds_read_b64_tr_b16 a[76:77], v14 offset:9056
    ds_read_b64_tr_b16 a[78:79], v14 offset:9312
    s_waitcnt lgkmcnt(4)
    v_mfma_f32_16x16x32_f16 v[68:71], a[68:71], a[60:63], v[68:71]
    s_waitcnt lgkmcnt(2)
    v_mfma_f32_16x16x32_f16 v[72:75], a[72:75], a[60:63], v[72:75]
    s_waitcnt lgkmcnt(0)
    v_mfma_f32_16x16x32_f16 v[76:79], a[76:79], a[60:63], v[76:79]
    s_nop 7
    ds_bpermute_b32 v48, v12, v64
    ds_bpermute_b32 v49, v12, v68
    ds_bpermute_b32 v50, v12, v72
    ds_bpermute_b32 v51, v12, v76
    s_waitcnt vmcnt(15)
    ds_read_b64 v[32:33], v8
    ds_read_b64 v[34:35], v9
    ds_read_b64 v[36:37], v10
    ds_read_b64 v[38:39], v11
    v_xor_b32 v8, 24, v8
    ds_read_b64 v[40:41], v8 offset:2048
    v_xor_b32 v9, 24, v9
    ds_read_b64 v[42:43], v9 offset:2048
    v_xor_b32 v10, 24, v10
    ds_read_b64 v[44:45], v10 offset:2048
    v_xor_b32 v11, 24, v11
    ds_read_b64 v[46:47], v11 offset:2048
    v_add_f32 v18, v18, v56
    v_add_f32 v19, v19, v56
    v_mov_b32 v52, v57
    s_waitcnt lgkmcnt(8)
    v_cndmask_b32 v48, v48, v49, s[38:39]
    v_cndmask_b32 v49, v49, v50, s[38:39]
    v_cndmask_b32 v50, v50, v51, s[38:39]
    v_cndmask_b32 v51, v51, v52, s[38:39]
    s_waitcnt lgkmcnt(7)
    v_lshlrev_b32 v24, 16, v32
    v_and_b32 v25, 0xffff0000, v32
    v_lshlrev_b32 v26, 16, v33
    v_and_b32 v27, 0xffff0000, v33
    v_sub_f32 v24, v24, v18
    v_sub_f32 v25, v25, v18
    v_sub_f32 v26, v26, v18
    v_sub_f32 v27, v27, v18
    v_add_f32 v24, v24, v64
    v_add_f32 v25, v25, v65
    v_add_f32 v26, v26, v66
    v_add_f32 v27, v27, v67
    v_cvt_pk_bf16_f32 v32, v24, v25
    v_cvt_pk_bf16_f32 v33, v26, v27
    v_mul_f32 v60, v24, v24
    v_fmac_f32 v60, v25, v25
    v_fmac_f32 v60, v26, v26
    v_fmac_f32 v60, v27, v27
    s_waitcnt lgkmcnt(6)
    v_lshlrev_b32 v24, 16, v34
    v_and_b32 v25, 0xffff0000, v34
    v_lshlrev_b32 v26, 16, v35
    v_and_b32 v27, 0xffff0000, v35
    v_sub_f32 v24, v24, v18
    v_sub_f32 v25, v25, v18
    v_sub_f32 v26, v26, v18
    v_sub_f32 v27, v27, v18
    v_add_f32 v24, v24, v68
    v_add_f32 v25, v25, v69
    v_add_f32 v26, v26, v70
    v_add_f32 v27, v27, v71
    v_cvt_pk_bf16_f32 v34, v24, v25
    v_cvt_pk_bf16_f32 v35, v26, v27
    buffer_store_dwordx4 v[32:35], v1, s[16:19], s44 offen offset:0
    v_fmac_f32 v60, v24, v24
    v_fmac_f32 v60, v25, v25
    v_fmac_f32 v60, v26, v26
    v_fmac_f32 v60, v27, v27
    s_waitcnt lgkmcnt(5)
    v_lshlrev_b32 v24, 16, v36
    v_and_b32 v25, 0xffff0000, v36
    v_lshlrev_b32 v26, 16, v37
    v_and_b32 v27, 0xffff0000, v37
    v_sub_f32 v24, v24, v18
    v_sub_f32 v25, v25, v18
    v_sub_f32 v26, v26, v18
    v_sub_f32 v27, v27, v18
    v_add_f32 v24, v24, v72
    v_add_f32 v25, v25, v73
    v_add_f32 v26, v26, v74
    v_add_f32 v27, v27, v75
    v_cvt_pk_bf16_f32 v36, v24, v25
    v_cvt_pk_bf16_f32 v37, v26, v27
    v_fmac_f32 v60, v24, v24
    v_fmac_f32 v60, v25, v25
    v_fmac_f32 v60, v26, v26
    v_fmac_f32 v60, v27, v27
    s_waitcnt lgkmcnt(4)
    v_lshlrev_b32 v24, 16, v38
    v_and_b32 v25, 0xffff0000, v38
    v_lshlrev_b32 v26, 16, v39
    v_and_b32 v27, 0xffff0000, v39
    v_sub_f32 v24, v24, v18
    v_sub_f32 v25, v25, v18
    v_sub_f32 v26, v26, v18
    v_sub_f32 v27, v27, v18
    v_add_f32 v24, v24, v76
    v_add_f32 v25, v25, v77
    v_add_f32 v26, v26, v78
    v_add_f32 v27, v27, v79
    v_cvt_pk_bf16_f32 v38, v24, v25
    v_cvt_pk_bf16_f32 v39, v26, v27
    buffer_store_dwordx4 v[36:39], v1, s[16:19], s44 offen offset:1024
    v_fmac_f32 v60, v24, v24
    v_fmac_f32 v60, v25, v25
    v_fmac_f32 v60, v26, v26
    v_fmac_f32 v60, v27, v27
    v_mov_b32 v61, v60
    s_nop 1
    v_permlane32_swap_b32 v60, v61
    v_add_f32 v60, v60, v61
    v_mov_b32 v61, v60
    s_nop 1
    v_permlane16_swap_b32 v60, v61
    v_add_f32 v60, v60, v61
    buffer_store_dword v60, v22, s[20:23], s45 offen
    s_waitcnt lgkmcnt(3)
    v_lshlrev_b32 v24, 16, v40
    v_and_b32 v25, 0xffff0000, v40
    v_lshlrev_b32 v26, 16, v41
    v_and_b32 v27, 0xffff0000, v41
    v_sub_f32 v24, v24, v19
    v_sub_f32 v25, v25, v19
    v_sub_f32 v26, v26, v19
    v_sub_f32 v27, v27, v19
    v_add_f32 v24, v24, v51
    v_add_f32 v25, v25, v79
    v_add_f32 v26, v26, v78
    v_add_f32 v27, v27, v77
    v_cvt_pk_bf16_f32 v40, v24, v25
    v_cvt_pk_bf16_f32 v41, v26, v27
    v_mul_f32 v62, v24, v24
    v_fmac_f32 v62, v25, v25
    v_fmac_f32 v62, v26, v26
    v_fmac_f32 v62, v27, v27
    s_waitcnt lgkmcnt(2)
    v_lshlrev_b32 v24, 16, v42
    v_and_b32 v25, 0xffff0000, v42
    v_lshlrev_b32 v26, 16, v43
    v_and_b32 v27, 0xffff0000, v43
    v_sub_f32 v24, v24, v19
    v_sub_f32 v25, v25, v19
    v_sub_f32 v26, v26, v19
    v_sub_f32 v27, v27, v19
    v_add_f32 v24, v24, v50
    v_add_f32 v25, v25, v75
    v_add_f32 v26, v26, v74
    v_add_f32 v27, v27, v73
    v_cvt_pk_bf16_f32 v42, v24, v25
    v_cvt_pk_bf16_f32 v43, v26, v27
    buffer_store_dwordx4 v[40:43], v16, s[16:19], s69 offen offset:0
    v_fmac_f32 v62, v24, v24
    v_fmac_f32 v62, v25, v25
    v_fmac_f32 v62, v26, v26
    v_fmac_f32 v62, v27, v27
    s_waitcnt lgkmcnt(1)
    v_lshlrev_b32 v24, 16, v44
    v_and_b32 v25, 0xffff0000, v44
    v_lshlrev_b32 v26, 16, v45
    v_and_b32 v27, 0xffff0000, v45
    v_sub_f32 v24, v24, v19
    v_sub_f32 v25, v25, v19
    v_sub_f32 v26, v26, v19
    v_sub_f32 v27, v27, v19
    v_add_f32 v24, v24, v49
    v_add_f32 v25, v25, v71
    v_add_f32 v26, v26, v70
    v_add_f32 v27, v27, v69
    v_cvt_pk_bf16_f32 v44, v24, v25
    v_cvt_pk_bf16_f32 v45, v26, v27
    v_fmac_f32 v62, v24, v24
    v_fmac_f32 v62, v25, v25
    v_fmac_f32 v62, v26, v26
    v_fmac_f32 v62, v27, v27
    s_waitcnt lgkmcnt(0)
    v_lshlrev_b32 v24, 16, v46
    v_and_b32 v25, 0xffff0000, v46
    v_lshlrev_b32 v26, 16, v47
    v_and_b32 v27, 0xffff0000, v47
    v_sub_f32 v24, v24, v19
    v_sub_f32 v25, v25, v19
    v_sub_f32 v26, v26, v19
    v_sub_f32 v27, v27, v19
    v_add_f32 v24, v24, v48
    v_add_f32 v25, v25, v67
    v_add_f32 v26, v26, v66
    v_add_f32 v27, v27, v65
    v_cvt_pk_bf16_f32 v46, v24, v25
    v_cvt_pk_bf16_f32 v47, v26, v27
    buffer_store_dwordx4 v[44:47], v16, s[16:19], s69 offen offset:1024
    v_fmac_f32 v62, v24, v24
    v_fmac_f32 v62, v25, v25
    v_fmac_f32 v62, v26, v26
    v_fmac_f32 v62, v27, v27
    v_mov_b32 v63, v62
    s_nop 1
    v_permlane32_swap_b32 v62, v63
    v_add_f32 v62, v62, v63
    v_mov_b32 v63, v62
    s_nop 1
    v_permlane16_swap_b32 v62, v63
    v_add_f32 v62, v62, v63
    buffer_store_dword v62, v17, s[20:23], s70 offen
    s_cmp_lg_u32 s33, 0
    s_cbranch_scc1 k2_kernel_nomt
    buffer_store_dword v18, v23, s[52:55], 0 offen
k2_kernel_nomt:
k2_kernel_end:
    s_endpgm
.globl g34_kernel
.p2align 8
.type g34_kernel,@function
g34_kernel:
    s_cmp_ge_u32 s2, 256
    s_cbranch_scc1 g34_kernel_end
    s_getpc_b64 s[56:57]
g34_kernel_pc:
    s_lshr_b32 s58, s2, 3
    s_lshl_b32 s58, s58, 2
    v_lshrrev_b32 v28, 6, v0
    v_add_u32 v28, s58, v28
    v_and_b32 v28, 15, v28
    v_lshlrev_b32 v28, 6, v28
    v_and_or_b32 v28, v0, 63, v28
    v_lshlrev_b32 v28, 7, v28
    v_min_u32 v28, ((g34_kernel_end - g34_kernel_pc) / 4) * 4 - 4, v28
    global_load_dword v31, v28, s[56:57]
    s_load_dwordx4 s[36:39], s[0:1], 48
    s_load_dwordx4 s[48:51], s[0:1], 64
    s_load_dwordx2 s[40:41], s[0:1], 88
    v_lshrrev_b32 v1, 6, v0
    v_and_b32 v0, 63, v0
    v_readfirstlane_b32 s24, v1
    s_and_b32 s31, s2, 7
    s_lshl_b32 s33, s31, 2
    s_lshr_b32 s31, s2, 3
    s_and_b32 s34, s31, 3
    s_add_u32 s33, s33, s34
    s_lshr_b32 s34, s31, 2
    s_lshl_b32 s31, s34, 4
    s_mul_i32 s42, s24, 4
    s_add_u32 s42, s42, s31
    s_lshl_b32 s43, s42, 15
    v_lshlrev_b32 v1, 4, v0
    s_add_u32 s31, s43, 0
    v_add_u32 v2, s31, v1
    s_add_u32 s31, s43, 32768
    v_add_u32 v3, s31, v1
    s_add_u32 s31, s43, 65536
    v_add_u32 v4, s31, v1
    s_add_u32 s31, s43, 98304
    v_add_u32 v5, s31, v1
    s_lshl_b32 s47, s42, 10
    v_add_u32 v20, 0, v0
    v_mul_u32_u24 v21, 4682, v20
    v_lshrrev_b32 v21, 16, v21
    v_mul_u32_u24 v21, 6944, v21
    v_lshl_add_u32 v6, v20, 4, v21
    v_add_u32 v20, 64, v0
    v_mul_u32_u24 v21, 4682, v20
    v_lshrrev_b32 v21, 16, v21
    v_mul_u32_u24 v21, 6944, v21
    v_lshl_add_u32 v7, v20, 4, v21
    v_subrev_u32 v7, 1024, v7
    v_add_u32 v20, 128, v0
    v_mul_u32_u24 v21, 4682, v20
    v_lshrrev_b32 v21, 16, v21
    v_mul_u32_u24 v21, 6944, v21
    v_lshl_add_u32 v8, v20, 4, v21
    v_subrev_u32 v8, 2048, v8
    v_add_u32 v20, 192, v0
    v_mul_u32_u24 v21, 4682, v20
    v_lshrrev_b32 v21, 16, v21
    v_mul_u32_u24 v21, 6944, v21
    v_lshl_add_u32 v9, v20, 4, v21
    v_subrev_u32 v9, 3072, v9
    v_add_u32 v20, 256, v0
    v_mul_u32_u24 v21, 4682, v20
    v_lshrrev_b32 v21, 16, v21
    v_mul_u32_u24 v21, 6944, v21
    v_lshl_add_u32 v10, v20, 4, v21
    v_add_u32 v20, 320, v0
    v_mul_u32_u24 v21, 4682, v20
    v_lshrrev_b32 v21, 16, v21
    v_mul_u32_u24 v21, 6944, v21
    v_lshl_add_u32 v11, v20, 4, v21
    v_subrev_u32 v11, 1024, v11
    v_add_u32 v20, 384, v0
    v_mul_u32_u24 v21, 4682, v20
    v_lshrrev_b32 v21, 16, v21
    v_mul_u32_u24 v21, 6944, v21
    v_lshl_add_u32 v12, v20, 4, v21
    v_subrev_u32 v12, 2048, v12
    s_and_b32 s31, s24, 1
    s_mul_i32 s25, s31, 229376
    s_mul_i32 s32, s33, 224
    s_add_u32 s25, s25, s32
    s_lshl_b32 s31, s31, 1
    s_bfe_u32 s32, s24, 0x10001
    s_add_u32 s32, s32, s31
    s_mul_i32 s28, s32, 7168
    s_waitcnt lgkmcnt(0)
    s_bitcmp1_b32 s24, 1
    s_cselect_b32 s12, s38, s36
    s_cselect_b32 s13, s39, s37
    s_and_b32 s13, s13, 0xffff
    s_mov_b32 s14, 7340032
    s_mov_b32 s15, 0x00020000
    s_add_u32 s8, s40, 0x800000
    s_addc_u32 s9, s41, 0
    s_and_b32 s9, s9, 0xffff
    s_mov_b32 s10, 0x400000
    s_mov_b32 s11, 0x00020000
    s_mov_b32 s26, 0
    s_add_u32 m0, s28, 0
    s_nop 0
    buffer_load_dwordx4 v6, s[12:15], s25 offen offset:0 lds
    buffer_load_dwordx4 v7, s[12:15], s25 offen offset:1024 lds
    buffer_load_dwordx4 v8, s[12:15], s25 offen offset:2048 lds
    buffer_load_dwordx4 v9, s[12:15], s25 offen offset:3072 lds
    s_add_u32 m0, s28, 4096
    s_nop 0
    buffer_load_dwordx4 v10, s[12:15], s25 offen offset:0 lds
    buffer_load_dwordx4 v11, s[12:15], s25 offen offset:1024 lds
    buffer_load_dwordx4 v12, s[12:15], s25 offen offset:2048 lds
    s_add_u32 s25, s25, 458752
    buffer_load_dwordx4 a[0:3], v2, s[8:11], s26 offen offset:0
    buffer_load_dwordx4 a[4:7], v3, s[8:11], s26 offen offset:0
    buffer_load_dwordx4 a[8:11], v4, s[8:11], s26 offen offset:0
    buffer_load_dwordx4 a[12:15], v5, s[8:11], s26 offen offset:0
    buffer_load_dwordx4 a[16:19], v2, s[8:11], s26 offen offset:1024
    buffer_load_dwordx4 a[20:23], v3, s[8:11], s26 offen offset:1024
    buffer_load_dwordx4 a[24:27], v4, s[8:11], s26 offen offset:1024
    buffer_load_dwordx4 a[28:31], v5, s[8:11], s26 offen offset:1024
    s_add_u32 m0, s28, 28672
    s_nop 0
    buffer_load_dwordx4 v6, s[12:15], s25 offen offset:0 lds
    buffer_load_dwordx4 v7, s[12:15], s25 offen offset:1024 lds
    buffer_load_dwordx4 v8, s[12:15], s25 offen offset:2048 lds
    s_add_u32 s20, s40, 0x640000
    s_addc_u32 s21, s41, 0
    s_and_b32 s21, s21, 0xffff
    s_mov_b32 s22, 0x20000
    s_mov_b32 s23, 0x00020000
    s_add_u32 s16, s40, 0x1000000
    s_addc_u32 s17, s41, 0
    s_and_b32 s17, s17, 0xffff
    s_mov_b32 s18, 0xe00000
    s_mov_b32 s19, 0x00020000
    v_lshrrev_b32 v20, 2, v0
    v_mul_u32_u24 v20, 224, v20
    v_and_b32 v21, 3, v0
    v_lshl_add_u32 v13, v21, 3, v20
    v_add_u32 v14, 57344, v13
    v_add_u32 v15, 114688, v13
    v_mov_b32 v29, v1
    s_mul_i32 s43, s42, 114688
    v_add_u32 v1, s43, v1
    s_lshr_b32 s31, s33, 4
    s_mul_i32 s46, s31, 57344
    s_and_b32 s31, s33, 15
    s_lshl_b32 s44, s31, 10
    s_add_u32 s44, s44, s46
    s_lshr_b32 s31, s31, 1
    s_lshl_b32 s31, s31, 10
    s_add_u32 s46, s46, s31
    s_and_b32 s31, s33, 1
    s_lshl_b32 s31, s31, 3
    s_add_u32 s46, s46, s31
    s_add_u32 s46, s46, 49152
    s_mov_b32 s64, s48
    s_and_b32 s65, s49, 0xffff
    s_mov_b32 s66, 0x700000
    s_mov_b32 s67, 0x00020000
    v_lshlrev_b32 v30, 7, v0
    v_cmp_lt_u32 vcc, 6, v0
    v_mov_b32 v20, 0x40000000
    s_lshr_b32 s70, s2, 3
    v_cndmask_b32 v30, v30, v20, vcc
    s_lshl_b32 s70, s70, 2
    s_add_u32 s70, s70, s24
    s_mul_i32 s68, s70, 28672
    s_bfe_u32 s71, s2, 0x10002
    s_mul_i32 s71, s71, 3670016
    s_add_u32 s68, s68, s71
    s_and_b32 s71, s2, 1
    s_lshl_b32 s71, s71, 10
    s_add_u32 s68, s68, s71
    s_bitcmp1_b32 s70, 6
    s_cselect_b32 s4, s38, s36
    s_cselect_b32 s5, s39, s37
    s_and_b32 s5, s5, 0xffff
    s_mov_b32 s6, 7340032
    s_mov_b32 s7, 0x00020000
    s_and_b32 s70, s70, 63
    s_mul_i32 s70, s70, 7168
    s_and_b32 s71, s2, 7
    s_mul_i32 s71, s71, 896
    s_add_u32 s70, s70, s71
    s_add_u32 s70, s70, 3670016
    s_add_u32 s52, s40, 0xc00000
    s_addc_u32 s53, s41, 0
    s_and_b32 s53, s53, 0xffff
    s_mov_b32 s54, 0x400000
    s_mov_b32 s55, 0x00020000
    s_lshl_b32 s69, s2, 2
    s_add_u32 s69, s69, s24
    s_mul_i32 s69, s69, 4096
    v_accvgpr_write_b32 a160, -1
    v_accvgpr_write_b32 a161, -1
    v_accvgpr_write_b32 a162, -1
    v_accvgpr_write_b32 a163, -1
    s_add_u32 s60, s40, 0x628000
    s_addc_u32 s61, s41, 0
    s_and_b32 s61, s61, 0xffff
    s_mov_b32 s62, 0x2000
    s_mov_b32 s63, 0x00020000
    s_lshr_b32 s59, s42, 2
    s_lshl_b32 s59, s59, 5
    s_add_u32 s59, s59, s33
    s_lshl_b32 s59, s59, 2
    s_waitcnt vmcnt(11)
    s_barrier
    ds_read_b64_tr_b16 a[128:129], v13 offset:0
    ds_read_b64_tr_b16 a[130:131], v13 offset:3584
    ds_read_b64_tr_b16 a[132:133], v13 offset:32
    ds_read_b64_tr_b16 a[134:135], v13 offset:3616
    ds_read_b64_tr_b16 a[136:137], v13 offset:64
    ds_read_b64_tr_b16 a[138:139], v13 offset:3648
    s_waitcnt vmcnt(7)
    s_waitcnt lgkmcnt(4)
    v_mfma_f32_16x16x32_bf16 v[32:35], a[128:131], a[0:3], 0
    ds_read_b64_tr_b16 a[140:141], v13 offset:96
    v_mfma_f32_16x16x32_bf16 v[36:39], a[128:131], a[4:7], 0
    ds_read_b64_tr_b16 a[142:143], v13 offset:3680
    v_mfma_f32_16x16x32_bf16 v[40:43], a[128:131], a[8:11], 0
    v_mfma_f32_16x16x32_bf16 v[44:47], a[128:131], a[12:15], 0
    s_waitcnt lgkmcnt(4)
    v_mfma_f32_16x16x32_bf16 v[48:51], a[132:135], a[0:3], 0
    ds_read_b64_tr_b16 a[128:129], v13 offset:128
    v_mfma_f32_16x16x32_bf16 v[52:55], a[132:135], a[4:7], 0
    ds_read_b64_tr_b16 a[130:131], v13 offset:3712
    v_mfma_f32_16x16x32_bf16 v[56:59], a[132:135], a[8:11], 0
    v_mfma_f32_16x16x32_bf16 v[60:63], a[132:135], a[12:15], 0
    buffer_load_dwordx4 v9, s[12:15], s25 offen offset:3072 lds
    s_waitcnt lgkmcnt(4)
    v_mfma_f32_16x16x32_bf16 v[64:67], a[136:139], a[0:3], 0
    ds_read_b64_tr_b16 a[132:133], v13 offset:160
    v_mfma_f32_16x16x32_bf16 v[68:71], a[136:139], a[4:7], 0
    ds_read_b64_tr_b16 a[134:135], v13 offset:3744
    v_mfma_f32_16x16x32_bf16 v[72:75], a[136:139], a[8:11], 0
    v_mfma_f32_16x16x32_bf16 v[76:79], a[136:139], a[12:15], 0
    s_waitcnt lgkmcnt(4)
    v_mfma_f32_16x16x32_bf16 v[80:83], a[140:143], a[0:3], 0
    ds_read_b64_tr_b16 a[136:137], v13 offset:192
    v_mfma_f32_16x16x32_bf16 v[84:87], a[140:143], a[4:7], 0
    ds_read_b64_tr_b16 a[138:139], v13 offset:3776
    v_mfma_f32_16x16x32_bf16 v[88:91], a[140:143], a[8:11], 0
    v_mfma_f32_16x16x32_bf16 v[92:95], a[140:143], a[12:15], 0
    s_add_u32 m0, s28, 32768
    s_nop 0
    buffer_load_dwordx4 v10, s[12:15], s25 offen offset:0 lds
    s_waitcnt lgkmcnt(4)
    v_mfma_f32_16x16x32_bf16 v[96:99], a[128:131], a[0:3], 0
    ds_read_b64_tr_b16 a[140:141], v13 offset:7168
    v_mfma_f32_16x16x32_bf16 v[100:103], a[128:131], a[4:7], 0
    ds_read_b64_tr_b16 a[142:143], v13 offset:10752
    v_mfma_f32_16x16x32_bf16 v[104:107], a[128:131], a[8:11], 0
    v_mfma_f32_16x16x32_bf16 v[108:111], a[128:131], a[12:15], 0
    buffer_load_dwordx4 v11, s[12:15], s25 offen offset:1024 lds
    s_waitcnt lgkmcnt(4)
    v_mfma_f32_16x16x32_bf16 v[112:115], a[132:135], a[0:3], 0
    ds_read_b64_tr_b16 a[128:129], v13 offset:7200
    v_mfma_f32_16x16x32_bf16 v[116:119], a[132:135], a[4:7], 0
    ds_read_b64_tr_b16 a[130:131], v13 offset:10784
    v_mfma_f32_16x16x32_bf16 v[120:123], a[132:135], a[8:11], 0
    v_mfma_f32_16x16x32_bf16 v[124:127], a[132:135], a[12:15], 0
    s_waitcnt lgkmcnt(4)
    v_mfma_f32_16x16x32_bf16 v[128:131], a[136:139], a[0:3], 0
    ds_read_b64_tr_b16 a[132:133], v13 offset:7232
    v_mfma_f32_16x16x32_bf16 v[132:135], a[136:139], a[4:7], 0
    ds_read_b64_tr_b16 a[134:135], v13 offset:10816
    v_mfma_f32_16x16x32_bf16 v[136:139], a[136:139], a[8:11], 0
    v_mfma_f32_16x16x32_bf16 v[140:143], a[136:139], a[12:15], 0
    buffer_load_dwordx4 v12, s[12:15], s25 offen offset:2048 lds
    s_add_u32 s25, s25, 458752
    s_waitcnt lgkmcnt(4)
    v_mfma_f32_16x16x32_bf16 v[144:147], a[140:143], a[0:3], 0
    ds_read_b64_tr_b16 a[136:137], v13 offset:7264
    v_mfma_f32_16x16x32_bf16 v[148:151], a[140:143], a[4:7], 0
    ds_read_b64_tr_b16 a[138:139], v13 offset:10848
    v_mfma_f32_16x16x32_bf16 v[152:155], a[140:143], a[8:11], 0
    v_mfma_f32_16x16x32_bf16 v[156:159], a[140:143], a[12:15], 0
    buffer_load_dwordx4 a[32:35], v2, s[8:11], s26 offen offset:2048
    s_waitcnt lgkmcnt(4)
    v_mfma_f32_16x16x32_bf16 v[160:163], a[128:131], a[0:3], 0
    ds_read_b64_tr_b16 a[140:141], v13 offset:7296
    v_mfma_f32_16x16x32_bf16 v[164:167], a[128:131], a[4:7], 0
    ds_read_b64_tr_b16 a[142:143], v13 offset:10880
    v_mfma_f32_16x16x32_bf16 v[168:171], a[128:131], a[8:11], 0
    v_mfma_f32_16x16x32_bf16 v[172:175], a[128:131], a[12:15], 0
    s_waitcnt lgkmcnt(4)
    v_mfma_f32_16x16x32_bf16 v[176:179], a[132:135], a[0:3], 0
    ds_read_b64_tr_b16 a[128:129], v13 offset:7328
    v_mfma_f32_16x16x32_bf16 v[180:183], a[132:135], a[4:7], 0
    ds_read_b64_tr_b16 a[130:131], v13 offset:10912
    v_mfma_f32_16x16x32_bf16 v[184:187], a[132:135], a[8:11], 0
    v_mfma_f32_16x16x32_bf16 v[188:191], a[132:135], a[12:15], 0
    buffer_load_dwordx4 a[36:39], v3, s[8:11], s26 offen offset:2048
    s_waitcnt lgkmcnt(4)
    v_mfma_f32_16x16x32_bf16 v[192:195], a[136:139], a[0:3], 0
    ds_read_b64_tr_b16 a[132:133], v13 offset:7360
    v_mfma_f32_16x16x32_bf16 v[196:199], a[136:139], a[4:7], 0
    ds_read_b64_tr_b16 a[134:135], v13 offset:10944
    v_mfma_f32_16x16x32_bf16 v[200:203], a[136:139], a[8:11], 0
    v_mfma_f32_16x16x32_bf16 v[204:207], a[136:139], a[12:15], 0
    buffer_load_dwordx4 a[40:43], v4, s[8:11], s26 offen offset:2048
    s_waitcnt lgkmcnt(4)
    v_mfma_f32_16x16x32_bf16 v[208:211], a[140:143], a[0:3], 0
    ds_read_b64_tr_b16 a[136:137], v13 offset:14336
    v_mfma_f32_16x16x32_bf16 v[212:215], a[140:143], a[4:7], 0
    ds_read_b64_tr_b16 a[138:139], v13 offset:17920
    v_mfma_f32_16x16x32_bf16 v[216:219], a[140:143], a[8:11], 0
    v_mfma_f32_16x16x32_bf16 v[220:223], a[140:143], a[12:15], 0
    s_waitcnt lgkmcnt(4)
    v_mfma_f32_16x16x32_bf16 v[224:227], a[128:131], a[0:3], 0
    ds_read_b64_tr_b16 a[140:141], v13 offset:14368
    v_mfma_f32_16x16x32_bf16 v[228:231], a[128:131], a[4:7], 0
    ds_read_b64_tr_b16 a[142:143], v13 offset:17952
    v_mfma_f32_16x16x32_bf16 v[232:235], a[128:131], a[8:11], 0
    v_mfma_f32_16x16x32_bf16 v[236:239], a[128:131], a[12:15], 0
    buffer_load_dwordx4 a[44:47], v5, s[8:11], s26 offen offset:2048
    s_waitcnt lgkmcnt(4)
    v_mfma_f32_16x16x32_bf16 v[240:243], a[132:135], a[0:3], 0
    ds_read_b64_tr_b16 a[128:129], v13 offset:14400
    v_mfma_f32_16x16x32_bf16 v[244:247], a[132:135], a[4:7], 0
    ds_read_b64_tr_b16 a[130:131], v13 offset:17984
    v_mfma_f32_16x16x32_bf16 v[248:251], a[132:135], a[8:11], 0
    v_mfma_f32_16x16x32_bf16 v[252:255], a[132:135], a[12:15], 0
    buffer_load_dwordx4 a[48:51], v2, s[8:11], s26 offen offset:3072
    s_waitcnt vmcnt(12)
    s_waitcnt lgkmcnt(4)
    v_mfma_f32_16x16x32_bf16 v[32:35], a[136:139], a[16:19], v[32:35]
    ds_read_b64_tr_b16 a[132:133], v13 offset:14432
    v_mfma_f32_16x16x32_bf16 v[36:39], a[136:139], a[20:23], v[36:39]
    ds_read_b64_tr_b16 a[134:135], v13 offset:18016
    v_mfma_f32_16x16x32_bf16 v[40:43], a[136:139], a[24:27], v[40:43]
    v_mfma_f32_16x16x32_bf16 v[44:47], a[136:139], a[28:31], v[44:47]
    s_waitcnt lgkmcnt(4)
    v_mfma_f32_16x16x32_bf16 v[48:51], a[140:143], a[16:19], v[48:51]
    ds_read_b64_tr_b16 a[136:137], v13 offset:14464
    v_mfma_f32_16x16x32_bf16 v[52:55], a[140:143], a[20:23], v[52:55]
    ds_read_b64_tr_b16 a[138:139], v13 offset:18048
    v_mfma_f32_16x16x32_bf16 v[56:59], a[140:143], a[24:27], v[56:59]
    v_mfma_f32_16x16x32_bf16 v[60:63], a[140:143], a[28:31], v[60:63]
    buffer_load_dwordx4 a[52:55], v3, s[8:11], s26 offen offset:3072
    s_waitcnt lgkmcnt(4)
    v_mfma_f32_16x16x32_bf16 v[64:67], a[128:131], a[16:19], v[64:67]
    ds_read_b64_tr_b16 a[140:141], v13 offset:14496
    v_mfma_f32_16x16x32_bf16 v[68:71], a[128:131], a[20:23], v[68:71]
    ds_read_b64_tr_b16 a[142:143], v13 offset:18080
    v_mfma_f32_16x16x32_bf16 v[72:75], a[128:131], a[24:27], v[72:75]
    v_mfma_f32_16x16x32_bf16 v[76:79], a[128:131], a[28:31], v[76:79]
    buffer_load_dwordx4 a[56:59], v4, s[8:11], s26 offen offset:3072
    s_waitcnt lgkmcnt(4)
    v_mfma_f32_16x16x32_bf16 v[80:83], a[132:135], a[16:19], v[80:83]
    ds_read_b64_tr_b16 a[128:129], v13 offset:14528
    v_mfma_f32_16x16x32_bf16 v[84:87], a[132:135], a[20:23], v[84:87]
    ds_read_b64_tr_b16 a[130:131], v13 offset:18112
    v_mfma_f32_16x16x32_bf16 v[88:91], a[132:135], a[24:27], v[88:91]
    v_mfma_f32_16x16x32_bf16 v[92:95], a[132:135], a[28:31], v[92:95]
    s_waitcnt lgkmcnt(4)
    v_mfma_f32_16x16x32_bf16 v[96:99], a[136:139], a[16:19], v[96:99]
    ds_read_b64_tr_b16 a[132:133], v13 offset:21504
    v_mfma_f32_16x16x32_bf16 v[100:103], a[136:139], a[20:23], v[100:103]
    ds_read_b64_tr_b16 a[134:135], v13 offset:25088
    v_mfma_f32_16x16x32_bf16 v[104:107], a[136:139], a[24:27], v[104:107]
    v_mfma_f32_16x16x32_bf16 v[108:111], a[136:139], a[28:31], v[108:111]
    buffer_load_dwordx4 a[60:63], v5, s[8:11], s26 offen offset:3072
    s_add_u32 s26, s26, 4096
    s_waitcnt lgkmcnt(4)
    v_mfma_f32_16x16x32_bf16 v[112:115], a[140:143], a[16:19], v[112:115]
    ds_read_b64_tr_b16 a[136:137], v13 offset:21536
    v_mfma_f32_16x16x32_bf16 v[116:119], a[140:143], a[20:23], v[116:119]
    ds_read_b64_tr_b16 a[138:139], v13 offset:25120
    v_mfma_f32_16x16x32_bf16 v[120:123], a[140:143], a[24:27], v[120:123]
    v_mfma_f32_16x16x32_bf16 v[124:127], a[140:143], a[28:31], v[124:127]
    s_add_u32 m0, s28, 57344
    s_nop 0
    buffer_load_dwordx4 v6, s[12:15], s25 offen offset:0 lds
    s_waitcnt lgkmcnt(4)
    v_mfma_f32_16x16x32_bf16 v[128:131], a[128:131], a[16:19], v[128:131]
    ds_read_b64_tr_b16 a[140:141], v13 offset:21568
    v_mfma_f32_16x16x32_bf16 v[132:135], a[128:131], a[20:23], v[132:135]
    ds_read_b64_tr_b16 a[142:143], v13 offset:25152
    v_mfma_f32_16x16x32_bf16 v[136:139], a[128:131], a[24:27], v[136:139]
    v_mfma_f32_16x16x32_bf16 v[140:143], a[128:131], a[28:31], v[140:143]
    s_waitcnt lgkmcnt(4)
    v_mfma_f32_16x16x32_bf16 v[144:147], a[132:135], a[16:19], v[144:147]
    ds_read_b64_tr_b16 a[128:129], v13 offset:21600
    v_mfma_f32_16x16x32_bf16 v[148:151], a[132:135], a[20:23], v[148:151]
    ds_read_b64_tr_b16 a[130:131], v13 offset:25184
    v_mfma_f32_16x16x32_bf16 v[152:155], a[132:135], a[24:27], v[152:155]
    v_mfma_f32_16x16x32_bf16 v[156:159], a[132:135], a[28:31], v[156:159]
    buffer_load_dwordx4 v7, s[12:15], s25 offen offset:1024 lds
    s_waitcnt lgkmcnt(4)
    v_mfma_f32_16x16x32_bf16 v[160:163], a[136:139], a[16:19], v[160:163]
    ds_read_b64_tr_b16 a[132:133], v13 offset:21632
    v_mfma_f32_16x16x32_bf16 v[164:167], a[136:139], a[20:23], v[164:167]
    ds_read_b64_tr_b16 a[134:135], v13 offset:25216
    v_mfma_f32_16x16x32_bf16 v[168:171], a[136:139], a[24:27], v[168:171]
    v_mfma_f32_16x16x32_bf16 v[172:175], a[136:139], a[28:31], v[172:175]
    buffer_load_dwordx4 v8, s[12:15], s25 offen offset:2048 lds
    s_waitcnt lgkmcnt(4)
    v_mfma_f32_16x16x32_bf16 v[176:179], a[140:143], a[16:19], v[176:179]
    ds_read_b64_tr_b16 a[136:137], v13 offset:21664
    v_mfma_f32_16x16x32_bf16 v[180:183], a[140:143], a[20:23], v[180:183]
    ds_read_b64_tr_b16 a[138:139], v13 offset:25248
    v_mfma_f32_16x16x32_bf16 v[184:187], a[140:143], a[24:27], v[184:187]
    v_mfma_f32_16x16x32_bf16 v[188:191], a[140:143], a[28:31], v[188:191]
    s_waitcnt lgkmcnt(4)
    v_mfma_f32_16x16x32_bf16 v[192:195], a[128:131], a[16:19], v[192:195]
    ds_read_b64_tr_b16 a[140:141], v13 offset:21696
    v_mfma_f32_16x16x32_bf16 v[196:199], a[128:131], a[20:23], v[196:199]
    ds_read_b64_tr_b16 a[142:143], v13 offset:25280
    v_mfma_f32_16x16x32_bf16 v[200:203], a[128:131], a[24:27], v[200:203]
    v_mfma_f32_16x16x32_bf16 v[204:207], a[128:131], a[28:31], v[204:207]
    buffer_load_dwordx4 v9, s[12:15], s25 offen offset:3072 lds
    s_waitcnt lgkmcnt(4)
    v_mfma_f32_16x16x32_bf16 v[208:211], a[132:135], a[16:19], v[208:211]
    s_waitcnt vmcnt(12)
    s_barrier
    ds_read_b64_tr_b16 a[128:129], v13 offset:28672
    v_mfma_f32_16x16x32_bf16 v[212:215], a[132:135], a[20:23], v[212:215]
    ds_read_b64_tr_b16 a[130:131], v13 offset:32256
    v_mfma_f32_16x16x32_bf16 v[216:219], a[132:135], a[24:27], v[216:219]
    v_mfma_f32_16x16x32_bf16 v[220:223], a[132:135], a[28:31], v[220:223]
    s_add_u32 m0, s28, 61440
    s_nop 0
    buffer_load_dwordx4 v10, s[12:15], s25 offen offset:0 lds
    s_waitcnt lgkmcnt(4)
    v_mfma_f32_16x16x32_bf16 v[224:227], a[136:139], a[16:19], v[224:227]
    ds_read_b64_tr_b16 a[132:133], v13 offset:28704
    v_mfma_f32_16x16x32_bf16 v[228:231], a[136:139], a[20:23], v[228:231]
    ds_read_b64_tr_b16 a[134:135], v13 offset:32288
    v_mfma_f32_16x16x32_bf16 v[232:235], a[136:139], a[24:27], v[232:235]
    v_mfma_f32_16x16x32_bf16 v[236:239], a[136:139], a[28:31], v[236:239]
    s_waitcnt lgkmcnt(4)
    v_mfma_f32_16x16x32_bf16 v[240:243], a[140:143], a[16:19], v[240:243]
    ds_read_b64_tr_b16 a[136:137], v13 offset:28736
    v_mfma_f32_16x16x32_bf16 v[244:247], a[140:143], a[20:23], v[244:247]
    ds_read_b64_tr_b16 a[138:139], v13 offset:32320
    v_mfma_f32_16x16x32_bf16 v[248:251], a[140:143], a[24:27], v[248:251]
    v_mfma_f32_16x16x32_bf16 v[252:255], a[140:143], a[28:31], v[252:255]
    buffer_load_dwordx4 v11, s[12:15], s25 offen offset:1024 lds
    s_waitcnt vmcnt(10)
    s_waitcnt lgkmcnt(4)
    v_mfma_f32_16x16x32_bf16 v[32:35], a[128:131], a[32:35], v[32:35]
    ds_read_b64_tr_b16 a[140:141], v13 offset:28768
    v_mfma_f32_16x16x32_bf16 v[36:39], a[128:131], a[36:39], v[36:39]
    ds_read_b64_tr_b16 a[142:143], v13 offset:32352
    v_mfma_f32_16x16x32_bf16 v[40:43], a[128:131], a[40:43], v[40:43]
    v_mfma_f32_16x16x32_bf16 v[44:47], a[128:131], a[44:47], v[44:47]
    buffer_load_dwordx4 v12, s[12:15], s25 offen offset:2048 lds
    s_add_u32 s25, s25, 458752
    s_waitcnt lgkmcnt(4)
    v_mfma_f32_16x16x32_bf16 v[48:51], a[132:135], a[32:35], v[48:51]
    ds_read_b64_tr_b16 a[128:129], v13 offset:28800
    v_mfma_f32_16x16x32_bf16 v[52:55], a[132:135], a[36:39], v[52:55]
    ds_read_b64_tr_b16 a[130:131], v13 offset:32384
    v_mfma_f32_16x16x32_bf16 v[56:59], a[132:135], a[40:43], v[56:59]
    v_mfma_f32_16x16x32_bf16 v[60:63], a[132:135], a[44:47], v[60:63]
    s_waitcnt lgkmcnt(4)
    v_mfma_f32_16x16x32_bf16 v[64:67], a[136:139], a[32:35], v[64:67]
    ds_read_b64_tr_b16 a[132:133], v13 offset:28832
    v_mfma_f32_16x16x32_bf16 v[68:71], a[136:139], a[36:39], v[68:71]
    ds_read_b64_tr_b16 a[134:135], v13 offset:32416
    v_mfma_f32_16x16x32_bf16 v[72:75], a[136:139], a[40:43], v[72:75]
    v_mfma_f32_16x16x32_bf16 v[76:79], a[136:139], a[44:47], v[76:79]
    buffer_load_dword v31, v30, s[4:7], s70 offen
    s_add_u32 s70, s70, 458752
    buffer_load_dwordx4 a[64:67], v2, s[8:11], s26 offen offset:0
    s_waitcnt lgkmcnt(4)
    v_mfma_f32_16x16x32_bf16 v[80:83], a[140:143], a[32:35], v[80:83]
    ds_read_b64_tr_b16 a[136:137], v13 offset:28864
    v_mfma_f32_16x16x32_bf16 v[84:87], a[140:143], a[36:39], v[84:87]
    ds_read_b64_tr_b16 a[138:139], v13 offset:32448
    v_mfma_f32_16x16x32_bf16 v[88:91], a[140:143], a[40:43], v[88:91]
    v_mfma_f32_16x16x32_bf16 v[92:95], a[140:143], a[44:47], v[92:95]
    buffer_load_dwordx4 a[68:71], v3, s[8:11], s26 offen offset:0
    s_waitcnt lgkmcnt(4)
    v_mfma_f32_16x16x32_bf16 v[96:99], a[128:131], a[32:35], v[96:99]
    ds_read_b64_tr_b16 a[140:141], v13 offset:35840
    v_mfma_f32_16x16x32_bf16 v[100:103], a[128:131], a[36:39], v[100:103]
    ds_read_b64_tr_b16 a[142:143], v13 offset:39424
    v_mfma_f32_16x16x32_bf16 v[104:107], a[128:131], a[40:43], v[104:107]
    v_mfma_f32_16x16x32_bf16 v[108:111], a[128:131], a[44:47], v[108:111]
    s_waitcnt lgkmcnt(4)
    v_mfma_f32_16x16x32_bf16 v[112:115], a[132:135], a[32:35], v[112:115]
    ds_read_b64_tr_b16 a[128:129], v13 offset:35872
    v_mfma_f32_16x16x32_bf16 v[116:119], a[132:135], a[36:39], v[116:119]
    ds_read_b64_tr_b16 a[130:131], v13 offset:39456
    v_mfma_f32_16x16x32_bf16 v[120:123], a[132:135], a[40:43], v[120:123]
    v_mfma_f32_16x16x32_bf16 v[124:127], a[132:135], a[44:47], v[124:127]
    buffer_load_dwordx4 a[72:75], v4, s[8:11], s26 offen offset:0
    s_waitcnt lgkmcnt(4)
    v_mfma_f32_16x16x32_bf16 v[128:131], a[136:139], a[32:35], v[128:131]
    ds_read_b64_tr_b16 a[132:133], v13 offset:35904
    v_mfma_f32_16x16x32_bf16 v[132:135], a[136:139], a[36:39], v[132:135]
    ds_read_b64_tr_b16 a[134:135], v13 offset:39488
    v_mfma_f32_16x16x32_bf16 v[136:139], a[136:139], a[40:43], v[136:139]
    v_mfma_f32_16x16x32_bf16 v[140:143], a[136:139], a[44:47], v[140:143]
    buffer_load_dwordx4 a[76:79], v5, s[8:11], s26 offen offset:0
    s_waitcnt lgkmcnt(4)
    v_mfma_f32_16x16x32_bf16 v[144:147], a[140:143], a[32:35], v[144:147]
    ds_read_b64_tr_b16 a[136:137], v13 offset:35936
    v_mfma_f32_16x16x32_bf16 v[148:151], a[140:143], a[36:39], v[148:151]
    ds_read_b64_tr_b16 a[138:139], v13 offset:39520
    v_mfma_f32_16x16x32_bf16 v[152:155], a[140:143], a[40:43], v[152:155]
    v_mfma_f32_16x16x32_bf16 v[156:159], a[140:143], a[44:47], v[156:159]
    s_waitcnt lgkmcnt(4)
    v_mfma_f32_16x16x32_bf16 v[160:163], a[128:131], a[32:35], v[160:163]
    ds_read_b64_tr_b16 a[140:141], v13 offset:35968
    v_mfma_f32_16x16x32_bf16 v[164:167], a[128:131], a[36:39], v[164:167]
    ds_read_b64_tr_b16 a[142:143], v13 offset:39552
    v_mfma_f32_16x16x32_bf16 v[168:171], a[128:131], a[40:43], v[168:171]
    v_mfma_f32_16x16x32_bf16 v[172:175], a[128:131], a[44:47], v[172:175]
    buffer_load_dwordx4 a[80:83], v2, s[8:11], s26 offen offset:1024
    s_waitcnt lgkmcnt(4)
    v_mfma_f32_16x16x32_bf16 v[176:179], a[132:135], a[32:35], v[176:179]
    ds_read_b64_tr_b16 a[128:129], v13 offset:36000
    v_mfma_f32_16x16x32_bf16 v[180:183], a[132:135], a[36:39], v[180:183]
    ds_read_b64_tr_b16 a[130:131], v13 offset:39584
    v_mfma_f32_16x16x32_bf16 v[184:187], a[132:135], a[40:43], v[184:187]
    v_mfma_f32_16x16x32_bf16 v[188:191], a[132:135], a[44:47], v[188:191]
    buffer_load_dwordx4 a[84:87], v3, s[8:11], s26 offen offset:1024
    s_waitcnt lgkmcnt(4)
    v_mfma_f32_16x16x32_bf16 v[192:195], a[136:139], a[32:35], v[192:195]
    ds_read_b64_tr_b16 a[132:133], v13 offset:36032
    v_mfma_f32_16x16x32_bf16 v[196:199], a[136:139], a[36:39], v[196:199]
    ds_read_b64_tr_b16 a[134:135], v13 offset:39616
    v_mfma_f32_16x16x32_bf16 v[200:203], a[136:139], a[40:43], v[200:203]
    v_mfma_f32_16x16x32_bf16 v[204:207], a[136:139], a[44:47], v[204:207]
    s_waitcnt lgkmcnt(4)
    v_mfma_f32_16x16x32_bf16 v[208:211], a[140:143], a[32:35], v[208:211]
    ds_read_b64_tr_b16 a[136:137], v13 offset:43008
    v_mfma_f32_16x16x32_bf16 v[212:215], a[140:143], a[36:39], v[212:215]
    ds_read_b64_tr_b16 a[138:139], v13 offset:46592
    v_mfma_f32_16x16x32_bf16 v[216:219], a[140:143], a[40:43], v[216:219]
    v_mfma_f32_16x16x32_bf16 v[220:223], a[140:143], a[44:47], v[220:223]
    buffer_load_dwordx4 a[88:91], v4, s[8:11], s26 offen offset:1024
    s_waitcnt lgkmcnt(4)
    v_mfma_f32_16x16x32_bf16 v[224:227], a[128:131], a[32:35], v[224:227]
    ds_read_b64_tr_b16 a[140:141], v13 offset:43040
    v_mfma_f32_16x16x32_bf16 v[228:231], a[128:131], a[36:39], v[228:231]
    ds_read_b64_tr_b16 a[142:143], v13 offset:46624
    v_mfma_f32_16x16x32_bf16 v[232:235], a[128:131], a[40:43], v[232:235]
    v_mfma_f32_16x16x32_bf16 v[236:239], a[128:131], a[44:47], v[236:239]
    buffer_load_dwordx4 a[92:95], v5, s[8:11], s26 offen offset:1024
    s_waitcnt lgkmcnt(4)
    v_mfma_f32_16x16x32_bf16 v[240:243], a[132:135], a[32:35], v[240:243]
    ds_read_b64_tr_b16 a[128:129], v13 offset:43072
    v_mfma_f32_16x16x32_bf16 v[244:247], a[132:135], a[36:39], v[244:247]
    ds_read_b64_tr_b16 a[130:131], v13 offset:46656
    v_mfma_f32_16x16x32_bf16 v[248:251], a[132:135], a[40:43], v[248:251]
    v_mfma_f32_16x16x32_bf16 v[252:255], a[132:135], a[44:47], v[252:255]
    s_waitcnt vmcnt(16)
    s_waitcnt lgkmcnt(4)
    v_mfma_f32_16x16x32_bf16 v[32:35], a[136:139], a[48:51], v[32:35]
    ds_read_b64_tr_b16 a[132:133], v13 offset:43104
    v_mfma_f32_16x16x32_bf16 v[36:39], a[136:139], a[52:55], v[36:39]
    ds_read_b64_tr_b16 a[134:135], v13 offset:46688
    v_mfma_f32_16x16x32_bf16 v[40:43], a[136:139], a[56:59], v[40:43]
    v_mfma_f32_16x16x32_bf16 v[44:47], a[136:139], a[60:63], v[44:47]
    s_add_u32 m0, s28, 86016
    s_nop 0
    buffer_load_dwordx4 v6, s[12:15], s25 offen offset:0 lds
    s_waitcnt lgkmcnt(4)
    v_mfma_f32_16x16x32_bf16 v[48:51], a[140:143], a[48:51], v[48:51]
    ds_read_b64_tr_b16 a[136:137], v13 offset:43136
    v_mfma_f32_16x16x32_bf16 v[52:55], a[140:143], a[52:55], v[52:55]
    ds_read_b64_tr_b16 a[138:139], v13 offset:46720
    v_mfma_f32_16x16x32_bf16 v[56:59], a[140:143], a[56:59], v[56:59]
    v_mfma_f32_16x16x32_bf16 v[60:63], a[140:143], a[60:63], v[60:63]
    buffer_load_dwordx4 v7, s[12:15], s25 offen offset:1024 lds
    s_waitcnt lgkmcnt(4)
    v_mfma_f32_16x16x32_bf16 v[64:67], a[128:131], a[48:51], v[64:67]
    ds_read_b64_tr_b16 a[140:141], v13 offset:43168
    v_mfma_f32_16x16x32_bf16 v[68:71], a[128:131], a[52:55], v[68:71]
    ds_read_b64_tr_b16 a[142:143], v13 offset:46752
    v_mfma_f32_16x16x32_bf16 v[72:75], a[128:131], a[56:59], v[72:75]
    v_mfma_f32_16x16x32_bf16 v[76:79], a[128:131], a[60:63], v[76:79]
    s_waitcnt lgkmcnt(4)
    v_mfma_f32_16x16x32_bf16 v[80:83], a[132:135], a[48:51], v[80:83]
    ds_read_b64_tr_b16 a[128:129], v13 offset:43200
    v_mfma_f32_16x16x32_bf16 v[84:87], a[132:135], a[52:55], v[84:87]
    ds_read_b64_tr_b16 a[130:131], v13 offset:46784
    v_mfma_f32_16x16x32_bf16 v[88:91], a[132:135], a[56:59], v[88:91]
    v_mfma_f32_16x16x32_bf16 v[92:95], a[132:135], a[60:63], v[92:95]
    buffer_load_dwordx4 v8, s[12:15], s25 offen offset:2048 lds
    s_waitcnt lgkmcnt(4)
    v_mfma_f32_16x16x32_bf16 v[96:99], a[136:139], a[48:51], v[96:99]
    ds_read_b64_tr_b16 a[132:133], v13 offset:50176
    v_mfma_f32_16x16x32_bf16 v[100:103], a[136:139], a[52:55], v[100:103]
    ds_read_b64_tr_b16 a[134:135], v13 offset:53760
    v_mfma_f32_16x16x32_bf16 v[104:107], a[136:139], a[56:59], v[104:107]
    v_mfma_f32_16x16x32_bf16 v[108:111], a[136:139], a[60:63], v[108:111]
    buffer_load_dwordx4 v9, s[12:15], s25 offen offset:3072 lds
    s_waitcnt lgkmcnt(4)
    v_mfma_f32_16x16x32_bf16 v[112:115], a[140:143], a[48:51], v[112:115]
    ds_read_b64_tr_b16 a[136:137], v13 offset:50208
    v_mfma_f32_16x16x32_bf16 v[116:119], a[140:143], a[52:55], v[116:119]
    ds_read_b64_tr_b16 a[138:139], v13 offset:53792
    v_mfma_f32_16x16x32_bf16 v[120:123], a[140:143], a[56:59], v[120:123]
    v_mfma_f32_16x16x32_bf16 v[124:127], a[140:143], a[60:63], v[124:127]
    s_waitcnt lgkmcnt(4)
    v_mfma_f32_16x16x32_bf16 v[128:131], a[128:131], a[48:51], v[128:131]
    ds_read_b64_tr_b16 a[140:141], v13 offset:50240
    v_mfma_f32_16x16x32_bf16 v[132:135], a[128:131], a[52:55], v[132:135]
    ds_read_b64_tr_b16 a[142:143], v13 offset:53824
    v_mfma_f32_16x16x32_bf16 v[136:139], a[128:131], a[56:59], v[136:139]
    v_mfma_f32_16x16x32_bf16 v[140:143], a[128:131], a[60:63], v[140:143]
    s_add_u32 m0, s28, 90112
    s_nop 0
    buffer_load_dwordx4 v10, s[12:15], s25 offen offset:0 lds
    s_waitcnt lgkmcnt(4)
    v_mfma_f32_16x16x32_bf16 v[144:147], a[132:135], a[48:51], v[144:147]
    ds_read_b64_tr_b16 a[128:129], v13 offset:50272
    v_mfma_f32_16x16x32_bf16 v[148:151], a[132:135], a[52:55], v[148:151]
    ds_read_b64_tr_b16 a[130:131], v13 offset:53856
    v_mfma_f32_16x16x32_bf16 v[152:155], a[132:135], a[56:59], v[152:155]
    v_mfma_f32_16x16x32_bf16 v[156:159], a[132:135], a[60:63], v[156:159]
    buffer_load_dwordx4 v11, s[12:15], s25 offen offset:1024 lds
    s_waitcnt lgkmcnt(4)
    v_mfma_f32_16x16x32_bf16 v[160:163], a[136:139], a[48:51], v[160:163]
    ds_read_b64_tr_b16 a[132:133], v13 offset:50304
    v_mfma_f32_16x16x32_bf16 v[164:167], a[136:139], a[52:55], v[164:167]
    ds_read_b64_tr_b16 a[134:135], v13 offset:53888
    v_mfma_f32_16x16x32_bf16 v[168:171], a[136:139], a[56:59], v[168:171]
    v_mfma_f32_16x16x32_bf16 v[172:175], a[136:139], a[60:63], v[172:175]
    s_waitcnt lgkmcnt(4)
    v_mfma_f32_16x16x32_bf16 v[176:179], a[140:143], a[48:51], v[176:179]
    ds_read_b64_tr_b16 a[136:137], v13 offset:50336
    v_mfma_f32_16x16x32_bf16 v[180:183], a[140:143], a[52:55], v[180:183]
    ds_read_b64_tr_b16 a[138:139], v13 offset:53920
    v_mfma_f32_16x16x32_bf16 v[184:187], a[140:143], a[56:59], v[184:187]
    v_mfma_f32_16x16x32_bf16 v[188:191], a[140:143], a[60:63], v[188:191]
    buffer_load_dwordx4 v12, s[12:15], s25 offen offset:2048 lds
    s_add_u32 s25, s25, 458752
    s_waitcnt lgkmcnt(4)
    v_mfma_f32_16x16x32_bf16 v[192:195], a[128:131], a[48:51], v[192:195]
    ds_read_b64_tr_b16 a[140:141], v13 offset:50368
    v_mfma_f32_16x16x32_bf16 v[196:199], a[128:131], a[52:55], v[196:199]
    ds_read_b64_tr_b16 a[142:143], v13 offset:53952
    v_mfma_f32_16x16x32_bf16 v[200:203], a[128:131], a[56:59], v[200:203]
    v_mfma_f32_16x16x32_bf16 v[204:207], a[128:131], a[60:63], v[204:207]
    s_waitcnt lgkmcnt(4)
    v_mfma_f32_16x16x32_bf16 v[208:211], a[132:135], a[48:51], v[208:211]
    s_waitcnt vmcnt(16)
    s_barrier
    ds_read_b64_tr_b16 a[128:129], v14 offset:0
    v_mfma_f32_16x16x32_bf16 v[212:215], a[132:135], a[52:55], v[212:215]
    ds_read_b64_tr_b16 a[130:131], v14 offset:3584
    v_mfma_f32_16x16x32_bf16 v[216:219], a[132:135], a[56:59], v[216:219]
    v_mfma_f32_16x16x32_bf16 v[220:223], a[132:135], a[60:63], v[220:223]
    buffer_load_dwordx4 a[96:99], v2, s[8:11], s26 offen offset:2048
    s_waitcnt lgkmcnt(4)
    v_mfma_f32_16x16x32_bf16 v[224:227], a[136:139], a[48:51], v[224:227]
    ds_read_b64_tr_b16 a[132:133], v14 offset:32
    v_mfma_f32_16x16x32_bf16 v[228:231], a[136:139], a[52:55], v[228:231]
    ds_read_b64_tr_b16 a[134:135], v14 offset:3616
    v_mfma_f32_16x16x32_bf16 v[232:235], a[136:139], a[56:59], v[232:235]
    v_mfma_f32_16x16x32_bf16 v[236:239], a[136:139], a[60:63], v[236:239]
    buffer_load_dword v31, v30, s[4:7], s70 offen
    s_add_u32 s70, s70, 458752
    buffer_load_dwordx4 a[100:103], v3, s[8:11], s26 offen offset:2048
    s_waitcnt lgkmcnt(4)
    v_mfma_f32_16x16x32_bf16 v[240:243], a[140:143], a[48:51], v[240:243]
    ds_read_b64_tr_b16 a[136:137], v14 offset:64
    v_mfma_f32_16x16x32_bf16 v[244:247], a[140:143], a[52:55], v[244:247]
    ds_read_b64_tr_b16 a[138:139], v14 offset:3648
    v_mfma_f32_16x16x32_bf16 v[248:251], a[140:143], a[56:59], v[248:251]
    v_mfma_f32_16x16x32_bf16 v[252:255], a[140:143], a[60:63], v[252:255]
    s_waitcnt vmcnt(14)
    s_waitcnt lgkmcnt(4)
    v_mfma_f32_16x16x32_bf16 v[32:35], a[128:131], a[64:67], v[32:35]
    ds_read_b64_tr_b16 a[140:141], v14 offset:96
    v_mfma_f32_16x16x32_bf16 v[36:39], a[128:131], a[68:71], v[36:39]
    ds_read_b64_tr_b16 a[142:143], v14 offset:3680
    v_mfma_f32_16x16x32_bf16 v[40:43], a[128:131], a[72:75], v[40:43]
    v_mfma_f32_16x16x32_bf16 v[44:47], a[128:131], a[76:79], v[44:47]
    buffer_load_dwordx4 a[104:107], v4, s[8:11], s26 offen offset:2048
    s_waitcnt lgkmcnt(4)
    v_mfma_f32_16x16x32_bf16 v[48:51], a[132:135], a[64:67], v[48:51]
    ds_read_b64_tr_b16 a[128:129], v14 offset:128
    v_mfma_f32_16x16x32_bf16 v[52:55], a[132:135], a[68:71], v[52:55]
    ds_read_b64_tr_b16 a[130:131], v14 offset:3712
    v_mfma_f32_16x16x32_bf16 v[56:59], a[132:135], a[72:75], v[56:59]
    v_mfma_f32_16x16x32_bf16 v[60:63], a[132:135], a[76:79], v[60:63]
    buffer_load_dwordx4 a[108:111], v5, s[8:11], s26 offen offset:2048
    s_waitcnt lgkmcnt(4)
    v_mfma_f32_16x16x32_bf16 v[64:67], a[136:139], a[64:67], v[64:67]
    ds_read_b64_tr_b16 a[132:133], v14 offset:160
    v_mfma_f32_16x16x32_bf16 v[68:71], a[136:139], a[68:71], v[68:71]
    ds_read_b64_tr_b16 a[134:135], v14 offset:3744
    v_mfma_f32_16x16x32_bf16 v[72:75], a[136:139], a[72:75], v[72:75]
    v_mfma_f32_16x16x32_bf16 v[76:79], a[136:139], a[76:79], v[76:79]
    s_waitcnt lgkmcnt(4)
    v_mfma_f32_16x16x32_bf16 v[80:83], a[140:143], a[64:67], v[80:83]
    ds_read_b64_tr_b16 a[136:137], v14 offset:192
    v_mfma_f32_16x16x32_bf16 v[84:87], a[140:143], a[68:71], v[84:87]
    ds_read_b64_tr_b16 a[138:139], v14 offset:3776
    v_mfma_f32_16x16x32_bf16 v[88:91], a[140:143], a[72:75], v[88:91]
    v_mfma_f32_16x16x32_bf16 v[92:95], a[140:143], a[76:79], v[92:95]
    buffer_load_dwordx4 a[112:115], v2, s[8:11], s26 offen offset:3072
    s_waitcnt lgkmcnt(4)
    v_mfma_f32_16x16x32_bf16 v[96:99], a[128:131], a[64:67], v[96:99]
    ds_read_b64_tr_b16 a[140:141], v14 offset:7168
    v_mfma_f32_16x16x32_bf16 v[100:103], a[128:131], a[68:71], v[100:103]
    ds_read_b64_tr_b16 a[142:143], v14 offset:10752
    v_mfma_f32_16x16x32_bf16 v[104:107], a[128:131], a[72:75], v[104:107]
    v_mfma_f32_16x16x32_bf16 v[108:111], a[128:131], a[76:79], v[108:111]
    buffer_load_dwordx4 a[116:119], v3, s[8:11], s26 offen offset:3072
    s_waitcnt lgkmcnt(4)
    v_mfma_f32_16x16x32_bf16 v[112:115], a[132:135], a[64:67], v[112:115]
    ds_read_b64_tr_b16 a[128:129], v14 offset:7200
    v_mfma_f32_16x16x32_bf16 v[116:119], a[132:135], a[68:71], v[116:119]
    ds_read_b64_tr_b16 a[130:131], v14 offset:10784
    v_mfma_f32_16x16x32_bf16 v[120:123], a[132:135], a[72:75], v[120:123]
    v_mfma_f32_16x16x32_bf16 v[124:127], a[132:135], a[76:79], v[124:127]
    s_waitcnt lgkmcnt(4)
    v_mfma_f32_16x16x32_bf16 v[128:131], a[136:139], a[64:67], v[128:131]
    ds_read_b64_tr_b16 a[132:133], v14 offset:7232
    v_mfma_f32_16x16x32_bf16 v[132:135], a[136:139], a[68:71], v[132:135]
    ds_read_b64_tr_b16 a[134:135], v14 offset:10816
    v_mfma_f32_16x16x32_bf16 v[136:139], a[136:139], a[72:75], v[136:139]
    v_mfma_f32_16x16x32_bf16 v[140:143], a[136:139], a[76:79], v[140:143]
    buffer_load_dwordx4 a[120:123], v4, s[8:11], s26 offen offset:3072
    s_waitcnt lgkmcnt(4)
    v_mfma_f32_16x16x32_bf16 v[144:147], a[140:143], a[64:67], v[144:147]
    ds_read_b64_tr_b16 a[136:137], v14 offset:7264
    v_mfma_f32_16x16x32_bf16 v[148:151], a[140:143], a[68:71], v[148:151]
    ds_read_b64_tr_b16 a[138:139], v14 offset:10848
    v_mfma_f32_16x16x32_bf16 v[152:155], a[140:143], a[72:75], v[152:155]
    v_mfma_f32_16x16x32_bf16 v[156:159], a[140:143], a[76:79], v[156:159]
    buffer_load_dwordx4 a[124:127], v5, s[8:11], s26 offen offset:3072
    s_add_u32 s26, s26, 4096
    s_waitcnt lgkmcnt(4)
    v_mfma_f32_16x16x32_bf16 v[160:163], a[128:131], a[64:67], v[160:163]
    ds_read_b64_tr_b16 a[140:141], v14 offset:7296
    v_mfma_f32_16x16x32_bf16 v[164:167], a[128:131], a[68:71], v[164:167]
    ds_read_b64_tr_b16 a[142:143], v14 offset:10880
    v_mfma_f32_16x16x32_bf16 v[168:171], a[128:131], a[72:75], v[168:171]
    v_mfma_f32_16x16x32_bf16 v[172:175], a[128:131], a[76:79], v[172:175]
    s_waitcnt lgkmcnt(4)
    v_mfma_f32_16x16x32_bf16 v[176:179], a[132:135], a[64:67], v[176:179]
    ds_read_b64_tr_b16 a[128:129], v14 offset:7328
    v_mfma_f32_16x16x32_bf16 v[180:183], a[132:135], a[68:71], v[180:183]
    ds_read_b64_tr_b16 a[130:131], v14 offset:10912
    v_mfma_f32_16x16x32_bf16 v[184:187], a[132:135], a[72:75], v[184:187]
    v_mfma_f32_16x16x32_bf16 v[188:191], a[132:135], a[76:79], v[188:191]
    s_add_u32 m0, s28, 114688
    s_nop 0
    buffer_load_dwordx4 v6, s[12:15], s25 offen offset:0 lds
    s_waitcnt lgkmcnt(4)
    v_mfma_f32_16x16x32_bf16 v[192:195], a[136:139], a[64:67], v[192:195]
    ds_read_b64_tr_b16 a[132:133], v14 offset:7360
    v_mfma_f32_16x16x32_bf16 v[196:199], a[136:139], a[68:71], v[196:199]
    ds_read_b64_tr_b16 a[134:135], v14 offset:10944
    v_mfma_f32_16x16x32_bf16 v[200:203], a[136:139], a[72:75], v[200:203]
    v_mfma_f32_16x16x32_bf16 v[204:207], a[136:139], a[76:79], v[204:207]
    buffer_load_dwordx4 v7, s[12:15], s25 offen offset:1024 lds
    s_waitcnt lgkmcnt(4)
    v_mfma_f32_16x16x32_bf16 v[208:211], a[140:143], a[64:67], v[208:211]
    ds_read_b64_tr_b16 a[136:137], v14 offset:14336
    v_mfma_f32_16x16x32_bf16 v[212:215], a[140:143], a[68:71], v[212:215]
    ds_read_b64_tr_b16 a[138:139], v14 offset:17920
    v_mfma_f32_16x16x32_bf16 v[216:219], a[140:143], a[72:75], v[216:219]
    v_mfma_f32_16x16x32_bf16 v[220:223], a[140:143], a[76:79], v[220:223]
    s_waitcnt lgkmcnt(4)
    v_mfma_f32_16x16x32_bf16 v[224:227], a[128:131], a[64:67], v[224:227]
    ds_read_b64_tr_b16 a[140:141], v14 offset:14368
    v_mfma_f32_16x16x32_bf16 v[228:231], a[128:131], a[68:71], v[228:231]
    ds_read_b64_tr_b16 a[142:143], v14 offset:17952
    v_mfma_f32_16x16x32_bf16 v[232:235], a[128:131], a[72:75], v[232:235]
    v_mfma_f32_16x16x32_bf16 v[236:239], a[128:131], a[76:79], v[236:239]
    buffer_load_dwordx4 v8, s[12:15], s25 offen offset:2048 lds
    s_waitcnt lgkmcnt(4)
    v_mfma_f32_16x16x32_bf16 v[240:243], a[132:135], a[64:67], v[240:243]
    ds_read_b64_tr_b16 a[128:129], v14 offset:14400
    v_mfma_f32_16x16x32_bf16 v[244:247], a[132:135], a[68:71], v[244:247]
    ds_read_b64_tr_b16 a[130:131], v14 offset:17984
    v_mfma_f32_16x16x32_bf16 v[248:251], a[132:135], a[72:75], v[248:251]
    v_mfma_f32_16x16x32_bf16 v[252:255], a[132:135], a[76:79], v[252:255]
    buffer_load_dwordx4 v9, s[12:15], s25 offen offset:3072 lds
    s_waitcnt vmcnt(20)
    s_waitcnt lgkmcnt(4)
    v_mfma_f32_16x16x32_bf16 v[32:35], a[136:139], a[80:83], v[32:35]
    ds_read_b64_tr_b16 a[132:133], v14 offset:14432
    v_mfma_f32_16x16x32_bf16 v[36:39], a[136:139], a[84:87], v[36:39]
    ds_read_b64_tr_b16 a[134:135], v14 offset:18016
    v_mfma_f32_16x16x32_bf16 v[40:43], a[136:139], a[88:91], v[40:43]
    v_mfma_f32_16x16x32_bf16 v[44:47], a[136:139], a[92:95], v[44:47]
    s_waitcnt lgkmcnt(4)
    v_mfma_f32_16x16x32_bf16 v[48:51], a[140:143], a[80:83], v[48:51]
    ds_read_b64_tr_b16 a[136:137], v14 offset:14464
    v_mfma_f32_16x16x32_bf16 v[52:55], a[140:143], a[84:87], v[52:55]
    ds_read_b64_tr_b16 a[138:139], v14 offset:18048
    v_mfma_f32_16x16x32_bf16 v[56:59], a[140:143], a[88:91], v[56:59]
    v_mfma_f32_16x16x32_bf16 v[60:63], a[140:143], a[92:95], v[60:63]
    s_add_u32 m0, s28, 118784
    s_nop 0
    buffer_load_dwordx4 v10, s[12:15], s25 offen offset:0 lds
    s_waitcnt lgkmcnt(4)
    v_mfma_f32_16x16x32_bf16 v[64:67], a[128:131], a[80:83], v[64:67]
    ds_read_b64_tr_b16 a[140:141], v14 offset:14496
    v_mfma_f32_16x16x32_bf16 v[68:71], a[128:131], a[84:87], v[68:71]
    ds_read_b64_tr_b16 a[142:143], v14 offset:18080
    v_mfma_f32_16x16x32_bf16 v[72:75], a[128:131], a[88:91], v[72:75]
    v_mfma_f32_16x16x32_bf16 v[76:79], a[128:131], a[92:95], v[76:79]
    buffer_load_dwordx4 v11, s[12:15], s25 offen offset:1024 lds
    s_waitcnt lgkmcnt(4)
    v_mfma_f32_16x16x32_bf16 v[80:83], a[132:135], a[80:83], v[80:83]
    ds_read_b64_tr_b16 a[128:129], v14 offset:14528
    v_mfma_f32_16x16x32_bf16 v[84:87], a[132:135], a[84:87], v[84:87]
    ds_read_b64_tr_b16 a[130:131], v14 offset:18112
    v_mfma_f32_16x16x32_bf16 v[88:91], a[132:135], a[88:91], v[88:91]
    v_mfma_f32_16x16x32_bf16 v[92:95], a[132:135], a[92:95], v[92:95]
    s_waitcnt lgkmcnt(4)
    v_mfma_f32_16x16x32_bf16 v[96:99], a[136:139], a[80:83], v[96:99]
    ds_read_b64_tr_b16 a[132:133], v14 offset:21504
    v_mfma_f32_16x16x32_bf16 v[100:103], a[136:139], a[84:87], v[100:103]
    ds_read_b64_tr_b16 a[134:135], v14 offset:25088
    v_mfma_f32_16x16x32_bf16 v[104:107], a[136:139], a[88:91], v[104:107]
    v_mfma_f32_16x16x32_bf16 v[108:111], a[136:139], a[92:95], v[108:111]
    buffer_load_dwordx4 v12, s[12:15], s25 offen offset:2048 lds
    s_add_u32 s25, s25, 458752
    s_waitcnt lgkmcnt(4)
    v_mfma_f32_16x16x32_bf16 v[112:115], a[140:143], a[80:83], v[112:115]
    ds_read_b64_tr_b16 a[136:137], v14 offset:21536
    v_mfma_f32_16x16x32_bf16 v[116:119], a[140:143], a[84:87], v[116:119]
    ds_read_b64_tr_b16 a[138:139], v14 offset:25120
    v_mfma_f32_16x16x32_bf16 v[120:123], a[140:143], a[88:91], v[120:123]
    v_mfma_f32_16x16x32_bf16 v[124:127], a[140:143], a[92:95], v[124:127]
    buffer_load_dwordx4 a[0:3], v2, s[8:11], s26 offen offset:0
    s_waitcnt lgkmcnt(4)
    v_mfma_f32_16x16x32_bf16 v[128:131], a[128:131], a[80:83], v[128:131]
    ds_read_b64_tr_b16 a[140:141], v14 offset:21568
    v_mfma_f32_16x16x32_bf16 v[132:135], a[128:131], a[84:87], v[132:135]
    ds_read_b64_tr_b16 a[142:143], v14 offset:25152
    v_mfma_f32_16x16x32_bf16 v[136:139], a[128:131], a[88:91], v[136:139]
    v_mfma_f32_16x16x32_bf16 v[140:143], a[128:131], a[92:95], v[140:143]
    s_waitcnt lgkmcnt(4)
    v_mfma_f32_16x16x32_bf16 v[144:147], a[132:135], a[80:83], v[144:147]
    ds_read_b64_tr_b16 a[128:129], v14 offset:21600
    v_mfma_f32_16x16x32_bf16 v[148:151], a[132:135], a[84:87], v[148:151]
    ds_read_b64_tr_b16 a[130:131], v14 offset:25184
    v_mfma_f32_16x16x32_bf16 v[152:155], a[132:135], a[88:91], v[152:155]
    v_mfma_f32_16x16x32_bf16 v[156:159], a[132:135], a[92:95], v[156:159]
    buffer_load_dwordx4 a[4:7], v3, s[8:11], s26 offen offset:0
    s_waitcnt lgkmcnt(4)
    v_mfma_f32_16x16x32_bf16 v[160:163], a[136:139], a[80:83], v[160:163]
    ds_read_b64_tr_b16 a[132:133], v14 offset:21632
    v_mfma_f32_16x16x32_bf16 v[164:167], a[136:139], a[84:87], v[164:167]
    ds_read_b64_tr_b16 a[134:135], v14 offset:25216
    v_mfma_f32_16x16x32_bf16 v[168:171], a[136:139], a[88:91], v[168:171]
    v_mfma_f32_16x16x32_bf16 v[172:175], a[136:139], a[92:95], v[172:175]
    buffer_load_dword v31, v30, s[4:7], s70 offen
    s_add_u32 s70, s70, 458752
    buffer_load_dwordx4 a[8:11], v4, s[8:11], s26 offen offset:0
    s_waitcnt lgkmcnt(4)
    v_mfma_f32_16x16x32_bf16 v[176:179], a[140:143], a[80:83], v[176:179]
    ds_read_b64_tr_b16 a[136:137], v14 offset:21664
    v_mfma_f32_16x16x32_bf16 v[180:183], a[140:143], a[84:87], v[180:183]
    ds_read_b64_tr_b16 a[138:139], v14 offset:25248
    v_mfma_f32_16x16x32_bf16 v[184:187], a[140:143], a[88:91], v[184:187]
    v_mfma_f32_16x16x32_bf16 v[188:191], a[140:143], a[92:95], v[188:191]
    s_waitcnt lgkmcnt(4)
    v_mfma_f32_16x16x32_bf16 v[192:195], a[128:131], a[80:83], v[192:195]
    ds_read_b64_tr_b16 a[140:141], v14 offset:21696
    v_mfma_f32_16x16x32_bf16 v[196:199], a[128:131], a[84:87], v[196:199]
    ds_read_b64_tr_b16 a[142:143], v14 offset:25280
    v_mfma_f32_16x16x32_bf16 v[200:203], a[128:131], a[88:91], v[200:203]
    v_mfma_f32_16x16x32_bf16 v[204:207], a[128:131], a[92:95], v[204:207]
    buffer_load_dwordx4 a[12:15], v5, s[8:11], s26 offen offset:0
    s_waitcnt lgkmcnt(4)
    v_mfma_f32_16x16x32_bf16 v[208:211], a[132:135], a[80:83], v[208:211]
    s_waitcnt vmcnt(21)
    s_barrier
    ds_read_b64_tr_b16 a[128:129], v14 offset:28672
    v_mfma_f32_16x16x32_bf16 v[212:215], a[132:135], a[84:87], v[212:215]
    ds_read_b64_tr_b16 a[130:131], v14 offset:32256
    v_mfma_f32_16x16x32_bf16 v[216:219], a[132:135], a[88:91], v[216:219]
    v_mfma_f32_16x16x32_bf16 v[220:223], a[132:135], a[92:95], v[220:223]
    buffer_load_dwordx4 a[16:19], v2, s[8:11], s26 offen offset:1024
    s_waitcnt lgkmcnt(4)
    v_mfma_f32_16x16x32_bf16 v[224:227], a[136:139], a[80:83], v[224:227]
    ds_read_b64_tr_b16 a[132:133], v14 offset:28704
    v_mfma_f32_16x16x32_bf16 v[228:231], a[136:139], a[84:87], v[228:231]
    ds_read_b64_tr_b16 a[134:135], v14 offset:32288
    v_mfma_f32_16x16x32_bf16 v[232:235], a[136:139], a[88:91], v[232:235]
    v_mfma_f32_16x16x32_bf16 v[236:239], a[136:139], a[92:95], v[236:239]
    s_waitcnt lgkmcnt(4)
    v_mfma_f32_16x16x32_bf16 v[240:243], a[140:143], a[80:83], v[240:243]
    ds_read_b64_tr_b16 a[136:137], v14 offset:28736
    v_mfma_f32_16x16x32_bf16 v[244:247], a[140:143], a[84:87], v[244:247]
    ds_read_b64_tr_b16 a[138:139], v14 offset:32320
    v_mfma_f32_16x16x32_bf16 v[248:251], a[140:143], a[88:91], v[248:251]
    v_mfma_f32_16x16x32_bf16 v[252:255], a[140:143], a[92:95], v[252:255]
    buffer_load_dwordx4 a[20:23], v3, s[8:11], s26 offen offset:1024
    s_waitcnt vmcnt(18)
    s_waitcnt lgkmcnt(4)
    v_mfma_f32_16x16x32_bf16 v[32:35], a[128:131], a[96:99], v[32:35]
    ds_read_b64_tr_b16 a[140:141], v14 offset:28768
    v_mfma_f32_16x16x32_bf16 v[36:39], a[128:131], a[100:103], v[36:39]
    ds_read_b64_tr_b16 a[142:143], v14 offset:32352
    v_mfma_f32_16x16x32_bf16 v[40:43], a[128:131], a[104:107], v[40:43]
    v_mfma_f32_16x16x32_bf16 v[44:47], a[128:131], a[108:111], v[44:47]
    buffer_load_dwordx4 a[24:27], v4, s[8:11], s26 offen offset:1024
    s_waitcnt lgkmcnt(4)
    v_mfma_f32_16x16x32_bf16 v[48:51], a[132:135], a[96:99], v[48:51]
    ds_read_b64_tr_b16 a[128:129], v14 offset:28800
    v_mfma_f32_16x16x32_bf16 v[52:55], a[132:135], a[100:103], v[52:55]
    ds_read_b64_tr_b16 a[130:131], v14 offset:32384
    v_mfma_f32_16x16x32_bf16 v[56:59], a[132:135], a[104:107], v[56:59]
    v_mfma_f32_16x16x32_bf16 v[60:63], a[132:135], a[108:111], v[60:63]
    s_waitcnt lgkmcnt(4)
    v_mfma_f32_16x16x32_bf16 v[64:67], a[136:139], a[96:99], v[64:67]
    ds_read_b64_tr_b16 a[132:133], v14 offset:28832
    v_mfma_f32_16x16x32_bf16 v[68:71], a[136:139], a[100:103], v[68:71]
    ds_read_b64_tr_b16 a[134:135], v14 offset:32416
    v_mfma_f32_16x16x32_bf16 v[72:75], a[136:139], a[104:107], v[72:75]
    v_mfma_f32_16x16x32_bf16 v[76:79], a[136:139], a[108:111], v[76:79]
    buffer_load_dwordx4 a[28:31], v5, s[8:11], s26 offen offset:1024
    s_waitcnt lgkmcnt(4)
    v_mfma_f32_16x16x32_bf16 v[80:83], a[140:143], a[96:99], v[80:83]
    ds_read_b64_tr_b16 a[136:137], v14 offset:28864
    v_mfma_f32_16x16x32_bf16 v[84:87], a[140:143], a[100:103], v[84:87]
    ds_read_b64_tr_b16 a[138:139], v14 offset:32448
    v_mfma_f32_16x16x32_bf16 v[88:91], a[140:143], a[104:107], v[88:91]
    v_mfma_f32_16x16x32_bf16 v[92:95], a[140:143], a[108:111], v[92:95]
    s_add_u32 m0, s28, 0
    s_nop 0
    buffer_load_dwordx4 v6, s[12:15], s25 offen offset:0 lds
    s_waitcnt lgkmcnt(4)
    v_mfma_f32_16x16x32_bf16 v[96:99], a[128:131], a[96:99], v[96:99]
    ds_read_b64_tr_b16 a[140:141], v14 offset:35840
    v_mfma_f32_16x16x32_bf16 v[100:103], a[128:131], a[100:103], v[100:103]
    ds_read_b64_tr_b16 a[142:143], v14 offset:39424
    v_mfma_f32_16x16x32_bf16 v[104:107], a[128:131], a[104:107], v[104:107]
    v_mfma_f32_16x16x32_bf16 v[108:111], a[128:131], a[108:111], v[108:111]
    s_waitcnt lgkmcnt(4)
    v_mfma_f32_16x16x32_bf16 v[112:115], a[132:135], a[96:99], v[112:115]
    ds_read_b64_tr_b16 a[128:129], v14 offset:35872
    v_mfma_f32_16x16x32_bf16 v[116:119], a[132:135], a[100:103], v[116:119]
    ds_read_b64_tr_b16 a[130:131], v14 offset:39456
    v_mfma_f32_16x16x32_bf16 v[120:123], a[132:135], a[104:107], v[120:123]
    v_mfma_f32_16x16x32_bf16 v[124:127], a[132:135], a[108:111], v[124:127]
    buffer_load_dwordx4 v7, s[12:15], s25 offen offset:1024 lds
    s_waitcnt lgkmcnt(4)
    v_mfma_f32_16x16x32_bf16 v[128:131], a[136:139], a[96:99], v[128:131]
    ds_read_b64_tr_b16 a[132:133], v14 offset:35904
    v_mfma_f32_16x16x32_bf16 v[132:135], a[136:139], a[100:103], v[132:135]
    ds_read_b64_tr_b16 a[134:135], v14 offset:39488
    v_mfma_f32_16x16x32_bf16 v[136:139], a[136:139], a[104:107], v[136:139]
    v_mfma_f32_16x16x32_bf16 v[140:143], a[136:139], a[108:111], v[140:143]
    buffer_load_dwordx4 v8, s[12:15], s25 offen offset:2048 lds
    s_waitcnt lgkmcnt(4)
    v_mfma_f32_16x16x32_bf16 v[144:147], a[140:143], a[96:99], v[144:147]
    ds_read_b64_tr_b16 a[136:137], v14 offset:35936
    v_mfma_f32_16x16x32_bf16 v[148:151], a[140:143], a[100:103], v[148:151]
    ds_read_b64_tr_b16 a[138:139], v14 offset:39520
    v_mfma_f32_16x16x32_bf16 v[152:155], a[140:143], a[104:107], v[152:155]
    v_mfma_f32_16x16x32_bf16 v[156:159], a[140:143], a[108:111], v[156:159]
    s_waitcnt lgkmcnt(4)
    v_mfma_f32_16x16x32_bf16 v[160:163], a[128:131], a[96:99], v[160:163]
    ds_read_b64_tr_b16 a[140:141], v14 offset:35968
    v_mfma_f32_16x16x32_bf16 v[164:167], a[128:131], a[100:103], v[164:167]
    ds_read_b64_tr_b16 a[142:143], v14 offset:39552
    v_mfma_f32_16x16x32_bf16 v[168:171], a[128:131], a[104:107], v[168:171]
    v_mfma_f32_16x16x32_bf16 v[172:175], a[128:131], a[108:111], v[172:175]
    buffer_load_dwordx4 v9, s[12:15], s25 offen offset:3072 lds
    s_waitcnt lgkmcnt(4)
    v_mfma_f32_16x16x32_bf16 v[176:179], a[132:135], a[96:99], v[176:179]
    ds_read_b64_tr_b16 a[128:129], v14 offset:36000
    v_mfma_f32_16x16x32_bf16 v[180:183], a[132:135], a[100:103], v[180:183]
    ds_read_b64_tr_b16 a[130:131], v14 offset:39584
    v_mfma_f32_16x16x32_bf16 v[184:187], a[132:135], a[104:107], v[184:187]
    v_mfma_f32_16x16x32_bf16 v[188:191], a[132:135], a[108:111], v[188:191]
    s_add_u32 m0, s28, 4096
    s_nop 0
    buffer_load_dwordx4 v10, s[12:15], s25 offen offset:0 lds
    s_waitcnt lgkmcnt(4)
    v_mfma_f32_16x16x32_bf16 v[192:195], a[136:139], a[96:99], v[192:195]
    ds_read_b64_tr_b16 a[132:133], v14 offset:36032
    v_mfma_f32_16x16x32_bf16 v[196:199], a[136:139], a[100:103], v[196:199]
    ds_read_b64_tr_b16 a[134:135], v14 offset:39616
    v_mfma_f32_16x16x32_bf16 v[200:203], a[136:139], a[104:107], v[200:203]
    v_mfma_f32_16x16x32_bf16 v[204:207], a[136:139], a[108:111], v[204:207]
    s_waitcnt lgkmcnt(4)
    v_mfma_f32_16x16x32_bf16 v[208:211], a[140:143], a[96:99], v[208:211]
    ds_read_b64_tr_b16 a[136:137], v14 offset:43008
    v_mfma_f32_16x16x32_bf16 v[212:215], a[140:143], a[100:103], v[212:215]
    ds_read_b64_tr_b16 a[138:139], v14 offset:46592
    v_mfma_f32_16x16x32_bf16 v[216:219], a[140:143], a[104:107], v[216:219]
    v_mfma_f32_16x16x32_bf16 v[220:223], a[140:143], a[108:111], v[220:223]
    buffer_load_dwordx4 v11, s[12:15], s25 offen offset:1024 lds
    s_waitcnt lgkmcnt(4)
    v_mfma_f32_16x16x32_bf16 v[224:227], a[128:131], a[96:99], v[224:227]
    ds_read_b64_tr_b16 a[140:141], v14 offset:43040
    v_mfma_f32_16x16x32_bf16 v[228:231], a[128:131], a[100:103], v[228:231]
    ds_read_b64_tr_b16 a[142:143], v14 offset:46624
    v_mfma_f32_16x16x32_bf16 v[232:235], a[128:131], a[104:107], v[232:235]
    v_mfma_f32_16x16x32_bf16 v[236:239], a[128:131], a[108:111], v[236:239]
    buffer_load_dwordx4 v12, s[12:15], s25 offen offset:2048 lds
    s_add_u32 s25, s25, 458752
    s_waitcnt lgkmcnt(4)
    v_mfma_f32_16x16x32_bf16 v[240:243], a[132:135], a[96:99], v[240:243]
    ds_read_b64_tr_b16 a[128:129], v14 offset:43072
    v_mfma_f32_16x16x32_bf16 v[244:247], a[132:135], a[100:103], v[244:247]
    ds_read_b64_tr_b16 a[130:131], v14 offset:46656
    v_mfma_f32_16x16x32_bf16 v[248:251], a[132:135], a[104:107], v[248:251]
    v_mfma_f32_16x16x32_bf16 v[252:255], a[132:135], a[108:111], v[252:255]
    s_waitcnt vmcnt(23)
    s_waitcnt lgkmcnt(4)
    v_mfma_f32_16x16x32_bf16 v[32:35], a[136:139], a[112:115], v[32:35]
    ds_read_b64_tr_b16 a[132:133], v14 offset:43104
    v_mfma_f32_16x16x32_bf16 v[36:39], a[136:139], a[116:119], v[36:39]
    ds_read_b64_tr_b16 a[134:135], v14 offset:46688
    v_mfma_f32_16x16x32_bf16 v[40:43], a[136:139], a[120:123], v[40:43]
    v_mfma_f32_16x16x32_bf16 v[44:47], a[136:139], a[124:127], v[44:47]
    buffer_load_dwordx4 a[32:35], v2, s[8:11], s26 offen offset:2048
    s_waitcnt lgkmcnt(4)
    v_mfma_f32_16x16x32_bf16 v[48:51], a[140:143], a[112:115], v[48:51]
    ds_read_b64_tr_b16 a[136:137], v14 offset:43136
    v_mfma_f32_16x16x32_bf16 v[52:55], a[140:143], a[116:119], v[52:55]
    ds_read_b64_tr_b16 a[138:139], v14 offset:46720
    v_mfma_f32_16x16x32_bf16 v[56:59], a[140:143], a[120:123], v[56:59]
    v_mfma_f32_16x16x32_bf16 v[60:63], a[140:143], a[124:127], v[60:63]
    buffer_load_dwordx4 a[36:39], v3, s[8:11], s26 offen offset:2048
    s_waitcnt lgkmcnt(4)
    v_mfma_f32_16x16x32_bf16 v[64:67], a[128:131], a[112:115], v[64:67]
    ds_read_b64_tr_b16 a[140:141], v14 offset:43168
    v_mfma_f32_16x16x32_bf16 v[68:71], a[128:131], a[116:119], v[68:71]
    ds_read_b64_tr_b16 a[142:143], v14 offset:46752
    v_mfma_f32_16x16x32_bf16 v[72:75], a[128:131], a[120:123], v[72:75]
    v_mfma_f32_16x16x32_bf16 v[76:79], a[128:131], a[124:127], v[76:79]
    s_waitcnt lgkmcnt(4)
    v_mfma_f32_16x16x32_bf16 v[80:83], a[132:135], a[112:115], v[80:83]
    ds_read_b64_tr_b16 a[128:129], v14 offset:43200
    v_mfma_f32_16x16x32_bf16 v[84:87], a[132:135], a[116:119], v[84:87]
    ds_read_b64_tr_b16 a[130:131], v14 offset:46784
    v_mfma_f32_16x16x32_bf16 v[88:91], a[132:135], a[120:123], v[88:91]
    v_mfma_f32_16x16x32_bf16 v[92:95], a[132:135], a[124:127], v[92:95]
    buffer_load_dwordx4 a[40:43], v4, s[8:11], s26 offen offset:2048
    s_waitcnt lgkmcnt(4)
    v_mfma_f32_16x16x32_bf16 v[96:99], a[136:139], a[112:115], v[96:99]
    ds_read_b64_tr_b16 a[132:133], v14 offset:50176
    v_mfma_f32_16x16x32_bf16 v[100:103], a[136:139], a[116:119], v[100:103]
    ds_read_b64_tr_b16 a[134:135], v14 offset:53760
    v_mfma_f32_16x16x32_bf16 v[104:107], a[136:139], a[120:123], v[104:107]
    v_mfma_f32_16x16x32_bf16 v[108:111], a[136:139], a[124:127], v[108:111]
    buffer_load_dword v31, v30, s[4:7], s70 offen
    s_add_u32 s70, s70, 458752
    s_waitcnt lgkmcnt(4)
    v_mfma_f32_16x16x32_bf16 v[112:115], a[140:143], a[112:115], v[112:115]
    ds_read_b64_tr_b16 a[136:137], v14 offset:50208
    v_mfma_f32_16x16x32_bf16 v[116:119], a[140:143], a[116:119], v[116:119]
    ds_read_b64_tr_b16 a[138:139], v14 offset:53792
    v_mfma_f32_16x16x32_bf16 v[120:123], a[140:143], a[120:123], v[120:123]
    v_mfma_f32_16x16x32_bf16 v[124:127], a[140:143], a[124:127], v[124:127]
    buffer_load_dwordx4 a[44:47], v5, s[8:11], s26 offen offset:2048
    s_waitcnt lgkmcnt(4)
    v_mfma_f32_16x16x32_bf16 v[128:131], a[128:131], a[112:115], v[128:131]
    ds_read_b64_tr_b16 a[140:141], v14 offset:50240
    v_mfma_f32_16x16x32_bf16 v[132:135], a[128:131], a[116:119], v[132:135]
    ds_read_b64_tr_b16 a[142:143], v14 offset:53824
    v_mfma_f32_16x16x32_bf16 v[136:139], a[128:131], a[120:123], v[136:139]
    v_mfma_f32_16x16x32_bf16 v[140:143], a[128:131], a[124:127], v[140:143]
    buffer_load_dwordx4 a[48:51], v2, s[8:11], s26 offen offset:3072
    s_waitcnt lgkmcnt(4)
    v_mfma_f32_16x16x32_bf16 v[144:147], a[132:135], a[112:115], v[144:147]
    ds_read_b64_tr_b16 a[128:129], v14 offset:50272
    v_mfma_f32_16x16x32_bf16 v[148:151], a[132:135], a[116:119], v[148:151]
    ds_read_b64_tr_b16 a[130:131], v14 offset:53856
    v_mfma_f32_16x16x32_bf16 v[152:155], a[132:135], a[120:123], v[152:155]
    v_mfma_f32_16x16x32_bf16 v[156:159], a[132:135], a[124:127], v[156:159]
    s_waitcnt lgkmcnt(4)
    v_mfma_f32_16x16x32_bf16 v[160:163], a[136:139], a[112:115], v[160:163]
    ds_read_b64_tr_b16 a[132:133], v14 offset:50304
    v_mfma_f32_16x16x32_bf16 v[164:167], a[136:139], a[116:119], v[164:167]
    ds_read_b64_tr_b16 a[134:135], v14 offset:53888
    v_mfma_f32_16x16x32_bf16 v[168:171], a[136:139], a[120:123], v[168:171]
    v_mfma_f32_16x16x32_bf16 v[172:175], a[136:139], a[124:127], v[172:175]
    buffer_load_dwordx4 a[52:55], v3, s[8:11], s26 offen offset:3072
    s_waitcnt lgkmcnt(4)
    v_mfma_f32_16x16x32_bf16 v[176:179], a[140:143], a[112:115], v[176:179]
    ds_read_b64_tr_b16 a[136:137], v14 offset:50336
    v_mfma_f32_16x16x32_bf16 v[180:183], a[140:143], a[116:119], v[180:183]
    ds_read_b64_tr_b16 a[138:139], v14 offset:53920
    v_mfma_f32_16x16x32_bf16 v[184:187], a[140:143], a[120:123], v[184:187]
    v_mfma_f32_16x16x32_bf16 v[188:191], a[140:143], a[124:127], v[188:191]
    buffer_load_dwordx4 a[56:59], v4, s[8:11], s26 offen offset:3072
    s_waitcnt lgkmcnt(4)
    v_mfma_f32_16x16x32_bf16 v[192:195], a[128:131], a[112:115], v[192:195]
    ds_read_b64_tr_b16 a[140:141], v14 offset:50368
    v_mfma_f32_16x16x32_bf16 v[196:199], a[128:131], a[116:119], v[196:199]
    ds_read_b64_tr_b16 a[142:143], v14 offset:53952
    v_mfma_f32_16x16x32_bf16 v[200:203], a[128:131], a[120:123], v[200:203]
    v_mfma_f32_16x16x32_bf16 v[204:207], a[128:131], a[124:127], v[204:207]
    s_waitcnt lgkmcnt(4)
    v_mfma_f32_16x16x32_bf16 v[208:211], a[132:135], a[112:115], v[208:211]
    s_waitcnt vmcnt(24)
    s_barrier
    ds_read_b64_tr_b16 a[128:129], v15 offset:0
    v_mfma_f32_16x16x32_bf16 v[212:215], a[132:135], a[116:119], v[212:215]
    ds_read_b64_tr_b16 a[130:131], v15 offset:3584
    v_mfma_f32_16x16x32_bf16 v[216:219], a[132:135], a[120:123], v[216:219]
    v_mfma_f32_16x16x32_bf16 v[220:223], a[132:135], a[124:127], v[220:223]
    buffer_load_dwordx4 a[60:63], v5, s[8:11], s26 offen offset:3072
    s_add_u32 s26, s26, 4096
    s_waitcnt lgkmcnt(4)
    v_mfma_f32_16x16x32_bf16 v[224:227], a[136:139], a[112:115], v[224:227]
    ds_read_b64_tr_b16 a[132:133], v15 offset:32
    v_mfma_f32_16x16x32_bf16 v[228:231], a[136:139], a[116:119], v[228:231]
    ds_read_b64_tr_b16 a[134:135], v15 offset:3616
    v_mfma_f32_16x16x32_bf16 v[232:235], a[136:139], a[120:123], v[232:235]
    v_mfma_f32_16x16x32_bf16 v[236:239], a[136:139], a[124:127], v[236:239]
    s_add_u32 m0, s28, 28672
    s_nop 0
    buffer_load_dwordx4 v6, s[12:15], s25 offen offset:0 lds
    s_waitcnt lgkmcnt(4)
    v_mfma_f32_16x16x32_bf16 v[240:243], a[140:143], a[112:115], v[240:243]
    ds_read_b64_tr_b16 a[136:137], v15 offset:64
    v_mfma_f32_16x16x32_bf16 v[244:247], a[140:143], a[116:119], v[244:247]
    ds_read_b64_tr_b16 a[138:139], v15 offset:3648
    v_mfma_f32_16x16x32_bf16 v[248:251], a[140:143], a[120:123], v[248:251]
    v_mfma_f32_16x16x32_bf16 v[252:255], a[140:143], a[124:127], v[252:255]
    s_waitcnt vmcnt(21)
    s_waitcnt lgkmcnt(4)
    v_mfma_f32_16x16x32_bf16 v[32:35], a[128:131], a[0:3], v[32:35]
    ds_read_b64_tr_b16 a[140:141], v15 offset:96
    v_mfma_f32_16x16x32_bf16 v[36:39], a[128:131], a[4:7], v[36:39]
    ds_read_b64_tr_b16 a[142:143], v15 offset:3680
    v_mfma_f32_16x16x32_bf16 v[40:43], a[128:131], a[8:11], v[40:43]
    v_mfma_f32_16x16x32_bf16 v[44:47], a[128:131], a[12:15], v[44:47]
    buffer_store_dwordx4 a[160:163], v29, s[52:55], s69 offen offset:0 sc1
    s_waitcnt lgkmcnt(4)
    v_mfma_f32_16x16x32_bf16 v[48:51], a[132:135], a[0:3], v[48:51]
    ds_read_b64_tr_b16 a[128:129], v15 offset:128
    v_mfma_f32_16x16x32_bf16 v[52:55], a[132:135], a[4:7], v[52:55]
    ds_read_b64_tr_b16 a[130:131], v15 offset:3712
    v_mfma_f32_16x16x32_bf16 v[56:59], a[132:135], a[8:11], v[56:59]
    v_mfma_f32_16x16x32_bf16 v[60:63], a[132:135], a[12:15], v[60:63]
    buffer_load_dwordx4 v7, s[12:15], s25 offen offset:1024 lds
    s_waitcnt lgkmcnt(4)
    v_mfma_f32_16x16x32_bf16 v[64:67], a[136:139], a[0:3], v[64:67]
    ds_read_b64_tr_b16 a[132:133], v15 offset:160
    v_mfma_f32_16x16x32_bf16 v[68:71], a[136:139], a[4:7], v[68:71]
    ds_read_b64_tr_b16 a[134:135], v15 offset:3744
    v_mfma_f32_16x16x32_bf16 v[72:75], a[136:139], a[8:11], v[72:75]
    v_mfma_f32_16x16x32_bf16 v[76:79], a[136:139], a[12:15], v[76:79]
    s_waitcnt lgkmcnt(4)
    v_mfma_f32_16x16x32_bf16 v[80:83], a[140:143], a[0:3], v[80:83]
    ds_read_b64_tr_b16 a[136:137], v15 offset:192
    v_mfma_f32_16x16x32_bf16 v[84:87], a[140:143], a[4:7], v[84:87]
    ds_read_b64_tr_b16 a[138:139], v15 offset:3776
    v_mfma_f32_16x16x32_bf16 v[88:91], a[140:143], a[8:11], v[88:91]
    v_mfma_f32_16x16x32_bf16 v[92:95], a[140:143], a[12:15], v[92:95]
    buffer_load_dwordx4 v8, s[12:15], s25 offen offset:2048 lds
    s_waitcnt lgkmcnt(4)
    v_mfma_f32_16x16x32_bf16 v[96:99], a[128:131], a[0:3], v[96:99]
    ds_read_b64_tr_b16 a[140:141], v15 offset:7168
    v_mfma_f32_16x16x32_bf16 v[100:103], a[128:131], a[4:7], v[100:103]
    ds_read_b64_tr_b16 a[142:143], v15 offset:10752
    v_mfma_f32_16x16x32_bf16 v[104:107], a[128:131], a[8:11], v[104:107]
    v_mfma_f32_16x16x32_bf16 v[108:111], a[128:131], a[12:15], v[108:111]
    buffer_load_dwordx4 v9, s[12:15], s25 offen offset:3072 lds
    s_waitcnt lgkmcnt(4)
    v_mfma_f32_16x16x32_bf16 v[112:115], a[132:135], a[0:3], v[112:115]
    ds_read_b64_tr_b16 a[128:129], v15 offset:7200
    v_mfma_f32_16x16x32_bf16 v[116:119], a[132:135], a[4:7], v[116:119]
    ds_read_b64_tr_b16 a[130:131], v15 offset:10784
    v_mfma_f32_16x16x32_bf16 v[120:123], a[132:135], a[8:11], v[120:123]
    v_mfma_f32_16x16x32_bf16 v[124:127], a[132:135], a[12:15], v[124:127]
    s_waitcnt lgkmcnt(4)
    v_mfma_f32_16x16x32_bf16 v[128:131], a[136:139], a[0:3], v[128:131]
    ds_read_b64_tr_b16 a[132:133], v15 offset:7232
    v_mfma_f32_16x16x32_bf16 v[132:135], a[136:139], a[4:7], v[132:135]
    ds_read_b64_tr_b16 a[134:135], v15 offset:10816
    v_mfma_f32_16x16x32_bf16 v[136:139], a[136:139], a[8:11], v[136:139]
    v_mfma_f32_16x16x32_bf16 v[140:143], a[136:139], a[12:15], v[140:143]
    s_add_u32 m0, s28, 32768
    s_nop 0
    buffer_load_dwordx4 v10, s[12:15], s25 offen offset:0 lds
    s_waitcnt lgkmcnt(4)
    v_mfma_f32_16x16x32_bf16 v[144:147], a[140:143], a[0:3], v[144:147]
    ds_read_b64_tr_b16 a[136:137], v15 offset:7264
    v_mfma_f32_16x16x32_bf16 v[148:151], a[140:143], a[4:7], v[148:151]
    ds_read_b64_tr_b16 a[138:139], v15 offset:10848
    v_mfma_f32_16x16x32_bf16 v[152:155], a[140:143], a[8:11], v[152:155]
    v_mfma_f32_16x16x32_bf16 v[156:159], a[140:143], a[12:15], v[156:159]
    buffer_load_dwordx4 v11, s[12:15], s25 offen offset:1024 lds
    s_waitcnt lgkmcnt(4)
    v_mfma_f32_16x16x32_bf16 v[160:163], a[128:131], a[0:3], v[160:163]
    ds_read_b64_tr_b16 a[140:141], v15 offset:7296
    v_mfma_f32_16x16x32_bf16 v[164:167], a[128:131], a[4:7], v[164:167]
    ds_read_b64_tr_b16 a[142:143], v15 offset:10880
    v_mfma_f32_16x16x32_bf16 v[168:171], a[128:131], a[8:11], v[168:171]
    v_mfma_f32_16x16x32_bf16 v[172:175], a[128:131], a[12:15], v[172:175]
    s_waitcnt lgkmcnt(4)
    v_mfma_f32_16x16x32_bf16 v[176:179], a[132:135], a[0:3], v[176:179]
    ds_read_b64_tr_b16 a[128:129], v15 offset:7328
    v_mfma_f32_16x16x32_bf16 v[180:183], a[132:135], a[4:7], v[180:183]
    ds_read_b64_tr_b16 a[130:131], v15 offset:10912
    v_mfma_f32_16x16x32_bf16 v[184:187], a[132:135], a[8:11], v[184:187]
    v_mfma_f32_16x16x32_bf16 v[188:191], a[132:135], a[12:15], v[188:191]
    buffer_store_dwordx4 a[160:163], v29, s[52:55], s69 offen offset:1024 sc1
    s_waitcnt lgkmcnt(4)
    v_mfma_f32_16x16x32_bf16 v[192:195], a[136:139], a[0:3], v[192:195]
    ds_read_b64_tr_b16 a[132:133], v15 offset:7360
    v_mfma_f32_16x16x32_bf16 v[196:199], a[136:139], a[4:7], v[196:199]
    ds_read_b64_tr_b16 a[134:135], v15 offset:10944
    v_mfma_f32_16x16x32_bf16 v[200:203], a[136:139], a[8:11], v[200:203]
    v_mfma_f32_16x16x32_bf16 v[204:207], a[136:139], a[12:15], v[204:207]
    buffer_load_dwordx4 v12, s[12:15], s25 offen offset:2048 lds
    s_add_u32 s25, s25, 458752
    s_waitcnt lgkmcnt(4)
    v_mfma_f32_16x16x32_bf16 v[208:211], a[140:143], a[0:3], v[208:211]
    ds_read_b64_tr_b16 a[136:137], v15 offset:14336
    v_mfma_f32_16x16x32_bf16 v[212:215], a[140:143], a[4:7], v[212:215]
    ds_read_b64_tr_b16 a[138:139], v15 offset:17920
    v_mfma_f32_16x16x32_bf16 v[216:219], a[140:143], a[8:11], v[216:219]
    v_mfma_f32_16x16x32_bf16 v[220:223], a[140:143], a[12:15], v[220:223]
    s_waitcnt lgkmcnt(4)
    v_mfma_f32_16x16x32_bf16 v[224:227], a[128:131], a[0:3], v[224:227]
    ds_read_b64_tr_b16 a[140:141], v15 offset:14368
    v_mfma_f32_16x16x32_bf16 v[228:231], a[128:131], a[4:7], v[228:231]
    ds_read_b64_tr_b16 a[142:143], v15 offset:17952
    v_mfma_f32_16x16x32_bf16 v[232:235], a[128:131], a[8:11], v[232:235]
    v_mfma_f32_16x16x32_bf16 v[236:239], a[128:131], a[12:15], v[236:239]
    buffer_load_dwordx4 a[64:67], v2, s[8:11], s26 offen offset:0
    s_waitcnt lgkmcnt(4)
    v_mfma_f32_16x16x32_bf16 v[240:243], a[132:135], a[0:3], v[240:243]
    ds_read_b64_tr_b16 a[128:129], v15 offset:14400
    v_mfma_f32_16x16x32_bf16 v[244:247], a[132:135], a[4:7], v[244:247]
    ds_read_b64_tr_b16 a[130:131], v15 offset:17984
    v_mfma_f32_16x16x32_bf16 v[248:251], a[132:135], a[8:11], v[248:251]
    v_mfma_f32_16x16x32_bf16 v[252:255], a[132:135], a[12:15], v[252:255]
    buffer_load_dwordx4 a[68:71], v3, s[8:11], s26 offen offset:0
    s_waitcnt vmcnt(27)
    s_waitcnt lgkmcnt(4)
    v_mfma_f32_16x16x32_bf16 v[32:35], a[136:139], a[16:19], v[32:35]
    ds_read_b64_tr_b16 a[132:133], v15 offset:14432
    v_mfma_f32_16x16x32_bf16 v[36:39], a[136:139], a[20:23], v[36:39]
    ds_read_b64_tr_b16 a[134:135], v15 offset:18016
    v_mfma_f32_16x16x32_bf16 v[40:43], a[136:139], a[24:27], v[40:43]
    v_mfma_f32_16x16x32_bf16 v[44:47], a[136:139], a[28:31], v[44:47]
    buffer_load_dword v31, v30, s[4:7], s70 offen
    s_add_u32 s70, s70, 458752
    s_waitcnt lgkmcnt(4)
    v_mfma_f32_16x16x32_bf16 v[48:51], a[140:143], a[16:19], v[48:51]
    ds_read_b64_tr_b16 a[136:137], v15 offset:14464
    v_mfma_f32_16x16x32_bf16 v[52:55], a[140:143], a[20:23], v[52:55]
    ds_read_b64_tr_b16 a[138:139], v15 offset:18048
    v_mfma_f32_16x16x32_bf16 v[56:59], a[140:143], a[24:27], v[56:59]
    v_mfma_f32_16x16x32_bf16 v[60:63], a[140:143], a[28:31], v[60:63]
    buffer_load_dwordx4 a[72:75], v4, s[8:11], s26 offen offset:0
    s_waitcnt lgkmcnt(4)
    v_mfma_f32_16x16x32_bf16 v[64:67], a[128:131], a[16:19], v[64:67]
    ds_read_b64_tr_b16 a[140:141], v15 offset:14496
    v_mfma_f32_16x16x32_bf16 v[68:71], a[128:131], a[20:23], v[68:71]
    ds_read_b64_tr_b16 a[142:143], v15 offset:18080
    v_mfma_f32_16x16x32_bf16 v[72:75], a[128:131], a[24:27], v[72:75]
    v_mfma_f32_16x16x32_bf16 v[76:79], a[128:131], a[28:31], v[76:79]
    buffer_load_dwordx4 a[76:79], v5, s[8:11], s26 offen offset:0
    s_waitcnt lgkmcnt(4)
    v_mfma_f32_16x16x32_bf16 v[80:83], a[132:135], a[16:19], v[80:83]
    ds_read_b64_tr_b16 a[128:129], v15 offset:14528
    v_mfma_f32_16x16x32_bf16 v[84:87], a[132:135], a[20:23], v[84:87]
    ds_read_b64_tr_b16 a[130:131], v15 offset:18112
    v_mfma_f32_16x16x32_bf16 v[88:91], a[132:135], a[24:27], v[88:91]
    v_mfma_f32_16x16x32_bf16 v[92:95], a[132:135], a[28:31], v[92:95]
    s_waitcnt lgkmcnt(4)
    v_mfma_f32_16x16x32_bf16 v[96:99], a[136:139], a[16:19], v[96:99]
    ds_read_b64_tr_b16 a[132:133], v15 offset:21504
    v_mfma_f32_16x16x32_bf16 v[100:103], a[136:139], a[20:23], v[100:103]
    ds_read_b64_tr_b16 a[134:135], v15 offset:25088
    v_mfma_f32_16x16x32_bf16 v[104:107], a[136:139], a[24:27], v[104:107]
    v_mfma_f32_16x16x32_bf16 v[108:111], a[136:139], a[28:31], v[108:111]
    buffer_store_dwordx4 a[160:163], v29, s[52:55], s69 offen offset:2048 sc1
    s_waitcnt lgkmcnt(4)
    v_mfma_f32_16x16x32_bf16 v[112:115], a[140:143], a[16:19], v[112:115]
    ds_read_b64_tr_b16 a[136:137], v15 offset:21536
    v_mfma_f32_16x16x32_bf16 v[116:119], a[140:143], a[20:23], v[116:119]
    ds_read_b64_tr_b16 a[138:139], v15 offset:25120
    v_mfma_f32_16x16x32_bf16 v[120:123], a[140:143], a[24:27], v[120:123]
    v_mfma_f32_16x16x32_bf16 v[124:127], a[140:143], a[28:31], v[124:127]
    buffer_load_dwordx4 a[80:83], v2, s[8:11], s26 offen offset:1024
    s_waitcnt lgkmcnt(4)
    v_mfma_f32_16x16x32_bf16 v[128:131], a[128:131], a[16:19], v[128:131]
    ds_read_b64_tr_b16 a[140:141], v15 offset:21568
    v_mfma_f32_16x16x32_bf16 v[132:135], a[128:131], a[20:23], v[132:135]
    ds_read_b64_tr_b16 a[142:143], v15 offset:25152
    v_mfma_f32_16x16x32_bf16 v[136:139], a[128:131], a[24:27], v[136:139]
    v_mfma_f32_16x16x32_bf16 v[140:143], a[128:131], a[28:31], v[140:143]
    s_waitcnt lgkmcnt(4)
    v_mfma_f32_16x16x32_bf16 v[144:147], a[132:135], a[16:19], v[144:147]
    ds_read_b64_tr_b16 a[128:129], v15 offset:21600
    v_mfma_f32_16x16x32_bf16 v[148:151], a[132:135], a[20:23], v[148:151]
    ds_read_b64_tr_b16 a[130:131], v15 offset:25184
    v_mfma_f32_16x16x32_bf16 v[152:155], a[132:135], a[24:27], v[152:155]
    v_mfma_f32_16x16x32_bf16 v[156:159], a[132:135], a[28:31], v[156:159]
    buffer_load_dwordx4 a[84:87], v3, s[8:11], s26 offen offset:1024
    s_waitcnt lgkmcnt(4)
    v_mfma_f32_16x16x32_bf16 v[160:163], a[136:139], a[16:19], v[160:163]
    ds_read_b64_tr_b16 a[132:133], v15 offset:21632
    v_mfma_f32_16x16x32_bf16 v[164:167], a[136:139], a[20:23], v[164:167]
    ds_read_b64_tr_b16 a[134:135], v15 offset:25216
    v_mfma_f32_16x16x32_bf16 v[168:171], a[136:139], a[24:27], v[168:171]
    v_mfma_f32_16x16x32_bf16 v[172:175], a[136:139], a[28:31], v[172:175]
    buffer_load_dwordx4 a[88:91], v4, s[8:11], s26 offen offset:1024
    s_waitcnt lgkmcnt(4)
    v_mfma_f32_16x16x32_bf16 v[176:179], a[140:143], a[16:19], v[176:179]
    ds_read_b64_tr_b16 a[136:137], v15 offset:21664
    v_mfma_f32_16x16x32_bf16 v[180:183], a[140:143], a[20:23], v[180:183]
    ds_read_b64_tr_b16 a[138:139], v15 offset:25248
    v_mfma_f32_16x16x32_bf16 v[184:187], a[140:143], a[24:27], v[184:187]
    v_mfma_f32_16x16x32_bf16 v[188:191], a[140:143], a[28:31], v[188:191]
    s_waitcnt lgkmcnt(4)
    v_mfma_f32_16x16x32_bf16 v[192:195], a[128:131], a[16:19], v[192:195]
    ds_read_b64_tr_b16 a[140:141], v15 offset:21696
    v_mfma_f32_16x16x32_bf16 v[196:199], a[128:131], a[20:23], v[196:199]
    ds_read_b64_tr_b16 a[142:143], v15 offset:25280
    v_mfma_f32_16x16x32_bf16 v[200:203], a[128:131], a[24:27], v[200:203]
    v_mfma_f32_16x16x32_bf16 v[204:207], a[128:131], a[28:31], v[204:207]
    buffer_load_dwordx4 a[92:95], v5, s[8:11], s26 offen offset:1024
    s_waitcnt lgkmcnt(4)
    v_mfma_f32_16x16x32_bf16 v[208:211], a[132:135], a[16:19], v[208:211]
    s_waitcnt vmcnt(28)
    s_barrier
    ds_read_b64_tr_b16 a[128:129], v13 offset:0
    v_mfma_f32_16x16x32_bf16 v[212:215], a[132:135], a[20:23], v[212:215]
    ds_read_b64_tr_b16 a[130:131], v13 offset:3584
    v_mfma_f32_16x16x32_bf16 v[216:219], a[132:135], a[24:27], v[216:219]
    v_mfma_f32_16x16x32_bf16 v[220:223], a[132:135], a[28:31], v[220:223]
    s_add_u32 m0, s28, 57344
    s_nop 0
    buffer_load_dwordx4 v6, s[12:15], s25 offen offset:0 lds
    s_waitcnt lgkmcnt(4)
    v_mfma_f32_16x16x32_bf16 v[224:227], a[136:139], a[16:19], v[224:227]
    ds_read_b64_tr_b16 a[132:133], v13 offset:32
    v_mfma_f32_16x16x32_bf16 v[228:231], a[136:139], a[20:23], v[228:231]
    ds_read_b64_tr_b16 a[134:135], v13 offset:3616
    v_mfma_f32_16x16x32_bf16 v[232:235], a[136:139], a[24:27], v[232:235]
    v_mfma_f32_16x16x32_bf16 v[236:239], a[136:139], a[28:31], v[236:239]
    s_waitcnt lgkmcnt(4)
    v_mfma_f32_16x16x32_bf16 v[240:243], a[140:143], a[16:19], v[240:243]
    ds_read_b64_tr_b16 a[136:137], v13 offset:64
    v_mfma_f32_16x16x32_bf16 v[244:247], a[140:143], a[20:23], v[244:247]
    ds_read_b64_tr_b16 a[138:139], v13 offset:3648
    v_mfma_f32_16x16x32_bf16 v[248:251], a[140:143], a[24:27], v[248:251]
    v_mfma_f32_16x16x32_bf16 v[252:255], a[140:143], a[28:31], v[252:255]
    buffer_store_dwordx4 a[160:163], v29, s[52:55], s69 offen offset:3072 sc1
    s_add_u32 s69, s69, 4096
    s_waitcnt vmcnt(25)
    s_waitcnt lgkmcnt(4)
    v_mfma_f32_16x16x32_bf16 v[32:35], a[128:131], a[32:35], v[32:35]
    ds_read_b64_tr_b16 a[140:141], v13 offset:96
    v_mfma_f32_16x16x32_bf16 v[36:39], a[128:131], a[36:39], v[36:39]
    ds_read_b64_tr_b16 a[142:143], v13 offset:3680
    v_mfma_f32_16x16x32_bf16 v[40:43], a[128:131], a[40:43], v[40:43]
    v_mfma_f32_16x16x32_bf16 v[44:47], a[128:131], a[44:47], v[44:47]
    buffer_load_dwordx4 v7, s[12:15], s25 offen offset:1024 lds
    s_waitcnt lgkmcnt(4)
    v_mfma_f32_16x16x32_bf16 v[48:51], a[132:135], a[32:35], v[48:51]
    ds_read_b64_tr_b16 a[128:129], v13 offset:128
    v_mfma_f32_16x16x32_bf16 v[52:55], a[132:135], a[36:39], v[52:55]
    ds_read_b64_tr_b16 a[130:131], v13 offset:3712
    v_mfma_f32_16x16x32_bf16 v[56:59], a[132:135], a[40:43], v[56:59]
    v_mfma_f32_16x16x32_bf16 v[60:63], a[132:135], a[44:47], v[60:63]
    s_waitcnt lgkmcnt(4)
    v_mfma_f32_16x16x32_bf16 v[64:67], a[136:139], a[32:35], v[64:67]
    ds_read_b64_tr_b16 a[132:133], v13 offset:160
    v_mfma_f32_16x16x32_bf16 v[68:71], a[136:139], a[36:39], v[68:71]
    ds_read_b64_tr_b16 a[134:135], v13 offset:3744
    v_mfma_f32_16x16x32_bf16 v[72:75], a[136:139], a[40:43], v[72:75]
    v_mfma_f32_16x16x32_bf16 v[76:79], a[136:139], a[44:47], v[76:79]
    buffer_load_dwordx4 v8, s[12:15], s25 offen offset:2048 lds
    s_waitcnt lgkmcnt(4)
    v_mfma_f32_16x16x32_bf16 v[80:83], a[140:143], a[32:35], v[80:83]
    ds_read_b64_tr_b16 a[136:137], v13 offset:192
    v_mfma_f32_16x16x32_bf16 v[84:87], a[140:143], a[36:39], v[84:87]
    ds_read_b64_tr_b16 a[138:139], v13 offset:3776
    v_mfma_f32_16x16x32_bf16 v[88:91], a[140:143], a[40:43], v[88:91]
    v_mfma_f32_16x16x32_bf16 v[92:95], a[140:143], a[44:47], v[92:95]
    buffer_load_dwordx4 v9, s[12:15], s25 offen offset:3072 lds
    s_waitcnt lgkmcnt(4)
    v_mfma_f32_16x16x32_bf16 v[96:99], a[128:131], a[32:35], v[96:99]
    ds_read_b64_tr_b16 a[140:141], v13 offset:7168
    v_mfma_f32_16x16x32_bf16 v[100:103], a[128:131], a[36:39], v[100:103]
    ds_read_b64_tr_b16 a[142:143], v13 offset:10752
    v_mfma_f32_16x16x32_bf16 v[104:107], a[128:131], a[40:43], v[104:107]
    v_mfma_f32_16x16x32_bf16 v[108:111], a[128:131], a[44:47], v[108:111]
    s_waitcnt lgkmcnt(4)
    v_mfma_f32_16x16x32_bf16 v[112:115], a[132:135], a[32:35], v[112:115]
    ds_read_b64_tr_b16 a[128:129], v13 offset:7200
    v_mfma_f32_16x16x32_bf16 v[116:119], a[132:135], a[36:39], v[116:119]
    ds_read_b64_tr_b16 a[130:131], v13 offset:10784
    v_mfma_f32_16x16x32_bf16 v[120:123], a[132:135], a[40:43], v[120:123]
    v_mfma_f32_16x16x32_bf16 v[124:127], a[132:135], a[44:47], v[124:127]
    s_add_u32 m0, s28, 61440
    s_nop 0
    buffer_load_dwordx4 v10, s[12:15], s25 offen offset:0 lds
    s_waitcnt lgkmcnt(4)
    v_mfma_f32_16x16x32_bf16 v[128:131], a[136:139], a[32:35], v[128:131]
    ds_read_b64_tr_b16 a[132:133], v13 offset:7232
    v_mfma_f32_16x16x32_bf16 v[132:135], a[136:139], a[36:39], v[132:135]
    ds_read_b64_tr_b16 a[134:135], v13 offset:10816
    v_mfma_f32_16x16x32_bf16 v[136:139], a[136:139], a[40:43], v[136:139]
    v_mfma_f32_16x16x32_bf16 v[140:143], a[136:139], a[44:47], v[140:143]
    buffer_load_dwordx4 v11, s[12:15], s25 offen offset:1024 lds
    s_waitcnt lgkmcnt(4)
    v_mfma_f32_16x16x32_bf16 v[144:147], a[140:143], a[32:35], v[144:147]
    ds_read_b64_tr_b16 a[136:137], v13 offset:7264
    v_mfma_f32_16x16x32_bf16 v[148:151], a[140:143], a[36:39], v[148:151]
    ds_read_b64_tr_b16 a[138:139], v13 offset:10848
    v_mfma_f32_16x16x32_bf16 v[152:155], a[140:143], a[40:43], v[152:155]
    v_mfma_f32_16x16x32_bf16 v[156:159], a[140:143], a[44:47], v[156:159]
    s_waitcnt lgkmcnt(4)
    v_mfma_f32_16x16x32_bf16 v[160:163], a[128:131], a[32:35], v[160:163]
    ds_read_b64_tr_b16 a[140:141], v13 offset:7296
    v_mfma_f32_16x16x32_bf16 v[164:167], a[128:131], a[36:39], v[164:167]
    ds_read_b64_tr_b16 a[142:143], v13 offset:10880
    v_mfma_f32_16x16x32_bf16 v[168:171], a[128:131], a[40:43], v[168:171]
    v_mfma_f32_16x16x32_bf16 v[172:175], a[128:131], a[44:47], v[172:175]
    buffer_load_dwordx4 v12, s[12:15], s25 offen offset:2048 lds
    s_add_u32 s25, s25, 458752
    s_waitcnt lgkmcnt(4)
    v_mfma_f32_16x16x32_bf16 v[176:179], a[132:135], a[32:35], v[176:179]
    ds_read_b64_tr_b16 a[128:129], v13 offset:7328
    v_mfma_f32_16x16x32_bf16 v[180:183], a[132:135], a[36:39], v[180:183]
    ds_read_b64_tr_b16 a[130:131], v13 offset:10912
    v_mfma_f32_16x16x32_bf16 v[184:187], a[132:135], a[40:43], v[184:187]
    v_mfma_f32_16x16x32_bf16 v[188:191], a[132:135], a[44:47], v[188:191]
    buffer_load_dwordx4 a[96:99], v2, s[8:11], s26 offen offset:2048
    s_waitcnt lgkmcnt(4)
    v_mfma_f32_16x16x32_bf16 v[192:195], a[136:139], a[32:35], v[192:195]
    ds_read_b64_tr_b16 a[132:133], v13 offset:7360
    v_mfma_f32_16x16x32_bf16 v[196:199], a[136:139], a[36:39], v[196:199]
    ds_read_b64_tr_b16 a[134:135], v13 offset:10944
    v_mfma_f32_16x16x32_bf16 v[200:203], a[136:139], a[40:43], v[200:203]
    v_mfma_f32_16x16x32_bf16 v[204:207], a[136:139], a[44:47], v[204:207]
    buffer_load_dword v31, v30, s[4:7], s70 offen
    s_add_u32 s70, s70, 458752
    s_waitcnt lgkmcnt(4)
    v_mfma_f32_16x16x32_bf16 v[208:211], a[140:143], a[32:35], v[208:211]
    ds_read_b64_tr_b16 a[136:137], v13 offset:14336
    v_mfma_f32_16x16x32_bf16 v[212:215], a[140:143], a[36:39], v[212:215]
    ds_read_b64_tr_b16 a[138:139], v13 offset:17920
    v_mfma_f32_16x16x32_bf16 v[216:219], a[140:143], a[40:43], v[216:219]
    v_mfma_f32_16x16x32_bf16 v[220:223], a[140:143], a[44:47], v[220:223]
    global_load_dword v31, v28, s[56:57]
    buffer_load_dwordx4 a[100:103], v3, s[8:11], s26 offen offset:2048
    s_waitcnt lgkmcnt(4)
    v_mfma_f32_16x16x32_bf16 v[224:227], a[128:131], a[32:35], v[224:227]
    ds_read_b64_tr_b16 a[140:141], v13 offset:14368
    v_mfma_f32_16x16x32_bf16 v[228:231], a[128:131], a[36:39], v[228:231]
    ds_read_b64_tr_b16 a[142:143], v13 offset:17952
    v_mfma_f32_16x16x32_bf16 v[232:235], a[128:131], a[40:43], v[232:235]
    v_mfma_f32_16x16x32_bf16 v[236:239], a[128:131], a[44:47], v[236:239]
    s_waitcnt lgkmcnt(4)
    v_mfma_f32_16x16x32_bf16 v[240:243], a[132:135], a[32:35], v[240:243]
    ds_read_b64_tr_b16 a[128:129], v13 offset:14400
    v_mfma_f32_16x16x32_bf16 v[244:247], a[132:135], a[36:39], v[244:247]
    ds_read_b64_tr_b16 a[130:131], v13 offset:17984
    v_mfma_f32_16x16x32_bf16 v[248:251], a[132:135], a[40:43], v[248:251]
    v_mfma_f32_16x16x32_bf16 v[252:255], a[132:135], a[44:47], v[252:255]
    buffer_load_dwordx4 a[104:107], v4, s[8:11], s26 offen offset:2048
    s_waitcnt vmcnt(32)
    s_waitcnt lgkmcnt(4)
    v_mfma_f32_16x16x32_bf16 v[32:35], a[136:139], a[48:51], v[32:35]
    ds_read_b64_tr_b16 a[132:133], v13 offset:14432
    v_mfma_f32_16x16x32_bf16 v[36:39], a[136:139], a[52:55], v[36:39]
    ds_read_b64_tr_b16 a[134:135], v13 offset:18016
    v_mfma_f32_16x16x32_bf16 v[40:43], a[136:139], a[56:59], v[40:43]
    v_mfma_f32_16x16x32_bf16 v[44:47], a[136:139], a[60:63], v[44:47]
    buffer_load_dwordx4 a[108:111], v5, s[8:11], s26 offen offset:2048
    s_waitcnt lgkmcnt(4)
    v_mfma_f32_16x16x32_bf16 v[48:51], a[140:143], a[48:51], v[48:51]
    ds_read_b64_tr_b16 a[136:137], v13 offset:14464
    v_mfma_f32_16x16x32_bf16 v[52:55], a[140:143], a[52:55], v[52:55]
    ds_read_b64_tr_b16 a[138:139], v13 offset:18048
    v_mfma_f32_16x16x32_bf16 v[56:59], a[140:143], a[56:59], v[56:59]
    v_mfma_f32_16x16x32_bf16 v[60:63], a[140:143], a[60:63], v[60:63]
    s_waitcnt lgkmcnt(4)
    v_mfma_f32_16x16x32_bf16 v[64:67], a[128:131], a[48:51], v[64:67]
    ds_read_b64_tr_b16 a[140:141], v13 offset:14496
    v_mfma_f32_16x16x32_bf16 v[68:71], a[128:131], a[52:55], v[68:71]
    ds_read_b64_tr_b16 a[142:143], v13 offset:18080
    v_mfma_f32_16x16x32_bf16 v[72:75], a[128:131], a[56:59], v[72:75]
    v_mfma_f32_16x16x32_bf16 v[76:79], a[128:131], a[60:63], v[76:79]
    buffer_load_dwordx4 a[112:115], v2, s[8:11], s26 offen offset:3072
    s_waitcnt lgkmcnt(4)
    v_mfma_f32_16x16x32_bf16 v[80:83], a[132:135], a[48:51], v[80:83]
    ds_read_b64_tr_b16 a[128:129], v13 offset:14528
    v_mfma_f32_16x16x32_bf16 v[84:87], a[132:135], a[52:55], v[84:87]
    ds_read_b64_tr_b16 a[130:131], v13 offset:18112
    v_mfma_f32_16x16x32_bf16 v[88:91], a[132:135], a[56:59], v[88:91]
    v_mfma_f32_16x16x32_bf16 v[92:95], a[132:135], a[60:63], v[92:95]
    buffer_load_dwordx4 a[116:119], v3, s[8:11], s26 offen offset:3072
    s_waitcnt lgkmcnt(4)
    v_mfma_f32_16x16x32_bf16 v[96:99], a[136:139], a[48:51], v[96:99]
    ds_read_b64_tr_b16 a[132:133], v13 offset:21504
    v_mfma_f32_16x16x32_bf16 v[100:103], a[136:139], a[52:55], v[100:103]
    ds_read_b64_tr_b16 a[134:135], v13 offset:25088
    v_mfma_f32_16x16x32_bf16 v[104:107], a[136:139], a[56:59], v[104:107]
    v_mfma_f32_16x16x32_bf16 v[108:111], a[136:139], a[60:63], v[108:111]
    s_waitcnt lgkmcnt(4)
    v_mfma_f32_16x16x32_bf16 v[112:115], a[140:143], a[48:51], v[112:115]
    ds_read_b64_tr_b16 a[136:137], v13 offset:21536
    v_mfma_f32_16x16x32_bf16 v[116:119], a[140:143], a[52:55], v[116:119]
    ds_read_b64_tr_b16 a[138:139], v13 offset:25120
    v_mfma_f32_16x16x32_bf16 v[120:123], a[140:143], a[56:59], v[120:123]
    v_mfma_f32_16x16x32_bf16 v[124:127], a[140:143], a[60:63], v[124:127]
    buffer_load_dwordx4 a[120:123], v4, s[8:11], s26 offen offset:3072
    s_waitcnt lgkmcnt(4)
    v_mfma_f32_16x16x32_bf16 v[128:131], a[128:131], a[48:51], v[128:131]
    ds_read_b64_tr_b16 a[140:141], v13 offset:21568
    v_mfma_f32_16x16x32_bf16 v[132:135], a[128:131], a[52:55], v[132:135]
    ds_read_b64_tr_b16 a[142:143], v13 offset:25152
    v_mfma_f32_16x16x32_bf16 v[136:139], a[128:131], a[56:59], v[136:139]
    v_mfma_f32_16x16x32_bf16 v[140:143], a[128:131], a[60:63], v[140:143]
    buffer_load_dwordx4 a[124:127], v5, s[8:11], s26 offen offset:3072
    s_add_u32 s26, s26, 4096
    s_waitcnt lgkmcnt(4)
    v_mfma_f32_16x16x32_bf16 v[144:147], a[132:135], a[48:51], v[144:147]
    ds_read_b64_tr_b16 a[128:129], v13 offset:21600
    v_mfma_f32_16x16x32_bf16 v[148:151], a[132:135], a[52:55], v[148:151]
    ds_read_b64_tr_b16 a[130:131], v13 offset:25184
    v_mfma_f32_16x16x32_bf16 v[152:155], a[132:135], a[56:59], v[152:155]
    v_mfma_f32_16x16x32_bf16 v[156:159], a[132:135], a[60:63], v[156:159]
    s_waitcnt lgkmcnt(4)
    v_mfma_f32_16x16x32_bf16 v[160:163], a[136:139], a[48:51], v[160:163]
    ds_read_b64_tr_b16 a[132:133], v13 offset:21632
    v_mfma_f32_16x16x32_bf16 v[164:167], a[136:139], a[52:55], v[164:167]
    ds_read_b64_tr_b16 a[134:135], v13 offset:25216
    v_mfma_f32_16x16x32_bf16 v[168:171], a[136:139], a[56:59], v[168:171]
    v_mfma_f32_16x16x32_bf16 v[172:175], a[136:139], a[60:63], v[172:175]
    s_add_u32 m0, s28, 86016
    s_nop 0
    buffer_load_dwordx4 v6, s[12:15], s25 offen offset:0 lds
    s_waitcnt lgkmcnt(4)
    v_mfma_f32_16x16x32_bf16 v[176:179], a[140:143], a[48:51], v[176:179]
    ds_read_b64_tr_b16 a[136:137], v13 offset:21664
    v_mfma_f32_16x16x32_bf16 v[180:183], a[140:143], a[52:55], v[180:183]
    ds_read_b64_tr_b16 a[138:139], v13 offset:25248
    v_mfma_f32_16x16x32_bf16 v[184:187], a[140:143], a[56:59], v[184:187]
    v_mfma_f32_16x16x32_bf16 v[188:191], a[140:143], a[60:63], v[188:191]
    buffer_load_dwordx4 v7, s[12:15], s25 offen offset:1024 lds
    s_waitcnt lgkmcnt(4)
    v_mfma_f32_16x16x32_bf16 v[192:195], a[128:131], a[48:51], v[192:195]
    ds_read_b64_tr_b16 a[140:141], v13 offset:21696
    v_mfma_f32_16x16x32_bf16 v[196:199], a[128:131], a[52:55], v[196:199]
    ds_read_b64_tr_b16 a[142:143], v13 offset:25280
    v_mfma_f32_16x16x32_bf16 v[200:203], a[128:131], a[56:59], v[200:203]
    v_mfma_f32_16x16x32_bf16 v[204:207], a[128:131], a[60:63], v[204:207]
    s_waitcnt lgkmcnt(4)
    v_mfma_f32_16x16x32_bf16 v[208:211], a[132:135], a[48:51], v[208:211]
    s_waitcnt vmcnt(30)
    s_barrier
    ds_read_b64_tr_b16 a[128:129], v13 offset:28672
    v_mfma_f32_16x16x32_bf16 v[212:215], a[132:135], a[52:55], v[212:215]
    ds_read_b64_tr_b16 a[130:131], v13 offset:32256
    v_mfma_f32_16x16x32_bf16 v[216:219], a[132:135], a[56:59], v[216:219]
    v_mfma_f32_16x16x32_bf16 v[220:223], a[132:135], a[60:63], v[220:223]
    buffer_load_dwordx4 v8, s[12:15], s25 offen offset:2048 lds
    s_waitcnt lgkmcnt(4)
    v_mfma_f32_16x16x32_bf16 v[224:227], a[136:139], a[48:51], v[224:227]
    ds_read_b64_tr_b16 a[132:133], v13 offset:28704
    v_mfma_f32_16x16x32_bf16 v[228:231], a[136:139], a[52:55], v[228:231]
    ds_read_b64_tr_b16 a[134:135], v13 offset:32288
    v_mfma_f32_16x16x32_bf16 v[232:235], a[136:139], a[56:59], v[232:235]
    v_mfma_f32_16x16x32_bf16 v[236:239], a[136:139], a[60:63], v[236:239]
    buffer_load_dwordx4 v9, s[12:15], s25 offen offset:3072 lds
    s_waitcnt lgkmcnt(4)
    v_mfma_f32_16x16x32_bf16 v[240:243], a[140:143], a[48:51], v[240:243]
    ds_read_b64_tr_b16 a[136:137], v13 offset:28736
    v_mfma_f32_16x16x32_bf16 v[244:247], a[140:143], a[52:55], v[244:247]
    ds_read_b64_tr_b16 a[138:139], v13 offset:32320
    v_mfma_f32_16x16x32_bf16 v[248:251], a[140:143], a[56:59], v[248:251]
    v_mfma_f32_16x16x32_bf16 v[252:255], a[140:143], a[60:63], v[252:255]
    s_waitcnt vmcnt(27)
    s_waitcnt lgkmcnt(4)
    v_mfma_f32_16x16x32_bf16 v[32:35], a[128:131], a[64:67], v[32:35]
    ds_read_b64_tr_b16 a[140:141], v13 offset:28768
    v_mfma_f32_16x16x32_bf16 v[36:39], a[128:131], a[68:71], v[36:39]
    ds_read_b64_tr_b16 a[142:143], v13 offset:32352
    v_mfma_f32_16x16x32_bf16 v[40:43], a[128:131], a[72:75], v[40:43]
    v_mfma_f32_16x16x32_bf16 v[44:47], a[128:131], a[76:79], v[44:47]
    buffer_load_dwordx4 a[144:147], v29, s[20:23], s47 offen offset:0
    s_waitcnt lgkmcnt(4)
    v_mfma_f32_16x16x32_bf16 v[48:51], a[132:135], a[64:67], v[48:51]
    ds_read_b64_tr_b16 a[128:129], v13 offset:28800
    v_mfma_f32_16x16x32_bf16 v[52:55], a[132:135], a[68:71], v[52:55]
    ds_read_b64_tr_b16 a[130:131], v13 offset:32384
    v_mfma_f32_16x16x32_bf16 v[56:59], a[132:135], a[72:75], v[56:59]
    v_mfma_f32_16x16x32_bf16 v[60:63], a[132:135], a[76:79], v[60:63]
    s_add_u32 m0, s28, 90112
    s_nop 0
    buffer_load_dwordx4 v10, s[12:15], s25 offen offset:0 lds
    s_waitcnt lgkmcnt(4)
    v_mfma_f32_16x16x32_bf16 v[64:67], a[136:139], a[64:67], v[64:67]
    ds_read_b64_tr_b16 a[132:133], v13 offset:28832
    v_mfma_f32_16x16x32_bf16 v[68:71], a[136:139], a[68:71], v[68:71]
    ds_read_b64_tr_b16 a[134:135], v13 offset:32416
    v_mfma_f32_16x16x32_bf16 v[72:75], a[136:139], a[72:75], v[72:75]
    v_mfma_f32_16x16x32_bf16 v[76:79], a[136:139], a[76:79], v[76:79]
    s_waitcnt lgkmcnt(4)
    v_mfma_f32_16x16x32_bf16 v[80:83], a[140:143], a[64:67], v[80:83]
    ds_read_b64_tr_b16 a[136:137], v13 offset:28864
    v_mfma_f32_16x16x32_bf16 v[84:87], a[140:143], a[68:71], v[84:87]
    ds_read_b64_tr_b16 a[138:139], v13 offset:32448
    v_mfma_f32_16x16x32_bf16 v[88:91], a[140:143], a[72:75], v[88:91]
    v_mfma_f32_16x16x32_bf16 v[92:95], a[140:143], a[76:79], v[92:95]
    buffer_load_dwordx4 v11, s[12:15], s25 offen offset:1024 lds
    s_waitcnt lgkmcnt(4)
    v_mfma_f32_16x16x32_bf16 v[96:99], a[128:131], a[64:67], v[96:99]
    ds_read_b64_tr_b16 a[140:141], v13 offset:35840
    v_mfma_f32_16x16x32_bf16 v[100:103], a[128:131], a[68:71], v[100:103]
    ds_read_b64_tr_b16 a[142:143], v13 offset:39424
    v_mfma_f32_16x16x32_bf16 v[104:107], a[128:131], a[72:75], v[104:107]
    v_mfma_f32_16x16x32_bf16 v[108:111], a[128:131], a[76:79], v[108:111]
    buffer_load_dwordx4 v12, s[12:15], s25 offen offset:2048 lds
    s_add_u32 s25, s25, 458752
    s_waitcnt lgkmcnt(4)
    v_mfma_f32_16x16x32_bf16 v[112:115], a[132:135], a[64:67], v[112:115]
    ds_read_b64_tr_b16 a[128:129], v13 offset:35872
    v_mfma_f32_16x16x32_bf16 v[116:119], a[132:135], a[68:71], v[116:119]
    ds_read_b64_tr_b16 a[130:131], v13 offset:39456
    v_mfma_f32_16x16x32_bf16 v[120:123], a[132:135], a[72:75], v[120:123]
    v_mfma_f32_16x16x32_bf16 v[124:127], a[132:135], a[76:79], v[124:127]
    s_waitcnt lgkmcnt(4)
    v_mfma_f32_16x16x32_bf16 v[128:131], a[136:139], a[64:67], v[128:131]
    ds_read_b64_tr_b16 a[132:133], v13 offset:35904
    v_mfma_f32_16x16x32_bf16 v[132:135], a[136:139], a[68:71], v[132:135]
    ds_read_b64_tr_b16 a[134:135], v13 offset:39488
    v_mfma_f32_16x16x32_bf16 v[136:139], a[136:139], a[72:75], v[136:139]
    v_mfma_f32_16x16x32_bf16 v[140:143], a[136:139], a[76:79], v[140:143]
    buffer_load_dwordx4 a[148:151], v29, s[20:23], s47 offen offset:1024
    s_waitcnt lgkmcnt(4)
    v_mfma_f32_16x16x32_bf16 v[144:147], a[140:143], a[64:67], v[144:147]
    ds_read_b64_tr_b16 a[136:137], v13 offset:35936
    v_mfma_f32_16x16x32_bf16 v[148:151], a[140:143], a[68:71], v[148:151]
    ds_read_b64_tr_b16 a[138:139], v13 offset:39520
    v_mfma_f32_16x16x32_bf16 v[152:155], a[140:143], a[72:75], v[152:155]
    v_mfma_f32_16x16x32_bf16 v[156:159], a[140:143], a[76:79], v[156:159]
    buffer_load_dword v31, v30, s[4:7], s70 offen
    s_add_u32 s70, s70, 458752
    buffer_load_dwordx4 a[0:3], v2, s[8:11], s26 offen offset:0
    s_waitcnt lgkmcnt(4)
    v_mfma_f32_16x16x32_bf16 v[160:163], a[128:131], a[64:67], v[160:163]
    ds_read_b64_tr_b16 a[140:141], v13 offset:35968
    v_mfma_f32_16x16x32_bf16 v[164:167], a[128:131], a[68:71], v[164:167]
    ds_read_b64_tr_b16 a[142:143], v13 offset:39552
    v_mfma_f32_16x16x32_bf16 v[168:171], a[128:131], a[72:75], v[168:171]
    v_mfma_f32_16x16x32_bf16 v[172:175], a[128:131], a[76:79], v[172:175]
    s_waitcnt lgkmcnt(4)
    v_mfma_f32_16x16x32_bf16 v[176:179], a[132:135], a[64:67], v[176:179]
    ds_read_b64_tr_b16 a[128:129], v13 offset:36000
    v_mfma_f32_16x16x32_bf16 v[180:183], a[132:135], a[68:71], v[180:183]
    ds_read_b64_tr_b16 a[130:131], v13 offset:39584
    v_mfma_f32_16x16x32_bf16 v[184:187], a[132:135], a[72:75], v[184:187]
    v_mfma_f32_16x16x32_bf16 v[188:191], a[132:135], a[76:79], v[188:191]
    buffer_load_dwordx4 a[4:7], v3, s[8:11], s26 offen offset:0
    s_waitcnt lgkmcnt(4)
    v_mfma_f32_16x16x32_bf16 v[192:195], a[136:139], a[64:67], v[192:195]
    ds_read_b64_tr_b16 a[132:133], v13 offset:36032
    v_mfma_f32_16x16x32_bf16 v[196:199], a[136:139], a[68:71], v[196:199]
    ds_read_b64_tr_b16 a[134:135], v13 offset:39616
    v_mfma_f32_16x16x32_bf16 v[200:203], a[136:139], a[72:75], v[200:203]
    v_mfma_f32_16x16x32_bf16 v[204:207], a[136:139], a[76:79], v[204:207]
    buffer_load_dwordx4 a[152:155], v29, s[20:23], s47 offen offset:2048
    s_waitcnt lgkmcnt(4)
    v_mfma_f32_16x16x32_bf16 v[208:211], a[140:143], a[64:67], v[208:211]
    ds_read_b64_tr_b16 a[136:137], v13 offset:43008
    v_mfma_f32_16x16x32_bf16 v[212:215], a[140:143], a[68:71], v[212:215]
    ds_read_b64_tr_b16 a[138:139], v13 offset:46592
    v_mfma_f32_16x16x32_bf16 v[216:219], a[140:143], a[72:75], v[216:219]
    v_mfma_f32_16x16x32_bf16 v[220:223], a[140:143], a[76:79], v[220:223]
    s_waitcnt lgkmcnt(4)
    v_mfma_f32_16x16x32_bf16 v[224:227], a[128:131], a[64:67], v[224:227]
    ds_read_b64_tr_b16 a[140:141], v13 offset:43040
    v_mfma_f32_16x16x32_bf16 v[228:231], a[128:131], a[68:71], v[228:231]
    ds_read_b64_tr_b16 a[142:143], v13 offset:46624
    v_mfma_f32_16x16x32_bf16 v[232:235], a[128:131], a[72:75], v[232:235]
    v_mfma_f32_16x16x32_bf16 v[236:239], a[128:131], a[76:79], v[236:239]
    buffer_load_dwordx4 a[8:11], v4, s[8:11], s26 offen offset:0
    s_waitcnt lgkmcnt(4)
    v_mfma_f32_16x16x32_bf16 v[240:243], a[132:135], a[64:67], v[240:243]
    ds_read_b64_tr_b16 a[128:129], v13 offset:43072
    v_mfma_f32_16x16x32_bf16 v[244:247], a[132:135], a[68:71], v[244:247]
    ds_read_b64_tr_b16 a[130:131], v13 offset:46656
    v_mfma_f32_16x16x32_bf16 v[248:251], a[132:135], a[72:75], v[248:251]
    v_mfma_f32_16x16x32_bf16 v[252:255], a[132:135], a[76:79], v[252:255]
    buffer_load_dwordx4 a[12:15], v5, s[8:11], s26 offen offset:0
    s_waitcnt vmcnt(33)
    s_waitcnt lgkmcnt(4)
    v_mfma_f32_16x16x32_bf16 v[32:35], a[136:139], a[80:83], v[32:35]
    ds_read_b64_tr_b16 a[132:133], v13 offset:43104
    v_mfma_f32_16x16x32_bf16 v[36:39], a[136:139], a[84:87], v[36:39]
    ds_read_b64_tr_b16 a[134:135], v13 offset:46688
    v_mfma_f32_16x16x32_bf16 v[40:43], a[136:139], a[88:91], v[40:43]
    v_mfma_f32_16x16x32_bf16 v[44:47], a[136:139], a[92:95], v[44:47]
    s_waitcnt lgkmcnt(4)
    v_mfma_f32_16x16x32_bf16 v[48:51], a[140:143], a[80:83], v[48:51]
    ds_read_b64_tr_b16 a[136:137], v13 offset:43136
    v_mfma_f32_16x16x32_bf16 v[52:55], a[140:143], a[84:87], v[52:55]
    ds_read_b64_tr_b16 a[138:139], v13 offset:46720
    v_mfma_f32_16x16x32_bf16 v[56:59], a[140:143], a[88:91], v[56:59]
    v_mfma_f32_16x16x32_bf16 v[60:63], a[140:143], a[92:95], v[60:63]
    buffer_load_dwordx4 a[156:159], v29, s[20:23], s47 offen offset:3072
    s_waitcnt lgkmcnt(4)
    v_mfma_f32_16x16x32_bf16 v[64:67], a[128:131], a[80:83], v[64:67]
    ds_read_b64_tr_b16 a[140:141], v13 offset:43168
    v_mfma_f32_16x16x32_bf16 v[68:71], a[128:131], a[84:87], v[68:71]
    ds_read_b64_tr_b16 a[142:143], v13 offset:46752
    v_mfma_f32_16x16x32_bf16 v[72:75], a[128:131], a[88:91], v[72:75]
    v_mfma_f32_16x16x32_bf16 v[76:79], a[128:131], a[92:95], v[76:79]
    buffer_load_dwordx4 a[16:19], v2, s[8:11], s26 offen offset:1024
    s_waitcnt lgkmcnt(4)
    v_mfma_f32_16x16x32_bf16 v[80:83], a[132:135], a[80:83], v[80:83]
    ds_read_b64_tr_b16 a[128:129], v13 offset:43200
    v_mfma_f32_16x16x32_bf16 v[84:87], a[132:135], a[84:87], v[84:87]
    ds_read_b64_tr_b16 a[130:131], v13 offset:46784
    v_mfma_f32_16x16x32_bf16 v[88:91], a[132:135], a[88:91], v[88:91]
    v_mfma_f32_16x16x32_bf16 v[92:95], a[132:135], a[92:95], v[92:95]
    s_waitcnt lgkmcnt(4)
    v_mfma_f32_16x16x32_bf16 v[96:99], a[136:139], a[80:83], v[96:99]
    ds_read_b64_tr_b16 a[132:133], v13 offset:50176
    v_mfma_f32_16x16x32_bf16 v[100:103], a[136:139], a[84:87], v[100:103]
    ds_read_b64_tr_b16 a[134:135], v13 offset:53760
    v_mfma_f32_16x16x32_bf16 v[104:107], a[136:139], a[88:91], v[104:107]
    v_mfma_f32_16x16x32_bf16 v[108:111], a[136:139], a[92:95], v[108:111]
    buffer_load_dwordx4 a[20:23], v3, s[8:11], s26 offen offset:1024
    s_waitcnt lgkmcnt(4)
    v_mfma_f32_16x16x32_bf16 v[112:115], a[140:143], a[80:83], v[112:115]
    ds_read_b64_tr_b16 a[136:137], v13 offset:50208
    v_mfma_f32_16x16x32_bf16 v[116:119], a[140:143], a[84:87], v[116:119]
    ds_read_b64_tr_b16 a[138:139], v13 offset:53792
    v_mfma_f32_16x16x32_bf16 v[120:123], a[140:143], a[88:91], v[120:123]
    v_mfma_f32_16x16x32_bf16 v[124:127], a[140:143], a[92:95], v[124:127]
    buffer_load_dwordx4 a[24:27], v4, s[8:11], s26 offen offset:1024
    s_waitcnt lgkmcnt(4)
    v_mfma_f32_16x16x32_bf16 v[128:131], a[128:131], a[80:83], v[128:131]
    ds_read_b64_tr_b16 a[140:141], v13 offset:50240
    v_mfma_f32_16x16x32_bf16 v[132:135], a[128:131], a[84:87], v[132:135]
    ds_read_b64_tr_b16 a[142:143], v13 offset:53824
    v_mfma_f32_16x16x32_bf16 v[136:139], a[128:131], a[88:91], v[136:139]
    v_mfma_f32_16x16x32_bf16 v[140:143], a[128:131], a[92:95], v[140:143]
    s_waitcnt lgkmcnt(4)
    v_mfma_f32_16x16x32_bf16 v[144:147], a[132:135], a[80:83], v[144:147]
    ds_read_b64_tr_b16 a[128:129], v13 offset:50272
    v_mfma_f32_16x16x32_bf16 v[148:151], a[132:135], a[84:87], v[148:151]
    ds_read_b64_tr_b16 a[130:131], v13 offset:53856
    v_mfma_f32_16x16x32_bf16 v[152:155], a[132:135], a[88:91], v[152:155]
    v_mfma_f32_16x16x32_bf16 v[156:159], a[132:135], a[92:95], v[156:159]
    buffer_load_dwordx4 a[28:31], v5, s[8:11], s26 offen offset:1024
    s_waitcnt lgkmcnt(4)
    v_mfma_f32_16x16x32_bf16 v[160:163], a[136:139], a[80:83], v[160:163]
    ds_read_b64_tr_b16 a[132:133], v13 offset:50304
    v_mfma_f32_16x16x32_bf16 v[164:167], a[136:139], a[84:87], v[164:167]
    ds_read_b64_tr_b16 a[134:135], v13 offset:53888
    v_mfma_f32_16x16x32_bf16 v[168:171], a[136:139], a[88:91], v[168:171]
    v_mfma_f32_16x16x32_bf16 v[172:175], a[136:139], a[92:95], v[172:175]
    s_add_u32 m0, s28, 114688
    s_nop 0
    buffer_load_dwordx4 v6, s[12:15], s25 offen offset:0 lds
    s_waitcnt lgkmcnt(4)
    v_mfma_f32_16x16x32_bf16 v[176:179], a[140:143], a[80:83], v[176:179]
    ds_read_b64_tr_b16 a[136:137], v13 offset:50336
    v_mfma_f32_16x16x32_bf16 v[180:183], a[140:143], a[84:87], v[180:183]
    ds_read_b64_tr_b16 a[138:139], v13 offset:53920
    v_mfma_f32_16x16x32_bf16 v[184:187], a[140:143], a[88:91], v[184:187]
    v_mfma_f32_16x16x32_bf16 v[188:191], a[140:143], a[92:95], v[188:191]
    s_waitcnt lgkmcnt(4)
    v_mfma_f32_16x16x32_bf16 v[192:195], a[128:131], a[80:83], v[192:195]
    ds_read_b64_tr_b16 a[140:141], v13 offset:50368
    v_mfma_f32_16x16x32_bf16 v[196:199], a[128:131], a[84:87], v[196:199]
    ds_read_b64_tr_b16 a[142:143], v13 offset:53952
    v_mfma_f32_16x16x32_bf16 v[200:203], a[128:131], a[88:91], v[200:203]
    v_mfma_f32_16x16x32_bf16 v[204:207], a[128:131], a[92:95], v[204:207]
    buffer_load_dwordx4 v7, s[12:15], s25 offen offset:1024 lds
    s_waitcnt lgkmcnt(4)
    v_mfma_f32_16x16x32_bf16 v[208:211], a[132:135], a[80:83], v[208:211]
    s_waitcnt vmcnt(32)
    s_barrier
    ds_read_b64_tr_b16 a[128:129], v14 offset:0
    v_mfma_f32_16x16x32_bf16 v[212:215], a[132:135], a[84:87], v[212:215]
    ds_read_b64_tr_b16 a[130:131], v14 offset:3584
    v_mfma_f32_16x16x32_bf16 v[216:219], a[132:135], a[88:91], v[216:219]
    v_mfma_f32_16x16x32_bf16 v[220:223], a[132:135], a[92:95], v[220:223]
    buffer_load_dwordx4 v8, s[12:15], s25 offen offset:2048 lds
    s_waitcnt lgkmcnt(4)
    v_mfma_f32_16x16x32_bf16 v[224:227], a[136:139], a[80:83], v[224:227]
    ds_read_b64_tr_b16 a[132:133], v14 offset:32
    v_mfma_f32_16x16x32_bf16 v[228:231], a[136:139], a[84:87], v[228:231]
    ds_read_b64_tr_b16 a[134:135], v14 offset:3616
    v_mfma_f32_16x16x32_bf16 v[232:235], a[136:139], a[88:91], v[232:235]
    v_mfma_f32_16x16x32_bf16 v[236:239], a[136:139], a[92:95], v[236:239]
    s_waitcnt lgkmcnt(4)
    v_mfma_f32_16x16x32_bf16 v[240:243], a[140:143], a[80:83], v[240:243]
    ds_read_b64_tr_b16 a[136:137], v14 offset:64
    v_mfma_f32_16x16x32_bf16 v[244:247], a[140:143], a[84:87], v[244:247]
    ds_read_b64_tr_b16 a[138:139], v14 offset:3648
    v_mfma_f32_16x16x32_bf16 v[248:251], a[140:143], a[88:91], v[248:251]
    v_mfma_f32_16x16x32_bf16 v[252:255], a[140:143], a[92:95], v[252:255]
    buffer_load_dwordx4 v9, s[12:15], s25 offen offset:3072 lds
    s_waitcnt vmcnt(28)
    s_waitcnt lgkmcnt(4)
    v_mfma_f32_16x16x32_bf16 v[32:35], a[128:131], a[96:99], v[32:35]
    ds_read_b64_tr_b16 a[140:141], v14 offset:96
    v_mfma_f32_16x16x32_bf16 v[36:39], a[128:131], a[100:103], v[36:39]
    ds_read_b64_tr_b16 a[142:143], v14 offset:3680
    v_mfma_f32_16x16x32_bf16 v[40:43], a[128:131], a[104:107], v[40:43]
    v_mfma_f32_16x16x32_bf16 v[44:47], a[128:131], a[108:111], v[44:47]
    s_add_u32 m0, s28, 118784
    s_nop 0
    buffer_load_dwordx4 v10, s[12:15], s25 offen offset:0 lds
    s_waitcnt lgkmcnt(4)
    v_mfma_f32_16x16x32_bf16 v[48:51], a[132:135], a[96:99], v[48:51]
    ds_read_b64_tr_b16 a[128:129], v14 offset:128
    v_mfma_f32_16x16x32_bf16 v[52:55], a[132:135], a[100:103], v[52:55]
    ds_read_b64_tr_b16 a[130:131], v14 offset:3712
    v_mfma_f32_16x16x32_bf16 v[56:59], a[132:135], a[104:107], v[56:59]
    v_mfma_f32_16x16x32_bf16 v[60:63], a[132:135], a[108:111], v[60:63]
    s_waitcnt lgkmcnt(4)
    v_mfma_f32_16x16x32_bf16 v[64:67], a[136:139], a[96:99], v[64:67]
    ds_read_b64_tr_b16 a[132:133], v14 offset:160
    v_mfma_f32_16x16x32_bf16 v[68:71], a[136:139], a[100:103], v[68:71]
    ds_read_b64_tr_b16 a[134:135], v14 offset:3744
    v_mfma_f32_16x16x32_bf16 v[72:75], a[136:139], a[104:107], v[72:75]
    v_mfma_f32_16x16x32_bf16 v[76:79], a[136:139], a[108:111], v[76:79]
    buffer_load_dword v31, v30, s[4:7], s70 offen
    s_add_u32 s70, s70, 458752
    buffer_load_dwordx4 v11, s[12:15], s25 offen offset:1024 lds
    s_waitcnt lgkmcnt(4)
    v_mfma_f32_16x16x32_bf16 v[80:83], a[140:143], a[96:99], v[80:83]
    ds_read_b64_tr_b16 a[136:137], v14 offset:192
    v_mfma_f32_16x16x32_bf16 v[84:87], a[140:143], a[100:103], v[84:87]
    ds_read_b64_tr_b16 a[138:139], v14 offset:3776
    v_mfma_f32_16x16x32_bf16 v[88:91], a[140:143], a[104:107], v[88:91]
    v_mfma_f32_16x16x32_bf16 v[92:95], a[140:143], a[108:111], v[92:95]
    buffer_load_dwordx4 v12, s[12:15], s25 offen offset:2048 lds
    s_add_u32 s25, s25, 458752
    s_waitcnt lgkmcnt(4)
    v_mfma_f32_16x16x32_bf16 v[96:99], a[128:131], a[96:99], v[96:99]
    ds_read_b64_tr_b16 a[140:141], v14 offset:7168
    v_mfma_f32_16x16x32_bf16 v[100:103], a[128:131], a[100:103], v[100:103]
    ds_read_b64_tr_b16 a[142:143], v14 offset:10752
    v_mfma_f32_16x16x32_bf16 v[104:107], a[128:131], a[104:107], v[104:107]
    v_mfma_f32_16x16x32_bf16 v[108:111], a[128:131], a[108:111], v[108:111]
    s_waitcnt lgkmcnt(4)
    v_mfma_f32_16x16x32_bf16 v[112:115], a[132:135], a[96:99], v[112:115]
    ds_read_b64_tr_b16 a[128:129], v14 offset:7200
    v_mfma_f32_16x16x32_bf16 v[116:119], a[132:135], a[100:103], v[116:119]
    ds_read_b64_tr_b16 a[130:131], v14 offset:10784
    v_mfma_f32_16x16x32_bf16 v[120:123], a[132:135], a[104:107], v[120:123]
    v_mfma_f32_16x16x32_bf16 v[124:127], a[132:135], a[108:111], v[124:127]
    buffer_load_dwordx4 a[32:35], v2, s[8:11], s26 offen offset:2048
    s_waitcnt lgkmcnt(4)
    v_mfma_f32_16x16x32_bf16 v[128:131], a[136:139], a[96:99], v[128:131]
    ds_read_b64_tr_b16 a[132:133], v14 offset:7232
    v_mfma_f32_16x16x32_bf16 v[132:135], a[136:139], a[100:103], v[132:135]
    ds_read_b64_tr_b16 a[134:135], v14 offset:10816
    v_mfma_f32_16x16x32_bf16 v[136:139], a[136:139], a[104:107], v[136:139]
    v_mfma_f32_16x16x32_bf16 v[140:143], a[136:139], a[108:111], v[140:143]
    s_waitcnt lgkmcnt(4)
    v_mfma_f32_16x16x32_bf16 v[144:147], a[140:143], a[96:99], v[144:147]
    ds_read_b64_tr_b16 a[136:137], v14 offset:7264
    v_mfma_f32_16x16x32_bf16 v[148:151], a[140:143], a[100:103], v[148:151]
    ds_read_b64_tr_b16 a[138:139], v14 offset:10848
    v_mfma_f32_16x16x32_bf16 v[152:155], a[140:143], a[104:107], v[152:155]
    v_mfma_f32_16x16x32_bf16 v[156:159], a[140:143], a[108:111], v[156:159]
    buffer_load_dwordx4 a[36:39], v3, s[8:11], s26 offen offset:2048
    s_waitcnt lgkmcnt(4)
    v_mfma_f32_16x16x32_bf16 v[160:163], a[128:131], a[96:99], v[160:163]
    ds_read_b64_tr_b16 a[140:141], v14 offset:7296
    v_mfma_f32_16x16x32_bf16 v[164:167], a[128:131], a[100:103], v[164:167]
    ds_read_b64_tr_b16 a[142:143], v14 offset:10880
    v_mfma_f32_16x16x32_bf16 v[168:171], a[128:131], a[104:107], v[168:171]
    v_mfma_f32_16x16x32_bf16 v[172:175], a[128:131], a[108:111], v[172:175]
    buffer_load_dwordx4 a[40:43], v4, s[8:11], s26 offen offset:2048
    s_waitcnt lgkmcnt(4)
    v_mfma_f32_16x16x32_bf16 v[176:179], a[132:135], a[96:99], v[176:179]
    ds_read_b64_tr_b16 a[128:129], v14 offset:7328
    v_mfma_f32_16x16x32_bf16 v[180:183], a[132:135], a[100:103], v[180:183]
    ds_read_b64_tr_b16 a[130:131], v14 offset:10912
    v_mfma_f32_16x16x32_bf16 v[184:187], a[132:135], a[104:107], v[184:187]
    v_mfma_f32_16x16x32_bf16 v[188:191], a[132:135], a[108:111], v[188:191]
    s_waitcnt lgkmcnt(4)
    v_mfma_f32_16x16x32_bf16 v[192:195], a[136:139], a[96:99], v[192:195]
    ds_read_b64_tr_b16 a[132:133], v14 offset:7360
    v_mfma_f32_16x16x32_bf16 v[196:199], a[136:139], a[100:103], v[196:199]
    ds_read_b64_tr_b16 a[134:135], v14 offset:10944
    v_mfma_f32_16x16x32_bf16 v[200:203], a[136:139], a[104:107], v[200:203]
    v_mfma_f32_16x16x32_bf16 v[204:207], a[136:139], a[108:111], v[204:207]
    buffer_load_dwordx4 a[44:47], v5, s[8:11], s26 offen offset:2048
    s_waitcnt lgkmcnt(4)
    v_mfma_f32_16x16x32_bf16 v[208:211], a[140:143], a[96:99], v[208:211]
    ds_read_b64_tr_b16 a[136:137], v14 offset:14336
    v_mfma_f32_16x16x32_bf16 v[212:215], a[140:143], a[100:103], v[212:215]
    ds_read_b64_tr_b16 a[138:139], v14 offset:17920
    v_mfma_f32_16x16x32_bf16 v[216:219], a[140:143], a[104:107], v[216:219]
    v_mfma_f32_16x16x32_bf16 v[220:223], a[140:143], a[108:111], v[220:223]
    buffer_load_dwordx4 a[48:51], v2, s[8:11], s26 offen offset:3072
    s_waitcnt lgkmcnt(4)
    v_mfma_f32_16x16x32_bf16 v[224:227], a[128:131], a[96:99], v[224:227]
    ds_read_b64_tr_b16 a[140:141], v14 offset:14368
    v_mfma_f32_16x16x32_bf16 v[228:231], a[128:131], a[100:103], v[228:231]
    ds_read_b64_tr_b16 a[142:143], v14 offset:17952
    v_mfma_f32_16x16x32_bf16 v[232:235], a[128:131], a[104:107], v[232:235]
    v_mfma_f32_16x16x32_bf16 v[236:239], a[128:131], a[108:111], v[236:239]
    s_waitcnt lgkmcnt(4)
    v_mfma_f32_16x16x32_bf16 v[240:243], a[132:135], a[96:99], v[240:243]
    ds_read_b64_tr_b16 a[128:129], v14 offset:14400
    v_mfma_f32_16x16x32_bf16 v[244:247], a[132:135], a[100:103], v[244:247]
    ds_read_b64_tr_b16 a[130:131], v14 offset:17984
    v_mfma_f32_16x16x32_bf16 v[248:251], a[132:135], a[104:107], v[248:251]
    v_mfma_f32_16x16x32_bf16 v[252:255], a[132:135], a[108:111], v[252:255]
    buffer_load_dwordx4 a[52:55], v3, s[8:11], s26 offen offset:3072
    s_waitcnt vmcnt(34)
    s_waitcnt lgkmcnt(4)
    v_mfma_f32_16x16x32_bf16 v[32:35], a[136:139], a[112:115], v[32:35]
    ds_read_b64_tr_b16 a[132:133], v14 offset:14432
    v_mfma_f32_16x16x32_bf16 v[36:39], a[136:139], a[116:119], v[36:39]
    ds_read_b64_tr_b16 a[134:135], v14 offset:18016
    v_mfma_f32_16x16x32_bf16 v[40:43], a[136:139], a[120:123], v[40:43]
    v_mfma_f32_16x16x32_bf16 v[44:47], a[136:139], a[124:127], v[44:47]
    buffer_load_dwordx4 a[56:59], v4, s[8:11], s26 offen offset:3072
    s_waitcnt lgkmcnt(4)
    v_mfma_f32_16x16x32_bf16 v[48:51], a[140:143], a[112:115], v[48:51]
    ds_read_b64_tr_b16 a[136:137], v14 offset:14464
    v_mfma_f32_16x16x32_bf16 v[52:55], a[140:143], a[116:119], v[52:55]
    ds_read_b64_tr_b16 a[138:139], v14 offset:18048
    v_mfma_f32_16x16x32_bf16 v[56:59], a[140:143], a[120:123], v[56:59]
    v_mfma_f32_16x16x32_bf16 v[60:63], a[140:143], a[124:127], v[60:63]
    s_waitcnt lgkmcnt(4)
    v_mfma_f32_16x16x32_bf16 v[64:67], a[128:131], a[112:115], v[64:67]
    ds_read_b64_tr_b16 a[140:141], v14 offset:14496
    v_mfma_f32_16x16x32_bf16 v[68:71], a[128:131], a[116:119], v[68:71]
    ds_read_b64_tr_b16 a[142:143], v14 offset:18080
    v_mfma_f32_16x16x32_bf16 v[72:75], a[128:131], a[120:123], v[72:75]
    v_mfma_f32_16x16x32_bf16 v[76:79], a[128:131], a[124:127], v[76:79]
    buffer_load_dwordx4 a[60:63], v5, s[8:11], s26 offen offset:3072
    s_add_u32 s26, s26, 4096
    s_waitcnt lgkmcnt(4)
    v_mfma_f32_16x16x32_bf16 v[80:83], a[132:135], a[112:115], v[80:83]
    ds_read_b64_tr_b16 a[128:129], v14 offset:14528
    v_mfma_f32_16x16x32_bf16 v[84:87], a[132:135], a[116:119], v[84:87]
    ds_read_b64_tr_b16 a[130:131], v14 offset:18112
    v_mfma_f32_16x16x32_bf16 v[88:91], a[132:135], a[120:123], v[88:91]
    v_mfma_f32_16x16x32_bf16 v[92:95], a[132:135], a[124:127], v[92:95]
    s_add_u32 m0, s28, 0
    s_nop 0
    buffer_load_dwordx4 v6, s[12:15], s25 offen offset:0 lds
    s_waitcnt lgkmcnt(4)
    v_mfma_f32_16x16x32_bf16 v[96:99], a[136:139], a[112:115], v[96:99]
    ds_read_b64_tr_b16 a[132:133], v14 offset:21504
    v_mfma_f32_16x16x32_bf16 v[100:103], a[136:139], a[116:119], v[100:103]
    ds_read_b64_tr_b16 a[134:135], v14 offset:25088
    v_mfma_f32_16x16x32_bf16 v[104:107], a[136:139], a[120:123], v[104:107]
    v_mfma_f32_16x16x32_bf16 v[108:111], a[136:139], a[124:127], v[108:111]
    s_waitcnt lgkmcnt(4)
    v_mfma_f32_16x16x32_bf16 v[112:115], a[140:143], a[112:115], v[112:115]
    ds_read_b64_tr_b16 a[136:137], v14 offset:21536
    v_mfma_f32_16x16x32_bf16 v[116:119], a[140:143], a[116:119], v[116:119]
    ds_read_b64_tr_b16 a[138:139], v14 offset:25120
    v_mfma_f32_16x16x32_bf16 v[120:123], a[140:143], a[120:123], v[120:123]
    v_mfma_f32_16x16x32_bf16 v[124:127], a[140:143], a[124:127], v[124:127]
    buffer_load_dwordx4 v7, s[12:15], s25 offen offset:1024 lds
    s_waitcnt lgkmcnt(4)
    v_mfma_f32_16x16x32_bf16 v[128:131], a[128:131], a[112:115], v[128:131]
    ds_read_b64_tr_b16 a[140:141], v14 offset:21568
    v_mfma_f32_16x16x32_bf16 v[132:135], a[128:131], a[116:119], v[132:135]
    ds_read_b64_tr_b16 a[142:143], v14 offset:25152
    v_mfma_f32_16x16x32_bf16 v[136:139], a[128:131], a[120:123], v[136:139]
    v_mfma_f32_16x16x32_bf16 v[140:143], a[128:131], a[124:127], v[140:143]
    buffer_load_dwordx4 v8, s[12:15], s25 offen offset:2048 lds
    s_waitcnt lgkmcnt(4)
    v_mfma_f32_16x16x32_bf16 v[144:147], a[132:135], a[112:115], v[144:147]
    ds_read_b64_tr_b16 a[128:129], v14 offset:21600
    v_mfma_f32_16x16x32_bf16 v[148:151], a[132:135], a[116:119], v[148:151]
    ds_read_b64_tr_b16 a[130:131], v14 offset:25184
    v_mfma_f32_16x16x32_bf16 v[152:155], a[132:135], a[120:123], v[152:155]
    v_mfma_f32_16x16x32_bf16 v[156:159], a[132:135], a[124:127], v[156:159]
    s_waitcnt lgkmcnt(4)
    v_mfma_f32_16x16x32_bf16 v[160:163], a[136:139], a[112:115], v[160:163]
    ds_read_b64_tr_b16 a[132:133], v14 offset:21632
    v_mfma_f32_16x16x32_bf16 v[164:167], a[136:139], a[116:119], v[164:167]
    ds_read_b64_tr_b16 a[134:135], v14 offset:25216
    v_mfma_f32_16x16x32_bf16 v[168:171], a[136:139], a[120:123], v[168:171]
    v_mfma_f32_16x16x32_bf16 v[172:175], a[136:139], a[124:127], v[172:175]
    buffer_load_dwordx4 v9, s[12:15], s25 offen offset:3072 lds
    s_waitcnt lgkmcnt(4)
    v_mfma_f32_16x16x32_bf16 v[176:179], a[140:143], a[112:115], v[176:179]
    ds_read_b64_tr_b16 a[136:137], v14 offset:21664
    v_mfma_f32_16x16x32_bf16 v[180:183], a[140:143], a[116:119], v[180:183]
    ds_read_b64_tr_b16 a[138:139], v14 offset:25248
    v_mfma_f32_16x16x32_bf16 v[184:187], a[140:143], a[120:123], v[184:187]
    v_mfma_f32_16x16x32_bf16 v[188:191], a[140:143], a[124:127], v[188:191]
    s_add_u32 m0, s28, 4096
    s_nop 0
    buffer_load_dwordx4 v10, s[12:15], s25 offen offset:0 lds
    s_waitcnt lgkmcnt(4)
    v_mfma_f32_16x16x32_bf16 v[192:195], a[128:131], a[112:115], v[192:195]
    ds_read_b64_tr_b16 a[140:141], v14 offset:21696
    v_mfma_f32_16x16x32_bf16 v[196:199], a[128:131], a[116:119], v[196:199]
    ds_read_b64_tr_b16 a[142:143], v14 offset:25280
    v_mfma_f32_16x16x32_bf16 v[200:203], a[128:131], a[120:123], v[200:203]
    v_mfma_f32_16x16x32_bf16 v[204:207], a[128:131], a[124:127], v[204:207]
    s_waitcnt lgkmcnt(4)
    v_mfma_f32_16x16x32_bf16 v[208:211], a[132:135], a[112:115], v[208:211]
    s_waitcnt vmcnt(33)
    s_barrier
    ds_read_b64_tr_b16 a[128:129], v14 offset:28672
    v_mfma_f32_16x16x32_bf16 v[212:215], a[132:135], a[116:119], v[212:215]
    ds_read_b64_tr_b16 a[130:131], v14 offset:32256
    v_mfma_f32_16x16x32_bf16 v[216:219], a[132:135], a[120:123], v[216:219]
    v_mfma_f32_16x16x32_bf16 v[220:223], a[132:135], a[124:127], v[220:223]
    buffer_load_dwordx4 v11, s[12:15], s25 offen offset:1024 lds
    s_waitcnt lgkmcnt(4)
    v_mfma_f32_16x16x32_bf16 v[224:227], a[136:139], a[112:115], v[224:227]
    ds_read_b64_tr_b16 a[132:133], v14 offset:28704
    v_mfma_f32_16x16x32_bf16 v[228:231], a[136:139], a[116:119], v[228:231]
    ds_read_b64_tr_b16 a[134:135], v14 offset:32288
    v_mfma_f32_16x16x32_bf16 v[232:235], a[136:139], a[120:123], v[232:235]
    v_mfma_f32_16x16x32_bf16 v[236:239], a[136:139], a[124:127], v[236:239]
    buffer_load_dwordx4 v12, s[12:15], s25 offen offset:2048 lds
    s_add_u32 s25, s25, 458752
    s_waitcnt lgkmcnt(4)
    v_mfma_f32_16x16x32_bf16 v[240:243], a[140:143], a[112:115], v[240:243]
    ds_read_b64_tr_b16 a[136:137], v14 offset:28736
    v_mfma_f32_16x16x32_bf16 v[244:247], a[140:143], a[116:119], v[244:247]
    ds_read_b64_tr_b16 a[138:139], v14 offset:32320
    v_mfma_f32_16x16x32_bf16 v[248:251], a[140:143], a[120:123], v[248:251]
    v_mfma_f32_16x16x32_bf16 v[252:255], a[140:143], a[124:127], v[252:255]
    s_waitcnt vmcnt(28)
    s_waitcnt lgkmcnt(4)
    v_mfma_f32_16x16x32_bf16 v[32:35], a[128:131], a[0:3], v[32:35]
    ds_read_b64_tr_b16 a[140:141], v14 offset:28768
    v_mfma_f32_16x16x32_bf16 v[36:39], a[128:131], a[4:7], v[36:39]
    ds_read_b64_tr_b16 a[142:143], v14 offset:32352
    v_mfma_f32_16x16x32_bf16 v[40:43], a[128:131], a[8:11], v[40:43]
    v_mfma_f32_16x16x32_bf16 v[44:47], a[128:131], a[12:15], v[44:47]
    buffer_load_dwordx4 a[64:67], v2, s[8:11], s26 offen offset:0
    s_waitcnt lgkmcnt(4)
    v_mfma_f32_16x16x32_bf16 v[48:51], a[132:135], a[0:3], v[48:51]
    ds_read_b64_tr_b16 a[128:129], v14 offset:28800
    v_mfma_f32_16x16x32_bf16 v[52:55], a[132:135], a[4:7], v[52:55]
    ds_read_b64_tr_b16 a[130:131], v14 offset:32384
    v_mfma_f32_16x16x32_bf16 v[56:59], a[132:135], a[8:11], v[56:59]
    v_mfma_f32_16x16x32_bf16 v[60:63], a[132:135], a[12:15], v[60:63]
    buffer_load_dwordx4 a[68:71], v3, s[8:11], s26 offen offset:0
    s_waitcnt lgkmcnt(4)
    v_mfma_f32_16x16x32_bf16 v[64:67], a[136:139], a[0:3], v[64:67]
    ds_read_b64_tr_b16 a[132:133], v14 offset:28832
    v_mfma_f32_16x16x32_bf16 v[68:71], a[136:139], a[4:7], v[68:71]
    ds_read_b64_tr_b16 a[134:135], v14 offset:32416
    v_mfma_f32_16x16x32_bf16 v[72:75], a[136:139], a[8:11], v[72:75]
    v_mfma_f32_16x16x32_bf16 v[76:79], a[136:139], a[12:15], v[76:79]
    s_waitcnt lgkmcnt(4)
    v_mfma_f32_16x16x32_bf16 v[80:83], a[140:143], a[0:3], v[80:83]
    ds_read_b64_tr_b16 a[136:137], v14 offset:28864
    v_mfma_f32_16x16x32_bf16 v[84:87], a[140:143], a[4:7], v[84:87]
    ds_read_b64_tr_b16 a[138:139], v14 offset:32448
    v_mfma_f32_16x16x32_bf16 v[88:91], a[140:143], a[8:11], v[88:91]
    v_mfma_f32_16x16x32_bf16 v[92:95], a[140:143], a[12:15], v[92:95]
    buffer_load_dwordx4 a[72:75], v4, s[8:11], s26 offen offset:0
    s_waitcnt lgkmcnt(4)
    v_mfma_f32_16x16x32_bf16 v[96:99], a[128:131], a[0:3], v[96:99]
    ds_read_b64_tr_b16 a[140:141], v14 offset:35840
    v_mfma_f32_16x16x32_bf16 v[100:103], a[128:131], a[4:7], v[100:103]
    ds_read_b64_tr_b16 a[142:143], v14 offset:39424
    v_mfma_f32_16x16x32_bf16 v[104:107], a[128:131], a[8:11], v[104:107]
    v_mfma_f32_16x16x32_bf16 v[108:111], a[128:131], a[12:15], v[108:111]
    buffer_load_dwordx4 a[76:79], v5, s[8:11], s26 offen offset:0
    s_waitcnt lgkmcnt(4)
    v_mfma_f32_16x16x32_bf16 v[112:115], a[132:135], a[0:3], v[112:115]
    ds_read_b64_tr_b16 a[128:129], v14 offset:35872
    v_mfma_f32_16x16x32_bf16 v[116:119], a[132:135], a[4:7], v[116:119]
    ds_read_b64_tr_b16 a[130:131], v14 offset:39456
    v_mfma_f32_16x16x32_bf16 v[120:123], a[132:135], a[8:11], v[120:123]
    v_mfma_f32_16x16x32_bf16 v[124:127], a[132:135], a[12:15], v[124:127]
    s_waitcnt lgkmcnt(4)
    v_mfma_f32_16x16x32_bf16 v[128:131], a[136:139], a[0:3], v[128:131]
    ds_read_b64_tr_b16 a[132:133], v14 offset:35904
    v_mfma_f32_16x16x32_bf16 v[132:135], a[136:139], a[4:7], v[132:135]
    ds_read_b64_tr_b16 a[134:135], v14 offset:39488
    v_mfma_f32_16x16x32_bf16 v[136:139], a[136:139], a[8:11], v[136:139]
    v_mfma_f32_16x16x32_bf16 v[140:143], a[136:139], a[12:15], v[140:143]
    buffer_load_dwordx4 a[80:83], v2, s[8:11], s26 offen offset:1024
    s_waitcnt lgkmcnt(4)
    v_mfma_f32_16x16x32_bf16 v[144:147], a[140:143], a[0:3], v[144:147]
    ds_read_b64_tr_b16 a[136:137], v14 offset:35936
    v_mfma_f32_16x16x32_bf16 v[148:151], a[140:143], a[4:7], v[148:151]
    ds_read_b64_tr_b16 a[138:139], v14 offset:39520
    v_mfma_f32_16x16x32_bf16 v[152:155], a[140:143], a[8:11], v[152:155]
    v_mfma_f32_16x16x32_bf16 v[156:159], a[140:143], a[12:15], v[156:159]
    buffer_load_dwordx4 a[84:87], v3, s[8:11], s26 offen offset:1024
    s_waitcnt lgkmcnt(4)
    v_mfma_f32_16x16x32_bf16 v[160:163], a[128:131], a[0:3], v[160:163]
    ds_read_b64_tr_b16 a[140:141], v14 offset:35968
    v_mfma_f32_16x16x32_bf16 v[164:167], a[128:131], a[4:7], v[164:167]
    ds_read_b64_tr_b16 a[142:143], v14 offset:39552
    v_mfma_f32_16x16x32_bf16 v[168:171], a[128:131], a[8:11], v[168:171]
    v_mfma_f32_16x16x32_bf16 v[172:175], a[128:131], a[12:15], v[172:175]
    s_waitcnt lgkmcnt(4)
    v_mfma_f32_16x16x32_bf16 v[176:179], a[132:135], a[0:3], v[176:179]
    ds_read_b64_tr_b16 a[128:129], v14 offset:36000
    v_mfma_f32_16x16x32_bf16 v[180:183], a[132:135], a[4:7], v[180:183]
    ds_read_b64_tr_b16 a[130:131], v14 offset:39584
    v_mfma_f32_16x16x32_bf16 v[184:187], a[132:135], a[8:11], v[184:187]
    v_mfma_f32_16x16x32_bf16 v[188:191], a[132:135], a[12:15], v[188:191]
    buffer_load_dwordx4 a[88:91], v4, s[8:11], s26 offen offset:1024
    s_waitcnt lgkmcnt(4)
    v_mfma_f32_16x16x32_bf16 v[192:195], a[136:139], a[0:3], v[192:195]
    ds_read_b64_tr_b16 a[132:133], v14 offset:36032
    v_mfma_f32_16x16x32_bf16 v[196:199], a[136:139], a[4:7], v[196:199]
    ds_read_b64_tr_b16 a[134:135], v14 offset:39616
    v_mfma_f32_16x16x32_bf16 v[200:203], a[136:139], a[8:11], v[200:203]
    v_mfma_f32_16x16x32_bf16 v[204:207], a[136:139], a[12:15], v[204:207]
    buffer_load_dwordx4 a[92:95], v5, s[8:11], s26 offen offset:1024
    s_waitcnt lgkmcnt(4)
    v_mfma_f32_16x16x32_bf16 v[208:211], a[140:143], a[0:3], v[208:211]
    ds_read_b64_tr_b16 a[136:137], v14 offset:43008
    v_mfma_f32_16x16x32_bf16 v[212:215], a[140:143], a[4:7], v[212:215]
    ds_read_b64_tr_b16 a[138:139], v14 offset:46592
    v_mfma_f32_16x16x32_bf16 v[216:219], a[140:143], a[8:11], v[216:219]
    v_mfma_f32_16x16x32_bf16 v[220:223], a[140:143], a[12:15], v[220:223]
    s_waitcnt lgkmcnt(4)
    v_mfma_f32_16x16x32_bf16 v[224:227], a[128:131], a[0:3], v[224:227]
    ds_read_b64_tr_b16 a[140:141], v14 offset:43040
    v_mfma_f32_16x16x32_bf16 v[228:231], a[128:131], a[4:7], v[228:231]
    ds_read_b64_tr_b16 a[142:143], v14 offset:46624
    v_mfma_f32_16x16x32_bf16 v[232:235], a[128:131], a[8:11], v[232:235]
    v_mfma_f32_16x16x32_bf16 v[236:239], a[128:131], a[12:15], v[236:239]
    s_add_u32 m0, s28, 28672
    s_nop 0
    buffer_load_dwordx4 v6, s[12:15], s25 offen offset:0 lds
    s_waitcnt lgkmcnt(4)
    v_mfma_f32_16x16x32_bf16 v[240:243], a[132:135], a[0:3], v[240:243]
    ds_read_b64_tr_b16 a[128:129], v14 offset:43072
    v_mfma_f32_16x16x32_bf16 v[244:247], a[132:135], a[4:7], v[244:247]
    ds_read_b64_tr_b16 a[130:131], v14 offset:46656
    v_mfma_f32_16x16x32_bf16 v[248:251], a[132:135], a[8:11], v[248:251]
    v_mfma_f32_16x16x32_bf16 v[252:255], a[132:135], a[12:15], v[252:255]
    buffer_load_dwordx4 v7, s[12:15], s25 offen offset:1024 lds
    s_waitcnt vmcnt(33)
    s_waitcnt lgkmcnt(4)
    v_mfma_f32_16x16x32_bf16 v[32:35], a[136:139], a[16:19], v[32:35]
    ds_read_b64_tr_b16 a[132:133], v14 offset:43104
    v_mfma_f32_16x16x32_bf16 v[36:39], a[136:139], a[20:23], v[36:39]
    ds_read_b64_tr_b16 a[134:135], v14 offset:46688
    v_mfma_f32_16x16x32_bf16 v[40:43], a[136:139], a[24:27], v[40:43]
    v_mfma_f32_16x16x32_bf16 v[44:47], a[136:139], a[28:31], v[44:47]
    s_waitcnt lgkmcnt(4)
    v_mfma_f32_16x16x32_bf16 v[48:51], a[140:143], a[16:19], v[48:51]
    ds_read_b64_tr_b16 a[136:137], v14 offset:43136
    v_mfma_f32_16x16x32_bf16 v[52:55], a[140:143], a[20:23], v[52:55]
    ds_read_b64_tr_b16 a[138:139], v14 offset:46720
    v_mfma_f32_16x16x32_bf16 v[56:59], a[140:143], a[24:27], v[56:59]
    v_mfma_f32_16x16x32_bf16 v[60:63], a[140:143], a[28:31], v[60:63]
    buffer_load_dwordx4 v8, s[12:15], s25 offen offset:2048 lds
    s_waitcnt lgkmcnt(4)
    v_mfma_f32_16x16x32_bf16 v[64:67], a[128:131], a[16:19], v[64:67]
    ds_read_b64_tr_b16 a[140:141], v14 offset:43168
    v_mfma_f32_16x16x32_bf16 v[68:71], a[128:131], a[20:23], v[68:71]
    ds_read_b64_tr_b16 a[142:143], v14 offset:46752
    v_mfma_f32_16x16x32_bf16 v[72:75], a[128:131], a[24:27], v[72:75]
    v_mfma_f32_16x16x32_bf16 v[76:79], a[128:131], a[28:31], v[76:79]
    buffer_load_dwordx4 v9, s[12:15], s25 offen offset:3072 lds
    s_waitcnt lgkmcnt(4)
    v_mfma_f32_16x16x32_bf16 v[80:83], a[132:135], a[16:19], v[80:83]
    ds_read_b64_tr_b16 a[128:129], v14 offset:43200
    v_mfma_f32_16x16x32_bf16 v[84:87], a[132:135], a[20:23], v[84:87]
    ds_read_b64_tr_b16 a[130:131], v14 offset:46784
    v_mfma_f32_16x16x32_bf16 v[88:91], a[132:135], a[24:27], v[88:91]
    v_mfma_f32_16x16x32_bf16 v[92:95], a[132:135], a[28:31], v[92:95]
    s_waitcnt lgkmcnt(4)
    v_mfma_f32_16x16x32_bf16 v[96:99], a[136:139], a[16:19], v[96:99]
    ds_read_b64_tr_b16 a[132:133], v14 offset:50176
    v_mfma_f32_16x16x32_bf16 v[100:103], a[136:139], a[20:23], v[100:103]
    ds_read_b64_tr_b16 a[134:135], v14 offset:53760
    v_mfma_f32_16x16x32_bf16 v[104:107], a[136:139], a[24:27], v[104:107]
    v_mfma_f32_16x16x32_bf16 v[108:111], a[136:139], a[28:31], v[108:111]
    s_add_u32 m0, s28, 32768
    s_nop 0
    buffer_load_dwordx4 v10, s[12:15], s25 offen offset:0 lds
    s_waitcnt lgkmcnt(4)
    v_mfma_f32_16x16x32_bf16 v[112:115], a[140:143], a[16:19], v[112:115]
    ds_read_b64_tr_b16 a[136:137], v14 offset:50208
    v_mfma_f32_16x16x32_bf16 v[116:119], a[140:143], a[20:23], v[116:119]
    ds_read_b64_tr_b16 a[138:139], v14 offset:53792
    v_mfma_f32_16x16x32_bf16 v[120:123], a[140:143], a[24:27], v[120:123]
    v_mfma_f32_16x16x32_bf16 v[124:127], a[140:143], a[28:31], v[124:127]
    buffer_load_dwordx4 v11, s[12:15], s25 offen offset:1024 lds
    s_waitcnt lgkmcnt(4)
    v_mfma_f32_16x16x32_bf16 v[128:131], a[128:131], a[16:19], v[128:131]
    ds_read_b64_tr_b16 a[140:141], v14 offset:50240
    v_mfma_f32_16x16x32_bf16 v[132:135], a[128:131], a[20:23], v[132:135]
    ds_read_b64_tr_b16 a[142:143], v14 offset:53824
    v_mfma_f32_16x16x32_bf16 v[136:139], a[128:131], a[24:27], v[136:139]
    v_mfma_f32_16x16x32_bf16 v[140:143], a[128:131], a[28:31], v[140:143]
    s_waitcnt lgkmcnt(4)
    v_mfma_f32_16x16x32_bf16 v[144:147], a[132:135], a[16:19], v[144:147]
    ds_read_b64_tr_b16 a[128:129], v14 offset:50272
    v_mfma_f32_16x16x32_bf16 v[148:151], a[132:135], a[20:23], v[148:151]
    ds_read_b64_tr_b16 a[130:131], v14 offset:53856
    v_mfma_f32_16x16x32_bf16 v[152:155], a[132:135], a[24:27], v[152:155]
    v_mfma_f32_16x16x32_bf16 v[156:159], a[132:135], a[28:31], v[156:159]
    buffer_load_dwordx4 v12, s[12:15], s25 offen offset:2048 lds
    s_add_u32 s25, s25, 458752
    s_waitcnt lgkmcnt(4)
    v_mfma_f32_16x16x32_bf16 v[160:163], a[136:139], a[16:19], v[160:163]
    ds_read_b64_tr_b16 a[132:133], v14 offset:50304
    v_mfma_f32_16x16x32_bf16 v[164:167], a[136:139], a[20:23], v[164:167]
    ds_read_b64_tr_b16 a[134:135], v14 offset:53888
    v_mfma_f32_16x16x32_bf16 v[168:171], a[136:139], a[24:27], v[168:171]
    v_mfma_f32_16x16x32_bf16 v[172:175], a[136:139], a[28:31], v[172:175]
    buffer_load_dwordx4 a[96:99], v2, s[8:11], s26 offen offset:2048
    s_waitcnt lgkmcnt(4)
    v_mfma_f32_16x16x32_bf16 v[176:179], a[140:143], a[16:19], v[176:179]
    ds_read_b64_tr_b16 a[136:137], v14 offset:50336
    v_mfma_f32_16x16x32_bf16 v[180:183], a[140:143], a[20:23], v[180:183]
    ds_read_b64_tr_b16 a[138:139], v14 offset:53920
    v_mfma_f32_16x16x32_bf16 v[184:187], a[140:143], a[24:27], v[184:187]
    v_mfma_f32_16x16x32_bf16 v[188:191], a[140:143], a[28:31], v[188:191]
    s_waitcnt lgkmcnt(4)
    v_mfma_f32_16x16x32_bf16 v[192:195], a[128:131], a[16:19], v[192:195]
    ds_read_b64_tr_b16 a[140:141], v14 offset:50368
    v_mfma_f32_16x16x32_bf16 v[196:199], a[128:131], a[20:23], v[196:199]
    ds_read_b64_tr_b16 a[142:143], v14 offset:53952
    v_mfma_f32_16x16x32_bf16 v[200:203], a[128:131], a[24:27], v[200:203]
    v_mfma_f32_16x16x32_bf16 v[204:207], a[128:131], a[28:31], v[204:207]
    buffer_load_dwordx4 a[100:103], v3, s[8:11], s26 offen offset:2048
    s_waitcnt lgkmcnt(4)
    v_mfma_f32_16x16x32_bf16 v[208:211], a[132:135], a[16:19], v[208:211]
    s_waitcnt vmcnt(32)
    s_barrier
    ds_read_b64_tr_b16 a[128:129], v15 offset:0
    v_mfma_f32_16x16x32_bf16 v[212:215], a[132:135], a[20:23], v[212:215]
    ds_read_b64_tr_b16 a[130:131], v15 offset:3584
    v_mfma_f32_16x16x32_bf16 v[216:219], a[132:135], a[24:27], v[216:219]
    v_mfma_f32_16x16x32_bf16 v[220:223], a[132:135], a[28:31], v[220:223]
    buffer_load_dwordx4 a[104:107], v4, s[8:11], s26 offen offset:2048
    s_waitcnt lgkmcnt(4)
    v_mfma_f32_16x16x32_bf16 v[224:227], a[136:139], a[16:19], v[224:227]
    ds_read_b64_tr_b16 a[132:133], v15 offset:32
    v_mfma_f32_16x16x32_bf16 v[228:231], a[136:139], a[20:23], v[228:231]
    ds_read_b64_tr_b16 a[134:135], v15 offset:3616
    v_mfma_f32_16x16x32_bf16 v[232:235], a[136:139], a[24:27], v[232:235]
    v_mfma_f32_16x16x32_bf16 v[236:239], a[136:139], a[28:31], v[236:239]
    s_waitcnt lgkmcnt(4)
    v_mfma_f32_16x16x32_bf16 v[240:243], a[140:143], a[16:19], v[240:243]
    ds_read_b64_tr_b16 a[136:137], v15 offset:64
    v_mfma_f32_16x16x32_bf16 v[244:247], a[140:143], a[20:23], v[244:247]
    ds_read_b64_tr_b16 a[138:139], v15 offset:3648
    v_mfma_f32_16x16x32_bf16 v[248:251], a[140:143], a[24:27], v[248:251]
    v_mfma_f32_16x16x32_bf16 v[252:255], a[140:143], a[28:31], v[252:255]
    buffer_load_dwordx4 a[108:111], v5, s[8:11], s26 offen offset:2048
    s_waitcnt vmcnt(30)
    s_waitcnt lgkmcnt(4)
    v_mfma_f32_16x16x32_bf16 v[32:35], a[128:131], a[32:35], v[32:35]
    ds_read_b64_tr_b16 a[140:141], v15 offset:96
    s_waitcnt vmcnt(46)
    v_accvgpr_read_b32 v20, a144
    v_mfma_f32_16x16x32_bf16 v[36:39], a[128:131], a[36:39], v[36:39]
    ds_read_b64_tr_b16 a[142:143], v15 offset:3680
    v_accvgpr_read_b32 v21, a145
    v_accvgpr_read_b32 v22, a146
    v_mfma_f32_16x16x32_bf16 v[40:43], a[128:131], a[40:43], v[40:43]
    v_accvgpr_read_b32 v23, a147
    v_add_f32 v20, v20, v21
    v_mfma_f32_16x16x32_bf16 v[44:47], a[128:131], a[44:47], v[44:47]
    v_add_f32 v22, v22, v23
    v_add_f32 v20, v20, v22
    s_waitcnt lgkmcnt(4)
    v_mfma_f32_16x16x32_bf16 v[48:51], a[132:135], a[32:35], v[48:51]
    ds_read_b64_tr_b16 a[128:129], v15 offset:128
    v_mov_b32 v21, v20
    s_nop 1
    v_mfma_f32_16x16x32_bf16 v[52:55], a[132:135], a[36:39], v[52:55]
    ds_read_b64_tr_b16 a[130:131], v15 offset:3712
    v_permlane32_swap_b32 v20, v21
    v_add_f32 v20, v20, v21
    v_mfma_f32_16x16x32_bf16 v[56:59], a[132:135], a[40:43], v[56:59]
    v_mov_b32 v21, v20
    s_nop 1
    v_mfma_f32_16x16x32_bf16 v[60:63], a[132:135], a[44:47], v[60:63]
    buffer_load_dwordx4 a[112:115], v2, s[8:11], s26 offen offset:3072
    v_permlane16_swap_b32 v20, v21
    v_add_f32 v20, v20, v21
    s_waitcnt lgkmcnt(4)
    v_mfma_f32_16x16x32_bf16 v[64:67], a[136:139], a[32:35], v[64:67]
    ds_read_b64_tr_b16 a[132:133], v15 offset:160
    v_mov_b32 v21, 0x3727c5ac
    v_fmac_f32 v21, 0x3a800000, v20
    v_mfma_f32_16x16x32_bf16 v[68:71], a[136:139], a[36:39], v[68:71]
    ds_read_b64_tr_b16 a[134:135], v15 offset:3744
    v_rsq_f32 v21, v21
    s_nop 0
    v_mfma_f32_16x16x32_bf16 v[72:75], a[136:139], a[40:43], v[72:75]
    v_mul_f32 v16, 0xbfb8aa3b, v21
    v_accvgpr_read_b32 v20, a148
    v_mfma_f32_16x16x32_bf16 v[76:79], a[136:139], a[44:47], v[76:79]
    buffer_load_dwordx4 a[116:119], v3, s[8:11], s26 offen offset:3072
    v_accvgpr_read_b32 v21, a149
    v_accvgpr_read_b32 v22, a150
    s_waitcnt lgkmcnt(4)
    v_mfma_f32_16x16x32_bf16 v[80:83], a[140:143], a[32:35], v[80:83]
    ds_read_b64_tr_b16 a[136:137], v15 offset:192
    v_accvgpr_read_b32 v23, a151
    v_add_f32 v20, v20, v21
    v_mfma_f32_16x16x32_bf16 v[84:87], a[140:143], a[36:39], v[84:87]
    ds_read_b64_tr_b16 a[138:139], v15 offset:3776
    v_add_f32 v22, v22, v23
    v_add_f32 v20, v20, v22
    v_mfma_f32_16x16x32_bf16 v[88:91], a[140:143], a[40:43], v[88:91]
    v_mov_b32 v21, v20
    s_nop 1
    v_mfma_f32_16x16x32_bf16 v[92:95], a[140:143], a[44:47], v[92:95]
    v_permlane32_swap_b32 v20, v21
    v_add_f32 v20, v20, v21
    s_waitcnt lgkmcnt(4)
    v_mfma_f32_16x16x32_bf16 v[96:99], a[128:131], a[32:35], v[96:99]
    ds_read_b64_tr_b16 a[140:141], v15 offset:7168
    v_mov_b32 v21, v20
    s_nop 1
    v_mfma_f32_16x16x32_bf16 v[100:103], a[128:131], a[36:39], v[100:103]
    ds_read_b64_tr_b16 a[142:143], v15 offset:10752
    v_permlane16_swap_b32 v20, v21
    v_add_f32 v20, v20, v21
    v_mfma_f32_16x16x32_bf16 v[104:107], a[128:131], a[40:43], v[104:107]
    v_mov_b32 v21, 0x3727c5ac
    v_fmac_f32 v21, 0x3a800000, v20
    v_mfma_f32_16x16x32_bf16 v[108:111], a[128:131], a[44:47], v[108:111]
    buffer_load_dwordx4 a[120:123], v4, s[8:11], s26 offen offset:3072
    v_rsq_f32 v21, v21
    s_nop 0
    s_waitcnt lgkmcnt(4)
    v_mfma_f32_16x16x32_bf16 v[112:115], a[132:135], a[32:35], v[112:115]
    ds_read_b64_tr_b16 a[128:129], v15 offset:7200
    v_mul_f32 v17, 0xbfb8aa3b, v21
    v_accvgpr_read_b32 v20, a152
    v_mfma_f32_16x16x32_bf16 v[116:119], a[132:135], a[36:39], v[116:119]
    ds_read_b64_tr_b16 a[130:131], v15 offset:10784
    v_accvgpr_read_b32 v21, a153
    v_accvgpr_read_b32 v22, a154
    v_mfma_f32_16x16x32_bf16 v[120:123], a[132:135], a[40:43], v[120:123]
    v_accvgpr_read_b32 v23, a155
    v_add_f32 v20, v20, v21
    v_mfma_f32_16x16x32_bf16 v[124:127], a[132:135], a[44:47], v[124:127]
    buffer_load_dwordx4 a[124:127], v5, s[8:11], s26 offen offset:3072
    s_add_u32 s26, s26, 4096
    v_add_f32 v22, v22, v23
    v_add_f32 v20, v20, v22
    s_waitcnt lgkmcnt(4)
    v_mfma_f32_16x16x32_bf16 v[128:131], a[136:139], a[32:35], v[128:131]
    ds_read_b64_tr_b16 a[132:133], v15 offset:7232
    v_mov_b32 v21, v20
    s_nop 1
    v_mfma_f32_16x16x32_bf16 v[132:135], a[136:139], a[36:39], v[132:135]
    ds_read_b64_tr_b16 a[134:135], v15 offset:10816
    v_permlane32_swap_b32 v20, v21
    v_add_f32 v20, v20, v21
    v_mfma_f32_16x16x32_bf16 v[136:139], a[136:139], a[40:43], v[136:139]
    v_mov_b32 v21, v20
    s_nop 1
    v_mfma_f32_16x16x32_bf16 v[140:143], a[136:139], a[44:47], v[140:143]
    v_permlane16_swap_b32 v20, v21
    v_add_f32 v20, v20, v21
    s_waitcnt lgkmcnt(4)
    v_mfma_f32_16x16x32_bf16 v[144:147], a[140:143], a[32:35], v[144:147]
    ds_read_b64_tr_b16 a[136:137], v15 offset:7264
    v_mov_b32 v21, 0x3727c5ac
    v_fmac_f32 v21, 0x3a800000, v20
    v_mfma_f32_16x16x32_bf16 v[148:151], a[140:143], a[36:39], v[148:151]
    ds_read_b64_tr_b16 a[138:139], v15 offset:10848
    v_rsq_f32 v21, v21
    s_nop 0
    v_mfma_f32_16x16x32_bf16 v[152:155], a[140:143], a[40:43], v[152:155]
    v_mul_f32 v18, 0xbfb8aa3b, v21
    v_accvgpr_read_b32 v20, a156
    v_mfma_f32_16x16x32_bf16 v[156:159], a[140:143], a[44:47], v[156:159]
    s_add_u32 m0, s28, 57344
    s_nop 0
    buffer_load_dwordx4 v6, s[12:15], s25 offen offset:0 lds
    v_accvgpr_read_b32 v21, a157
    v_accvgpr_read_b32 v22, a158
    s_waitcnt lgkmcnt(4)
    v_mfma_f32_16x16x32_bf16 v[160:163], a[128:131], a[32:35], v[160:163]
    ds_read_b64_tr_b16 a[140:141], v15 offset:7296
    v_accvgpr_read_b32 v23, a159
    v_add_f32 v20, v20, v21
    v_mfma_f32_16x16x32_bf16 v[164:167], a[128:131], a[36:39], v[164:167]
    ds_read_b64_tr_b16 a[142:143], v15 offset:10880
    v_add_f32 v22, v22, v23
    v_add_f32 v20, v20, v22
    v_mfma_f32_16x16x32_bf16 v[168:171], a[128:131], a[40:43], v[168:171]
    v_mov_b32 v21, v20
    s_nop 1
    v_mfma_f32_16x16x32_bf16 v[172:175], a[128:131], a[44:47], v[172:175]
    buffer_load_dwordx4 v7, s[12:15], s25 offen offset:1024 lds
    v_permlane32_swap_b32 v20, v21
    v_add_f32 v20, v20, v21
    s_waitcnt lgkmcnt(4)
    v_mfma_f32_16x16x32_bf16 v[176:179], a[132:135], a[32:35], v[176:179]
    ds_read_b64_tr_b16 a[128:129], v15 offset:7328
    v_mov_b32 v21, v20
    s_nop 1
    v_mfma_f32_16x16x32_bf16 v[180:183], a[132:135], a[36:39], v[180:183]
    ds_read_b64_tr_b16 a[130:131], v15 offset:10912
    v_permlane16_swap_b32 v20, v21
    v_add_f32 v20, v20, v21
    v_mfma_f32_16x16x32_bf16 v[184:187], a[132:135], a[40:43], v[184:187]
    v_mov_b32 v21, 0x3727c5ac
    v_fmac_f32 v21, 0x3a800000, v20
    v_mfma_f32_16x16x32_bf16 v[188:191], a[132:135], a[44:47], v[188:191]
    v_rsq_f32 v21, v21
    s_nop 0
    s_waitcnt lgkmcnt(4)
    v_mfma_f32_16x16x32_bf16 v[192:195], a[136:139], a[32:35], v[192:195]
    ds_read_b64_tr_b16 a[132:133], v15 offset:7360
    v_mul_f32 v19, 0xbfb8aa3b, v21
    v_mfma_f32_16x16x32_bf16 v[196:199], a[136:139], a[36:39], v[196:199]
    ds_read_b64_tr_b16 a[134:135], v15 offset:10944
    v_mfma_f32_16x16x32_bf16 v[200:203], a[136:139], a[40:43], v[200:203]
    v_mfma_f32_16x16x32_bf16 v[204:207], a[136:139], a[44:47], v[204:207]
    buffer_load_dwordx4 v8, s[12:15], s25 offen offset:2048 lds
    s_waitcnt lgkmcnt(4)
    v_mfma_f32_16x16x32_bf16 v[208:211], a[140:143], a[32:35], v[208:211]
    ds_read_b64_tr_b16 a[136:137], v15 offset:14336
    v_mfma_f32_16x16x32_bf16 v[212:215], a[140:143], a[36:39], v[212:215]
    ds_read_b64_tr_b16 a[138:139], v15 offset:17920
    v_mfma_f32_16x16x32_bf16 v[216:219], a[140:143], a[40:43], v[216:219]
    v_mfma_f32_16x16x32_bf16 v[220:223], a[140:143], a[44:47], v[220:223]
    buffer_load_dwordx4 v9, s[12:15], s25 offen offset:3072 lds
    s_waitcnt lgkmcnt(4)
    v_mfma_f32_16x16x32_bf16 v[224:227], a[128:131], a[32:35], v[224:227]
    ds_read_b64_tr_b16 a[140:141], v15 offset:14368
    v_mfma_f32_16x16x32_bf16 v[228:231], a[128:131], a[36:39], v[228:231]
    ds_read_b64_tr_b16 a[142:143], v15 offset:17952
    v_mfma_f32_16x16x32_bf16 v[232:235], a[128:131], a[40:43], v[232:235]
    v_mfma_f32_16x16x32_bf16 v[236:239], a[128:131], a[44:47], v[236:239]
    s_waitcnt lgkmcnt(4)
    v_mfma_f32_16x16x32_bf16 v[240:243], a[132:135], a[32:35], v[240:243]
    ds_read_b64_tr_b16 a[128:129], v15 offset:14400
    v_mfma_f32_16x16x32_bf16 v[244:247], a[132:135], a[36:39], v[244:247]
    ds_read_b64_tr_b16 a[130:131], v15 offset:17984
    v_mfma_f32_16x16x32_bf16 v[248:251], a[132:135], a[40:43], v[248:251]
    v_mfma_f32_16x16x32_bf16 v[252:255], a[132:135], a[44:47], v[252:255]
    s_add_u32 m0, s28, 61440
    s_nop 0
    buffer_load_dwordx4 v10, s[12:15], s25 offen offset:0 lds
    s_waitcnt vmcnt(35)
    s_waitcnt lgkmcnt(4)
    v_mfma_f32_16x16x32_bf16 v[32:35], a[136:139], a[48:51], v[32:35]
    ds_read_b64_tr_b16 a[132:133], v15 offset:14432
    v_mfma_f32_16x16x32_bf16 v[36:39], a[136:139], a[52:55], v[36:39]
    ds_read_b64_tr_b16 a[134:135], v15 offset:18016
    v_mfma_f32_16x16x32_bf16 v[40:43], a[136:139], a[56:59], v[40:43]
    v_mfma_f32_16x16x32_bf16 v[44:47], a[136:139], a[60:63], v[44:47]
    buffer_load_dwordx4 v11, s[12:15], s25 offen offset:1024 lds
    s_waitcnt lgkmcnt(4)
    v_mfma_f32_16x16x32_bf16 v[48:51], a[140:143], a[48:51], v[48:51]
    ds_read_b64_tr_b16 a[136:137], v15 offset:14464
    v_mfma_f32_16x16x32_bf16 v[52:55], a[140:143], a[52:55], v[52:55]
    ds_read_b64_tr_b16 a[138:139], v15 offset:18048
    v_mfma_f32_16x16x32_bf16 v[56:59], a[140:143], a[56:59], v[56:59]
    v_mfma_f32_16x16x32_bf16 v[60:63], a[140:143], a[60:63], v[60:63]
    s_waitcnt lgkmcnt(4)
    v_mfma_f32_16x16x32_bf16 v[64:67], a[128:131], a[48:51], v[64:67]
    ds_read_b64_tr_b16 a[140:141], v15 offset:14496
    v_mfma_f32_16x16x32_bf16 v[68:71], a[128:131], a[52:55], v[68:71]
    ds_read_b64_tr_b16 a[142:143], v15 offset:18080
    v_mfma_f32_16x16x32_bf16 v[72:75], a[128:131], a[56:59], v[72:75]
    v_mfma_f32_16x16x32_bf16 v[76:79], a[128:131], a[60:63], v[76:79]
    buffer_load_dwordx4 v12, s[12:15], s25 offen offset:2048 lds
    s_add_u32 s25, s25, 458752
    s_waitcnt lgkmcnt(4)
    v_mfma_f32_16x16x32_bf16 v[80:83], a[132:135], a[48:51], v[80:83]
    ds_read_b64_tr_b16 a[128:129], v15 offset:14528
    v_mfma_f32_16x16x32_bf16 v[84:87], a[132:135], a[52:55], v[84:87]
    ds_read_b64_tr_b16 a[130:131], v15 offset:18112
    v_mfma_f32_16x16x32_bf16 v[88:91], a[132:135], a[56:59], v[88:91]
    v_mfma_f32_16x16x32_bf16 v[92:95], a[132:135], a[60:63], v[92:95]
    buffer_load_dwordx4 a[0:3], v2, s[8:11], s26 offen offset:0
    s_waitcnt lgkmcnt(4)
    v_mfma_f32_16x16x32_bf16 v[96:99], a[136:139], a[48:51], v[96:99]
    ds_read_b64_tr_b16 a[132:133], v15 offset:21504
    v_mfma_f32_16x16x32_bf16 v[100:103], a[136:139], a[52:55], v[100:103]
    ds_read_b64_tr_b16 a[134:135], v15 offset:25088
    v_mfma_f32_16x16x32_bf16 v[104:107], a[136:139], a[56:59], v[104:107]
    v_mfma_f32_16x16x32_bf16 v[108:111], a[136:139], a[60:63], v[108:111]
    s_waitcnt lgkmcnt(4)
    v_mfma_f32_16x16x32_bf16 v[112:115], a[140:143], a[48:51], v[112:115]
    ds_read_b64_tr_b16 a[136:137], v15 offset:21536
    v_mfma_f32_16x16x32_bf16 v[116:119], a[140:143], a[52:55], v[116:119]
    ds_read_b64_tr_b16 a[138:139], v15 offset:25120
    v_mfma_f32_16x16x32_bf16 v[120:123], a[140:143], a[56:59], v[120:123]
    v_mfma_f32_16x16x32_bf16 v[124:127], a[140:143], a[60:63], v[124:127]
    buffer_load_dwordx4 a[4:7], v3, s[8:11], s26 offen offset:0
    s_waitcnt lgkmcnt(4)
    v_mfma_f32_16x16x32_bf16 v[128:131], a[128:131], a[48:51], v[128:131]
    ds_read_b64_tr_b16 a[140:141], v15 offset:21568
    v_mfma_f32_16x16x32_bf16 v[132:135], a[128:131], a[52:55], v[132:135]
    ds_read_b64_tr_b16 a[142:143], v15 offset:25152
    v_mfma_f32_16x16x32_bf16 v[136:139], a[128:131], a[56:59], v[136:139]
    v_mfma_f32_16x16x32_bf16 v[140:143], a[128:131], a[60:63], v[140:143]
    buffer_load_dwordx4 a[8:11], v4, s[8:11], s26 offen offset:0
    s_waitcnt lgkmcnt(4)
    v_mfma_f32_16x16x32_bf16 v[144:147], a[132:135], a[48:51], v[144:147]
    ds_read_b64_tr_b16 a[128:129], v15 offset:21600
    v_mfma_f32_16x16x32_bf16 v[148:151], a[132:135], a[52:55], v[148:151]
    ds_read_b64_tr_b16 a[130:131], v15 offset:25184
    v_mfma_f32_16x16x32_bf16 v[152:155], a[132:135], a[56:59], v[152:155]
    v_mfma_f32_16x16x32_bf16 v[156:159], a[132:135], a[60:63], v[156:159]
    s_waitcnt lgkmcnt(4)
    v_mfma_f32_16x16x32_bf16 v[160:163], a[136:139], a[48:51], v[160:163]
    ds_read_b64_tr_b16 a[132:133], v15 offset:21632
    v_mfma_f32_16x16x32_bf16 v[164:167], a[136:139], a[52:55], v[164:167]
    ds_read_b64_tr_b16 a[134:135], v15 offset:25216
    v_mfma_f32_16x16x32_bf16 v[168:171], a[136:139], a[56:59], v[168:171]
    v_mfma_f32_16x16x32_bf16 v[172:175], a[136:139], a[60:63], v[172:175]
    buffer_load_dwordx4 a[12:15], v5, s[8:11], s26 offen offset:0
    s_waitcnt lgkmcnt(4)
    v_mfma_f32_16x16x32_bf16 v[176:179], a[140:143], a[48:51], v[176:179]
    ds_read_b64_tr_b16 a[136:137], v15 offset:21664
    v_mfma_f32_16x16x32_bf16 v[180:183], a[140:143], a[52:55], v[180:183]
    ds_read_b64_tr_b16 a[138:139], v15 offset:25248
    v_mfma_f32_16x16x32_bf16 v[184:187], a[140:143], a[56:59], v[184:187]
    v_mfma_f32_16x16x32_bf16 v[188:191], a[140:143], a[60:63], v[188:191]
    buffer_load_dwordx4 a[16:19], v2, s[8:11], s26 offen offset:1024
    s_waitcnt lgkmcnt(4)
    v_mfma_f32_16x16x32_bf16 v[192:195], a[128:131], a[48:51], v[192:195]
    ds_read_b64_tr_b16 a[140:141], v15 offset:21696
    v_mfma_f32_16x16x32_bf16 v[196:199], a[128:131], a[52:55], v[196:199]
    ds_read_b64_tr_b16 a[142:143], v15 offset:25280
    v_mfma_f32_16x16x32_bf16 v[200:203], a[128:131], a[56:59], v[200:203]
    v_mfma_f32_16x16x32_bf16 v[204:207], a[128:131], a[60:63], v[204:207]
    s_waitcnt lgkmcnt(4)
    v_mfma_f32_16x16x32_bf16 v[208:211], a[132:135], a[48:51], v[208:211]
    s_waitcnt vmcnt(35)
    s_barrier
    ds_read_b64_tr_b16 a[128:129], v13 offset:0
    v_mfma_f32_16x16x32_bf16 v[212:215], a[132:135], a[52:55], v[212:215]
    ds_read_b64_tr_b16 a[130:131], v13 offset:3584
    v_mfma_f32_16x16x32_bf16 v[216:219], a[132:135], a[56:59], v[216:219]
    v_mfma_f32_16x16x32_bf16 v[220:223], a[132:135], a[60:63], v[220:223]
    buffer_load_dwordx4 a[20:23], v3, s[8:11], s26 offen offset:1024
    s_waitcnt lgkmcnt(4)
    v_mfma_f32_16x16x32_bf16 v[224:227], a[136:139], a[48:51], v[224:227]
    ds_read_b64_tr_b16 a[132:133], v13 offset:32
    v_mfma_f32_16x16x32_bf16 v[228:231], a[136:139], a[52:55], v[228:231]
    ds_read_b64_tr_b16 a[134:135], v13 offset:3616
    v_mfma_f32_16x16x32_bf16 v[232:235], a[136:139], a[56:59], v[232:235]
    v_mfma_f32_16x16x32_bf16 v[236:239], a[136:139], a[60:63], v[236:239]
    buffer_load_dwordx4 a[24:27], v4, s[8:11], s26 offen offset:1024
    s_waitcnt lgkmcnt(4)
    v_mfma_f32_16x16x32_bf16 v[240:243], a[140:143], a[48:51], v[240:243]
    ds_read_b64_tr_b16 a[136:137], v13 offset:64
    v_mfma_f32_16x16x32_bf16 v[244:247], a[140:143], a[52:55], v[244:247]
    ds_read_b64_tr_b16 a[138:139], v13 offset:3648
    v_mfma_f32_16x16x32_bf16 v[248:251], a[140:143], a[56:59], v[248:251]
    v_mfma_f32_16x16x32_bf16 v[252:255], a[140:143], a[60:63], v[252:255]
    s_waitcnt vmcnt(33)
    s_waitcnt lgkmcnt(4)
    v_mfma_f32_16x16x32_bf16 v[32:35], a[128:131], a[64:67], v[32:35]
    ds_read_b64_tr_b16 a[140:141], v13 offset:96
    v_mfma_f32_16x16x32_bf16 v[36:39], a[128:131], a[68:71], v[36:39]
    ds_read_b64_tr_b16 a[142:143], v13 offset:3680
    v_mfma_f32_16x16x32_bf16 v[40:43], a[128:131], a[72:75], v[40:43]
    v_mfma_f32_16x16x32_bf16 v[44:47], a[128:131], a[76:79], v[44:47]
    buffer_load_dwordx4 a[28:31], v5, s[8:11], s26 offen offset:1024
    s_waitcnt lgkmcnt(4)
    v_mfma_f32_16x16x32_bf16 v[48:51], a[132:135], a[64:67], v[48:51]
    ds_read_b64_tr_b16 a[128:129], v13 offset:128
    v_mfma_f32_16x16x32_bf16 v[52:55], a[132:135], a[68:71], v[52:55]
    ds_read_b64_tr_b16 a[130:131], v13 offset:3712
    v_mfma_f32_16x16x32_bf16 v[56:59], a[132:135], a[72:75], v[56:59]
    v_mfma_f32_16x16x32_bf16 v[60:63], a[132:135], a[76:79], v[60:63]
    s_add_u32 m0, s28, 86016
    s_nop 0
    buffer_load_dwordx4 v6, s[12:15], s25 offen offset:0 lds
    s_waitcnt lgkmcnt(4)
    v_mfma_f32_16x16x32_bf16 v[64:67], a[136:139], a[64:67], v[64:67]
    ds_read_b64_tr_b16 a[132:133], v13 offset:160
    v_mfma_f32_16x16x32_bf16 v[68:71], a[136:139], a[68:71], v[68:71]
    ds_read_b64_tr_b16 a[134:135], v13 offset:3744
    v_mfma_f32_16x16x32_bf16 v[72:75], a[136:139], a[72:75], v[72:75]
    v_mfma_f32_16x16x32_bf16 v[76:79], a[136:139], a[76:79], v[76:79]
    s_waitcnt lgkmcnt(4)
    v_mfma_f32_16x16x32_bf16 v[80:83], a[140:143], a[64:67], v[80:83]
    ds_read_b64_tr_b16 a[136:137], v13 offset:192
    v_mfma_f32_16x16x32_bf16 v[84:87], a[140:143], a[68:71], v[84:87]
    ds_read_b64_tr_b16 a[138:139], v13 offset:3776
    v_mfma_f32_16x16x32_bf16 v[88:91], a[140:143], a[72:75], v[88:91]
    v_mfma_f32_16x16x32_bf16 v[92:95], a[140:143], a[76:79], v[92:95]
    buffer_load_dwordx4 v7, s[12:15], s25 offen offset:1024 lds
    s_waitcnt lgkmcnt(4)
    v_mfma_f32_16x16x32_bf16 v[96:99], a[128:131], a[64:67], v[96:99]
    ds_read_b64_tr_b16 a[140:141], v13 offset:7168
    v_mfma_f32_16x16x32_bf16 v[100:103], a[128:131], a[68:71], v[100:103]
    ds_read_b64_tr_b16 a[142:143], v13 offset:10752
    v_mfma_f32_16x16x32_bf16 v[104:107], a[128:131], a[72:75], v[104:107]
    v_mfma_f32_16x16x32_bf16 v[108:111], a[128:131], a[76:79], v[108:111]
    buffer_load_dwordx4 v8, s[12:15], s25 offen offset:2048 lds
    s_waitcnt lgkmcnt(4)
    v_mfma_f32_16x16x32_bf16 v[112:115], a[132:135], a[64:67], v[112:115]
    ds_read_b64_tr_b16 a[128:129], v13 offset:7200
    v_mfma_f32_16x16x32_bf16 v[116:119], a[132:135], a[68:71], v[116:119]
    ds_read_b64_tr_b16 a[130:131], v13 offset:10784
    v_mfma_f32_16x16x32_bf16 v[120:123], a[132:135], a[72:75], v[120:123]
    v_mfma_f32_16x16x32_bf16 v[124:127], a[132:135], a[76:79], v[124:127]
    s_waitcnt lgkmcnt(4)
    v_mfma_f32_16x16x32_bf16 v[128:131], a[136:139], a[64:67], v[128:131]
    ds_read_b64_tr_b16 a[132:133], v13 offset:7232
    v_mfma_f32_16x16x32_bf16 v[132:135], a[136:139], a[68:71], v[132:135]
    ds_read_b64_tr_b16 a[134:135], v13 offset:10816
    v_mfma_f32_16x16x32_bf16 v[136:139], a[136:139], a[72:75], v[136:139]
    v_mfma_f32_16x16x32_bf16 v[140:143], a[136:139], a[76:79], v[140:143]
    buffer_load_dwordx4 v9, s[12:15], s25 offen offset:3072 lds
    s_waitcnt lgkmcnt(4)
    v_mfma_f32_16x16x32_bf16 v[144:147], a[140:143], a[64:67], v[144:147]
    ds_read_b64_tr_b16 a[136:137], v13 offset:7264
    v_mfma_f32_16x16x32_bf16 v[148:151], a[140:143], a[68:71], v[148:151]
    ds_read_b64_tr_b16 a[138:139], v13 offset:10848
    v_mfma_f32_16x16x32_bf16 v[152:155], a[140:143], a[72:75], v[152:155]
    v_mfma_f32_16x16x32_bf16 v[156:159], a[140:143], a[76:79], v[156:159]
    s_add_u32 m0, s28, 90112
    s_nop 0
    buffer_load_dwordx4 v10, s[12:15], s25 offen offset:0 lds
    s_waitcnt lgkmcnt(4)
    v_mfma_f32_16x16x32_bf16 v[160:163], a[128:131], a[64:67], v[160:163]
    ds_read_b64_tr_b16 a[140:141], v13 offset:7296
    v_mfma_f32_16x16x32_bf16 v[164:167], a[128:131], a[68:71], v[164:167]
    ds_read_b64_tr_b16 a[142:143], v13 offset:10880
    v_mfma_f32_16x16x32_bf16 v[168:171], a[128:131], a[72:75], v[168:171]
    v_mfma_f32_16x16x32_bf16 v[172:175], a[128:131], a[76:79], v[172:175]
    s_waitcnt lgkmcnt(4)
    v_mfma_f32_16x16x32_bf16 v[176:179], a[132:135], a[64:67], v[176:179]
    ds_read_b64_tr_b16 a[128:129], v13 offset:7328
    v_mfma_f32_16x16x32_bf16 v[180:183], a[132:135], a[68:71], v[180:183]
    ds_read_b64_tr_b16 a[130:131], v13 offset:10912
    v_mfma_f32_16x16x32_bf16 v[184:187], a[132:135], a[72:75], v[184:187]
    v_mfma_f32_16x16x32_bf16 v[188:191], a[132:135], a[76:79], v[188:191]
    buffer_load_dwordx4 v11, s[12:15], s25 offen offset:1024 lds
    s_waitcnt lgkmcnt(4)
    v_mfma_f32_16x16x32_bf16 v[192:195], a[136:139], a[64:67], v[192:195]
    ds_read_b64_tr_b16 a[132:133], v13 offset:7360
    v_mfma_f32_16x16x32_bf16 v[196:199], a[136:139], a[68:71], v[196:199]
    ds_read_b64_tr_b16 a[134:135], v13 offset:10944
    v_mfma_f32_16x16x32_bf16 v[200:203], a[136:139], a[72:75], v[200:203]
    v_mfma_f32_16x16x32_bf16 v[204:207], a[136:139], a[76:79], v[204:207]
    buffer_load_dwordx4 v12, s[12:15], s25 offen offset:2048 lds
    s_add_u32 s25, s25, 458752
    s_waitcnt lgkmcnt(4)
    v_mfma_f32_16x16x32_bf16 v[208:211], a[140:143], a[64:67], v[208:211]
    ds_read_b64_tr_b16 a[136:137], v13 offset:14336
    v_mfma_f32_16x16x32_bf16 v[212:215], a[140:143], a[68:71], v[212:215]
    ds_read_b64_tr_b16 a[138:139], v13 offset:17920
    v_mfma_f32_16x16x32_bf16 v[216:219], a[140:143], a[72:75], v[216:219]
    v_mfma_f32_16x16x32_bf16 v[220:223], a[140:143], a[76:79], v[220:223]
    s_waitcnt lgkmcnt(4)
    v_mfma_f32_16x16x32_bf16 v[224:227], a[128:131], a[64:67], v[224:227]
    ds_read_b64_tr_b16 a[140:141], v13 offset:14368
    v_mfma_f32_16x16x32_bf16 v[228:231], a[128:131], a[68:71], v[228:231]
    ds_read_b64_tr_b16 a[142:143], v13 offset:17952
    v_mfma_f32_16x16x32_bf16 v[232:235], a[128:131], a[72:75], v[232:235]
    v_mfma_f32_16x16x32_bf16 v[236:239], a[128:131], a[76:79], v[236:239]
    buffer_load_dwordx4 a[32:35], v2, s[8:11], s26 offen offset:2048
    s_waitcnt lgkmcnt(4)
    v_mfma_f32_16x16x32_bf16 v[240:243], a[132:135], a[64:67], v[240:243]
    ds_read_b64_tr_b16 a[128:129], v13 offset:14400
    v_mfma_f32_16x16x32_bf16 v[244:247], a[132:135], a[68:71], v[244:247]
    ds_read_b64_tr_b16 a[130:131], v13 offset:17984
    v_mfma_f32_16x16x32_bf16 v[248:251], a[132:135], a[72:75], v[248:251]
    v_mfma_f32_16x16x32_bf16 v[252:255], a[132:135], a[76:79], v[252:255]
    buffer_load_dwordx4 a[36:39], v3, s[8:11], s26 offen offset:2048
    s_waitcnt vmcnt(39)
    s_waitcnt lgkmcnt(4)
    v_mfma_f32_16x16x32_bf16 v[32:35], a[136:139], a[80:83], v[32:35]
    ds_read_b64_tr_b16 a[132:133], v13 offset:14432
    v_mfma_f32_16x16x32_bf16 v[36:39], a[136:139], a[84:87], v[36:39]
    ds_read_b64_tr_b16 a[134:135], v13 offset:18016
    v_mfma_f32_16x16x32_bf16 v[40:43], a[136:139], a[88:91], v[40:43]
    v_mfma_f32_16x16x32_bf16 v[44:47], a[136:139], a[92:95], v[44:47]
    s_waitcnt lgkmcnt(4)
    v_mfma_f32_16x16x32_bf16 v[48:51], a[140:143], a[80:83], v[48:51]
    ds_read_b64_tr_b16 a[136:137], v13 offset:14464
    v_mfma_f32_16x16x32_bf16 v[52:55], a[140:143], a[84:87], v[52:55]
    ds_read_b64_tr_b16 a[138:139], v13 offset:18048
    v_mfma_f32_16x16x32_bf16 v[56:59], a[140:143], a[88:91], v[56:59]
    v_mfma_f32_16x16x32_bf16 v[60:63], a[140:143], a[92:95], v[60:63]
    buffer_load_dwordx4 a[40:43], v4, s[8:11], s26 offen offset:2048
    s_waitcnt lgkmcnt(4)
    v_mfma_f32_16x16x32_bf16 v[64:67], a[128:131], a[80:83], v[64:67]
    ds_read_b64_tr_b16 a[140:141], v13 offset:14496
    v_mfma_f32_16x16x32_bf16 v[68:71], a[128:131], a[84:87], v[68:71]
    ds_read_b64_tr_b16 a[142:143], v13 offset:18080
    v_mfma_f32_16x16x32_bf16 v[72:75], a[128:131], a[88:91], v[72:75]
    v_mfma_f32_16x16x32_bf16 v[76:79], a[128:131], a[92:95], v[76:79]
    buffer_load_dwordx4 a[44:47], v5, s[8:11], s26 offen offset:2048
    s_waitcnt lgkmcnt(4)
    v_mfma_f32_16x16x32_bf16 v[80:83], a[132:135], a[80:83], v[80:83]
    ds_read_b64_tr_b16 a[128:129], v13 offset:14528
    v_mfma_f32_16x16x32_bf16 v[84:87], a[132:135], a[84:87], v[84:87]
    ds_read_b64_tr_b16 a[130:131], v13 offset:18112
    v_mfma_f32_16x16x32_bf16 v[88:91], a[132:135], a[88:91], v[88:91]
    v_mfma_f32_16x16x32_bf16 v[92:95], a[132:135], a[92:95], v[92:95]
    s_waitcnt lgkmcnt(4)
    v_mfma_f32_16x16x32_bf16 v[96:99], a[136:139], a[80:83], v[96:99]
    ds_read_b64_tr_b16 a[132:133], v13 offset:21504
    v_mfma_f32_16x16x32_bf16 v[100:103], a[136:139], a[84:87], v[100:103]
    ds_read_b64_tr_b16 a[134:135], v13 offset:25088
    v_mfma_f32_16x16x32_bf16 v[104:107], a[136:139], a[88:91], v[104:107]
    v_mfma_f32_16x16x32_bf16 v[108:111], a[136:139], a[92:95], v[108:111]
    buffer_load_dwordx4 a[48:51], v2, s[8:11], s26 offen offset:3072
    s_waitcnt lgkmcnt(4)
    v_mfma_f32_16x16x32_bf16 v[112:115], a[140:143], a[80:83], v[112:115]
    ds_read_b64_tr_b16 a[136:137], v13 offset:21536
    v_mfma_f32_16x16x32_bf16 v[116:119], a[140:143], a[84:87], v[116:119]
    ds_read_b64_tr_b16 a[138:139], v13 offset:25120
    v_mfma_f32_16x16x32_bf16 v[120:123], a[140:143], a[88:91], v[120:123]
    v_mfma_f32_16x16x32_bf16 v[124:127], a[140:143], a[92:95], v[124:127]
    buffer_load_dwordx4 a[52:55], v3, s[8:11], s26 offen offset:3072
    s_waitcnt lgkmcnt(4)
    v_mfma_f32_16x16x32_bf16 v[128:131], a[128:131], a[80:83], v[128:131]
    ds_read_b64_tr_b16 a[140:141], v13 offset:21568
    v_mfma_f32_16x16x32_bf16 v[132:135], a[128:131], a[84:87], v[132:135]
    ds_read_b64_tr_b16 a[142:143], v13 offset:25152
    v_mfma_f32_16x16x32_bf16 v[136:139], a[128:131], a[88:91], v[136:139]
    v_mfma_f32_16x16x32_bf16 v[140:143], a[128:131], a[92:95], v[140:143]
    global_load_dword v31, v28, s[56:57]
    s_waitcnt lgkmcnt(4)
    v_mfma_f32_16x16x32_bf16 v[144:147], a[132:135], a[80:83], v[144:147]
    ds_read_b64_tr_b16 a[128:129], v13 offset:21600
    v_mfma_f32_16x16x32_bf16 v[148:151], a[132:135], a[84:87], v[148:151]
    ds_read_b64_tr_b16 a[130:131], v13 offset:25184
    v_mfma_f32_16x16x32_bf16 v[152:155], a[132:135], a[88:91], v[152:155]
    v_mfma_f32_16x16x32_bf16 v[156:159], a[132:135], a[92:95], v[156:159]
    buffer_load_dwordx4 a[56:59], v4, s[8:11], s26 offen offset:3072
    s_waitcnt lgkmcnt(4)
    v_mfma_f32_16x16x32_bf16 v[160:163], a[136:139], a[80:83], v[160:163]
    ds_read_b64_tr_b16 a[132:133], v13 offset:21632
    v_mfma_f32_16x16x32_bf16 v[164:167], a[136:139], a[84:87], v[164:167]
    ds_read_b64_tr_b16 a[134:135], v13 offset:25216
    v_mfma_f32_16x16x32_bf16 v[168:171], a[136:139], a[88:91], v[168:171]
    v_mfma_f32_16x16x32_bf16 v[172:175], a[136:139], a[92:95], v[172:175]
    s_waitcnt lgkmcnt(4)
    v_mfma_f32_16x16x32_bf16 v[176:179], a[140:143], a[80:83], v[176:179]
    ds_read_b64_tr_b16 a[136:137], v13 offset:21664
    v_mfma_f32_16x16x32_bf16 v[180:183], a[140:143], a[84:87], v[180:183]
    ds_read_b64_tr_b16 a[138:139], v13 offset:25248
    v_mfma_f32_16x16x32_bf16 v[184:187], a[140:143], a[88:91], v[184:187]
    v_mfma_f32_16x16x32_bf16 v[188:191], a[140:143], a[92:95], v[188:191]
    buffer_load_dwordx4 a[60:63], v5, s[8:11], s26 offen offset:3072
    s_add_u32 s26, s26, 4096
    s_waitcnt lgkmcnt(4)
    v_mfma_f32_16x16x32_bf16 v[192:195], a[128:131], a[80:83], v[192:195]
    ds_read_b64_tr_b16 a[140:141], v13 offset:21696
    v_mfma_f32_16x16x32_bf16 v[196:199], a[128:131], a[84:87], v[196:199]
    ds_read_b64_tr_b16 a[142:143], v13 offset:25280
    v_mfma_f32_16x16x32_bf16 v[200:203], a[128:131], a[88:91], v[200:203]
    v_mfma_f32_16x16x32_bf16 v[204:207], a[128:131], a[92:95], v[204:207]
    buffer_load_dwordx4 a[64:67], v2, s[8:11], s26 offen offset:0
    s_waitcnt lgkmcnt(4)
    v_mfma_f32_16x16x32_bf16 v[208:211], a[132:135], a[80:83], v[208:211]
    s_waitcnt vmcnt(40)
    s_barrier
    ds_read_b64_tr_b16 a[128:129], v13 offset:28672
    v_mfma_f32_16x16x32_bf16 v[212:215], a[132:135], a[84:87], v[212:215]
    ds_read_b64_tr_b16 a[130:131], v13 offset:32256
    v_mfma_f32_16x16x32_bf16 v[216:219], a[132:135], a[88:91], v[216:219]
    v_mfma_f32_16x16x32_bf16 v[220:223], a[132:135], a[92:95], v[220:223]
    s_waitcnt lgkmcnt(4)
    v_mfma_f32_16x16x32_bf16 v[224:227], a[136:139], a[80:83], v[224:227]
    ds_read_b64_tr_b16 a[132:133], v13 offset:28704
    v_mfma_f32_16x16x32_bf16 v[228:231], a[136:139], a[84:87], v[228:231]
    ds_read_b64_tr_b16 a[134:135], v13 offset:32288
    v_mfma_f32_16x16x32_bf16 v[232:235], a[136:139], a[88:91], v[232:235]
    v_mfma_f32_16x16x32_bf16 v[236:239], a[136:139], a[92:95], v[236:239]
    s_add_u32 m0, s28, 114688
    s_nop 0
    buffer_load_dwordx4 v6, s[12:15], s25 offen offset:0 lds
    s_waitcnt lgkmcnt(4)
    v_mfma_f32_16x16x32_bf16 v[240:243], a[140:143], a[80:83], v[240:243]
    ds_read_b64_tr_b16 a[136:137], v13 offset:28736
    v_mfma_f32_16x16x32_bf16 v[244:247], a[140:143], a[84:87], v[244:247]
    ds_read_b64_tr_b16 a[138:139], v13 offset:32320
    v_mfma_f32_16x16x32_bf16 v[248:251], a[140:143], a[88:91], v[248:251]
    v_mfma_f32_16x16x32_bf16 v[252:255], a[140:143], a[92:95], v[252:255]
    buffer_load_dwordx4 v7, s[12:15], s25 offen offset:1024 lds
    s_waitcnt vmcnt(38)
    s_waitcnt lgkmcnt(4)
    v_mfma_f32_16x16x32_bf16 v[32:35], a[128:131], a[96:99], v[32:35]
    ds_read_b64_tr_b16 a[140:141], v13 offset:28768
    v_mfma_f32_16x16x32_bf16 v[36:39], a[128:131], a[100:103], v[36:39]
    ds_read_b64_tr_b16 a[142:143], v13 offset:32352
    v_mfma_f32_16x16x32_bf16 v[40:43], a[128:131], a[104:107], v[40:43]
    v_mfma_f32_16x16x32_bf16 v[44:47], a[128:131], a[108:111], v[44:47]
    s_waitcnt lgkmcnt(4)
    v_mfma_f32_16x16x32_bf16 v[48:51], a[132:135], a[96:99], v[48:51]
    ds_read_b64_tr_b16 a[128:129], v13 offset:28800
    v_mfma_f32_16x16x32_bf16 v[52:55], a[132:135], a[100:103], v[52:55]
    ds_read_b64_tr_b16 a[130:131], v13 offset:32384
    v_mfma_f32_16x16x32_bf16 v[56:59], a[132:135], a[104:107], v[56:59]
    v_mfma_f32_16x16x32_bf16 v[60:63], a[132:135], a[108:111], v[60:63]
    buffer_load_dwordx4 v8, s[12:15], s25 offen offset:2048 lds
    s_waitcnt lgkmcnt(4)
    v_mfma_f32_16x16x32_bf16 v[64:67], a[136:139], a[96:99], v[64:67]
    ds_read_b64_tr_b16 a[132:133], v13 offset:28832
    v_mfma_f32_16x16x32_bf16 v[68:71], a[136:139], a[100:103], v[68:71]
    ds_read_b64_tr_b16 a[134:135], v13 offset:32416
    v_mfma_f32_16x16x32_bf16 v[72:75], a[136:139], a[104:107], v[72:75]
    v_mfma_f32_16x16x32_bf16 v[76:79], a[136:139], a[108:111], v[76:79]
    buffer_load_dwordx4 v9, s[12:15], s25 offen offset:3072 lds
    s_waitcnt lgkmcnt(4)
    v_mfma_f32_16x16x32_bf16 v[80:83], a[140:143], a[96:99], v[80:83]
    ds_read_b64_tr_b16 a[136:137], v13 offset:28864
    v_mfma_f32_16x16x32_bf16 v[84:87], a[140:143], a[100:103], v[84:87]
    ds_read_b64_tr_b16 a[138:139], v13 offset:32448
    v_mfma_f32_16x16x32_bf16 v[88:91], a[140:143], a[104:107], v[88:91]
    v_mfma_f32_16x16x32_bf16 v[92:95], a[140:143], a[108:111], v[92:95]
    s_waitcnt lgkmcnt(4)
    v_mfma_f32_16x16x32_bf16 v[96:99], a[128:131], a[96:99], v[96:99]
    ds_read_b64_tr_b16 a[140:141], v13 offset:35840
    v_mfma_f32_16x16x32_bf16 v[100:103], a[128:131], a[100:103], v[100:103]
    ds_read_b64_tr_b16 a[142:143], v13 offset:39424
    v_mfma_f32_16x16x32_bf16 v[104:107], a[128:131], a[104:107], v[104:107]
    v_mfma_f32_16x16x32_bf16 v[108:111], a[128:131], a[108:111], v[108:111]
    s_add_u32 m0, s28, 118784
    s_nop 0
    buffer_load_dwordx4 v10, s[12:15], s25 offen offset:0 lds
    s_waitcnt lgkmcnt(4)
    v_mfma_f32_16x16x32_bf16 v[112:115], a[132:135], a[96:99], v[112:115]
    ds_read_b64_tr_b16 a[128:129], v13 offset:35872
    v_mfma_f32_16x16x32_bf16 v[116:119], a[132:135], a[100:103], v[116:119]
    ds_read_b64_tr_b16 a[130:131], v13 offset:39456
    v_mfma_f32_16x16x32_bf16 v[120:123], a[132:135], a[104:107], v[120:123]
    v_mfma_f32_16x16x32_bf16 v[124:127], a[132:135], a[108:111], v[124:127]
    buffer_load_dwordx4 v11, s[12:15], s25 offen offset:1024 lds
    s_waitcnt lgkmcnt(4)
    v_mfma_f32_16x16x32_bf16 v[128:131], a[136:139], a[96:99], v[128:131]
    ds_read_b64_tr_b16 a[132:133], v13 offset:35904
    v_mfma_f32_16x16x32_bf16 v[132:135], a[136:139], a[100:103], v[132:135]
    ds_read_b64_tr_b16 a[134:135], v13 offset:39488
    v_mfma_f32_16x16x32_bf16 v[136:139], a[136:139], a[104:107], v[136:139]
    v_mfma_f32_16x16x32_bf16 v[140:143], a[136:139], a[108:111], v[140:143]
    s_waitcnt lgkmcnt(4)
    v_mfma_f32_16x16x32_bf16 v[144:147], a[140:143], a[96:99], v[144:147]
    ds_read_b64_tr_b16 a[136:137], v13 offset:35936
    v_mfma_f32_16x16x32_bf16 v[148:151], a[140:143], a[100:103], v[148:151]
    ds_read_b64_tr_b16 a[138:139], v13 offset:39520
    v_mfma_f32_16x16x32_bf16 v[152:155], a[140:143], a[104:107], v[152:155]
    v_mfma_f32_16x16x32_bf16 v[156:159], a[140:143], a[108:111], v[156:159]
    buffer_load_dwordx4 v12, s[12:15], s25 offen offset:2048 lds
    s_add_u32 s25, s25, 458752
    s_waitcnt lgkmcnt(4)
    v_mfma_f32_16x16x32_bf16 v[160:163], a[128:131], a[96:99], v[160:163]
    ds_read_b64_tr_b16 a[140:141], v13 offset:35968
    v_mfma_f32_16x16x32_bf16 v[164:167], a[128:131], a[100:103], v[164:167]
    ds_read_b64_tr_b16 a[142:143], v13 offset:39552
    v_mfma_f32_16x16x32_bf16 v[168:171], a[128:131], a[104:107], v[168:171]
    v_mfma_f32_16x16x32_bf16 v[172:175], a[128:131], a[108:111], v[172:175]
    buffer_load_dwordx4 a[68:71], v3, s[8:11], s26 offen offset:0
    s_waitcnt lgkmcnt(4)
    v_mfma_f32_16x16x32_bf16 v[176:179], a[132:135], a[96:99], v[176:179]
    ds_read_b64_tr_b16 a[128:129], v13 offset:36000
    v_mfma_f32_16x16x32_bf16 v[180:183], a[132:135], a[100:103], v[180:183]
    ds_read_b64_tr_b16 a[130:131], v13 offset:39584
    v_mfma_f32_16x16x32_bf16 v[184:187], a[132:135], a[104:107], v[184:187]
    v_mfma_f32_16x16x32_bf16 v[188:191], a[132:135], a[108:111], v[188:191]
    s_waitcnt lgkmcnt(4)
    v_mfma_f32_16x16x32_bf16 v[192:195], a[136:139], a[96:99], v[192:195]
    ds_read_b64_tr_b16 a[132:133], v13 offset:36032
    v_mfma_f32_16x16x32_bf16 v[196:199], a[136:139], a[100:103], v[196:199]
    ds_read_b64_tr_b16 a[134:135], v13 offset:39616
    v_mfma_f32_16x16x32_bf16 v[200:203], a[136:139], a[104:107], v[200:203]
    v_mfma_f32_16x16x32_bf16 v[204:207], a[136:139], a[108:111], v[204:207]
    buffer_load_dwordx4 a[72:75], v4, s[8:11], s26 offen offset:0
    s_waitcnt lgkmcnt(4)
    v_mfma_f32_16x16x32_bf16 v[208:211], a[140:143], a[96:99], v[208:211]
    ds_read_b64_tr_b16 a[136:137], v13 offset:43008
    v_mfma_f32_16x16x32_bf16 v[212:215], a[140:143], a[100:103], v[212:215]
    ds_read_b64_tr_b16 a[138:139], v13 offset:46592
    v_mfma_f32_16x16x32_bf16 v[216:219], a[140:143], a[104:107], v[216:219]
    v_mfma_f32_16x16x32_bf16 v[220:223], a[140:143], a[108:111], v[220:223]
    buffer_load_dwordx4 a[76:79], v5, s[8:11], s26 offen offset:0
    s_waitcnt lgkmcnt(4)
    v_mfma_f32_16x16x32_bf16 v[224:227], a[128:131], a[96:99], v[224:227]
    ds_read_b64_tr_b16 a[140:141], v13 offset:43040
    v_mfma_f32_16x16x32_bf16 v[228:231], a[128:131], a[100:103], v[228:231]
    ds_read_b64_tr_b16 a[142:143], v13 offset:46624
    v_mfma_f32_16x16x32_bf16 v[232:235], a[128:131], a[104:107], v[232:235]
    v_mfma_f32_16x16x32_bf16 v[236:239], a[128:131], a[108:111], v[236:239]
    s_waitcnt lgkmcnt(4)
    v_mfma_f32_16x16x32_bf16 v[240:243], a[132:135], a[96:99], v[240:243]
    ds_read_b64_tr_b16 a[128:129], v13 offset:43072
    v_mfma_f32_16x16x32_bf16 v[244:247], a[132:135], a[100:103], v[244:247]
    ds_read_b64_tr_b16 a[130:131], v13 offset:46656
    v_mfma_f32_16x16x32_bf16 v[248:251], a[132:135], a[104:107], v[248:251]
    v_mfma_f32_16x16x32_bf16 v[252:255], a[132:135], a[108:111], v[252:255]
    buffer_load_dwordx4 a[80:83], v2, s[8:11], s26 offen offset:1024
    s_waitcnt vmcnt(43)
    s_waitcnt lgkmcnt(4)
    v_mfma_f32_16x16x32_bf16 v[32:35], a[136:139], a[112:115], v[32:35]
    ds_read_b64_tr_b16 a[132:133], v13 offset:43104
    v_mfma_f32_16x16x32_bf16 v[36:39], a[136:139], a[116:119], v[36:39]
    ds_read_b64_tr_b16 a[134:135], v13 offset:46688
    v_mfma_f32_16x16x32_bf16 v[40:43], a[136:139], a[120:123], v[40:43]
    v_mfma_f32_16x16x32_bf16 v[44:47], a[136:139], a[124:127], v[44:47]
    buffer_load_dwordx4 a[84:87], v3, s[8:11], s26 offen offset:1024
    s_waitcnt lgkmcnt(4)
    v_mfma_f32_16x16x32_bf16 v[48:51], a[140:143], a[112:115], v[48:51]
    ds_read_b64_tr_b16 a[136:137], v13 offset:43136
    v_mfma_f32_16x16x32_bf16 v[52:55], a[140:143], a[116:119], v[52:55]
    ds_read_b64_tr_b16 a[138:139], v13 offset:46720
    v_mfma_f32_16x16x32_bf16 v[56:59], a[140:143], a[120:123], v[56:59]
    v_mfma_f32_16x16x32_bf16 v[60:63], a[140:143], a[124:127], v[60:63]
    s_waitcnt lgkmcnt(4)
    v_mfma_f32_16x16x32_bf16 v[64:67], a[128:131], a[112:115], v[64:67]
    ds_read_b64_tr_b16 a[140:141], v13 offset:43168
    v_mfma_f32_16x16x32_bf16 v[68:71], a[128:131], a[116:119], v[68:71]
    ds_read_b64_tr_b16 a[142:143], v13 offset:46752
    v_mfma_f32_16x16x32_bf16 v[72:75], a[128:131], a[120:123], v[72:75]
    v_mfma_f32_16x16x32_bf16 v[76:79], a[128:131], a[124:127], v[76:79]
    buffer_load_dwordx4 a[88:91], v4, s[8:11], s26 offen offset:1024
    s_waitcnt lgkmcnt(4)
    v_mfma_f32_16x16x32_bf16 v[80:83], a[132:135], a[112:115], v[80:83]
    ds_read_b64_tr_b16 a[128:129], v13 offset:43200
    v_mfma_f32_16x16x32_bf16 v[84:87], a[132:135], a[116:119], v[84:87]
    ds_read_b64_tr_b16 a[130:131], v13 offset:46784
    v_mfma_f32_16x16x32_bf16 v[88:91], a[132:135], a[120:123], v[88:91]
    v_mfma_f32_16x16x32_bf16 v[92:95], a[132:135], a[124:127], v[92:95]
    buffer_load_dwordx4 a[92:95], v5, s[8:11], s26 offen offset:1024
    s_waitcnt lgkmcnt(4)
    v_mfma_f32_16x16x32_bf16 v[96:99], a[136:139], a[112:115], v[96:99]
    ds_read_b64_tr_b16 a[132:133], v13 offset:50176
    v_mfma_f32_16x16x32_bf16 v[100:103], a[136:139], a[116:119], v[100:103]
    ds_read_b64_tr_b16 a[134:135], v13 offset:53760
    v_mfma_f32_16x16x32_bf16 v[104:107], a[136:139], a[120:123], v[104:107]
    v_mfma_f32_16x16x32_bf16 v[108:111], a[136:139], a[124:127], v[108:111]
    s_waitcnt lgkmcnt(4)
    v_mfma_f32_16x16x32_bf16 v[112:115], a[140:143], a[112:115], v[112:115]
    ds_read_b64_tr_b16 a[136:137], v13 offset:50208
    v_mfma_f32_16x16x32_bf16 v[116:119], a[140:143], a[116:119], v[116:119]
    ds_read_b64_tr_b16 a[138:139], v13 offset:53792
    v_mfma_f32_16x16x32_bf16 v[120:123], a[140:143], a[120:123], v[120:123]
    v_mfma_f32_16x16x32_bf16 v[124:127], a[140:143], a[124:127], v[124:127]
    buffer_load_dwordx4 a[96:99], v2, s[8:11], s26 offen offset:2048
    s_waitcnt lgkmcnt(4)
    v_mfma_f32_16x16x32_bf16 v[128:131], a[128:131], a[112:115], v[128:131]
    ds_read_b64_tr_b16 a[140:141], v13 offset:50240
    v_mfma_f32_16x16x32_bf16 v[132:135], a[128:131], a[116:119], v[132:135]
    ds_read_b64_tr_b16 a[142:143], v13 offset:53824
    v_mfma_f32_16x16x32_bf16 v[136:139], a[128:131], a[120:123], v[136:139]
    v_mfma_f32_16x16x32_bf16 v[140:143], a[128:131], a[124:127], v[140:143]
    buffer_load_dwordx4 a[100:103], v3, s[8:11], s26 offen offset:2048
    s_waitcnt lgkmcnt(4)
    v_mfma_f32_16x16x32_bf16 v[144:147], a[132:135], a[112:115], v[144:147]
    ds_read_b64_tr_b16 a[128:129], v13 offset:50272
    v_mfma_f32_16x16x32_bf16 v[148:151], a[132:135], a[116:119], v[148:151]
    ds_read_b64_tr_b16 a[130:131], v13 offset:53856
    v_mfma_f32_16x16x32_bf16 v[152:155], a[132:135], a[120:123], v[152:155]
    v_mfma_f32_16x16x32_bf16 v[156:159], a[132:135], a[124:127], v[156:159]
    s_waitcnt lgkmcnt(4)
    v_mfma_f32_16x16x32_bf16 v[160:163], a[136:139], a[112:115], v[160:163]
    ds_read_b64_tr_b16 a[132:133], v13 offset:50304
    v_mfma_f32_16x16x32_bf16 v[164:167], a[136:139], a[116:119], v[164:167]
    ds_read_b64_tr_b16 a[134:135], v13 offset:53888
    v_mfma_f32_16x16x32_bf16 v[168:171], a[136:139], a[120:123], v[168:171]
    v_mfma_f32_16x16x32_bf16 v[172:175], a[136:139], a[124:127], v[172:175]
    buffer_load_dwordx4 a[104:107], v4, s[8:11], s26 offen offset:2048
    s_waitcnt lgkmcnt(4)
    v_mfma_f32_16x16x32_bf16 v[176:179], a[140:143], a[112:115], v[176:179]
    ds_read_b64_tr_b16 a[136:137], v13 offset:50336
    v_mfma_f32_16x16x32_bf16 v[180:183], a[140:143], a[116:119], v[180:183]
    ds_read_b64_tr_b16 a[138:139], v13 offset:53920
    v_mfma_f32_16x16x32_bf16 v[184:187], a[140:143], a[120:123], v[184:187]
    v_mfma_f32_16x16x32_bf16 v[188:191], a[140:143], a[124:127], v[188:191]
    buffer_load_dwordx4 a[108:111], v5, s[8:11], s26 offen offset:2048
    s_waitcnt lgkmcnt(4)
    v_mfma_f32_16x16x32_bf16 v[192:195], a[128:131], a[112:115], v[192:195]
    ds_read_b64_tr_b16 a[140:141], v13 offset:50368
    v_mfma_f32_16x16x32_bf16 v[196:199], a[128:131], a[116:119], v[196:199]
    ds_read_b64_tr_b16 a[142:143], v13 offset:53952
    v_mfma_f32_16x16x32_bf16 v[200:203], a[128:131], a[120:123], v[200:203]
    v_mfma_f32_16x16x32_bf16 v[204:207], a[128:131], a[124:127], v[204:207]
    s_waitcnt lgkmcnt(4)
    v_mfma_f32_16x16x32_bf16 v[208:211], a[132:135], a[112:115], v[208:211]
    s_waitcnt vmcnt(43)
    s_barrier
    ds_read_b64_tr_b16 a[128:129], v14 offset:0
    v_mfma_f32_16x16x32_bf16 v[212:215], a[132:135], a[116:119], v[212:215]
    ds_read_b64_tr_b16 a[130:131], v14 offset:3584
    v_mfma_f32_16x16x32_bf16 v[216:219], a[132:135], a[120:123], v[216:219]
    v_mfma_f32_16x16x32_bf16 v[220:223], a[132:135], a[124:127], v[220:223]
    s_add_u32 m0, s28, 0
    s_nop 0
    buffer_load_dwordx4 v6, s[12:15], s25 offen offset:0 lds
    s_waitcnt lgkmcnt(4)
    v_mfma_f32_16x16x32_bf16 v[224:227], a[136:139], a[112:115], v[224:227]
    ds_read_b64_tr_b16 a[132:133], v14 offset:32
    v_mfma_f32_16x16x32_bf16 v[228:231], a[136:139], a[116:119], v[228:231]
    ds_read_b64_tr_b16 a[134:135], v14 offset:3616
    v_mfma_f32_16x16x32_bf16 v[232:235], a[136:139], a[120:123], v[232:235]
    v_mfma_f32_16x16x32_bf16 v[236:239], a[136:139], a[124:127], v[236:239]
    buffer_load_dwordx4 v7, s[12:15], s25 offen offset:1024 lds
    s_waitcnt lgkmcnt(4)
    v_mfma_f32_16x16x32_bf16 v[240:243], a[140:143], a[112:115], v[240:243]
    ds_read_b64_tr_b16 a[136:137], v14 offset:64
    v_mfma_f32_16x16x32_bf16 v[244:247], a[140:143], a[116:119], v[244:247]
    ds_read_b64_tr_b16 a[138:139], v14 offset:3648
    v_mfma_f32_16x16x32_bf16 v[248:251], a[140:143], a[120:123], v[248:251]
    v_mfma_f32_16x16x32_bf16 v[252:255], a[140:143], a[124:127], v[252:255]
    s_waitcnt vmcnt(41)
    s_waitcnt lgkmcnt(4)
    v_mfma_f32_16x16x32_bf16 v[32:35], a[128:131], a[0:3], v[32:35]
    ds_read_b64_tr_b16 a[140:141], v14 offset:96
    v_mfma_f32_16x16x32_bf16 v[36:39], a[128:131], a[4:7], v[36:39]
    ds_read_b64_tr_b16 a[142:143], v14 offset:3680
    v_mfma_f32_16x16x32_bf16 v[40:43], a[128:131], a[8:11], v[40:43]
    v_mfma_f32_16x16x32_bf16 v[44:47], a[128:131], a[12:15], v[44:47]
    buffer_load_dwordx4 v8, s[12:15], s25 offen offset:2048 lds
    s_waitcnt lgkmcnt(4)
    v_mfma_f32_16x16x32_bf16 v[48:51], a[132:135], a[0:3], v[48:51]
    ds_read_b64_tr_b16 a[128:129], v14 offset:128
    v_mfma_f32_16x16x32_bf16 v[52:55], a[132:135], a[4:7], v[52:55]
    ds_read_b64_tr_b16 a[130:131], v14 offset:3712
    v_mfma_f32_16x16x32_bf16 v[56:59], a[132:135], a[8:11], v[56:59]
    v_mfma_f32_16x16x32_bf16 v[60:63], a[132:135], a[12:15], v[60:63]
    buffer_load_dwordx4 v9, s[12:15], s25 offen offset:3072 lds
    s_waitcnt lgkmcnt(4)
    v_mfma_f32_16x16x32_bf16 v[64:67], a[136:139], a[0:3], v[64:67]
    ds_read_b64_tr_b16 a[132:133], v14 offset:160
    v_mfma_f32_16x16x32_bf16 v[68:71], a[136:139], a[4:7], v[68:71]
    ds_read_b64_tr_b16 a[134:135], v14 offset:3744
    v_mfma_f32_16x16x32_bf16 v[72:75], a[136:139], a[8:11], v[72:75]
    v_mfma_f32_16x16x32_bf16 v[76:79], a[136:139], a[12:15], v[76:79]
    s_waitcnt lgkmcnt(4)
    v_mfma_f32_16x16x32_bf16 v[80:83], a[140:143], a[0:3], v[80:83]
    ds_read_b64_tr_b16 a[136:137], v14 offset:192
    v_mfma_f32_16x16x32_bf16 v[84:87], a[140:143], a[4:7], v[84:87]
    ds_read_b64_tr_b16 a[138:139], v14 offset:3776
    v_mfma_f32_16x16x32_bf16 v[88:91], a[140:143], a[8:11], v[88:91]
    v_mfma_f32_16x16x32_bf16 v[92:95], a[140:143], a[12:15], v[92:95]
    s_add_u32 m0, s28, 4096
    s_nop 0
    buffer_load_dwordx4 v10, s[12:15], s25 offen offset:0 lds
    s_waitcnt lgkmcnt(4)
    v_mfma_f32_16x16x32_bf16 v[96:99], a[128:131], a[0:3], v[96:99]
    ds_read_b64_tr_b16 a[140:141], v14 offset:7168
    v_mfma_f32_16x16x32_bf16 v[100:103], a[128:131], a[4:7], v[100:103]
    ds_read_b64_tr_b16 a[142:143], v14 offset:10752
    v_mfma_f32_16x16x32_bf16 v[104:107], a[128:131], a[8:11], v[104:107]
    v_mfma_f32_16x16x32_bf16 v[108:111], a[128:131], a[12:15], v[108:111]
    buffer_load_dwordx4 v11, s[12:15], s25 offen offset:1024 lds
    s_waitcnt lgkmcnt(4)
    v_mfma_f32_16x16x32_bf16 v[112:115], a[132:135], a[0:3], v[112:115]
    ds_read_b64_tr_b16 a[128:129], v14 offset:7200
    v_mfma_f32_16x16x32_bf16 v[116:119], a[132:135], a[4:7], v[116:119]
    ds_read_b64_tr_b16 a[130:131], v14 offset:10784
    v_mfma_f32_16x16x32_bf16 v[120:123], a[132:135], a[8:11], v[120:123]
    v_mfma_f32_16x16x32_bf16 v[124:127], a[132:135], a[12:15], v[124:127]
    s_waitcnt lgkmcnt(4)
    v_mfma_f32_16x16x32_bf16 v[128:131], a[136:139], a[0:3], v[128:131]
    ds_read_b64_tr_b16 a[132:133], v14 offset:7232
    v_mfma_f32_16x16x32_bf16 v[132:135], a[136:139], a[4:7], v[132:135]
    ds_read_b64_tr_b16 a[134:135], v14 offset:10816
    v_mfma_f32_16x16x32_bf16 v[136:139], a[136:139], a[8:11], v[136:139]
    v_mfma_f32_16x16x32_bf16 v[140:143], a[136:139], a[12:15], v[140:143]
    buffer_load_dwordx4 v12, s[12:15], s25 offen offset:2048 lds
    s_waitcnt lgkmcnt(4)
    v_mfma_f32_16x16x32_bf16 v[144:147], a[140:143], a[0:3], v[144:147]
    ds_read_b64_tr_b16 a[136:137], v14 offset:7264
    v_mfma_f32_16x16x32_bf16 v[148:151], a[140:143], a[4:7], v[148:151]
    ds_read_b64_tr_b16 a[138:139], v14 offset:10848
    v_mfma_f32_16x16x32_bf16 v[152:155], a[140:143], a[8:11], v[152:155]
    v_mfma_f32_16x16x32_bf16 v[156:159], a[140:143], a[12:15], v[156:159]
    buffer_load_dwordx4 a[112:115], v2, s[8:11], s26 offen offset:3072
    s_waitcnt lgkmcnt(4)
    v_mfma_f32_16x16x32_bf16 v[160:163], a[128:131], a[0:3], v[160:163]
    ds_read_b64_tr_b16 a[140:141], v14 offset:7296
    v_mfma_f32_16x16x32_bf16 v[164:167], a[128:131], a[4:7], v[164:167]
    ds_read_b64_tr_b16 a[142:143], v14 offset:10880
    v_mfma_f32_16x16x32_bf16 v[168:171], a[128:131], a[8:11], v[168:171]
    v_mfma_f32_16x16x32_bf16 v[172:175], a[128:131], a[12:15], v[172:175]
    s_waitcnt lgkmcnt(4)
    v_mfma_f32_16x16x32_bf16 v[176:179], a[132:135], a[0:3], v[176:179]
    ds_read_b64_tr_b16 a[128:129], v14 offset:7328
    v_mfma_f32_16x16x32_bf16 v[180:183], a[132:135], a[4:7], v[180:183]
    ds_read_b64_tr_b16 a[130:131], v14 offset:10912
    v_mfma_f32_16x16x32_bf16 v[184:187], a[132:135], a[8:11], v[184:187]
    v_mfma_f32_16x16x32_bf16 v[188:191], a[132:135], a[12:15], v[188:191]
    buffer_load_dwordx4 a[116:119], v3, s[8:11], s26 offen offset:3072
    s_waitcnt lgkmcnt(4)
    v_mfma_f32_16x16x32_bf16 v[192:195], a[136:139], a[0:3], v[192:195]
    ds_read_b64_tr_b16 a[132:133], v14 offset:7360
    v_mfma_f32_16x16x32_bf16 v[196:199], a[136:139], a[4:7], v[196:199]
    ds_read_b64_tr_b16 a[134:135], v14 offset:10944
    v_mfma_f32_16x16x32_bf16 v[200:203], a[136:139], a[8:11], v[200:203]
    v_mfma_f32_16x16x32_bf16 v[204:207], a[136:139], a[12:15], v[204:207]
    buffer_load_dwordx4 a[120:123], v4, s[8:11], s26 offen offset:3072
    s_waitcnt lgkmcnt(4)
    v_mfma_f32_16x16x32_bf16 v[208:211], a[140:143], a[0:3], v[208:211]
    ds_read_b64_tr_b16 a[136:137], v14 offset:14336
    v_mfma_f32_16x16x32_bf16 v[212:215], a[140:143], a[4:7], v[212:215]
    ds_read_b64_tr_b16 a[138:139], v14 offset:17920
    v_mfma_f32_16x16x32_bf16 v[216:219], a[140:143], a[8:11], v[216:219]
    v_mfma_f32_16x16x32_bf16 v[220:223], a[140:143], a[12:15], v[220:223]
    s_waitcnt lgkmcnt(4)
    v_mfma_f32_16x16x32_bf16 v[224:227], a[128:131], a[0:3], v[224:227]
    ds_read_b64_tr_b16 a[140:141], v14 offset:14368
    v_mfma_f32_16x16x32_bf16 v[228:231], a[128:131], a[4:7], v[228:231]
    ds_read_b64_tr_b16 a[142:143], v14 offset:17952
    v_mfma_f32_16x16x32_bf16 v[232:235], a[128:131], a[8:11], v[232:235]
    v_mfma_f32_16x16x32_bf16 v[236:239], a[128:131], a[12:15], v[236:239]
    buffer_load_dwordx4 a[124:127], v5, s[8:11], s26 offen offset:3072
    s_add_u32 s26, s26, 4096
    s_waitcnt lgkmcnt(4)
    v_mfma_f32_16x16x32_bf16 v[240:243], a[132:135], a[0:3], v[240:243]
    ds_read_b64_tr_b16 a[128:129], v14 offset:14400
    v_mfma_f32_16x16x32_bf16 v[244:247], a[132:135], a[4:7], v[244:247]
    ds_read_b64_tr_b16 a[130:131], v14 offset:17984
    v_mfma_f32_16x16x32_bf16 v[248:251], a[132:135], a[8:11], v[248:251]
    v_mfma_f32_16x16x32_bf16 v[252:255], a[132:135], a[12:15], v[252:255]
    s_waitcnt vmcnt(46)
    s_waitcnt lgkmcnt(4)
    v_mfma_f32_16x16x32_bf16 v[32:35], a[136:139], a[16:19], v[32:35]
    ds_read_b64_tr_b16 a[132:133], v14 offset:14432
    v_mfma_f32_16x16x32_bf16 v[36:39], a[136:139], a[20:23], v[36:39]
    ds_read_b64_tr_b16 a[134:135], v14 offset:18016
    v_mfma_f32_16x16x32_bf16 v[40:43], a[136:139], a[24:27], v[40:43]
    v_mfma_f32_16x16x32_bf16 v[44:47], a[136:139], a[28:31], v[44:47]
    s_waitcnt lgkmcnt(4)
    v_mfma_f32_16x16x32_bf16 v[48:51], a[140:143], a[16:19], v[48:51]
    ds_read_b64_tr_b16 a[136:137], v14 offset:14464
    v_mfma_f32_16x16x32_bf16 v[52:55], a[140:143], a[20:23], v[52:55]
    ds_read_b64_tr_b16 a[138:139], v14 offset:18048
    v_mfma_f32_16x16x32_bf16 v[56:59], a[140:143], a[24:27], v[56:59]
    v_mfma_f32_16x16x32_bf16 v[60:63], a[140:143], a[28:31], v[60:63]
    s_waitcnt lgkmcnt(4)
    v_mfma_f32_16x16x32_bf16 v[64:67], a[128:131], a[16:19], v[64:67]
    ds_read_b64_tr_b16 a[140:141], v14 offset:14496
    v_mfma_f32_16x16x32_bf16 v[68:71], a[128:131], a[20:23], v[68:71]
    ds_read_b64_tr_b16 a[142:143], v14 offset:18080
    v_mfma_f32_16x16x32_bf16 v[72:75], a[128:131], a[24:27], v[72:75]
    v_mfma_f32_16x16x32_bf16 v[76:79], a[128:131], a[28:31], v[76:79]
    s_waitcnt lgkmcnt(4)
    v_mfma_f32_16x16x32_bf16 v[80:83], a[132:135], a[16:19], v[80:83]
    ds_read_b64_tr_b16 a[128:129], v14 offset:14528
    v_mfma_f32_16x16x32_bf16 v[84:87], a[132:135], a[20:23], v[84:87]
    ds_read_b64_tr_b16 a[130:131], v14 offset:18112
    v_mfma_f32_16x16x32_bf16 v[88:91], a[132:135], a[24:27], v[88:91]
    v_mfma_f32_16x16x32_bf16 v[92:95], a[132:135], a[28:31], v[92:95]
    s_waitcnt lgkmcnt(4)
    v_mfma_f32_16x16x32_bf16 v[96:99], a[136:139], a[16:19], v[96:99]
    ds_read_b64_tr_b16 a[132:133], v14 offset:21504
    v_mfma_f32_16x16x32_bf16 v[100:103], a[136:139], a[20:23], v[100:103]
    ds_read_b64_tr_b16 a[134:135], v14 offset:25088
    v_mfma_f32_16x16x32_bf16 v[104:107], a[136:139], a[24:27], v[104:107]
    v_mfma_f32_16x16x32_bf16 v[108:111], a[136:139], a[28:31], v[108:111]
    s_waitcnt lgkmcnt(4)
    v_mfma_f32_16x16x32_bf16 v[112:115], a[140:143], a[16:19], v[112:115]
    ds_read_b64_tr_b16 a[136:137], v14 offset:21536
    v_mfma_f32_16x16x32_bf16 v[116:119], a[140:143], a[20:23], v[116:119]
    ds_read_b64_tr_b16 a[138:139], v14 offset:25120
    v_mfma_f32_16x16x32_bf16 v[120:123], a[140:143], a[24:27], v[120:123]
    v_mfma_f32_16x16x32_bf16 v[124:127], a[140:143], a[28:31], v[124:127]
    s_waitcnt lgkmcnt(4)
    v_mfma_f32_16x16x32_bf16 v[128:131], a[128:131], a[16:19], v[128:131]
    ds_read_b64_tr_b16 a[140:141], v14 offset:21568
    v_mfma_f32_16x16x32_bf16 v[132:135], a[128:131], a[20:23], v[132:135]
    ds_read_b64_tr_b16 a[142:143], v14 offset:25152
    v_mfma_f32_16x16x32_bf16 v[136:139], a[128:131], a[24:27], v[136:139]
    v_mfma_f32_16x16x32_bf16 v[140:143], a[128:131], a[28:31], v[140:143]
    s_waitcnt lgkmcnt(4)
    v_mfma_f32_16x16x32_bf16 v[144:147], a[132:135], a[16:19], v[144:147]
    ds_read_b64_tr_b16 a[128:129], v14 offset:21600
    v_mfma_f32_16x16x32_bf16 v[148:151], a[132:135], a[20:23], v[148:151]
    ds_read_b64_tr_b16 a[130:131], v14 offset:25184
    v_mfma_f32_16x16x32_bf16 v[152:155], a[132:135], a[24:27], v[152:155]
    v_mfma_f32_16x16x32_bf16 v[156:159], a[132:135], a[28:31], v[156:159]
    s_waitcnt lgkmcnt(4)
    v_mfma_f32_16x16x32_bf16 v[160:163], a[136:139], a[16:19], v[160:163]
    ds_read_b64_tr_b16 a[132:133], v14 offset:21632
    v_mfma_f32_16x16x32_bf16 v[164:167], a[136:139], a[20:23], v[164:167]
    ds_read_b64_tr_b16 a[134:135], v14 offset:25216
    v_mfma_f32_16x16x32_bf16 v[168:171], a[136:139], a[24:27], v[168:171]
    v_mfma_f32_16x16x32_bf16 v[172:175], a[136:139], a[28:31], v[172:175]
    s_waitcnt lgkmcnt(4)
    v_mfma_f32_16x16x32_bf16 v[176:179], a[140:143], a[16:19], v[176:179]
    ds_read_b64_tr_b16 a[136:137], v14 offset:21664
    v_mfma_f32_16x16x32_bf16 v[180:183], a[140:143], a[20:23], v[180:183]
    ds_read_b64_tr_b16 a[138:139], v14 offset:25248
    v_mfma_f32_16x16x32_bf16 v[184:187], a[140:143], a[24:27], v[184:187]
    v_mfma_f32_16x16x32_bf16 v[188:191], a[140:143], a[28:31], v[188:191]
    s_waitcnt lgkmcnt(4)
    v_mfma_f32_16x16x32_bf16 v[192:195], a[128:131], a[16:19], v[192:195]
    ds_read_b64_tr_b16 a[140:141], v14 offset:21696
    v_mfma_f32_16x16x32_bf16 v[196:199], a[128:131], a[20:23], v[196:199]
    ds_read_b64_tr_b16 a[142:143], v14 offset:25280
    v_mfma_f32_16x16x32_bf16 v[200:203], a[128:131], a[24:27], v[200:203]
    v_mfma_f32_16x16x32_bf16 v[204:207], a[128:131], a[28:31], v[204:207]
    s_waitcnt lgkmcnt(4)
    v_mfma_f32_16x16x32_bf16 v[208:211], a[132:135], a[16:19], v[208:211]
    s_waitcnt vmcnt(39)
    s_barrier
    ds_read_b64_tr_b16 a[128:129], v14 offset:28672
    v_mfma_f32_16x16x32_bf16 v[212:215], a[132:135], a[20:23], v[212:215]
    ds_read_b64_tr_b16 a[130:131], v14 offset:32256
    v_mfma_f32_16x16x32_bf16 v[216:219], a[132:135], a[24:27], v[216:219]
    v_mfma_f32_16x16x32_bf16 v[220:223], a[132:135], a[28:31], v[220:223]
    s_waitcnt lgkmcnt(4)
    v_mfma_f32_16x16x32_bf16 v[224:227], a[136:139], a[16:19], v[224:227]
    ds_read_b64_tr_b16 a[132:133], v14 offset:35840
    v_mfma_f32_16x16x32_bf16 v[228:231], a[136:139], a[20:23], v[228:231]
    ds_read_b64_tr_b16 a[134:135], v14 offset:39424
    v_mfma_f32_16x16x32_bf16 v[232:235], a[136:139], a[24:27], v[232:235]
    v_mfma_f32_16x16x32_bf16 v[236:239], a[136:139], a[28:31], v[236:239]
    s_waitcnt lgkmcnt(4)
    v_mfma_f32_16x16x32_bf16 v[240:243], a[140:143], a[16:19], v[240:243]
    ds_read_b64_tr_b16 a[136:137], v14 offset:43008
    v_mfma_f32_16x16x32_bf16 v[244:247], a[140:143], a[20:23], v[244:247]
    ds_read_b64_tr_b16 a[138:139], v14 offset:46592
    v_mfma_f32_16x16x32_bf16 v[248:251], a[140:143], a[24:27], v[248:251]
    v_mfma_f32_16x16x32_bf16 v[252:255], a[140:143], a[28:31], v[252:255]
    s_waitcnt vmcnt(35)
    s_waitcnt lgkmcnt(4)
    v_mfma_f32_16x16x32_bf16 v[32:35], a[128:131], a[32:35], v[32:35]
    ds_read_b64_tr_b16 a[140:141], v14 offset:50176
    v_mfma_f32_16x16x32_bf16 v[36:39], a[128:131], a[36:39], v[36:39]
    ds_read_b64_tr_b16 a[142:143], v14 offset:53760
    v_mfma_f32_16x16x32_bf16 v[40:43], a[128:131], a[40:43], v[40:43]
    v_mfma_f32_16x16x32_bf16 v[44:47], a[128:131], a[44:47], v[44:47]
    v_lshrrev_b32 v30, 3, v0
    v_lshlrev_b32 v30, 10, v30
    v_lshl_add_u32 v30, v0, 7, v30
    s_nop 0
    buffer_load_dword v31, v30, s[64:67], s68 offen
    s_add_u32 s68, s68, 14336
    s_waitcnt lgkmcnt(4)
    v_mfma_f32_16x16x32_bf16 v[144:147], a[132:135], a[32:35], v[144:147]
    s_waitcnt vmcnt(23)
    s_barrier
    ds_read_b64_tr_b16 a[128:129], v15 offset:0
    v_mfma_f32_16x16x32_bf16 v[148:151], a[132:135], a[36:39], v[148:151]
    ds_read_b64_tr_b16 a[130:131], v15 offset:3584
    v_mfma_f32_16x16x32_bf16 v[152:155], a[132:135], a[40:43], v[152:155]
    v_mfma_f32_16x16x32_bf16 v[156:159], a[132:135], a[44:47], v[156:159]
    buffer_load_dword v31, v30, s[64:67], s68 offen
    s_add_u32 s68, s68, 14336
    s_waitcnt vmcnt(32)
    s_waitcnt lgkmcnt(4)
    v_mfma_f32_16x16x32_bf16 v[32:35], a[136:139], a[48:51], v[32:35]
    ds_read_b64_tr_b16 a[132:133], v15 offset:7168
    v_mfma_f32_16x16x32_bf16 v[36:39], a[136:139], a[52:55], v[36:39]
    ds_read_b64_tr_b16 a[134:135], v15 offset:10752
    v_mfma_f32_16x16x32_bf16 v[40:43], a[136:139], a[56:59], v[40:43]
    v_mfma_f32_16x16x32_bf16 v[44:47], a[136:139], a[60:63], v[44:47]
    s_waitcnt lgkmcnt(4)
    v_mfma_f32_16x16x32_bf16 v[144:147], a[140:143], a[48:51], v[144:147]
    ds_read_b64_tr_b16 a[136:137], v15 offset:14336
    v_mfma_f32_16x16x32_bf16 v[148:151], a[140:143], a[52:55], v[148:151]
    ds_read_b64_tr_b16 a[138:139], v15 offset:17920
    v_mfma_f32_16x16x32_bf16 v[152:155], a[140:143], a[56:59], v[152:155]
    v_mfma_f32_16x16x32_bf16 v[156:159], a[140:143], a[60:63], v[156:159]
    s_waitcnt vmcnt(21)
    s_waitcnt lgkmcnt(4)
    v_mfma_f32_16x16x32_bf16 v[32:35], a[128:131], a[64:67], v[32:35]
    ds_read_b64_tr_b16 a[140:141], v15 offset:21504
    s_mov_b32 s70, s59
    s_add_u32 s4, s40, 0x628000
    v_mfma_f32_16x16x32_bf16 v[36:39], a[128:131], a[68:71], v[36:39]
    ds_read_b64_tr_b16 a[142:143], v15 offset:25088
    s_addc_u32 s5, s41, 0
    s_and_b32 s5, s5, 0xffff
    v_mfma_f32_16x16x32_bf16 v[40:43], a[128:131], a[72:75], v[40:43]
    s_mov_b32 s6, 0x1000
    s_mov_b32 s7, 0x00020000
    v_mfma_f32_16x16x32_bf16 v[44:47], a[128:131], a[76:79], v[44:47]
    s_bfe_u32 s35, s2, 0x10002
    s_bfe_u32 s31, s2, 0x10001
    s_waitcnt lgkmcnt(4)
    v_mfma_f32_16x16x32_bf16 v[144:147], a[132:135], a[64:67], v[144:147]
    s_waitcnt vmcnt(6)
    s_barrier
    ds_read_b64_tr_b16 a[128:129], v13 offset:0
    s_lshl_b32 s34, s31, 3
    s_lshr_b32 s31, s2, 5
    v_mfma_f32_16x16x32_bf16 v[148:151], a[132:135], a[68:71], v[148:151]
    ds_read_b64_tr_b16 a[130:131], v13 offset:3584
    s_add_u32 s34, s34, s31
    s_and_b32 s31, s2, 1
    v_mfma_f32_16x16x32_bf16 v[152:155], a[132:135], a[72:75], v[152:155]
    s_lshl_b32 s33, s31, 2
    s_bfe_u32 s31, s2, 0x20003
    v_mfma_f32_16x16x32_bf16 v[156:159], a[132:135], a[76:79], v[156:159]
    s_add_u32 s33, s33, s31
    s_mul_i32 s42, s34, 8
    s_waitcnt vmcnt(17)
    s_waitcnt lgkmcnt(4)
    v_mfma_f32_16x16x32_bf16 v[32:35], a[136:139], a[80:83], v[32:35]
    ds_read_b64_tr_b16 a[132:133], v13 offset:7168
    s_mul_i32 s31, s24, 2
    s_add_u32 s42, s42, s31
    v_mfma_f32_16x16x32_bf16 v[36:39], a[136:139], a[84:87], v[36:39]
    ds_read_b64_tr_b16 a[134:135], v13 offset:10752
    s_lshr_b32 s31, s42, 2
    s_lshl_b32 s31, s31, 7
    v_mfma_f32_16x16x32_bf16 v[40:43], a[136:139], a[88:91], v[40:43]
    s_lshl_b32 s71, s35, 6
    s_add_u32 s31, s31, s71
    v_mfma_f32_16x16x32_bf16 v[44:47], a[136:139], a[92:95], v[44:47]
    v_and_b32 v10, 15, v0
    v_lshlrev_b32 v10, 2, v10
    s_waitcnt lgkmcnt(4)
    v_mfma_f32_16x16x32_bf16 v[144:147], a[140:143], a[80:83], v[144:147]
    ds_read_b64_tr_b16 a[136:137], v13 offset:14336
    v_add_u32 v10, s31, v10
    s_xor_b32 s71, s70, 64
    v_mfma_f32_16x16x32_bf16 v[148:151], a[140:143], a[84:87], v[148:151]
    ds_read_b64_tr_b16 a[138:139], v13 offset:17920
    v_mov_b32 v11, s71
    v_cmp_gt_u32 vcc, 32, v0
    v_mfma_f32_16x16x32_bf16 v[152:155], a[140:143], a[88:91], v[152:155]
    s_mov_b32 s67, 0
    s_nop 0
    v_mfma_f32_16x16x32_bf16 v[156:159], a[140:143], a[92:95], v[156:159]
    v_cndmask_b32 v11, v11, v10, vcc
    s_mul_i32 s43, s42, 114688
    s_waitcnt vmcnt(13)
    s_waitcnt lgkmcnt(4)
    v_mfma_f32_16x16x32_bf16 v[32:35], a[128:131], a[96:99], v[32:35]
    ds_read_b64_tr_b16 a[140:141], v13 offset:21504
    s_mul_i32 s31, s35, 57344
    s_add_u32 s43, s43, s31
    v_mfma_f32_16x16x32_bf16 v[36:39], a[128:131], a[100:103], v[36:39]
    ds_read_b64_tr_b16 a[142:143], v13 offset:25088
    s_add_u32 s31, s43, 0
    v_add_u32 v2, s31, v29
    v_mfma_f32_16x16x32_bf16 v[40:43], a[128:131], a[104:107], v[40:43]
    s_add_u32 s31, s43, 114688
    v_add_u32 v3, s31, v29
    v_mfma_f32_16x16x32_bf16 v[44:47], a[128:131], a[108:111], v[44:47]
    v_lshrrev_b32 v4, 3, v0
    v_lshlrev_b32 v4, 13, v4
    s_waitcnt lgkmcnt(4)
    v_mfma_f32_16x16x32_bf16 v[144:147], a[132:135], a[96:99], v[144:147]
    ds_read_b64_tr_b16 a[128:129], v14 offset:28704
    v_and_b32 v5, 7, v0
    v_lshl_add_u32 v4, v5, 4, v4
    v_mfma_f32_16x16x32_bf16 v[148:151], a[132:135], a[100:103], v[148:151]
    ds_read_b64_tr_b16 a[130:131], v14 offset:32288
    s_lshl_b32 s31, s35, 7
    v_add_u32 v8, s31, v4
    v_mfma_f32_16x16x32_bf16 v[152:155], a[132:135], a[104:107], v[152:155]
    v_xor_b32 v6, 128, v8
    v_add_u32 v7, 992, v6
    v_mfma_f32_16x16x32_bf16 v[156:159], a[132:135], a[108:111], v[156:159]
    v_add_u32 v9, 992, v8
    s_lshr_b32 s31, s24, 1
    s_waitcnt vmcnt(2)
    s_waitcnt lgkmcnt(4)
    v_mfma_f32_16x16x32_bf16 v[32:35], a[136:139], a[112:115], v[32:35]
    ds_read_b64_tr_b16 a[132:133], v14 offset:35872
    s_mul_i32 s28, s31, 8448
    s_and_b32 s32, s24, 1
    v_mfma_f32_16x16x32_bf16 v[36:39], a[136:139], a[116:119], v[36:39]
    ds_read_b64_tr_b16 a[134:135], v14 offset:39456
    s_mul_i32 s25, s32, 2112
    s_add_u32 s28, s28, s25
    v_mfma_f32_16x16x32_bf16 v[40:43], a[136:139], a[120:123], v[40:43]
    s_mul_i32 s25, s35, 3670016
    s_lshl_b32 s32, s32, 12
    v_mfma_f32_16x16x32_bf16 v[44:47], a[136:139], a[124:127], v[44:47]
    s_add_u32 s25, s25, s32
    s_lshl_b32 s32, s33, 8
    s_waitcnt lgkmcnt(4)
    v_mfma_f32_16x16x32_bf16 v[144:147], a[140:143], a[112:115], v[144:147]
    ds_read_b64_tr_b16 a[136:137], v14 offset:43040
    s_add_u32 s25, s25, s32
    s_mul_i32 s27, s31, 229376
    v_mfma_f32_16x16x32_bf16 v[148:151], a[140:143], a[116:119], v[148:151]
    ds_read_b64_tr_b16 a[138:139], v14 offset:46624
    s_add_u32 s27, s27, s25
    s_mul_i32 s30, s31, 458752
    v_mfma_f32_16x16x32_bf16 v[152:155], a[140:143], a[120:123], v[152:155]
    s_add_u32 s30, s30, s25
    s_mov_b32 s12, s48
    v_mfma_f32_16x16x32_bf16 v[156:159], a[140:143], a[124:127], v[156:159]
    s_and_b32 s13, s49, 0xffff
    s_mov_b32 s14, 0x700000
    s_waitcnt lgkmcnt(4)
    v_mfma_f32_16x16x32_bf16 v[48:51], a[128:131], a[32:35], v[48:51]
    ds_read_b64_tr_b16 a[140:141], v14 offset:50208
    s_mov_b32 s15, 0x00020000
    s_add_u32 s8, s40, 0x1000000
    v_mfma_f32_16x16x32_bf16 v[52:55], a[128:131], a[36:39], v[52:55]
    ds_read_b64_tr_b16 a[142:143], v14 offset:53792
    s_addc_u32 s9, s41, 0
    s_and_b32 s9, s9, 0xffff
    v_mfma_f32_16x16x32_bf16 v[56:59], a[128:131], a[40:43], v[56:59]
    s_mov_b32 s10, 0xe00000
    s_mov_b32 s11, 0x00020000
    v_mfma_f32_16x16x32_bf16 v[60:63], a[128:131], a[44:47], v[60:63]
    s_waitcnt lgkmcnt(4)
    v_mfma_f32_16x16x32_bf16 v[160:163], a[132:135], a[32:35], v[160:163]
    ds_read_b64_tr_b16 a[128:129], v15 offset:32
    v_mfma_f32_16x16x32_bf16 v[164:167], a[132:135], a[36:39], v[164:167]
    ds_read_b64_tr_b16 a[130:131], v15 offset:3616
    v_mfma_f32_16x16x32_bf16 v[168:171], a[132:135], a[40:43], v[168:171]
    v_mfma_f32_16x16x32_bf16 v[172:175], a[132:135], a[44:47], v[172:175]
    s_waitcnt lgkmcnt(4)
    v_mfma_f32_16x16x32_bf16 v[48:51], a[136:139], a[48:51], v[48:51]
    ds_read_b64_tr_b16 a[132:133], v15 offset:7200
    v_mul_f32 v20, v32, v16
    v_mul_f32 v21, v33, v16
    v_mfma_f32_16x16x32_bf16 v[52:55], a[136:139], a[52:55], v[52:55]
    ds_read_b64_tr_b16 a[134:135], v15 offset:10784
    v_mul_f32 v22, v34, v16
    v_mul_f32 v23, v35, v16
    v_mfma_f32_16x16x32_bf16 v[56:59], a[136:139], a[56:59], v[56:59]
    v_exp_f32 v20, v20
    v_mul_f32 v32, v32, v144
    v_mfma_f32_16x16x32_bf16 v[60:63], a[136:139], a[60:63], v[60:63]
    v_exp_f32 v21, v21
    v_mul_f32 v33, v33, v145
    s_waitcnt lgkmcnt(4)
    v_mfma_f32_16x16x32_bf16 v[160:163], a[140:143], a[48:51], v[160:163]
    ds_read_b64_tr_b16 a[136:137], v15 offset:14368
    v_exp_f32 v22, v22
    v_mul_f32 v34, v34, v146
    v_mfma_f32_16x16x32_bf16 v[164:167], a[140:143], a[52:55], v[164:167]
    ds_read_b64_tr_b16 a[138:139], v15 offset:17952
    v_exp_f32 v23, v23
    v_mul_f32 v35, v35, v147
    v_mfma_f32_16x16x32_bf16 v[168:171], a[140:143], a[56:59], v[168:171]
    v_add_f32 v20, 1.0, v20
    v_add_f32 v21, 1.0, v21
    v_mfma_f32_16x16x32_bf16 v[172:175], a[140:143], a[60:63], v[172:175]
    v_add_f32 v22, 1.0, v22
    v_add_f32 v23, 1.0, v23
    s_waitcnt lgkmcnt(4)
    v_mfma_f32_16x16x32_bf16 v[48:51], a[128:131], a[64:67], v[48:51]
    ds_read_b64_tr_b16 a[140:141], v15 offset:21536
    v_rcp_f32 v20, v20
    v_rcp_f32 v21, v21
    v_mfma_f32_16x16x32_bf16 v[52:55], a[128:131], a[68:71], v[52:55]
    ds_read_b64_tr_b16 a[142:143], v15 offset:25120
    v_rcp_f32 v22, v22
    v_rcp_f32 v23, v23
    v_mfma_f32_16x16x32_bf16 v[56:59], a[128:131], a[72:75], v[56:59]
    v_mul_f32 v32, v32, v20
    v_mul_f32 v33, v33, v21
    v_mfma_f32_16x16x32_bf16 v[60:63], a[128:131], a[76:79], v[60:63]
    v_mul_f32 v34, v34, v22
    v_mul_f32 v35, v35, v23
    s_waitcnt lgkmcnt(4)
    v_mfma_f32_16x16x32_bf16 v[160:163], a[132:135], a[64:67], v[160:163]
    ds_read_b64_tr_b16 a[128:129], v13 offset:32
    v_cvt_pk_bf16_f32 v32, v32, v33
    v_cvt_pk_bf16_f32 v33, v34, v35
    v_mfma_f32_16x16x32_bf16 v[164:167], a[132:135], a[68:71], v[164:167]
    ds_read_b64_tr_b16 a[130:131], v13 offset:3616
    v_mul_f32 v24, v36, v17
    v_mul_f32 v25, v37, v17
    v_mfma_f32_16x16x32_bf16 v[168:171], a[132:135], a[72:75], v[168:171]
    v_mul_f32 v26, v38, v17
    v_mul_f32 v27, v39, v17
    v_mfma_f32_16x16x32_bf16 v[172:175], a[132:135], a[76:79], v[172:175]
    v_exp_f32 v24, v24
    v_mul_f32 v36, v36, v148
    s_waitcnt lgkmcnt(4)
    v_mfma_f32_16x16x32_bf16 v[48:51], a[136:139], a[80:83], v[48:51]
    ds_read_b64_tr_b16 a[132:133], v13 offset:7200
    v_exp_f32 v25, v25
    v_mul_f32 v37, v37, v149
    v_mfma_f32_16x16x32_bf16 v[52:55], a[136:139], a[84:87], v[52:55]
    ds_read_b64_tr_b16 a[134:135], v13 offset:10784
    v_exp_f32 v26, v26
    v_mul_f32 v38, v38, v150
    v_mfma_f32_16x16x32_bf16 v[56:59], a[136:139], a[88:91], v[56:59]
    v_exp_f32 v27, v27
    v_mul_f32 v39, v39, v151
    v_mfma_f32_16x16x32_bf16 v[60:63], a[136:139], a[92:95], v[60:63]
    v_add_f32 v24, 1.0, v24
    v_add_f32 v25, 1.0, v25
    s_waitcnt lgkmcnt(4)
    v_mfma_f32_16x16x32_bf16 v[160:163], a[140:143], a[80:83], v[160:163]
    ds_read_b64_tr_b16 a[136:137], v13 offset:14368
    v_add_f32 v26, 1.0, v26
    v_add_f32 v27, 1.0, v27
    v_mfma_f32_16x16x32_bf16 v[164:167], a[140:143], a[84:87], v[164:167]
    ds_read_b64_tr_b16 a[138:139], v13 offset:17952
    v_rcp_f32 v24, v24
    v_rcp_f32 v25, v25
    v_mfma_f32_16x16x32_bf16 v[168:171], a[140:143], a[88:91], v[168:171]
    v_rcp_f32 v26, v26
    v_rcp_f32 v27, v27
    v_mfma_f32_16x16x32_bf16 v[172:175], a[140:143], a[92:95], v[172:175]
    v_mul_f32 v36, v36, v24
    v_mul_f32 v37, v37, v25
    s_waitcnt lgkmcnt(4)
    v_mfma_f32_16x16x32_bf16 v[48:51], a[128:131], a[96:99], v[48:51]
    ds_read_b64_tr_b16 a[140:141], v13 offset:21536
    v_mul_f32 v38, v38, v26
    v_mul_f32 v39, v39, v27
    v_mfma_f32_16x16x32_bf16 v[52:55], a[128:131], a[100:103], v[52:55]
    ds_read_b64_tr_b16 a[142:143], v13 offset:25120
    v_cvt_pk_bf16_f32 v36, v36, v37
    v_cvt_pk_bf16_f32 v37, v38, v39
    v_mfma_f32_16x16x32_bf16 v[56:59], a[128:131], a[104:107], v[56:59]
    v_mul_f32 v20, v40, v18
    v_mul_f32 v21, v41, v18
    v_mfma_f32_16x16x32_bf16 v[60:63], a[128:131], a[108:111], v[60:63]
    v_mul_f32 v22, v42, v18
    v_mul_f32 v23, v43, v18
    s_waitcnt lgkmcnt(4)
    v_mfma_f32_16x16x32_bf16 v[160:163], a[132:135], a[96:99], v[160:163]
    ds_read_b64_tr_b16 a[128:129], v14 offset:28864
    v_exp_f32 v20, v20
    v_mul_f32 v40, v40, v152
    v_mfma_f32_16x16x32_bf16 v[164:167], a[132:135], a[100:103], v[164:167]
    ds_read_b64_tr_b16 a[130:131], v14 offset:32448
    v_exp_f32 v21, v21
    v_mul_f32 v41, v41, v153
    v_mfma_f32_16x16x32_bf16 v[168:171], a[132:135], a[104:107], v[168:171]
    v_exp_f32 v22, v22
    v_mul_f32 v42, v42, v154
    v_mfma_f32_16x16x32_bf16 v[172:175], a[132:135], a[108:111], v[172:175]
    v_exp_f32 v23, v23
    v_mul_f32 v43, v43, v155
    s_waitcnt lgkmcnt(4)
    v_mfma_f32_16x16x32_bf16 v[48:51], a[136:139], a[112:115], v[48:51]
    ds_read_b64_tr_b16 a[132:133], v14 offset:36032
    v_add_f32 v20, 1.0, v20
    v_add_f32 v21, 1.0, v21
    v_mfma_f32_16x16x32_bf16 v[52:55], a[136:139], a[116:119], v[52:55]
    ds_read_b64_tr_b16 a[134:135], v14 offset:39616
    v_add_f32 v22, 1.0, v22
    v_add_f32 v23, 1.0, v23
    v_mfma_f32_16x16x32_bf16 v[56:59], a[136:139], a[120:123], v[56:59]
    v_rcp_f32 v20, v20
    v_rcp_f32 v21, v21
    v_mfma_f32_16x16x32_bf16 v[60:63], a[136:139], a[124:127], v[60:63]
    v_rcp_f32 v22, v22
    v_rcp_f32 v23, v23
    s_waitcnt lgkmcnt(4)
    v_mfma_f32_16x16x32_bf16 v[160:163], a[140:143], a[112:115], v[160:163]
    ds_read_b64_tr_b16 a[136:137], v14 offset:43200
    v_mul_f32 v40, v40, v20
    v_mul_f32 v41, v41, v21
    v_mfma_f32_16x16x32_bf16 v[164:167], a[140:143], a[116:119], v[164:167]
    ds_read_b64_tr_b16 a[138:139], v14 offset:46784
    v_mul_f32 v42, v42, v22
    v_mul_f32 v43, v43, v23
    v_mfma_f32_16x16x32_bf16 v[168:171], a[140:143], a[120:123], v[168:171]
    v_cvt_pk_bf16_f32 v40, v40, v41
    v_cvt_pk_bf16_f32 v41, v42, v43
    v_mfma_f32_16x16x32_bf16 v[172:175], a[140:143], a[124:127], v[172:175]
    v_mul_f32 v24, v44, v19
    v_mul_f32 v25, v45, v19
    s_waitcnt lgkmcnt(4)
    v_mfma_f32_16x16x32_bf16 v[128:131], a[128:131], a[32:35], v[128:131]
    ds_read_b64_tr_b16 a[140:141], v14 offset:50368
    v_mul_f32 v26, v46, v19
    v_mul_f32 v27, v47, v19
    v_mfma_f32_16x16x32_bf16 v[132:135], a[128:131], a[36:39], v[132:135]
    ds_read_b64_tr_b16 a[142:143], v14 offset:53952
    v_exp_f32 v24, v24
    v_mul_f32 v44, v44, v156
    v_mfma_f32_16x16x32_bf16 v[136:139], a[128:131], a[40:43], v[136:139]
    v_exp_f32 v25, v25
    v_mul_f32 v45, v45, v157
    v_mfma_f32_16x16x32_bf16 v[140:143], a[128:131], a[44:47], v[140:143]
    v_exp_f32 v26, v26
    v_mul_f32 v46, v46, v158
    s_waitcnt lgkmcnt(4)
    v_mfma_f32_16x16x32_bf16 v[240:243], a[132:135], a[32:35], v[240:243]
    ds_read_b64_tr_b16 a[128:129], v15 offset:192
    v_exp_f32 v27, v27
    v_mul_f32 v47, v47, v159
    v_mfma_f32_16x16x32_bf16 v[244:247], a[132:135], a[36:39], v[244:247]
    ds_read_b64_tr_b16 a[130:131], v15 offset:3776
    v_add_f32 v24, 1.0, v24
    v_add_f32 v25, 1.0, v25
    v_mfma_f32_16x16x32_bf16 v[248:251], a[132:135], a[40:43], v[248:251]
    v_add_f32 v26, 1.0, v26
    v_add_f32 v27, 1.0, v27
    v_mfma_f32_16x16x32_bf16 v[252:255], a[132:135], a[44:47], v[252:255]
    v_rcp_f32 v24, v24
    v_rcp_f32 v25, v25
    s_waitcnt lgkmcnt(4)
    v_mfma_f32_16x16x32_bf16 v[128:131], a[136:139], a[48:51], v[128:131]
    ds_read_b64_tr_b16 a[132:133], v15 offset:7360
    v_rcp_f32 v26, v26
    v_rcp_f32 v27, v27
    v_mfma_f32_16x16x32_bf16 v[132:135], a[136:139], a[52:55], v[132:135]
    ds_read_b64_tr_b16 a[134:135], v15 offset:10944
    v_mul_f32 v44, v44, v24
    v_mul_f32 v45, v45, v25
    v_mfma_f32_16x16x32_bf16 v[136:139], a[136:139], a[56:59], v[136:139]
    v_mul_f32 v46, v46, v26
    v_mul_f32 v47, v47, v27
    v_mfma_f32_16x16x32_bf16 v[140:143], a[136:139], a[60:63], v[140:143]
    v_cvt_pk_bf16_f32 v44, v44, v45
    v_cvt_pk_bf16_f32 v45, v46, v47
    s_waitcnt lgkmcnt(4)
    v_mfma_f32_16x16x32_bf16 v[240:243], a[140:143], a[48:51], v[240:243]
    ds_read_b64_tr_b16 a[136:137], v15 offset:14528
    s_add_u32 s45, s44, 0
    v_mul_f32 v20, v48, v16
    v_mfma_f32_16x16x32_bf16 v[244:247], a[140:143], a[52:55], v[244:247]
    ds_read_b64_tr_b16 a[138:139], v15 offset:18112
    v_mul_f32 v21, v49, v16
    v_mul_f32 v22, v50, v16
    v_mfma_f32_16x16x32_bf16 v[248:251], a[140:143], a[56:59], v[248:251]
    v_mul_f32 v23, v51, v16
    v_exp_f32 v20, v20
    v_mfma_f32_16x16x32_bf16 v[252:255], a[140:143], a[60:63], v[252:255]
    v_mul_f32 v48, v48, v160
    v_exp_f32 v21, v21
    s_waitcnt lgkmcnt(4)
    v_mfma_f32_16x16x32_bf16 v[128:131], a[128:131], a[64:67], v[128:131]
    ds_read_b64_tr_b16 a[140:141], v15 offset:21696
    v_mul_f32 v49, v49, v161
    v_exp_f32 v22, v22
    v_mfma_f32_16x16x32_bf16 v[132:135], a[128:131], a[68:71], v[132:135]
    ds_read_b64_tr_b16 a[142:143], v15 offset:25280
    v_mul_f32 v50, v50, v162
    v_exp_f32 v23, v23
    v_mfma_f32_16x16x32_bf16 v[136:139], a[128:131], a[72:75], v[136:139]
    v_mul_f32 v51, v51, v163
    v_add_f32 v20, 1.0, v20
    v_mfma_f32_16x16x32_bf16 v[140:143], a[128:131], a[76:79], v[140:143]
    v_add_f32 v21, 1.0, v21
    v_add_f32 v22, 1.0, v22
    s_waitcnt lgkmcnt(4)
    v_mfma_f32_16x16x32_bf16 v[240:243], a[132:135], a[64:67], v[240:243]
    ds_read_b64_tr_b16 a[128:129], v13 offset:192
    v_add_f32 v23, 1.0, v23
    v_rcp_f32 v20, v20
    v_mfma_f32_16x16x32_bf16 v[244:247], a[132:135], a[68:71], v[244:247]
    ds_read_b64_tr_b16 a[130:131], v13 offset:3776
    v_rcp_f32 v21, v21
    v_rcp_f32 v22, v22
    v_mfma_f32_16x16x32_bf16 v[248:251], a[132:135], a[72:75], v[248:251]
    v_rcp_f32 v23, v23
    v_mul_f32 v48, v48, v20
    v_mfma_f32_16x16x32_bf16 v[252:255], a[132:135], a[76:79], v[252:255]
    v_mul_f32 v49, v49, v21
    v_mul_f32 v50, v50, v22
    s_waitcnt lgkmcnt(4)
    v_mfma_f32_16x16x32_bf16 v[128:131], a[136:139], a[80:83], v[128:131]
    ds_read_b64_tr_b16 a[132:133], v13 offset:7360
    v_mul_f32 v51, v51, v23
    v_cvt_pk_bf16_f32 v34, v48, v49
    v_mfma_f32_16x16x32_bf16 v[132:135], a[136:139], a[84:87], v[132:135]
    ds_read_b64_tr_b16 a[134:135], v13 offset:10944
    v_cvt_pk_bf16_f32 v35, v50, v51
    buffer_store_dwordx4 v[32:35], v1, s[16:19], s45 offen sc1
    v_mfma_f32_16x16x32_bf16 v[136:139], a[136:139], a[88:91], v[136:139]
    v_mul_f32 v24, v52, v17
    v_mul_f32 v25, v53, v17
    v_mfma_f32_16x16x32_bf16 v[140:143], a[136:139], a[92:95], v[140:143]
    v_mul_f32 v26, v54, v17
    v_mul_f32 v27, v55, v17
    s_waitcnt lgkmcnt(4)
    v_mfma_f32_16x16x32_bf16 v[240:243], a[140:143], a[80:83], v[240:243]
    ds_read_b64_tr_b16 a[136:137], v13 offset:14528
    v_exp_f32 v24, v24
    v_mul_f32 v52, v52, v164
    v_mfma_f32_16x16x32_bf16 v[244:247], a[140:143], a[84:87], v[244:247]
    ds_read_b64_tr_b16 a[138:139], v13 offset:18112
    v_exp_f32 v25, v25
    v_mul_f32 v53, v53, v165
    v_mfma_f32_16x16x32_bf16 v[248:251], a[140:143], a[88:91], v[248:251]
    v_exp_f32 v26, v26
    v_mul_f32 v54, v54, v166
    v_mfma_f32_16x16x32_bf16 v[252:255], a[140:143], a[92:95], v[252:255]
    v_exp_f32 v27, v27
    v_mul_f32 v55, v55, v167
    s_waitcnt lgkmcnt(4)
    v_mfma_f32_16x16x32_bf16 v[128:131], a[128:131], a[96:99], v[128:131]
    ds_read_b64_tr_b16 a[140:141], v13 offset:21696
    v_add_f32 v24, 1.0, v24
    v_add_f32 v25, 1.0, v25
    v_mfma_f32_16x16x32_bf16 v[132:135], a[128:131], a[100:103], v[132:135]
    ds_read_b64_tr_b16 a[142:143], v13 offset:25280
    v_add_f32 v26, 1.0, v26
    v_add_f32 v27, 1.0, v27
    v_mfma_f32_16x16x32_bf16 v[136:139], a[128:131], a[104:107], v[136:139]
    v_rcp_f32 v24, v24
    v_rcp_f32 v25, v25
    v_mfma_f32_16x16x32_bf16 v[140:143], a[128:131], a[108:111], v[140:143]
    v_rcp_f32 v26, v26
    v_rcp_f32 v27, v27
    s_waitcnt lgkmcnt(4)
    v_mfma_f32_16x16x32_bf16 v[240:243], a[132:135], a[96:99], v[240:243]
    ds_read_b64_tr_b16 a[128:129], v14 offset:28736
    s_add_u32 s45, s45, 114688
    v_mul_f32 v52, v52, v24
    v_mfma_f32_16x16x32_bf16 v[244:247], a[132:135], a[100:103], v[244:247]
    ds_read_b64_tr_b16 a[130:131], v14 offset:32320
    v_mul_f32 v53, v53, v25
    v_mul_f32 v54, v54, v26
    v_mfma_f32_16x16x32_bf16 v[248:251], a[132:135], a[104:107], v[248:251]
    v_mul_f32 v55, v55, v27
    v_cvt_pk_bf16_f32 v38, v52, v53
    v_mfma_f32_16x16x32_bf16 v[252:255], a[132:135], a[108:111], v[252:255]
    v_cvt_pk_bf16_f32 v39, v54, v55
    buffer_store_dwordx4 v[36:39], v1, s[16:19], s45 offen sc1
    s_waitcnt lgkmcnt(4)
    v_mfma_f32_16x16x32_bf16 v[128:131], a[136:139], a[112:115], v[128:131]
    ds_read_b64_tr_b16 a[132:133], v14 offset:35904
    v_mul_f32 v20, v56, v18
    v_mul_f32 v21, v57, v18
    v_mfma_f32_16x16x32_bf16 v[132:135], a[136:139], a[116:119], v[132:135]
    ds_read_b64_tr_b16 a[134:135], v14 offset:39488
    v_mul_f32 v22, v58, v18
    v_mul_f32 v23, v59, v18
    v_mfma_f32_16x16x32_bf16 v[136:139], a[136:139], a[120:123], v[136:139]
    v_exp_f32 v20, v20
    v_mul_f32 v56, v56, v168
    v_mfma_f32_16x16x32_bf16 v[140:143], a[136:139], a[124:127], v[140:143]
    v_exp_f32 v21, v21
    v_mul_f32 v57, v57, v169
    s_waitcnt lgkmcnt(4)
    v_mfma_f32_16x16x32_bf16 v[240:243], a[140:143], a[112:115], v[240:243]
    ds_read_b64_tr_b16 a[136:137], v14 offset:43072
    v_exp_f32 v22, v22
    v_mul_f32 v58, v58, v170
    v_mfma_f32_16x16x32_bf16 v[244:247], a[140:143], a[116:119], v[244:247]
    ds_read_b64_tr_b16 a[138:139], v14 offset:46656
    v_exp_f32 v23, v23
    v_mul_f32 v59, v59, v171
    v_mfma_f32_16x16x32_bf16 v[248:251], a[140:143], a[120:123], v[248:251]
    v_add_f32 v20, 1.0, v20
    v_add_f32 v21, 1.0, v21
    v_mfma_f32_16x16x32_bf16 v[252:255], a[140:143], a[124:127], v[252:255]
    v_add_f32 v22, 1.0, v22
    v_add_f32 v23, 1.0, v23
    s_waitcnt lgkmcnt(4)
    v_mfma_f32_16x16x32_bf16 v[64:67], a[128:131], a[32:35], v[64:67]
    ds_read_b64_tr_b16 a[140:141], v14 offset:50240
    v_rcp_f32 v20, v20
    v_rcp_f32 v21, v21
    v_mfma_f32_16x16x32_bf16 v[68:71], a[128:131], a[36:39], v[68:71]
    ds_read_b64_tr_b16 a[142:143], v14 offset:53824
    v_rcp_f32 v22, v22
    v_rcp_f32 v23, v23
    v_mfma_f32_16x16x32_bf16 v[72:75], a[128:131], a[40:43], v[72:75]
    s_add_u32 s45, s45, 114688
    v_mul_f32 v56, v56, v20
    v_mfma_f32_16x16x32_bf16 v[76:79], a[128:131], a[44:47], v[76:79]
    v_mul_f32 v57, v57, v21
    v_mul_f32 v58, v58, v22
    s_waitcnt lgkmcnt(4)
    v_mfma_f32_16x16x32_bf16 v[176:179], a[132:135], a[32:35], v[176:179]
    ds_read_b64_tr_b16 a[128:129], v15 offset:64
    v_mul_f32 v59, v59, v23
    v_cvt_pk_bf16_f32 v42, v56, v57
    v_mfma_f32_16x16x32_bf16 v[180:183], a[132:135], a[36:39], v[180:183]
    ds_read_b64_tr_b16 a[130:131], v15 offset:3648
    v_cvt_pk_bf16_f32 v43, v58, v59
    buffer_store_dwordx4 v[40:43], v1, s[16:19], s45 offen sc1
    v_mfma_f32_16x16x32_bf16 v[184:187], a[132:135], a[40:43], v[184:187]
    v_mul_f32 v24, v60, v19
    v_mul_f32 v25, v61, v19
    v_mfma_f32_16x16x32_bf16 v[188:191], a[132:135], a[44:47], v[188:191]
    v_mul_f32 v26, v62, v19
    v_mul_f32 v27, v63, v19
    s_waitcnt lgkmcnt(4)
    v_mfma_f32_16x16x32_bf16 v[64:67], a[136:139], a[48:51], v[64:67]
    ds_read_b64_tr_b16 a[132:133], v15 offset:7232
    v_exp_f32 v24, v24
    v_mul_f32 v60, v60, v172
    v_mfma_f32_16x16x32_bf16 v[68:71], a[136:139], a[52:55], v[68:71]
    ds_read_b64_tr_b16 a[134:135], v15 offset:10816
    v_exp_f32 v25, v25
    v_mul_f32 v61, v61, v173
    v_mfma_f32_16x16x32_bf16 v[72:75], a[136:139], a[56:59], v[72:75]
    v_exp_f32 v26, v26
    v_mul_f32 v62, v62, v174
    v_mfma_f32_16x16x32_bf16 v[76:79], a[136:139], a[60:63], v[76:79]
    v_exp_f32 v27, v27
    v_mul_f32 v63, v63, v175
    s_waitcnt lgkmcnt(4)
    v_mfma_f32_16x16x32_bf16 v[176:179], a[140:143], a[48:51], v[176:179]
    ds_read_b64_tr_b16 a[136:137], v15 offset:14400
    v_add_f32 v24, 1.0, v24
    v_add_f32 v25, 1.0, v25
    v_mfma_f32_16x16x32_bf16 v[180:183], a[140:143], a[52:55], v[180:183]
    ds_read_b64_tr_b16 a[138:139], v15 offset:17984
    v_add_f32 v26, 1.0, v26
    v_add_f32 v27, 1.0, v27
    v_mfma_f32_16x16x32_bf16 v[184:187], a[140:143], a[56:59], v[184:187]
    v_rcp_f32 v24, v24
    v_rcp_f32 v25, v25
    v_mfma_f32_16x16x32_bf16 v[188:191], a[140:143], a[60:63], v[188:191]
    v_rcp_f32 v26, v26
    v_rcp_f32 v27, v27
    s_waitcnt lgkmcnt(4)
    v_mfma_f32_16x16x32_bf16 v[64:67], a[128:131], a[64:67], v[64:67]
    ds_read_b64_tr_b16 a[140:141], v15 offset:21568
    s_add_u32 s45, s45, 114688
    v_mul_f32 v60, v60, v24
    v_mfma_f32_16x16x32_bf16 v[68:71], a[128:131], a[68:71], v[68:71]
    ds_read_b64_tr_b16 a[142:143], v15 offset:25152
    v_mul_f32 v61, v61, v25
    v_mul_f32 v62, v62, v26
    v_mfma_f32_16x16x32_bf16 v[72:75], a[128:131], a[72:75], v[72:75]
    v_mul_f32 v63, v63, v27
    v_cvt_pk_bf16_f32 v46, v60, v61
    v_mfma_f32_16x16x32_bf16 v[76:79], a[128:131], a[76:79], v[76:79]
    v_cvt_pk_bf16_f32 v47, v62, v63
    buffer_store_dwordx4 v[44:47], v1, s[16:19], s45 offen sc1
    s_waitcnt lgkmcnt(4)
    v_mfma_f32_16x16x32_bf16 v[176:179], a[132:135], a[64:67], v[176:179]
    ds_read_b64_tr_b16 a[128:129], v13 offset:64
    s_mov_b32 s45, s46
    v_mul_f32 v20, v128, v16
    v_mfma_f32_16x16x32_bf16 v[180:183], a[132:135], a[68:71], v[180:183]
    ds_read_b64_tr_b16 a[130:131], v13 offset:3648
    v_mul_f32 v21, v129, v16
    v_mul_f32 v22, v130, v16
    v_mfma_f32_16x16x32_bf16 v[184:187], a[132:135], a[72:75], v[184:187]
    v_mul_f32 v23, v131, v16
    v_exp_f32 v20, v20
    v_mfma_f32_16x16x32_bf16 v[188:191], a[132:135], a[76:79], v[188:191]
    v_mul_f32 v128, v128, v240
    v_exp_f32 v21, v21
    s_waitcnt lgkmcnt(4)
    v_mfma_f32_16x16x32_bf16 v[64:67], a[136:139], a[80:83], v[64:67]
    ds_read_b64_tr_b16 a[132:133], v13 offset:7232
    v_mul_f32 v129, v129, v241
    v_exp_f32 v22, v22
    v_mfma_f32_16x16x32_bf16 v[68:71], a[136:139], a[84:87], v[68:71]
    ds_read_b64_tr_b16 a[134:135], v13 offset:10816
    v_mul_f32 v130, v130, v242
    v_exp_f32 v23, v23
    v_mfma_f32_16x16x32_bf16 v[72:75], a[136:139], a[88:91], v[72:75]
    v_mul_f32 v131, v131, v243
    v_add_f32 v20, 1.0, v20
    v_mfma_f32_16x16x32_bf16 v[76:79], a[136:139], a[92:95], v[76:79]
    v_add_f32 v21, 1.0, v21
    v_add_f32 v22, 1.0, v22
    s_waitcnt lgkmcnt(4)
    v_mfma_f32_16x16x32_bf16 v[176:179], a[140:143], a[80:83], v[176:179]
    ds_read_b64_tr_b16 a[136:137], v13 offset:14400
    v_add_f32 v23, 1.0, v23
    v_rcp_f32 v20, v20
    v_mfma_f32_16x16x32_bf16 v[180:183], a[140:143], a[84:87], v[180:183]
    ds_read_b64_tr_b16 a[138:139], v13 offset:17984
    v_rcp_f32 v21, v21
    v_rcp_f32 v22, v22
    v_mfma_f32_16x16x32_bf16 v[184:187], a[140:143], a[88:91], v[184:187]
    v_rcp_f32 v23, v23
    v_mul_f32 v128, v128, v20
    v_mfma_f32_16x16x32_bf16 v[188:191], a[140:143], a[92:95], v[188:191]
    v_mul_f32 v129, v129, v21
    v_mul_f32 v130, v130, v22
    s_waitcnt lgkmcnt(4)
    v_mfma_f32_16x16x32_bf16 v[64:67], a[128:131], a[96:99], v[64:67]
    ds_read_b64_tr_b16 a[140:141], v13 offset:21568
    v_mul_f32 v131, v131, v23
    v_cvt_pk_bf16_f32 v128, v128, v129
    v_mfma_f32_16x16x32_bf16 v[68:71], a[128:131], a[100:103], v[68:71]
    ds_read_b64_tr_b16 a[142:143], v13 offset:25152
    v_cvt_pk_bf16_f32 v129, v130, v131
    buffer_store_dwordx2 v[128:129], v1, s[16:19], s45 offen sc1
    v_mfma_f32_16x16x32_bf16 v[72:75], a[128:131], a[104:107], v[72:75]
    v_mul_f32 v24, v132, v17
    v_mul_f32 v25, v133, v17
    v_mfma_f32_16x16x32_bf16 v[76:79], a[128:131], a[108:111], v[76:79]
    v_mul_f32 v26, v134, v17
    v_mul_f32 v27, v135, v17
    s_waitcnt lgkmcnt(4)
    v_mfma_f32_16x16x32_bf16 v[176:179], a[132:135], a[96:99], v[176:179]
    ds_read_b64_tr_b16 a[128:129], v14 offset:28768
    v_exp_f32 v24, v24
    v_mul_f32 v132, v132, v244
    v_mfma_f32_16x16x32_bf16 v[180:183], a[132:135], a[100:103], v[180:183]
    ds_read_b64_tr_b16 a[130:131], v14 offset:32352
    v_exp_f32 v25, v25
    v_mul_f32 v133, v133, v245
    v_mfma_f32_16x16x32_bf16 v[184:187], a[132:135], a[104:107], v[184:187]
    v_exp_f32 v26, v26
    v_mul_f32 v134, v134, v246
    v_mfma_f32_16x16x32_bf16 v[188:191], a[132:135], a[108:111], v[188:191]
    v_exp_f32 v27, v27
    v_mul_f32 v135, v135, v247
    s_waitcnt lgkmcnt(4)
    v_mfma_f32_16x16x32_bf16 v[64:67], a[136:139], a[112:115], v[64:67]
    ds_read_b64_tr_b16 a[132:133], v14 offset:35936
    v_add_f32 v24, 1.0, v24
    v_add_f32 v25, 1.0, v25
    v_mfma_f32_16x16x32_bf16 v[68:71], a[136:139], a[116:119], v[68:71]
    ds_read_b64_tr_b16 a[134:135], v14 offset:39520
    v_add_f32 v26, 1.0, v26
    v_add_f32 v27, 1.0, v27
    v_mfma_f32_16x16x32_bf16 v[72:75], a[136:139], a[120:123], v[72:75]
    v_rcp_f32 v24, v24
    v_rcp_f32 v25, v25
    v_mfma_f32_16x16x32_bf16 v[76:79], a[136:139], a[124:127], v[76:79]
    v_rcp_f32 v26, v26
    v_rcp_f32 v27, v27
    s_waitcnt lgkmcnt(4)
    v_mfma_f32_16x16x32_bf16 v[176:179], a[140:143], a[112:115], v[176:179]
    ds_read_b64_tr_b16 a[136:137], v14 offset:43104
    s_add_u32 s45, s45, 114688
    v_mul_f32 v132, v132, v24
    v_mfma_f32_16x16x32_bf16 v[180:183], a[140:143], a[116:119], v[180:183]
    ds_read_b64_tr_b16 a[138:139], v14 offset:46688
    v_mul_f32 v133, v133, v25
    v_mul_f32 v134, v134, v26
    v_mfma_f32_16x16x32_bf16 v[184:187], a[140:143], a[120:123], v[184:187]
    v_mul_f32 v135, v135, v27
    v_cvt_pk_bf16_f32 v132, v132, v133
    v_mfma_f32_16x16x32_bf16 v[188:191], a[140:143], a[124:127], v[188:191]
    v_cvt_pk_bf16_f32 v133, v134, v135
    buffer_store_dwordx2 v[132:133], v1, s[16:19], s45 offen sc1
    s_waitcnt lgkmcnt(4)
    v_mfma_f32_16x16x32_bf16 v[80:83], a[128:131], a[32:35], v[80:83]
    ds_read_b64_tr_b16 a[140:141], v14 offset:50272
    v_mul_f32 v20, v136, v18
    v_mul_f32 v21, v137, v18
    v_mfma_f32_16x16x32_bf16 v[84:87], a[128:131], a[36:39], v[84:87]
    ds_read_b64_tr_b16 a[142:143], v14 offset:53856
    v_mul_f32 v22, v138, v18
    v_mul_f32 v23, v139, v18
    v_mfma_f32_16x16x32_bf16 v[88:91], a[128:131], a[40:43], v[88:91]
    v_exp_f32 v20, v20
    v_mul_f32 v136, v136, v248
    v_mfma_f32_16x16x32_bf16 v[92:95], a[128:131], a[44:47], v[92:95]
    s_add_u32 s25, s27, 0
    s_add_u32 m0, s28, 38016
    s_nop 0
    buffer_load_dwordx4 v6, s[12:15], s25 offen offset:0 lds
    v_exp_f32 v21, v21
    v_mul_f32 v137, v137, v249
    s_waitcnt lgkmcnt(4)
    v_mfma_f32_16x16x32_bf16 v[192:195], a[132:135], a[32:35], v[192:195]
    ds_read_b64_tr_b16 a[128:129], v15 offset:96
    v_exp_f32 v22, v22
    v_mul_f32 v138, v138, v250
    v_mfma_f32_16x16x32_bf16 v[196:199], a[132:135], a[36:39], v[196:199]
    ds_read_b64_tr_b16 a[130:131], v15 offset:3680
    v_exp_f32 v23, v23
    v_mul_f32 v139, v139, v251
    v_mfma_f32_16x16x32_bf16 v[200:203], a[132:135], a[40:43], v[200:203]
    v_add_f32 v20, 1.0, v20
    v_add_f32 v21, 1.0, v21
    v_mfma_f32_16x16x32_bf16 v[204:207], a[132:135], a[44:47], v[204:207]
    v_add_f32 v22, 1.0, v22
    v_add_f32 v23, 1.0, v23
    s_waitcnt lgkmcnt(4)
    v_mfma_f32_16x16x32_bf16 v[80:83], a[136:139], a[48:51], v[80:83]
    ds_read_b64_tr_b16 a[132:133], v15 offset:7264
    v_rcp_f32 v20, v20
    v_rcp_f32 v21, v21
    v_mfma_f32_16x16x32_bf16 v[84:87], a[136:139], a[52:55], v[84:87]
    ds_read_b64_tr_b16 a[134:135], v15 offset:10848
    v_rcp_f32 v22, v22
    v_rcp_f32 v23, v23
    v_mfma_f32_16x16x32_bf16 v[88:91], a[136:139], a[56:59], v[88:91]
    s_add_u32 s45, s45, 114688
    v_mul_f32 v136, v136, v20
    v_mfma_f32_16x16x32_bf16 v[92:95], a[136:139], a[60:63], v[92:95]
    buffer_load_dwordx4 v7, s[12:15], s25 offen offset:1056 lds
    v_mul_f32 v137, v137, v21
    v_mul_f32 v138, v138, v22
    s_waitcnt lgkmcnt(4)
    v_mfma_f32_16x16x32_bf16 v[192:195], a[140:143], a[48:51], v[192:195]
    ds_read_b64_tr_b16 a[136:137], v15 offset:14432
    v_mul_f32 v139, v139, v23
    v_cvt_pk_bf16_f32 v136, v136, v137
    v_mfma_f32_16x16x32_bf16 v[196:199], a[140:143], a[52:55], v[196:199]
    ds_read_b64_tr_b16 a[138:139], v15 offset:18016
    v_cvt_pk_bf16_f32 v137, v138, v139
    buffer_store_dwordx2 v[136:137], v1, s[16:19], s45 offen sc1
    v_mfma_f32_16x16x32_bf16 v[200:203], a[140:143], a[56:59], v[200:203]
    v_mul_f32 v24, v140, v19
    v_mul_f32 v25, v141, v19
    v_mfma_f32_16x16x32_bf16 v[204:207], a[140:143], a[60:63], v[204:207]
    v_mul_f32 v26, v142, v19
    v_mul_f32 v27, v143, v19
    s_waitcnt lgkmcnt(4)
    v_mfma_f32_16x16x32_bf16 v[80:83], a[128:131], a[64:67], v[80:83]
    ds_read_b64_tr_b16 a[140:141], v15 offset:21600
    v_exp_f32 v24, v24
    v_mul_f32 v140, v140, v252
    v_mfma_f32_16x16x32_bf16 v[84:87], a[128:131], a[68:71], v[84:87]
    ds_read_b64_tr_b16 a[142:143], v15 offset:25184
    v_exp_f32 v25, v25
    v_mul_f32 v141, v141, v253
    v_mfma_f32_16x16x32_bf16 v[88:91], a[128:131], a[72:75], v[88:91]
    v_exp_f32 v26, v26
    v_mul_f32 v142, v142, v254
    v_mfma_f32_16x16x32_bf16 v[92:95], a[128:131], a[76:79], v[92:95]
    s_add_u32 m0, s28, 33792
    s_nop 0
    buffer_load_dwordx4 v8, s[12:15], s25 offen offset:0 lds
    v_exp_f32 v27, v27
    v_mul_f32 v143, v143, v255
    s_waitcnt lgkmcnt(4)
    v_mfma_f32_16x16x32_bf16 v[192:195], a[132:135], a[64:67], v[192:195]
    ds_read_b64_tr_b16 a[128:129], v13 offset:96
    v_add_f32 v24, 1.0, v24
    v_add_f32 v25, 1.0, v25
    v_mfma_f32_16x16x32_bf16 v[196:199], a[132:135], a[68:71], v[196:199]
    ds_read_b64_tr_b16 a[130:131], v13 offset:3680
    v_add_f32 v26, 1.0, v26
    v_add_f32 v27, 1.0, v27
    v_mfma_f32_16x16x32_bf16 v[200:203], a[132:135], a[72:75], v[200:203]
    v_rcp_f32 v24, v24
    v_rcp_f32 v25, v25
    v_mfma_f32_16x16x32_bf16 v[204:207], a[132:135], a[76:79], v[204:207]
    v_rcp_f32 v26, v26
    v_rcp_f32 v27, v27
    s_waitcnt lgkmcnt(4)
    v_mfma_f32_16x16x32_bf16 v[80:83], a[136:139], a[80:83], v[80:83]
    ds_read_b64_tr_b16 a[132:133], v13 offset:7264
    s_add_u32 s45, s45, 114688
    v_mul_f32 v140, v140, v24
    v_mfma_f32_16x16x32_bf16 v[84:87], a[136:139], a[84:87], v[84:87]
    ds_read_b64_tr_b16 a[134:135], v13 offset:10848
    v_mul_f32 v141, v141, v25
    v_mul_f32 v142, v142, v26
    v_mfma_f32_16x16x32_bf16 v[88:91], a[136:139], a[88:91], v[88:91]
    v_mul_f32 v143, v143, v27
    v_cvt_pk_bf16_f32 v140, v140, v141
    v_mfma_f32_16x16x32_bf16 v[92:95], a[136:139], a[92:95], v[92:95]
    buffer_load_dwordx4 v9, s[12:15], s25 offen offset:1056 lds
    v_cvt_pk_bf16_f32 v141, v142, v143
    buffer_store_dwordx2 v[140:141], v1, s[16:19], s45 offen sc1
    s_waitcnt lgkmcnt(4)
    v_mfma_f32_16x16x32_bf16 v[192:195], a[140:143], a[80:83], v[192:195]
    ds_read_b64_tr_b16 a[136:137], v13 offset:14432
    s_waitcnt vmcnt(8)
    v_mov_b32 v28, 1
    v_mfma_f32_16x16x32_bf16 v[196:199], a[140:143], a[84:87], v[196:199]
    ds_read_b64_tr_b16 a[138:139], v13 offset:18016
    v_mov_b32 v30, 0
    buffer_store_dword v28, v30, s[60:63], s59 offen sc1
    v_mfma_f32_16x16x32_bf16 v[200:203], a[140:143], a[88:91], v[200:203]
    v_mul_f32 v20, v64, v16
    v_mul_f32 v21, v65, v16
    v_mfma_f32_16x16x32_bf16 v[204:207], a[140:143], a[92:95], v[204:207]
    v_mul_f32 v22, v66, v16
    v_mul_f32 v23, v67, v16
    s_waitcnt lgkmcnt(4)
    v_mfma_f32_16x16x32_bf16 v[80:83], a[128:131], a[96:99], v[80:83]
    ds_read_b64_tr_b16 a[140:141], v13 offset:21600
    v_exp_f32 v20, v20
    v_mul_f32 v64, v64, v176
    v_mfma_f32_16x16x32_bf16 v[84:87], a[128:131], a[100:103], v[84:87]
    ds_read_b64_tr_b16 a[142:143], v13 offset:25184
    v_exp_f32 v21, v21
    v_mul_f32 v65, v65, v177
    v_mfma_f32_16x16x32_bf16 v[88:91], a[128:131], a[104:107], v[88:91]
    v_exp_f32 v22, v22
    v_mul_f32 v66, v66, v178
    v_mfma_f32_16x16x32_bf16 v[92:95], a[128:131], a[108:111], v[92:95]
    s_add_u32 s25, s27, 458752
    s_add_u32 m0, s28, 54912
    s_nop 0
    buffer_load_dwordx4 v6, s[12:15], s25 offen offset:0 lds
    v_exp_f32 v23, v23
    v_mul_f32 v67, v67, v179
    s_waitcnt lgkmcnt(4)
    v_mfma_f32_16x16x32_bf16 v[192:195], a[132:135], a[96:99], v[192:195]
    ds_read_b64_tr_b16 a[128:129], v14 offset:28800
    v_add_f32 v20, 1.0, v20
    v_add_f32 v21, 1.0, v21
    v_mfma_f32_16x16x32_bf16 v[196:199], a[132:135], a[100:103], v[196:199]
    ds_read_b64_tr_b16 a[130:131], v14 offset:32384
    v_add_f32 v22, 1.0, v22
    v_add_f32 v23, 1.0, v23
    v_mfma_f32_16x16x32_bf16 v[200:203], a[132:135], a[104:107], v[200:203]
    v_rcp_f32 v20, v20
    v_rcp_f32 v21, v21
    v_mfma_f32_16x16x32_bf16 v[204:207], a[132:135], a[108:111], v[204:207]
    v_rcp_f32 v22, v22
    v_rcp_f32 v23, v23
    s_waitcnt lgkmcnt(4)
    v_mfma_f32_16x16x32_bf16 v[80:83], a[136:139], a[112:115], v[80:83]
    ds_read_b64_tr_b16 a[132:133], v14 offset:35968
    v_mul_f32 v64, v64, v20
    v_mul_f32 v65, v65, v21
    v_mfma_f32_16x16x32_bf16 v[84:87], a[136:139], a[116:119], v[84:87]
    ds_read_b64_tr_b16 a[134:135], v14 offset:39552
    v_mul_f32 v66, v66, v22
    v_mul_f32 v67, v67, v23
    v_mfma_f32_16x16x32_bf16 v[88:91], a[136:139], a[120:123], v[88:91]
    v_cvt_pk_bf16_f32 v64, v64, v65
    v_cvt_pk_bf16_f32 v65, v66, v67
    v_mfma_f32_16x16x32_bf16 v[92:95], a[136:139], a[124:127], v[92:95]
    buffer_load_dwordx4 v7, s[12:15], s25 offen offset:1056 lds
    v_mul_f32 v24, v68, v17
    v_mul_f32 v25, v69, v17
    s_waitcnt lgkmcnt(4)
    v_mfma_f32_16x16x32_bf16 v[192:195], a[140:143], a[112:115], v[192:195]
    ds_read_b64_tr_b16 a[136:137], v14 offset:43136
    v_mul_f32 v26, v70, v17
    v_mul_f32 v27, v71, v17
    v_mfma_f32_16x16x32_bf16 v[196:199], a[140:143], a[116:119], v[196:199]
    ds_read_b64_tr_b16 a[138:139], v14 offset:46720
    v_exp_f32 v24, v24
    v_mul_f32 v68, v68, v180
    v_mfma_f32_16x16x32_bf16 v[200:203], a[140:143], a[120:123], v[200:203]
    v_exp_f32 v25, v25
    v_mul_f32 v69, v69, v181
    v_mfma_f32_16x16x32_bf16 v[204:207], a[140:143], a[124:127], v[204:207]
    v_exp_f32 v26, v26
    v_mul_f32 v70, v70, v182
    s_waitcnt lgkmcnt(4)
    v_mfma_f32_16x16x32_bf16 v[96:99], a[128:131], a[32:35], v[96:99]
    ds_read_b64_tr_b16 a[140:141], v14 offset:50304
    v_exp_f32 v27, v27
    v_mul_f32 v71, v71, v183
    v_mfma_f32_16x16x32_bf16 v[100:103], a[128:131], a[36:39], v[100:103]
    ds_read_b64_tr_b16 a[142:143], v14 offset:53888
    v_add_f32 v24, 1.0, v24
    v_add_f32 v25, 1.0, v25
    v_mfma_f32_16x16x32_bf16 v[104:107], a[128:131], a[40:43], v[104:107]
    v_add_f32 v26, 1.0, v26
    v_add_f32 v27, 1.0, v27
    v_mfma_f32_16x16x32_bf16 v[108:111], a[128:131], a[44:47], v[108:111]
    s_add_u32 m0, s28, 50688
    s_nop 0
    buffer_load_dwordx4 v8, s[12:15], s25 offen offset:0 lds
    v_rcp_f32 v24, v24
    v_rcp_f32 v25, v25
    s_waitcnt lgkmcnt(4)
    v_mfma_f32_16x16x32_bf16 v[208:211], a[132:135], a[32:35], v[208:211]
    ds_read_b64_tr_b16 a[128:129], v15 offset:128
    v_rcp_f32 v26, v26
    v_rcp_f32 v27, v27
    v_mfma_f32_16x16x32_bf16 v[212:215], a[132:135], a[36:39], v[212:215]
    ds_read_b64_tr_b16 a[130:131], v15 offset:3712
    v_mul_f32 v68, v68, v24
    v_mul_f32 v69, v69, v25
    v_mfma_f32_16x16x32_bf16 v[216:219], a[132:135], a[40:43], v[216:219]
    v_mul_f32 v70, v70, v26
    v_mul_f32 v71, v71, v27
    v_mfma_f32_16x16x32_bf16 v[220:223], a[132:135], a[44:47], v[220:223]
    v_cvt_pk_bf16_f32 v68, v68, v69
    v_cvt_pk_bf16_f32 v69, v70, v71
    s_waitcnt lgkmcnt(4)
    v_mfma_f32_16x16x32_bf16 v[96:99], a[136:139], a[48:51], v[96:99]
    ds_read_b64_tr_b16 a[132:133], v15 offset:7296
    v_mul_f32 v20, v72, v18
    v_mul_f32 v21, v73, v18
    v_mfma_f32_16x16x32_bf16 v[100:103], a[136:139], a[52:55], v[100:103]
    ds_read_b64_tr_b16 a[134:135], v15 offset:10880
    v_mul_f32 v22, v74, v18
    v_mul_f32 v23, v75, v18
    v_mfma_f32_16x16x32_bf16 v[104:107], a[136:139], a[56:59], v[104:107]
    v_exp_f32 v20, v20
    v_mul_f32 v72, v72, v184
    v_mfma_f32_16x16x32_bf16 v[108:111], a[136:139], a[60:63], v[108:111]
    buffer_load_dwordx4 v9, s[12:15], s25 offen offset:1056 lds
    v_exp_f32 v21, v21
    v_mul_f32 v73, v73, v185
    s_waitcnt lgkmcnt(4)
    v_mfma_f32_16x16x32_bf16 v[208:211], a[140:143], a[48:51], v[208:211]
    ds_read_b64_tr_b16 a[136:137], v15 offset:14464
    v_exp_f32 v22, v22
    v_mul_f32 v74, v74, v186
    v_mfma_f32_16x16x32_bf16 v[212:215], a[140:143], a[52:55], v[212:215]
    ds_read_b64_tr_b16 a[138:139], v15 offset:18048
    v_exp_f32 v23, v23
    v_mul_f32 v75, v75, v187
    v_mfma_f32_16x16x32_bf16 v[216:219], a[140:143], a[56:59], v[216:219]
    v_add_f32 v20, 1.0, v20
    v_add_f32 v21, 1.0, v21
    v_mfma_f32_16x16x32_bf16 v[220:223], a[140:143], a[60:63], v[220:223]
    v_add_f32 v22, 1.0, v22
    v_add_f32 v23, 1.0, v23
    s_waitcnt lgkmcnt(4)
    v_mfma_f32_16x16x32_bf16 v[96:99], a[128:131], a[64:67], v[96:99]
    ds_read_b64_tr_b16 a[140:141], v15 offset:21632
    v_rcp_f32 v20, v20
    v_rcp_f32 v21, v21
    v_mfma_f32_16x16x32_bf16 v[100:103], a[128:131], a[68:71], v[100:103]
    ds_read_b64_tr_b16 a[142:143], v15 offset:25216
    v_rcp_f32 v22, v22
    v_rcp_f32 v23, v23
    v_mfma_f32_16x16x32_bf16 v[104:107], a[128:131], a[72:75], v[104:107]
    v_mul_f32 v72, v72, v20
    v_mul_f32 v73, v73, v21
    v_mfma_f32_16x16x32_bf16 v[108:111], a[128:131], a[76:79], v[108:111]
    s_add_u32 s25, s27, 917504
    s_add_u32 m0, s28, 71808
    s_nop 0
    buffer_load_dwordx4 v6, s[12:15], s25 offen offset:0 lds
    v_mul_f32 v74, v74, v22
    v_mul_f32 v75, v75, v23
    s_waitcnt lgkmcnt(4)
    v_mfma_f32_16x16x32_bf16 v[208:211], a[132:135], a[64:67], v[208:211]
    ds_read_b64_tr_b16 a[128:129], v13 offset:128
    v_cvt_pk_bf16_f32 v72, v72, v73
    v_cvt_pk_bf16_f32 v73, v74, v75
    v_mfma_f32_16x16x32_bf16 v[212:215], a[132:135], a[68:71], v[212:215]
    ds_read_b64_tr_b16 a[130:131], v13 offset:3712
    v_mul_f32 v24, v76, v19
    v_mul_f32 v25, v77, v19
    v_mfma_f32_16x16x32_bf16 v[216:219], a[132:135], a[72:75], v[216:219]
    v_mul_f32 v26, v78, v19
    v_mul_f32 v27, v79, v19
    v_mfma_f32_16x16x32_bf16 v[220:223], a[132:135], a[76:79], v[220:223]
    v_exp_f32 v24, v24
    v_mul_f32 v76, v76, v188
    s_waitcnt lgkmcnt(4)
    v_mfma_f32_16x16x32_bf16 v[96:99], a[136:139], a[80:83], v[96:99]
    ds_read_b64_tr_b16 a[132:133], v13 offset:7296
    v_exp_f32 v25, v25
    v_mul_f32 v77, v77, v189
    v_mfma_f32_16x16x32_bf16 v[100:103], a[136:139], a[84:87], v[100:103]
    ds_read_b64_tr_b16 a[134:135], v13 offset:10880
    v_exp_f32 v26, v26
    v_mul_f32 v78, v78, v190
    v_mfma_f32_16x16x32_bf16 v[104:107], a[136:139], a[88:91], v[104:107]
    v_exp_f32 v27, v27
    v_mul_f32 v79, v79, v191
    v_mfma_f32_16x16x32_bf16 v[108:111], a[136:139], a[92:95], v[108:111]
    buffer_load_dwordx4 v7, s[12:15], s25 offen offset:1056 lds
    v_add_f32 v24, 1.0, v24
    v_add_f32 v25, 1.0, v25
    s_waitcnt lgkmcnt(4)
    v_mfma_f32_16x16x32_bf16 v[208:211], a[140:143], a[80:83], v[208:211]
    ds_read_b64_tr_b16 a[136:137], v13 offset:14464
    v_add_f32 v26, 1.0, v26
    v_add_f32 v27, 1.0, v27
    v_mfma_f32_16x16x32_bf16 v[212:215], a[140:143], a[84:87], v[212:215]
    ds_read_b64_tr_b16 a[138:139], v13 offset:18048
    v_rcp_f32 v24, v24
    v_rcp_f32 v25, v25
    v_mfma_f32_16x16x32_bf16 v[216:219], a[140:143], a[88:91], v[216:219]
    v_rcp_f32 v26, v26
    v_rcp_f32 v27, v27
    v_mfma_f32_16x16x32_bf16 v[220:223], a[140:143], a[92:95], v[220:223]
    v_mul_f32 v76, v76, v24
    v_mul_f32 v77, v77, v25
    s_waitcnt lgkmcnt(4)
    v_mfma_f32_16x16x32_bf16 v[96:99], a[128:131], a[96:99], v[96:99]
    ds_read_b64_tr_b16 a[140:141], v13 offset:21632
    v_mul_f32 v78, v78, v26
    v_mul_f32 v79, v79, v27
    v_mfma_f32_16x16x32_bf16 v[100:103], a[128:131], a[100:103], v[100:103]
    ds_read_b64_tr_b16 a[142:143], v13 offset:25216
    v_cvt_pk_bf16_f32 v76, v76, v77
    v_cvt_pk_bf16_f32 v77, v78, v79
    v_mfma_f32_16x16x32_bf16 v[104:107], a[128:131], a[104:107], v[104:107]
    s_add_u32 s45, s44, 16384
    v_mul_f32 v20, v80, v16
    v_mfma_f32_16x16x32_bf16 v[108:111], a[128:131], a[108:111], v[108:111]
    s_add_u32 m0, s28, 67584
    s_nop 0
    buffer_load_dwordx4 v8, s[12:15], s25 offen offset:0 lds
    v_mul_f32 v21, v81, v16
    v_mul_f32 v22, v82, v16
    s_waitcnt lgkmcnt(4)
    v_mfma_f32_16x16x32_bf16 v[208:211], a[132:135], a[96:99], v[208:211]
    ds_read_b64_tr_b16 a[128:129], v14 offset:28832
    v_mul_f32 v23, v83, v16
    v_exp_f32 v20, v20
    v_mfma_f32_16x16x32_bf16 v[212:215], a[132:135], a[100:103], v[212:215]
    ds_read_b64_tr_b16 a[130:131], v14 offset:32416
    v_mul_f32 v80, v80, v192
    v_exp_f32 v21, v21
    v_mfma_f32_16x16x32_bf16 v[216:219], a[132:135], a[104:107], v[216:219]
    v_mul_f32 v81, v81, v193
    v_exp_f32 v22, v22
    v_mfma_f32_16x16x32_bf16 v[220:223], a[132:135], a[108:111], v[220:223]
    v_mul_f32 v82, v82, v194
    v_exp_f32 v23, v23
    s_waitcnt lgkmcnt(4)
    v_mfma_f32_16x16x32_bf16 v[96:99], a[136:139], a[112:115], v[96:99]
    ds_read_b64_tr_b16 a[132:133], v14 offset:36000
    v_mul_f32 v83, v83, v195
    v_add_f32 v20, 1.0, v20
    v_mfma_f32_16x16x32_bf16 v[100:103], a[136:139], a[116:119], v[100:103]
    ds_read_b64_tr_b16 a[134:135], v14 offset:39584
    v_add_f32 v21, 1.0, v21
    v_add_f32 v22, 1.0, v22
    v_mfma_f32_16x16x32_bf16 v[104:107], a[136:139], a[120:123], v[104:107]
    v_add_f32 v23, 1.0, v23
    v_rcp_f32 v20, v20
    v_mfma_f32_16x16x32_bf16 v[108:111], a[136:139], a[124:127], v[108:111]
    buffer_load_dwordx4 v9, s[12:15], s25 offen offset:1056 lds
    v_rcp_f32 v21, v21
    v_rcp_f32 v22, v22
    s_waitcnt lgkmcnt(4)
    v_mfma_f32_16x16x32_bf16 v[208:211], a[140:143], a[112:115], v[208:211]
    ds_read_b64_tr_b16 a[136:137], v14 offset:43168
    v_rcp_f32 v23, v23
    v_mul_f32 v80, v80, v20
    v_mfma_f32_16x16x32_bf16 v[212:215], a[140:143], a[116:119], v[212:215]
    ds_read_b64_tr_b16 a[138:139], v14 offset:46752
    v_mul_f32 v81, v81, v21
    v_mul_f32 v82, v82, v22
    v_mfma_f32_16x16x32_bf16 v[216:219], a[140:143], a[120:123], v[216:219]
    v_mul_f32 v83, v83, v23
    v_cvt_pk_bf16_f32 v66, v80, v81
    v_mfma_f32_16x16x32_bf16 v[220:223], a[140:143], a[124:127], v[220:223]
    v_cvt_pk_bf16_f32 v67, v82, v83
    buffer_store_dwordx4 v[64:67], v1, s[16:19], s45 offen sc1
    s_waitcnt lgkmcnt(4)
    v_mfma_f32_16x16x32_bf16 v[112:115], a[128:131], a[32:35], v[112:115]
    ds_read_b64_tr_b16 a[140:141], v14 offset:50336
    v_mul_f32 v24, v84, v17
    v_mul_f32 v25, v85, v17
    v_mfma_f32_16x16x32_bf16 v[116:119], a[128:131], a[36:39], v[116:119]
    ds_read_b64_tr_b16 a[142:143], v14 offset:53920
    v_mul_f32 v26, v86, v17
    v_mul_f32 v27, v87, v17
    v_mfma_f32_16x16x32_bf16 v[120:123], a[128:131], a[40:43], v[120:123]
    v_exp_f32 v24, v24
    v_mul_f32 v84, v84, v196
    v_mfma_f32_16x16x32_bf16 v[124:127], a[128:131], a[44:47], v[124:127]
    v_exp_f32 v25, v25
    v_mul_f32 v85, v85, v197
    s_waitcnt lgkmcnt(4)
    v_mfma_f32_16x16x32_bf16 v[224:227], a[132:135], a[32:35], v[224:227]
    ds_read_b64_tr_b16 a[128:129], v15 offset:160
    v_exp_f32 v26, v26
    v_mul_f32 v86, v86, v198
    v_mfma_f32_16x16x32_bf16 v[228:231], a[132:135], a[36:39], v[228:231]
    ds_read_b64_tr_b16 a[130:131], v15 offset:3744
    v_exp_f32 v27, v27
    v_mul_f32 v87, v87, v199
    v_mfma_f32_16x16x32_bf16 v[232:235], a[132:135], a[40:43], v[232:235]
    v_add_f32 v24, 1.0, v24
    v_add_f32 v25, 1.0, v25
    v_mfma_f32_16x16x32_bf16 v[236:239], a[132:135], a[44:47], v[236:239]
    v_add_f32 v26, 1.0, v26
    v_add_f32 v27, 1.0, v27
    s_waitcnt lgkmcnt(4)
    v_mfma_f32_16x16x32_bf16 v[112:115], a[136:139], a[48:51], v[112:115]
    ds_read_b64_tr_b16 a[132:133], v15 offset:7328
    v_rcp_f32 v24, v24
    v_rcp_f32 v25, v25
    v_mfma_f32_16x16x32_bf16 v[116:119], a[136:139], a[52:55], v[116:119]
    ds_read_b64_tr_b16 a[134:135], v15 offset:10912
    v_rcp_f32 v26, v26
    v_rcp_f32 v27, v27
    v_mfma_f32_16x16x32_bf16 v[120:123], a[136:139], a[56:59], v[120:123]
    s_add_u32 s45, s45, 114688
    v_mul_f32 v84, v84, v24
    v_mfma_f32_16x16x32_bf16 v[124:127], a[136:139], a[60:63], v[124:127]
    v_mul_f32 v85, v85, v25
    v_mul_f32 v86, v86, v26
    s_waitcnt lgkmcnt(4)
    v_mfma_f32_16x16x32_bf16 v[224:227], a[140:143], a[48:51], v[224:227]
    ds_read_b64_tr_b16 a[136:137], v15 offset:14496
    v_mul_f32 v87, v87, v27
    v_cvt_pk_bf16_f32 v70, v84, v85
    v_mfma_f32_16x16x32_bf16 v[228:231], a[140:143], a[52:55], v[228:231]
    ds_read_b64_tr_b16 a[138:139], v15 offset:18080
    v_cvt_pk_bf16_f32 v71, v86, v87
    buffer_store_dwordx4 v[68:71], v1, s[16:19], s45 offen sc1
    v_mfma_f32_16x16x32_bf16 v[232:235], a[140:143], a[56:59], v[232:235]
    v_mul_f32 v20, v88, v18
    v_mul_f32 v21, v89, v18
    v_mfma_f32_16x16x32_bf16 v[236:239], a[140:143], a[60:63], v[236:239]
    v_mul_f32 v22, v90, v18
    v_mul_f32 v23, v91, v18
    s_waitcnt lgkmcnt(4)
    v_mfma_f32_16x16x32_bf16 v[112:115], a[128:131], a[64:67], v[112:115]
    ds_read_b64_tr_b16 a[140:141], v15 offset:21664
    v_exp_f32 v20, v20
    v_mul_f32 v88, v88, v200
    v_mfma_f32_16x16x32_bf16 v[116:119], a[128:131], a[68:71], v[116:119]
    ds_read_b64_tr_b16 a[142:143], v15 offset:25248
    v_exp_f32 v21, v21
    v_mul_f32 v89, v89, v201
    v_mfma_f32_16x16x32_bf16 v[120:123], a[128:131], a[72:75], v[120:123]
    v_exp_f32 v22, v22
    v_mul_f32 v90, v90, v202
    v_mfma_f32_16x16x32_bf16 v[124:127], a[128:131], a[76:79], v[124:127]
    buffer_load_dword v12, v10, s[4:7], 0 offen sc1
    v_exp_f32 v23, v23
    v_mul_f32 v91, v91, v203
    s_waitcnt lgkmcnt(4)
    v_mfma_f32_16x16x32_bf16 v[224:227], a[132:135], a[64:67], v[224:227]
    ds_read_b64_tr_b16 a[128:129], v13 offset:160
    v_add_f32 v20, 1.0, v20
    v_add_f32 v21, 1.0, v21
    v_mfma_f32_16x16x32_bf16 v[228:231], a[132:135], a[68:71], v[228:231]
    ds_read_b64_tr_b16 a[130:131], v13 offset:3744
    v_add_f32 v22, 1.0, v22
    v_add_f32 v23, 1.0, v23
    v_mfma_f32_16x16x32_bf16 v[232:235], a[132:135], a[72:75], v[232:235]
    v_rcp_f32 v20, v20
    v_rcp_f32 v21, v21
    v_mfma_f32_16x16x32_bf16 v[236:239], a[132:135], a[76:79], v[236:239]
    v_rcp_f32 v22, v22
    v_rcp_f32 v23, v23
    s_waitcnt lgkmcnt(4)
    v_mfma_f32_16x16x32_bf16 v[112:115], a[136:139], a[80:83], v[112:115]
    ds_read_b64_tr_b16 a[132:133], v13 offset:7328
    s_add_u32 s45, s45, 114688
    v_mul_f32 v88, v88, v20
    v_mfma_f32_16x16x32_bf16 v[116:119], a[136:139], a[84:87], v[116:119]
    ds_read_b64_tr_b16 a[134:135], v13 offset:10912
    v_mul_f32 v89, v89, v21
    v_mul_f32 v90, v90, v22
    v_mfma_f32_16x16x32_bf16 v[120:123], a[136:139], a[88:91], v[120:123]
    v_mul_f32 v91, v91, v23
    v_cvt_pk_bf16_f32 v74, v88, v89
    v_mfma_f32_16x16x32_bf16 v[124:127], a[136:139], a[92:95], v[124:127]
    v_cvt_pk_bf16_f32 v75, v90, v91
    buffer_store_dwordx4 v[72:75], v1, s[16:19], s45 offen sc1
    s_waitcnt lgkmcnt(4)
    v_mfma_f32_16x16x32_bf16 v[224:227], a[140:143], a[80:83], v[224:227]
    ds_read_b64_tr_b16 a[136:137], v13 offset:14496
    v_mul_f32 v24, v92, v19
    v_mul_f32 v25, v93, v19
    v_mfma_f32_16x16x32_bf16 v[228:231], a[140:143], a[84:87], v[228:231]
    ds_read_b64_tr_b16 a[138:139], v13 offset:18080
    v_mul_f32 v26, v94, v19
    v_mul_f32 v27, v95, v19
    v_mfma_f32_16x16x32_bf16 v[232:235], a[140:143], a[88:91], v[232:235]
    v_exp_f32 v24, v24
    v_mul_f32 v92, v92, v204
    v_mfma_f32_16x16x32_bf16 v[236:239], a[140:143], a[92:95], v[236:239]
    v_exp_f32 v25, v25
    v_mul_f32 v93, v93, v205
    s_waitcnt lgkmcnt(4)
    v_mfma_f32_16x16x32_bf16 v[112:115], a[128:131], a[96:99], v[112:115]
    ds_read_b64_tr_b16 a[140:141], v13 offset:21664
    v_exp_f32 v26, v26
    v_mul_f32 v94, v94, v206
    v_mfma_f32_16x16x32_bf16 v[116:119], a[128:131], a[100:103], v[116:119]
    ds_read_b64_tr_b16 a[142:143], v13 offset:25248
    v_exp_f32 v27, v27
    v_mul_f32 v95, v95, v207
    v_mfma_f32_16x16x32_bf16 v[120:123], a[128:131], a[104:107], v[120:123]
    v_add_f32 v24, 1.0, v24
    v_add_f32 v25, 1.0, v25
    v_mfma_f32_16x16x32_bf16 v[124:127], a[128:131], a[108:111], v[124:127]
    v_add_f32 v26, 1.0, v26
    v_add_f32 v27, 1.0, v27
    s_waitcnt lgkmcnt(4)
    v_mfma_f32_16x16x32_bf16 v[224:227], a[132:135], a[96:99], v[224:227]
    v_rcp_f32 v24, v24
    v_rcp_f32 v25, v25
    v_mfma_f32_16x16x32_bf16 v[228:231], a[132:135], a[100:103], v[228:231]
    v_rcp_f32 v26, v26
    v_rcp_f32 v27, v27
    v_mfma_f32_16x16x32_bf16 v[232:235], a[132:135], a[104:107], v[232:235]
    s_add_u32 s45, s45, 114688
    v_mul_f32 v92, v92, v24
    v_mfma_f32_16x16x32_bf16 v[236:239], a[132:135], a[108:111], v[236:239]
    v_mul_f32 v93, v93, v25
    v_mul_f32 v94, v94, v26
    s_waitcnt lgkmcnt(2)
    v_mfma_f32_16x16x32_bf16 v[112:115], a[136:139], a[112:115], v[112:115]
    v_mul_f32 v95, v95, v27
    v_cvt_pk_bf16_f32 v78, v92, v93
    v_mfma_f32_16x16x32_bf16 v[116:119], a[136:139], a[116:119], v[116:119]
    v_cvt_pk_bf16_f32 v79, v94, v95
    buffer_store_dwordx4 v[76:79], v1, s[16:19], s45 offen sc1
    v_mfma_f32_16x16x32_bf16 v[120:123], a[136:139], a[120:123], v[120:123]
    v_mul_f32 v20, v96, v16
    v_mul_f32 v21, v97, v16
    v_mfma_f32_16x16x32_bf16 v[124:127], a[136:139], a[124:127], v[124:127]
    v_mul_f32 v22, v98, v16
    v_mul_f32 v23, v99, v16
    s_waitcnt lgkmcnt(0)
    v_mfma_f32_16x16x32_bf16 v[224:227], a[140:143], a[112:115], v[224:227]
    v_exp_f32 v20, v20
    v_mul_f32 v96, v96, v208
    v_mfma_f32_16x16x32_bf16 v[228:231], a[140:143], a[116:119], v[228:231]
    v_exp_f32 v21, v21
    v_mul_f32 v97, v97, v209
    v_mfma_f32_16x16x32_bf16 v[232:235], a[140:143], a[120:123], v[232:235]
    v_exp_f32 v22, v22
    v_mul_f32 v98, v98, v210
    v_mfma_f32_16x16x32_bf16 v[236:239], a[140:143], a[124:127], v[236:239]
    v_exp_f32 v23, v23
    v_mul_f32 v99, v99, v211
    s_barrier
    s_nop 7
    s_mov_b32 s26, 0
    s_waitcnt vmcnt(2)
    v_cmp_gt_u32 vcc, 1, v12
    s_nop 1
    s_cbranch_vccnz g34_slow0
g34_cont0:
    s_nop 0
    buffer_load_dwordx4 a[0:3], v2, s[8:11], s26 offen offset:0 sc1
    buffer_load_dwordx4 a[4:7], v3, s[8:11], s26 offen offset:0 sc1
    buffer_load_dwordx4 a[8:11], v2, s[8:11], s26 offen offset:1024 sc1
    buffer_load_dwordx4 a[12:15], v3, s[8:11], s26 offen offset:1024 sc1
    buffer_load_dwordx4 a[16:19], v2, s[8:11], s26 offen offset:2048 sc1
    buffer_load_dwordx4 a[20:23], v3, s[8:11], s26 offen offset:2048 sc1
    buffer_load_dwordx4 a[24:27], v2, s[8:11], s26 offen offset:3072 sc1
    buffer_load_dwordx4 a[28:31], v3, s[8:11], s26 offen offset:3072 sc1
    s_add_u32 s26, s26, 4096
    buffer_load_dwordx4 a[32:35], v2, s[8:11], s26 offen offset:0 sc1
    buffer_load_dwordx4 a[36:39], v3, s[8:11], s26 offen offset:0 sc1
    v_add_f32 v20, 1.0, v20
    v_add_f32 v21, 1.0, v21
    v_add_f32 v22, 1.0, v22
    v_add_f32 v23, 1.0, v23
    v_rcp_f32 v20, v20
    v_rcp_f32 v21, v21
    v_rcp_f32 v22, v22
    v_rcp_f32 v23, v23
    v_mul_f32 v96, v96, v20
    v_mul_f32 v97, v97, v21
    v_mul_f32 v98, v98, v22
    v_mul_f32 v99, v99, v23
    v_cvt_pk_bf16_f32 v96, v96, v97
    v_cvt_pk_bf16_f32 v97, v98, v99
    v_mul_f32 v24, v100, v17
    v_mul_f32 v25, v101, v17
    v_mul_f32 v26, v102, v17
    v_mul_f32 v27, v103, v17
    v_exp_f32 v24, v24
    v_mul_f32 v100, v100, v212
    v_exp_f32 v25, v25
    v_mul_f32 v101, v101, v213
    v_exp_f32 v26, v26
    v_mul_f32 v102, v102, v214
    v_exp_f32 v27, v27
    v_mul_f32 v103, v103, v215
    v_add_f32 v24, 1.0, v24
    v_add_f32 v25, 1.0, v25
    v_add_f32 v26, 1.0, v26
    v_add_f32 v27, 1.0, v27
    v_rcp_f32 v24, v24
    v_rcp_f32 v25, v25
    v_rcp_f32 v26, v26
    v_rcp_f32 v27, v27
    v_mul_f32 v100, v100, v24
    v_mul_f32 v101, v101, v25
    v_mul_f32 v102, v102, v26
    v_mul_f32 v103, v103, v27
    v_cvt_pk_bf16_f32 v100, v100, v101
    v_cvt_pk_bf16_f32 v101, v102, v103
    v_mul_f32 v20, v104, v18
    v_mul_f32 v21, v105, v18
    v_mul_f32 v22, v106, v18
    v_mul_f32 v23, v107, v18
    v_exp_f32 v20, v20
    v_mul_f32 v104, v104, v216
    v_exp_f32 v21, v21
    v_mul_f32 v105, v105, v217
    v_exp_f32 v22, v22
    v_mul_f32 v106, v106, v218
    v_exp_f32 v23, v23
    v_mul_f32 v107, v107, v219
    v_add_f32 v20, 1.0, v20
    v_add_f32 v21, 1.0, v21
    v_add_f32 v22, 1.0, v22
    v_add_f32 v23, 1.0, v23
    v_rcp_f32 v20, v20
    v_rcp_f32 v21, v21
    v_rcp_f32 v22, v22
    v_rcp_f32 v23, v23
    v_mul_f32 v104, v104, v20
    v_mul_f32 v105, v105, v21
    v_mul_f32 v106, v106, v22
    v_mul_f32 v107, v107, v23
    v_cvt_pk_bf16_f32 v104, v104, v105
    v_cvt_pk_bf16_f32 v105, v106, v107
    v_mul_f32 v24, v108, v19
    v_mul_f32 v25, v109, v19
    v_mul_f32 v26, v110, v19
    v_mul_f32 v27, v111, v19
    v_exp_f32 v24, v24
    v_mul_f32 v108, v108, v220
    v_exp_f32 v25, v25
    v_mul_f32 v109, v109, v221
    v_exp_f32 v26, v26
    v_mul_f32 v110, v110, v222
    v_exp_f32 v27, v27
    v_mul_f32 v111, v111, v223
    v_add_f32 v24, 1.0, v24
    v_add_f32 v25, 1.0, v25
    v_add_f32 v26, 1.0, v26
    v_add_f32 v27, 1.0, v27
    v_rcp_f32 v24, v24
    v_rcp_f32 v25, v25
    v_rcp_f32 v26, v26
    v_rcp_f32 v27, v27
    v_mul_f32 v108, v108, v24
    v_mul_f32 v109, v109, v25
    v_mul_f32 v110, v110, v26
    v_mul_f32 v111, v111, v27
    v_cvt_pk_bf16_f32 v108, v108, v109
    v_cvt_pk_bf16_f32 v109, v110, v111
    s_add_u32 s45, s44, 32768
    v_mul_f32 v20, v112, v16
    v_mul_f32 v21, v113, v16
    v_mul_f32 v22, v114, v16
    v_mul_f32 v23, v115, v16
    v_exp_f32 v20, v20
    v_mul_f32 v112, v112, v224
    v_exp_f32 v21, v21
    v_mul_f32 v113, v113, v225
    v_exp_f32 v22, v22
    v_mul_f32 v114, v114, v226
    v_exp_f32 v23, v23
    v_mul_f32 v115, v115, v227
    v_add_f32 v20, 1.0, v20
    v_add_f32 v21, 1.0, v21
    v_add_f32 v22, 1.0, v22
    v_add_f32 v23, 1.0, v23
    v_rcp_f32 v20, v20
    v_rcp_f32 v21, v21
    v_rcp_f32 v22, v22
    v_rcp_f32 v23, v23
    v_mul_f32 v112, v112, v20
    v_mul_f32 v113, v113, v21
    v_mul_f32 v114, v114, v22
    v_mul_f32 v115, v115, v23
    v_cvt_pk_bf16_f32 v98, v112, v113
    v_cvt_pk_bf16_f32 v99, v114, v115
    buffer_store_dwordx4 v[96:99], v1, s[16:19], s45 offen sc1
    v_mul_f32 v24, v116, v17
    v_mul_f32 v25, v117, v17
    v_mul_f32 v26, v118, v17
    v_mul_f32 v27, v119, v17
    v_exp_f32 v24, v24
    v_mul_f32 v116, v116, v228
    v_exp_f32 v25, v25
    v_mul_f32 v117, v117, v229
    v_exp_f32 v26, v26
    v_mul_f32 v118, v118, v230
    v_exp_f32 v27, v27
    v_mul_f32 v119, v119, v231
    v_add_f32 v24, 1.0, v24
    v_add_f32 v25, 1.0, v25
    v_add_f32 v26, 1.0, v26
    v_add_f32 v27, 1.0, v27
    v_rcp_f32 v24, v24
    v_rcp_f32 v25, v25
    v_rcp_f32 v26, v26
    v_rcp_f32 v27, v27
    s_add_u32 s45, s45, 114688
    v_mul_f32 v116, v116, v24
    v_mul_f32 v117, v117, v25
    v_mul_f32 v118, v118, v26
    v_mul_f32 v119, v119, v27
    v_cvt_pk_bf16_f32 v102, v116, v117
    v_cvt_pk_bf16_f32 v103, v118, v119
    buffer_store_dwordx4 v[100:103], v1, s[16:19], s45 offen sc1
    v_mul_f32 v20, v120, v18
    v_mul_f32 v21, v121, v18
    v_mul_f32 v22, v122, v18
    v_mul_f32 v23, v123, v18
    v_exp_f32 v20, v20
    v_mul_f32 v120, v120, v232
    v_exp_f32 v21, v21
    v_mul_f32 v121, v121, v233
    v_exp_f32 v22, v22
    v_mul_f32 v122, v122, v234
    v_exp_f32 v23, v23
    v_mul_f32 v123, v123, v235
    v_add_f32 v20, 1.0, v20
    v_add_f32 v21, 1.0, v21
    v_add_f32 v22, 1.0, v22
    v_add_f32 v23, 1.0, v23
    v_rcp_f32 v20, v20
    v_rcp_f32 v21, v21
    v_rcp_f32 v22, v22
    v_rcp_f32 v23, v23
    s_add_u32 s45, s45, 114688
    v_mul_f32 v120, v120, v20
    v_mul_f32 v121, v121, v21
    v_mul_f32 v122, v122, v22
    v_mul_f32 v123, v123, v23
    v_cvt_pk_bf16_f32 v106, v120, v121
    v_cvt_pk_bf16_f32 v107, v122, v123
    buffer_store_dwordx4 v[104:107], v1, s[16:19], s45 offen sc1
    v_mul_f32 v24, v124, v19
    v_mul_f32 v25, v125, v19
    v_mul_f32 v26, v126, v19
    v_mul_f32 v27, v127, v19
    v_exp_f32 v24, v24
    v_mul_f32 v124, v124, v236
    v_exp_f32 v25, v25
    v_mul_f32 v125, v125, v237
    v_exp_f32 v26, v26
    v_mul_f32 v126, v126, v238
    v_exp_f32 v27, v27
    v_mul_f32 v127, v127, v239
    v_add_f32 v24, 1.0, v24
    v_add_f32 v25, 1.0, v25
    v_add_f32 v26, 1.0, v26
    v_add_f32 v27, 1.0, v27
    v_rcp_f32 v24, v24
    v_rcp_f32 v25, v25
    v_rcp_f32 v26, v26
    v_rcp_f32 v27, v27
    s_add_u32 s45, s45, 114688
    v_mul_f32 v124, v124, v24
    v_mul_f32 v125, v125, v25
    v_mul_f32 v126, v126, v26
    v_mul_f32 v127, v127, v27
    v_cvt_pk_bf16_f32 v110, v124, v125
    v_cvt_pk_bf16_f32 v111, v126, v127
    buffer_store_dwordx4 v[108:111], v1, s[16:19], s45 offen sc1
    v_lshlrev_b32 v1, 4, v0
    v_mov_b32 v123, 4
    v_mov_b32 v124, 0
    v_mov_b32 v125, 2
    v_bfe_u32 v20, v0, 2, 2
    v_mul_u32_u24 v20, 1056, v20
    v_lshrrev_b32 v21, 4, v0
    v_lshl_add_u32 v20, v21, 7, v20
    v_and_b32 v21, 3, v0
    v_lshl_add_u32 v13, v21, 3, v20
    v_lshrrev_b32 v20, 5, v0
    v_mul_u32_u24 v20, 196608, v20
    v_add_u32 v116, v6, v20
    v_add_u32 v117, v7, v20
    v_add_u32 v118, v8, v20
    v_add_u32 v119, v9, v20
    v_add_u32 v14, 50688, v13
    v_add_u32 v15, 101376, v13
    s_add_u32 s20, s40, 0x640000
    s_addc_u32 s21, s41, 0
    s_and_b32 s21, s21, 0xffff
    s_mov_b32 s22, 0x20000
    s_mov_b32 s23, 0x00020000
    s_mov_b32 s16, s50
    s_and_b32 s17, s51, 0xffff
    s_mov_b32 s18, 0x400000
    s_mov_b32 s19, 0x00020000
    s_add_u32 s48, s40, 0x800000
    s_addc_u32 s49, s41, 0
    s_and_b32 s49, s49, 0xffff
    s_mov_b32 s50, 0x400000
    s_mov_b32 s51, 0x00020000
    s_add_u32 s52, s40, 0x622000
    s_addc_u32 s53, s41, 0
    s_and_b32 s53, s53, 0xffff
    s_mov_b32 s54, 0x2000
    s_mov_b32 s55, 0x00020000
    s_add_u32 s56, s40, 0xc00000
    s_addc_u32 s57, s41, 0
    s_and_b32 s57, s57, 0xffff
    s_mov_b32 s58, 0x400000
    s_mov_b32 s59, 0x00020000
    s_lshl_b32 s47, s42, 10
    s_lshl_b32 s45, s42, 5
    s_lshl_b32 s31, s33, 2
    s_add_u32 s45, s45, s31
    s_mul_i32 s31, s35, 2
    s_add_u32 s45, s45, s31
    s_lshl_b32 s45, s45, 10
    s_lshl_b32 s44, s24, 12
    s_lshl_b32 s63, s2, 14
    s_add_u32 s63, s63, s44
    s_xor_b32 s60, s63, 65536
    v_and_b32 v20, 15, v0
    s_lshl_b32 s31, s42, 4
    v_add_u32 v30, s31, v20
    v_lshlrev_b32 v30, 2, v30
    s_lshl_b32 s64, s24, 12
    s_add_u32 s64, s64, 135168
    v_lshlrev_b32 v21, 7, v20
    v_add_u32 v21, s64, v21
    v_bfe_u32 v22, v0, 4, 1
    v_lshl_add_u32 v21, v22, 3, v21
    v_lshrrev_b32 v22, 5, v0
    v_and_b32 v23, 7, v0
    v_xor_b32 v22, v22, v23
    v_xor_b32 v23, 0, v22
    v_lshl_add_u32 v24, v23, 4, v21
    v_xor_b32 v23, 2, v22
    v_lshl_add_u32 v25, v23, 4, v21
    v_xor_b32 v23, 4, v22
    v_lshl_add_u32 v26, v23, 4, v21
    v_xor_b32 v23, 6, v22
    v_lshl_add_u32 v27, v23, 4, v21
    v_add_u32 v28, s64, v1
    v_lshrrev_b32 v21, 3, v0
    v_and_b32 v22, 7, v0
    v_xor_b32 v22, v22, v21
    v_lshlrev_b32 v21, 14, v21
    v_lshl_add_u32 v20, v22, 4, v21
    s_lshr_b32 s44, s42, 4
    s_and_b32 s31, s42, 15
    s_lshl_b32 s31, s31, 7
    s_add_u32 s44, s44, s31
    s_lshl_b32 s44, s44, 11
    s_lshl_b32 s31, s33, 8
    s_add_u32 s44, s44, s31
    s_mul_i32 s31, s35, 128
    s_add_u32 s44, s44, s31
    s_mov_b32 s66, 0
    s_waitcnt vmcnt(29)
    s_barrier
    ds_read_b64_tr_b16 a[160:161], v13 offset:33792
    ds_read_b64_tr_b16 a[162:163], v13 offset:34304
    ds_read_b64_tr_b16 a[164:165], v13 offset:33824
    ds_read_b64_tr_b16 a[166:167], v13 offset:34336
    ds_read_b64_tr_b16 a[168:169], v13 offset:33856
    ds_read_b64_tr_b16 a[170:171], v13 offset:34368
    s_waitcnt vmcnt(12)
    s_waitcnt lgkmcnt(4)
    v_mfma_f32_16x16x32_bf16 v[128:131], a[160:163], a[0:3], 0
    ds_read_b64_tr_b16 a[172:173], v13 offset:33888
    v_mfma_f32_16x16x32_bf16 v[132:135], a[160:163], a[4:7], 0
    ds_read_b64_tr_b16 a[174:175], v13 offset:34400
    s_waitcnt vmcnt(14)
    s_nop 0
    buffer_store_dword v125, v124, s[4:7], s70 offen sc1
    s_waitcnt lgkmcnt(4)
    v_mfma_f32_16x16x32_bf16 v[136:139], a[164:167], a[0:3], 0
    ds_read_b64_tr_b16 a[160:161], v13 offset:38016
    v_mfma_f32_16x16x32_bf16 v[140:143], a[164:167], a[4:7], 0
    ds_read_b64_tr_b16 a[162:163], v13 offset:38528
    buffer_load_dwordx4 a[40:43], v2, s[8:11], s26 offen offset:1024 sc1
    s_waitcnt lgkmcnt(4)
    v_mfma_f32_16x16x32_bf16 v[144:147], a[168:171], a[0:3], 0
    ds_read_b64_tr_b16 a[164:165], v13 offset:38048
    v_mfma_f32_16x16x32_bf16 v[148:151], a[168:171], a[4:7], 0
    ds_read_b64_tr_b16 a[166:167], v13 offset:38560
    s_waitcnt lgkmcnt(4)
    v_mfma_f32_16x16x32_bf16 v[152:155], a[172:175], a[0:3], 0
    ds_read_b64_tr_b16 a[168:169], v13 offset:38080
    v_mfma_f32_16x16x32_bf16 v[156:159], a[172:175], a[4:7], 0
    ds_read_b64_tr_b16 a[170:171], v13 offset:38592
    buffer_load_dwordx4 a[44:47], v3, s[8:11], s26 offen offset:1024 sc1
    s_waitcnt lgkmcnt(4)
    v_mfma_f32_16x16x32_bf16 v[160:163], a[160:163], a[0:3], 0
    ds_read_b64_tr_b16 a[172:173], v13 offset:38112
    v_mfma_f32_16x16x32_bf16 v[164:167], a[160:163], a[4:7], 0
    ds_read_b64_tr_b16 a[174:175], v13 offset:38624
    s_waitcnt lgkmcnt(4)
    v_mfma_f32_16x16x32_bf16 v[168:171], a[164:167], a[0:3], 0
    ds_read_b64_tr_b16 a[160:161], v13 offset:42240
    v_mfma_f32_16x16x32_bf16 v[172:175], a[164:167], a[4:7], 0
    ds_read_b64_tr_b16 a[162:163], v13 offset:42752
    s_add_u32 s25, s27, 1376256
    s_add_u32 m0, s28, 88704
    s_nop 0
    buffer_load_dwordx4 v6, s[12:15], s25 offen offset:0 lds
    s_waitcnt lgkmcnt(4)
    v_mfma_f32_16x16x32_bf16 v[176:179], a[168:171], a[0:3], 0
    ds_read_b64_tr_b16 a[164:165], v13 offset:42272
    v_mfma_f32_16x16x32_bf16 v[180:183], a[168:171], a[4:7], 0
    ds_read_b64_tr_b16 a[166:167], v13 offset:42784
    s_waitcnt lgkmcnt(4)
    v_mfma_f32_16x16x32_bf16 v[184:187], a[172:175], a[0:3], 0
    ds_read_b64_tr_b16 a[168:169], v13 offset:42304
    v_mfma_f32_16x16x32_bf16 v[188:191], a[172:175], a[4:7], 0
    ds_read_b64_tr_b16 a[170:171], v13 offset:42816
    buffer_load_dwordx4 v7, s[12:15], s25 offen offset:1056 lds
    s_waitcnt vmcnt(15)
    s_waitcnt lgkmcnt(4)
    v_mfma_f32_16x16x32_bf16 v[128:131], a[160:163], a[8:11], v[128:131]
    ds_read_b64_tr_b16 a[172:173], v13 offset:42336
    v_mfma_f32_16x16x32_bf16 v[132:135], a[160:163], a[12:15], v[132:135]
    ds_read_b64_tr_b16 a[174:175], v13 offset:42848
    s_add_u32 m0, s28, 84480
    s_nop 0
    buffer_load_dwordx4 v8, s[12:15], s25 offen offset:0 lds
    s_waitcnt lgkmcnt(4)
    v_mfma_f32_16x16x32_bf16 v[136:139], a[164:167], a[8:11], v[136:139]
    ds_read_b64_tr_b16 a[160:161], v13 offset:46464
    v_mfma_f32_16x16x32_bf16 v[140:143], a[164:167], a[12:15], v[140:143]
    ds_read_b64_tr_b16 a[162:163], v13 offset:46976
    s_waitcnt lgkmcnt(4)
    v_mfma_f32_16x16x32_bf16 v[144:147], a[168:171], a[8:11], v[144:147]
    ds_read_b64_tr_b16 a[164:165], v13 offset:46496
    v_mfma_f32_16x16x32_bf16 v[148:151], a[168:171], a[12:15], v[148:151]
    ds_read_b64_tr_b16 a[166:167], v13 offset:47008
    buffer_load_dwordx4 v9, s[12:15], s25 offen offset:1056 lds
    s_waitcnt lgkmcnt(4)
    v_mfma_f32_16x16x32_bf16 v[152:155], a[172:175], a[8:11], v[152:155]
    ds_read_b64_tr_b16 a[168:169], v13 offset:46528
    v_mfma_f32_16x16x32_bf16 v[156:159], a[172:175], a[12:15], v[156:159]
    ds_read_b64_tr_b16 a[170:171], v13 offset:47040
    s_waitcnt lgkmcnt(4)
    v_mfma_f32_16x16x32_bf16 v[160:163], a[160:163], a[8:11], v[160:163]
    ds_read_b64_tr_b16 a[172:173], v13 offset:46560
    v_mfma_f32_16x16x32_bf16 v[164:167], a[160:163], a[12:15], v[164:167]
    ds_read_b64_tr_b16 a[174:175], v13 offset:47072
    buffer_load_dwordx4 a[48:51], v2, s[8:11], s26 offen offset:2048 sc1
    s_waitcnt lgkmcnt(4)
    v_mfma_f32_16x16x32_bf16 v[168:171], a[164:167], a[8:11], v[168:171]
    s_waitcnt vmcnt(31)
    s_barrier
    ds_read_b64_tr_b16 a[160:161], v14 offset:0
    v_mfma_f32_16x16x32_bf16 v[172:175], a[164:167], a[12:15], v[172:175]
    ds_read_b64_tr_b16 a[162:163], v14 offset:512
    s_waitcnt lgkmcnt(4)
    v_mfma_f32_16x16x32_bf16 v[176:179], a[168:171], a[8:11], v[176:179]
    ds_read_b64_tr_b16 a[164:165], v14 offset:32
    v_mfma_f32_16x16x32_bf16 v[180:183], a[168:171], a[12:15], v[180:183]
    ds_read_b64_tr_b16 a[166:167], v14 offset:544
    buffer_load_dwordx4 a[52:55], v3, s[8:11], s26 offen offset:2048 sc1
    s_waitcnt lgkmcnt(4)
    v_mfma_f32_16x16x32_bf16 v[184:187], a[172:175], a[8:11], v[184:187]
    ds_read_b64_tr_b16 a[168:169], v14 offset:64
    v_mfma_f32_16x16x32_bf16 v[188:191], a[172:175], a[12:15], v[188:191]
    ds_read_b64_tr_b16 a[170:171], v14 offset:576
    buffer_load_dwordx4 a[56:59], v2, s[8:11], s26 offen offset:3072 sc1
    s_waitcnt vmcnt(18)
    s_waitcnt lgkmcnt(4)
    v_mfma_f32_16x16x32_bf16 v[128:131], a[160:163], a[16:19], v[128:131]
    ds_read_b64_tr_b16 a[172:173], v14 offset:96
    v_mfma_f32_16x16x32_bf16 v[132:135], a[160:163], a[20:23], v[132:135]
    ds_read_b64_tr_b16 a[174:175], v14 offset:608
    s_waitcnt lgkmcnt(4)
    v_mfma_f32_16x16x32_bf16 v[136:139], a[164:167], a[16:19], v[136:139]
    ds_read_b64_tr_b16 a[160:161], v14 offset:4224
    v_mfma_f32_16x16x32_bf16 v[140:143], a[164:167], a[20:23], v[140:143]
    ds_read_b64_tr_b16 a[162:163], v14 offset:4736
    buffer_load_dwordx4 a[60:63], v3, s[8:11], s26 offen offset:3072 sc1
    s_add_u32 s26, s26, 4096
    s_waitcnt lgkmcnt(4)
    v_mfma_f32_16x16x32_bf16 v[144:147], a[168:171], a[16:19], v[144:147]
    ds_read_b64_tr_b16 a[164:165], v14 offset:4256
    v_mfma_f32_16x16x32_bf16 v[148:151], a[168:171], a[20:23], v[148:151]
    ds_read_b64_tr_b16 a[166:167], v14 offset:4768
    s_waitcnt lgkmcnt(4)
    v_mfma_f32_16x16x32_bf16 v[152:155], a[172:175], a[16:19], v[152:155]
    ds_read_b64_tr_b16 a[168:169], v14 offset:4288
    v_mfma_f32_16x16x32_bf16 v[156:159], a[172:175], a[20:23], v[156:159]
    ds_read_b64_tr_b16 a[170:171], v14 offset:4800
    s_add_u32 s25, s27, 1835008
    s_add_u32 m0, s28, 105600
    s_nop 0
    buffer_load_dwordx4 v6, s[12:15], s25 offen offset:0 lds
    s_waitcnt lgkmcnt(4)
    v_mfma_f32_16x16x32_bf16 v[160:163], a[160:163], a[16:19], v[160:163]
    ds_read_b64_tr_b16 a[172:173], v14 offset:4320
    v_mfma_f32_16x16x32_bf16 v[164:167], a[160:163], a[20:23], v[164:167]
    ds_read_b64_tr_b16 a[174:175], v14 offset:4832
    s_waitcnt lgkmcnt(4)
    v_mfma_f32_16x16x32_bf16 v[168:171], a[164:167], a[16:19], v[168:171]
    ds_read_b64_tr_b16 a[160:161], v14 offset:8448
    v_mfma_f32_16x16x32_bf16 v[172:175], a[164:167], a[20:23], v[172:175]
    ds_read_b64_tr_b16 a[162:163], v14 offset:8960
    buffer_load_dwordx4 v7, s[12:15], s25 offen offset:1056 lds
    s_waitcnt lgkmcnt(4)
    v_mfma_f32_16x16x32_bf16 v[176:179], a[168:171], a[16:19], v[176:179]
    ds_read_b64_tr_b16 a[164:165], v14 offset:8480
    v_mfma_f32_16x16x32_bf16 v[180:183], a[168:171], a[20:23], v[180:183]
    ds_read_b64_tr_b16 a[166:167], v14 offset:8992
    s_add_u32 m0, s28, 101376
    s_nop 0
    buffer_load_dwordx4 v8, s[12:15], s25 offen offset:0 lds
    s_waitcnt lgkmcnt(4)
    v_mfma_f32_16x16x32_bf16 v[184:187], a[172:175], a[16:19], v[184:187]
    ds_read_b64_tr_b16 a[168:169], v14 offset:8512
    v_mfma_f32_16x16x32_bf16 v[188:191], a[172:175], a[20:23], v[188:191]
    ds_read_b64_tr_b16 a[170:171], v14 offset:9024
    s_waitcnt vmcnt(20)
    s_waitcnt lgkmcnt(4)
    v_mfma_f32_16x16x32_bf16 v[128:131], a[160:163], a[24:27], v[128:131]
    ds_read_b64_tr_b16 a[172:173], v14 offset:8544
    v_mfma_f32_16x16x32_bf16 v[132:135], a[160:163], a[28:31], v[132:135]
    ds_read_b64_tr_b16 a[174:175], v14 offset:9056
    s_waitcnt vmcnt(14)
    s_nop 0
    buffer_store_dword v123, v124, s[4:7], s70 offen sc1
    buffer_load_dwordx4 v9, s[12:15], s25 offen offset:1056 lds
    s_waitcnt lgkmcnt(4)
    v_mfma_f32_16x16x32_bf16 v[136:139], a[164:167], a[24:27], v[136:139]
    ds_read_b64_tr_b16 a[160:161], v14 offset:12672
    v_mfma_f32_16x16x32_bf16 v[140:143], a[164:167], a[28:31], v[140:143]
    ds_read_b64_tr_b16 a[162:163], v14 offset:13184
    s_waitcnt lgkmcnt(4)
    v_mfma_f32_16x16x32_bf16 v[144:147], a[168:171], a[24:27], v[144:147]
    ds_read_b64_tr_b16 a[164:165], v14 offset:12704
    v_mfma_f32_16x16x32_bf16 v[148:151], a[168:171], a[28:31], v[148:151]
    ds_read_b64_tr_b16 a[166:167], v14 offset:13216
    buffer_load_dwordx4 a[64:67], v2, s[8:11], s26 offen offset:0 sc1
    s_waitcnt lgkmcnt(4)
    v_mfma_f32_16x16x32_bf16 v[152:155], a[172:175], a[24:27], v[152:155]
    ds_read_b64_tr_b16 a[168:169], v14 offset:12736
    v_mfma_f32_16x16x32_bf16 v[156:159], a[172:175], a[28:31], v[156:159]
    ds_read_b64_tr_b16 a[170:171], v14 offset:13248
    s_waitcnt lgkmcnt(4)
    v_mfma_f32_16x16x32_bf16 v[160:163], a[160:163], a[24:27], v[160:163]
    ds_read_b64_tr_b16 a[172:173], v14 offset:12768
    v_mfma_f32_16x16x32_bf16 v[164:167], a[160:163], a[28:31], v[164:167]
    ds_read_b64_tr_b16 a[174:175], v14 offset:13280
    buffer_load_dwordx4 a[68:71], v3, s[8:11], s26 offen offset:0 sc1
    s_waitcnt lgkmcnt(4)
    v_mfma_f32_16x16x32_bf16 v[168:171], a[164:167], a[24:27], v[168:171]
    s_waitcnt vmcnt(37)
    s_barrier
    ds_read_b64_tr_b16 a[160:161], v14 offset:16896
    v_mfma_f32_16x16x32_bf16 v[172:175], a[164:167], a[28:31], v[172:175]
    ds_read_b64_tr_b16 a[162:163], v14 offset:17408
    buffer_load_dwordx4 a[72:75], v2, s[8:11], s26 offen offset:1024 sc1
    s_waitcnt lgkmcnt(4)
    v_mfma_f32_16x16x32_bf16 v[176:179], a[168:171], a[24:27], v[176:179]
    ds_read_b64_tr_b16 a[164:165], v14 offset:16928
    v_mfma_f32_16x16x32_bf16 v[180:183], a[168:171], a[28:31], v[180:183]
    ds_read_b64_tr_b16 a[166:167], v14 offset:17440
    s_waitcnt lgkmcnt(4)
    v_mfma_f32_16x16x32_bf16 v[184:187], a[172:175], a[24:27], v[184:187]
    ds_read_b64_tr_b16 a[168:169], v14 offset:16960
    v_mfma_f32_16x16x32_bf16 v[188:191], a[172:175], a[28:31], v[188:191]
    ds_read_b64_tr_b16 a[170:171], v14 offset:17472
    buffer_load_dwordx4 a[76:79], v3, s[8:11], s26 offen offset:1024 sc1
    s_waitcnt vmcnt(24)
    s_waitcnt lgkmcnt(4)
    v_mfma_f32_16x16x32_bf16 v[128:131], a[160:163], a[32:35], v[128:131]
    ds_read_b64_tr_b16 a[172:173], v14 offset:16992
    v_mfma_f32_16x16x32_bf16 v[132:135], a[160:163], a[36:39], v[132:135]
    ds_read_b64_tr_b16 a[174:175], v14 offset:17504
    s_waitcnt lgkmcnt(4)
    v_mfma_f32_16x16x32_bf16 v[136:139], a[164:167], a[32:35], v[136:139]
    ds_read_b64_tr_b16 a[160:161], v14 offset:21120
    v_mfma_f32_16x16x32_bf16 v[140:143], a[164:167], a[36:39], v[140:143]
    ds_read_b64_tr_b16 a[162:163], v14 offset:21632
    s_add_u32 s25, s27, 2293760
    s_add_u32 m0, s28, 122496
    s_nop 0
    buffer_load_dwordx4 v6, s[12:15], s25 offen offset:0 lds
    s_waitcnt lgkmcnt(4)
    v_mfma_f32_16x16x32_bf16 v[144:147], a[168:171], a[32:35], v[144:147]
    ds_read_b64_tr_b16 a[164:165], v14 offset:21152
    v_mfma_f32_16x16x32_bf16 v[148:151], a[168:171], a[36:39], v[148:151]
    ds_read_b64_tr_b16 a[166:167], v14 offset:21664
    s_waitcnt lgkmcnt(4)
    v_mfma_f32_16x16x32_bf16 v[152:155], a[172:175], a[32:35], v[152:155]
    ds_read_b64_tr_b16 a[168:169], v14 offset:21184
    v_mfma_f32_16x16x32_bf16 v[156:159], a[172:175], a[36:39], v[156:159]
    ds_read_b64_tr_b16 a[170:171], v14 offset:21696
    buffer_load_dwordx4 v7, s[12:15], s25 offen offset:1056 lds
    s_waitcnt lgkmcnt(4)
    v_mfma_f32_16x16x32_bf16 v[160:163], a[160:163], a[32:35], v[160:163]
    ds_read_b64_tr_b16 a[172:173], v14 offset:21216
    v_mfma_f32_16x16x32_bf16 v[164:167], a[160:163], a[36:39], v[164:167]
    ds_read_b64_tr_b16 a[174:175], v14 offset:21728
    s_add_u32 m0, s28, 118272
    s_nop 0
    buffer_load_dwordx4 v8, s[12:15], s25 offen offset:0 lds
    s_waitcnt lgkmcnt(4)
    v_mfma_f32_16x16x32_bf16 v[168:171], a[164:167], a[32:35], v[168:171]
    ds_read_b64_tr_b16 a[160:161], v14 offset:25344
    v_mfma_f32_16x16x32_bf16 v[172:175], a[164:167], a[36:39], v[172:175]
    ds_read_b64_tr_b16 a[162:163], v14 offset:25856
    s_waitcnt lgkmcnt(4)
    v_mfma_f32_16x16x32_bf16 v[176:179], a[168:171], a[32:35], v[176:179]
    ds_read_b64_tr_b16 a[164:165], v14 offset:25376
    v_mfma_f32_16x16x32_bf16 v[180:183], a[168:171], a[36:39], v[180:183]
    ds_read_b64_tr_b16 a[166:167], v14 offset:25888
    buffer_load_dwordx4 v9, s[12:15], s25 offen offset:1056 lds
    s_waitcnt lgkmcnt(4)
    v_mfma_f32_16x16x32_bf16 v[184:187], a[172:175], a[32:35], v[184:187]
    ds_read_b64_tr_b16 a[168:169], v14 offset:25408
    v_mfma_f32_16x16x32_bf16 v[188:191], a[172:175], a[36:39], v[188:191]
    ds_read_b64_tr_b16 a[170:171], v14 offset:25920
    s_waitcnt vmcnt(21)
    s_waitcnt lgkmcnt(4)
    v_mfma_f32_16x16x32_bf16 v[128:131], a[160:163], a[40:43], v[128:131]
    ds_read_b64_tr_b16 a[172:173], v14 offset:25440
    v_mfma_f32_16x16x32_bf16 v[132:135], a[160:163], a[44:47], v[132:135]
    ds_read_b64_tr_b16 a[174:175], v14 offset:25952
    buffer_load_dwordx4 a[80:83], v2, s[8:11], s26 offen offset:2048 sc1
    s_waitcnt lgkmcnt(4)
    v_mfma_f32_16x16x32_bf16 v[136:139], a[164:167], a[40:43], v[136:139]
    ds_read_b64_tr_b16 a[160:161], v14 offset:29568
    v_mfma_f32_16x16x32_bf16 v[140:143], a[164:167], a[44:47], v[140:143]
    ds_read_b64_tr_b16 a[162:163], v14 offset:30080
    s_waitcnt lgkmcnt(4)
    v_mfma_f32_16x16x32_bf16 v[144:147], a[168:171], a[40:43], v[144:147]
    ds_read_b64_tr_b16 a[164:165], v14 offset:29600
    v_mfma_f32_16x16x32_bf16 v[148:151], a[168:171], a[44:47], v[148:151]
    ds_read_b64_tr_b16 a[166:167], v14 offset:30112
    buffer_load_dwordx4 a[84:87], v3, s[8:11], s26 offen offset:2048 sc1
    s_waitcnt lgkmcnt(4)
    v_mfma_f32_16x16x32_bf16 v[152:155], a[172:175], a[40:43], v[152:155]
    ds_read_b64_tr_b16 a[168:169], v14 offset:29632
    v_mfma_f32_16x16x32_bf16 v[156:159], a[172:175], a[44:47], v[156:159]
    ds_read_b64_tr_b16 a[170:171], v14 offset:30144
    buffer_load_dwordx4 a[88:91], v2, s[8:11], s26 offen offset:3072 sc1
    s_waitcnt lgkmcnt(4)
    v_mfma_f32_16x16x32_bf16 v[160:163], a[160:163], a[40:43], v[160:163]
    ds_read_b64_tr_b16 a[172:173], v14 offset:29664
    v_mfma_f32_16x16x32_bf16 v[164:167], a[160:163], a[44:47], v[164:167]
    ds_read_b64_tr_b16 a[174:175], v14 offset:30176
    s_waitcnt lgkmcnt(4)
    v_mfma_f32_16x16x32_bf16 v[168:171], a[164:167], a[40:43], v[168:171]
    s_waitcnt vmcnt(20)
    s_barrier
    ds_read_b64_tr_b16 a[160:161], v14 offset:33792
    v_mfma_f32_16x16x32_bf16 v[172:175], a[164:167], a[44:47], v[172:175]
    ds_read_b64_tr_b16 a[162:163], v14 offset:34304
    buffer_load_dwordx4 a[92:95], v3, s[8:11], s26 offen offset:3072 sc1
    s_add_u32 s26, s26, 4096
    s_waitcnt lgkmcnt(4)
    v_mfma_f32_16x16x32_bf16 v[176:179], a[168:171], a[40:43], v[176:179]
    ds_read_b64_tr_b16 a[164:165], v14 offset:33824
    v_mfma_f32_16x16x32_bf16 v[180:183], a[168:171], a[44:47], v[180:183]
    ds_read_b64_tr_b16 a[166:167], v14 offset:34336
    s_waitcnt lgkmcnt(4)
    v_mfma_f32_16x16x32_bf16 v[184:187], a[172:175], a[40:43], v[184:187]
    ds_read_b64_tr_b16 a[168:169], v14 offset:33856
    v_mfma_f32_16x16x32_bf16 v[188:191], a[172:175], a[44:47], v[188:191]
    ds_read_b64_tr_b16 a[170:171], v14 offset:34368
    s_add_u32 s25, s27, 2752512
    s_add_u32 m0, s28, 4224
    s_nop 0
    buffer_load_dwordx4 v6, s[12:15], s25 offen offset:0 lds
    s_waitcnt vmcnt(20)
    s_waitcnt lgkmcnt(4)
    v_mfma_f32_16x16x32_bf16 v[128:131], a[160:163], a[48:51], v[128:131]
    ds_read_b64_tr_b16 a[172:173], v14 offset:33888
    v_mfma_f32_16x16x32_bf16 v[132:135], a[160:163], a[52:55], v[132:135]
    ds_read_b64_tr_b16 a[174:175], v14 offset:34400
    s_waitcnt lgkmcnt(4)
    v_mfma_f32_16x16x32_bf16 v[136:139], a[164:167], a[48:51], v[136:139]
    ds_read_b64_tr_b16 a[160:161], v14 offset:38016
    v_mfma_f32_16x16x32_bf16 v[140:143], a[164:167], a[52:55], v[140:143]
    ds_read_b64_tr_b16 a[162:163], v14 offset:38528
    buffer_load_dwordx4 v7, s[12:15], s25 offen offset:1056 lds
    s_waitcnt lgkmcnt(4)
    v_mfma_f32_16x16x32_bf16 v[144:147], a[168:171], a[48:51], v[144:147]
    ds_read_b64_tr_b16 a[164:165], v14 offset:38048
    v_mfma_f32_16x16x32_bf16 v[148:151], a[168:171], a[52:55], v[148:151]
    ds_read_b64_tr_b16 a[166:167], v14 offset:38560
    s_add_u32 m0, s28, 0
    s_nop 0
    buffer_load_dwordx4 v8, s[12:15], s25 offen offset:0 lds
    s_waitcnt lgkmcnt(4)
    v_mfma_f32_16x16x32_bf16 v[152:155], a[172:175], a[48:51], v[152:155]
    ds_read_b64_tr_b16 a[168:169], v14 offset:38080
    v_mfma_f32_16x16x32_bf16 v[156:159], a[172:175], a[52:55], v[156:159]
    ds_read_b64_tr_b16 a[170:171], v14 offset:38592
    s_waitcnt lgkmcnt(4)
    v_mfma_f32_16x16x32_bf16 v[160:163], a[160:163], a[48:51], v[160:163]
    ds_read_b64_tr_b16 a[172:173], v14 offset:38112
    v_mfma_f32_16x16x32_bf16 v[164:167], a[160:163], a[52:55], v[164:167]
    ds_read_b64_tr_b16 a[174:175], v14 offset:38624
    buffer_load_dwordx4 v9, s[12:15], s25 offen offset:1056 lds
    s_waitcnt lgkmcnt(4)
    v_mfma_f32_16x16x32_bf16 v[168:171], a[164:167], a[48:51], v[168:171]
    ds_read_b64_tr_b16 a[160:161], v14 offset:42240
    v_mfma_f32_16x16x32_bf16 v[172:175], a[164:167], a[52:55], v[172:175]
    ds_read_b64_tr_b16 a[162:163], v14 offset:42752
    s_waitcnt lgkmcnt(4)
    v_mfma_f32_16x16x32_bf16 v[176:179], a[168:171], a[48:51], v[176:179]
    ds_read_b64_tr_b16 a[164:165], v14 offset:42272
    v_mfma_f32_16x16x32_bf16 v[180:183], a[168:171], a[52:55], v[180:183]
    ds_read_b64_tr_b16 a[166:167], v14 offset:42784
    buffer_load_dwordx4 a[96:99], v2, s[8:11], s26 offen offset:0 sc1
    s_waitcnt lgkmcnt(4)
    v_mfma_f32_16x16x32_bf16 v[184:187], a[172:175], a[48:51], v[184:187]
    ds_read_b64_tr_b16 a[168:169], v14 offset:42304
    v_mfma_f32_16x16x32_bf16 v[188:191], a[172:175], a[52:55], v[188:191]
    ds_read_b64_tr_b16 a[170:171], v14 offset:42816
    s_waitcnt vmcnt(22)
    s_waitcnt lgkmcnt(4)
    v_mfma_f32_16x16x32_bf16 v[128:131], a[160:163], a[56:59], v[128:131]
    ds_read_b64_tr_b16 a[172:173], v14 offset:42336
    v_mfma_f32_16x16x32_bf16 v[132:135], a[160:163], a[60:63], v[132:135]
    ds_read_b64_tr_b16 a[174:175], v14 offset:42848
    buffer_load_dwordx4 a[100:103], v3, s[8:11], s26 offen offset:0 sc1
    s_waitcnt lgkmcnt(4)
    v_mfma_f32_16x16x32_bf16 v[136:139], a[164:167], a[56:59], v[136:139]
    ds_read_b64_tr_b16 a[160:161], v14 offset:46464
    v_mfma_f32_16x16x32_bf16 v[140:143], a[164:167], a[60:63], v[140:143]
    ds_read_b64_tr_b16 a[162:163], v14 offset:46976
    buffer_load_dwordx4 a[104:107], v2, s[8:11], s26 offen offset:1024 sc1
    s_waitcnt lgkmcnt(4)
    v_mfma_f32_16x16x32_bf16 v[144:147], a[168:171], a[56:59], v[144:147]
    ds_read_b64_tr_b16 a[164:165], v14 offset:46496
    v_mfma_f32_16x16x32_bf16 v[148:151], a[168:171], a[60:63], v[148:151]
    ds_read_b64_tr_b16 a[166:167], v14 offset:47008
    s_waitcnt lgkmcnt(4)
    v_mfma_f32_16x16x32_bf16 v[152:155], a[172:175], a[56:59], v[152:155]
    ds_read_b64_tr_b16 a[168:169], v14 offset:46528
    v_mfma_f32_16x16x32_bf16 v[156:159], a[172:175], a[60:63], v[156:159]
    ds_read_b64_tr_b16 a[170:171], v14 offset:47040
    buffer_load_dwordx4 a[108:111], v3, s[8:11], s26 offen offset:1024 sc1
    s_waitcnt lgkmcnt(4)
    v_mfma_f32_16x16x32_bf16 v[160:163], a[160:163], a[56:59], v[160:163]
    ds_read_b64_tr_b16 a[172:173], v14 offset:46560
    v_mfma_f32_16x16x32_bf16 v[164:167], a[160:163], a[60:63], v[164:167]
    ds_read_b64_tr_b16 a[174:175], v14 offset:47072
    s_waitcnt lgkmcnt(4)
    v_mfma_f32_16x16x32_bf16 v[168:171], a[164:167], a[56:59], v[168:171]
    s_waitcnt vmcnt(20)
    s_barrier
    ds_read_b64_tr_b16 a[160:161], v15 offset:0
    v_mfma_f32_16x16x32_bf16 v[172:175], a[164:167], a[60:63], v[172:175]
    ds_read_b64_tr_b16 a[162:163], v15 offset:512
    s_add_u32 s25, s27, 3211264
    s_add_u32 m0, s28, 21120
    s_nop 0
    buffer_load_dwordx4 v6, s[12:15], s25 offen offset:0 lds
    s_waitcnt lgkmcnt(4)
    v_mfma_f32_16x16x32_bf16 v[176:179], a[168:171], a[56:59], v[176:179]
    ds_read_b64_tr_b16 a[164:165], v15 offset:32
    v_mfma_f32_16x16x32_bf16 v[180:183], a[168:171], a[60:63], v[180:183]
    ds_read_b64_tr_b16 a[166:167], v15 offset:544
    s_waitcnt lgkmcnt(4)
    v_mfma_f32_16x16x32_bf16 v[184:187], a[172:175], a[56:59], v[184:187]
    ds_read_b64_tr_b16 a[168:169], v15 offset:64
    v_mfma_f32_16x16x32_bf16 v[188:191], a[172:175], a[60:63], v[188:191]
    ds_read_b64_tr_b16 a[170:171], v15 offset:576
    buffer_load_dwordx4 v7, s[12:15], s25 offen offset:1056 lds
    s_waitcnt vmcnt(20)
    s_waitcnt lgkmcnt(4)
    v_mfma_f32_16x16x32_bf16 v[128:131], a[160:163], a[64:67], v[128:131]
    ds_read_b64_tr_b16 a[172:173], v15 offset:96
    v_mfma_f32_16x16x32_bf16 v[132:135], a[160:163], a[68:71], v[132:135]
    ds_read_b64_tr_b16 a[174:175], v15 offset:608
    s_add_u32 m0, s28, 16896
    s_nop 0
    buffer_load_dwordx4 v8, s[12:15], s25 offen offset:0 lds
    s_waitcnt lgkmcnt(4)
    v_mfma_f32_16x16x32_bf16 v[136:139], a[164:167], a[64:67], v[136:139]
    ds_read_b64_tr_b16 a[160:161], v15 offset:4224
    v_mfma_f32_16x16x32_bf16 v[140:143], a[164:167], a[68:71], v[140:143]
    ds_read_b64_tr_b16 a[162:163], v15 offset:4736
    s_waitcnt lgkmcnt(4)
    v_mfma_f32_16x16x32_bf16 v[144:147], a[168:171], a[64:67], v[144:147]
    ds_read_b64_tr_b16 a[164:165], v15 offset:4256
    v_mfma_f32_16x16x32_bf16 v[148:151], a[168:171], a[68:71], v[148:151]
    ds_read_b64_tr_b16 a[166:167], v15 offset:4768
    buffer_load_dwordx4 v9, s[12:15], s25 offen offset:1056 lds
    s_waitcnt lgkmcnt(4)
    v_mfma_f32_16x16x32_bf16 v[152:155], a[172:175], a[64:67], v[152:155]
    ds_read_b64_tr_b16 a[168:169], v15 offset:4288
    v_mfma_f32_16x16x32_bf16 v[156:159], a[172:175], a[68:71], v[156:159]
    ds_read_b64_tr_b16 a[170:171], v15 offset:4800
    buffer_load_dword v12, v10, s[4:7], 0 offen sc1
    s_waitcnt lgkmcnt(4)
    v_mfma_f32_16x16x32_bf16 v[160:163], a[160:163], a[64:67], v[160:163]
    ds_read_b64_tr_b16 a[172:173], v15 offset:4320
    v_mfma_f32_16x16x32_bf16 v[164:167], a[160:163], a[68:71], v[164:167]
    ds_read_b64_tr_b16 a[174:175], v15 offset:4832
    buffer_load_dwordx4 a[112:115], v2, s[8:11], s26 offen offset:2048 sc1
    s_waitcnt lgkmcnt(4)
    v_mfma_f32_16x16x32_bf16 v[168:171], a[164:167], a[64:67], v[168:171]
    ds_read_b64_tr_b16 a[160:161], v15 offset:8448
    v_mfma_f32_16x16x32_bf16 v[172:175], a[164:167], a[68:71], v[172:175]
    ds_read_b64_tr_b16 a[162:163], v15 offset:8960
    s_waitcnt lgkmcnt(4)
    v_mfma_f32_16x16x32_bf16 v[176:179], a[168:171], a[64:67], v[176:179]
    ds_read_b64_tr_b16 a[164:165], v15 offset:8480
    v_mfma_f32_16x16x32_bf16 v[180:183], a[168:171], a[68:71], v[180:183]
    ds_read_b64_tr_b16 a[166:167], v15 offset:8992
    buffer_load_dwordx4 a[116:119], v3, s[8:11], s26 offen offset:2048 sc1
    s_waitcnt lgkmcnt(4)
    v_mfma_f32_16x16x32_bf16 v[184:187], a[172:175], a[64:67], v[184:187]
    ds_read_b64_tr_b16 a[168:169], v15 offset:8512
    v_mfma_f32_16x16x32_bf16 v[188:191], a[172:175], a[68:71], v[188:191]
    ds_read_b64_tr_b16 a[170:171], v15 offset:9024
    buffer_load_dwordx4 a[120:123], v2, s[8:11], s26 offen offset:3072 sc1
    s_waitcnt vmcnt(24)
    s_waitcnt lgkmcnt(4)
    v_mfma_f32_16x16x32_bf16 v[128:131], a[160:163], a[72:75], v[128:131]
    ds_read_b64_tr_b16 a[172:173], v15 offset:8544
    v_mfma_f32_16x16x32_bf16 v[132:135], a[160:163], a[76:79], v[132:135]
    ds_read_b64_tr_b16 a[174:175], v15 offset:9056
    s_waitcnt lgkmcnt(4)
    v_mfma_f32_16x16x32_bf16 v[136:139], a[164:167], a[72:75], v[136:139]
    ds_read_b64_tr_b16 a[160:161], v15 offset:12672
    v_mfma_f32_16x16x32_bf16 v[140:143], a[164:167], a[76:79], v[140:143]
    ds_read_b64_tr_b16 a[162:163], v15 offset:13184
    buffer_load_dwordx4 a[124:127], v3, s[8:11], s26 offen offset:3072 sc1
    s_add_u32 s26, s26, 4096
    s_waitcnt lgkmcnt(4)
    v_mfma_f32_16x16x32_bf16 v[144:147], a[168:171], a[72:75], v[144:147]
    ds_read_b64_tr_b16 a[164:165], v15 offset:12704
    v_mfma_f32_16x16x32_bf16 v[148:151], a[168:171], a[76:79], v[148:151]
    ds_read_b64_tr_b16 a[166:167], v15 offset:13216
    s_waitcnt lgkmcnt(4)
    v_mfma_f32_16x16x32_bf16 v[152:155], a[172:175], a[72:75], v[152:155]
    ds_read_b64_tr_b16 a[168:169], v15 offset:12736
    v_mfma_f32_16x16x32_bf16 v[156:159], a[172:175], a[76:79], v[156:159]
    ds_read_b64_tr_b16 a[170:171], v15 offset:13248
    s_add_u32 s25, s27, 65536
    s_add_u32 m0, s28, 38016
    s_nop 0
    buffer_load_dwordx4 v6, s[12:15], s25 offen offset:0 lds
    s_waitcnt lgkmcnt(4)
    v_mfma_f32_16x16x32_bf16 v[160:163], a[160:163], a[72:75], v[160:163]
    ds_read_b64_tr_b16 a[172:173], v15 offset:12768
    v_mfma_f32_16x16x32_bf16 v[164:167], a[160:163], a[76:79], v[164:167]
    ds_read_b64_tr_b16 a[174:175], v15 offset:13280
    s_waitcnt lgkmcnt(4)
    v_mfma_f32_16x16x32_bf16 v[168:171], a[164:167], a[72:75], v[168:171]
    s_waitcnt vmcnt(22)
    s_barrier
    ds_read_b64_tr_b16 a[160:161], v15 offset:16896
    v_mfma_f32_16x16x32_bf16 v[172:175], a[164:167], a[76:79], v[172:175]
    ds_read_b64_tr_b16 a[162:163], v15 offset:17408
    buffer_load_dwordx4 v7, s[12:15], s25 offen offset:1056 lds
    s_waitcnt lgkmcnt(4)
    v_mfma_f32_16x16x32_bf16 v[176:179], a[168:171], a[72:75], v[176:179]
    ds_read_b64_tr_b16 a[164:165], v15 offset:16928
    v_mfma_f32_16x16x32_bf16 v[180:183], a[168:171], a[76:79], v[180:183]
    ds_read_b64_tr_b16 a[166:167], v15 offset:17440
    s_add_u32 m0, s28, 33792
    s_nop 0
    buffer_load_dwordx4 v8, s[12:15], s25 offen offset:0 lds
    s_waitcnt lgkmcnt(4)
    v_mfma_f32_16x16x32_bf16 v[184:187], a[172:175], a[72:75], v[184:187]
    ds_read_b64_tr_b16 a[168:169], v15 offset:16960
    v_mfma_f32_16x16x32_bf16 v[188:191], a[172:175], a[76:79], v[188:191]
    ds_read_b64_tr_b16 a[170:171], v15 offset:17472
    s_waitcnt vmcnt(22)
    s_waitcnt lgkmcnt(4)
    v_mfma_f32_16x16x32_bf16 v[128:131], a[160:163], a[80:83], v[128:131]
    ds_read_b64_tr_b16 a[172:173], v15 offset:16992
    v_mfma_f32_16x16x32_bf16 v[132:135], a[160:163], a[84:87], v[132:135]
    ds_read_b64_tr_b16 a[174:175], v15 offset:17504
    buffer_load_dwordx4 v9, s[12:15], s25 offen offset:1056 lds
    s_waitcnt lgkmcnt(4)
    v_mfma_f32_16x16x32_bf16 v[136:139], a[164:167], a[80:83], v[136:139]
    ds_read_b64_tr_b16 a[160:161], v15 offset:21120
    v_mfma_f32_16x16x32_bf16 v[140:143], a[164:167], a[84:87], v[140:143]
    ds_read_b64_tr_b16 a[162:163], v15 offset:21632
    s_waitcnt lgkmcnt(4)
    v_mfma_f32_16x16x32_bf16 v[144:147], a[168:171], a[80:83], v[144:147]
    ds_read_b64_tr_b16 a[164:165], v15 offset:21152
    v_mfma_f32_16x16x32_bf16 v[148:151], a[168:171], a[84:87], v[148:151]
    ds_read_b64_tr_b16 a[166:167], v15 offset:21664
    s_waitcnt vmcnt(8)
    v_cmp_gt_u32 vcc, 2, v12
    s_nop 1
    s_cbranch_vccnz g34_slow1
g34_cont1:
    s_nop 0
    buffer_load_dwordx4 a[128:131], v2, s[8:11], s26 offen offset:0 sc1
    s_waitcnt lgkmcnt(4)
    v_mfma_f32_16x16x32_bf16 v[152:155], a[172:175], a[80:83], v[152:155]
    ds_read_b64_tr_b16 a[168:169], v15 offset:21184
    v_mfma_f32_16x16x32_bf16 v[156:159], a[172:175], a[84:87], v[156:159]
    ds_read_b64_tr_b16 a[170:171], v15 offset:21696
    s_waitcnt lgkmcnt(4)
    v_mfma_f32_16x16x32_bf16 v[160:163], a[160:163], a[80:83], v[160:163]
    ds_read_b64_tr_b16 a[172:173], v15 offset:21216
    v_mfma_f32_16x16x32_bf16 v[164:167], a[160:163], a[84:87], v[164:167]
    ds_read_b64_tr_b16 a[174:175], v15 offset:21728
    buffer_load_dwordx4 a[132:135], v3, s[8:11], s26 offen offset:0 sc1
    s_waitcnt lgkmcnt(4)
    v_mfma_f32_16x16x32_bf16 v[168:171], a[164:167], a[80:83], v[168:171]
    ds_read_b64_tr_b16 a[160:161], v15 offset:25344
    v_mfma_f32_16x16x32_bf16 v[172:175], a[164:167], a[84:87], v[172:175]
    ds_read_b64_tr_b16 a[162:163], v15 offset:25856
    buffer_load_dwordx4 a[136:139], v2, s[8:11], s26 offen offset:1024 sc1
    s_waitcnt lgkmcnt(4)
    v_mfma_f32_16x16x32_bf16 v[176:179], a[168:171], a[80:83], v[176:179]
    ds_read_b64_tr_b16 a[164:165], v15 offset:25376
    v_mfma_f32_16x16x32_bf16 v[180:183], a[168:171], a[84:87], v[180:183]
    ds_read_b64_tr_b16 a[166:167], v15 offset:25888
    s_waitcnt lgkmcnt(4)
    v_mfma_f32_16x16x32_bf16 v[184:187], a[172:175], a[80:83], v[184:187]
    ds_read_b64_tr_b16 a[168:169], v15 offset:25408
    v_mfma_f32_16x16x32_bf16 v[188:191], a[172:175], a[84:87], v[188:191]
    ds_read_b64_tr_b16 a[170:171], v15 offset:25920
    buffer_load_dwordx4 a[140:143], v3, s[8:11], s26 offen offset:1024 sc1
    s_waitcnt vmcnt(25)
    s_waitcnt lgkmcnt(4)
    v_mfma_f32_16x16x32_bf16 v[128:131], a[160:163], a[88:91], v[128:131]
    ds_read_b64_tr_b16 a[172:173], v15 offset:25440
    v_mfma_f32_16x16x32_bf16 v[132:135], a[160:163], a[92:95], v[132:135]
    ds_read_b64_tr_b16 a[174:175], v15 offset:25952
    s_waitcnt lgkmcnt(4)
    v_mfma_f32_16x16x32_bf16 v[136:139], a[164:167], a[88:91], v[136:139]
    ds_read_b64_tr_b16 a[160:161], v15 offset:29568
    v_mfma_f32_16x16x32_bf16 v[140:143], a[164:167], a[92:95], v[140:143]
    ds_read_b64_tr_b16 a[162:163], v15 offset:30080
    s_add_u32 s25, s27, 524288
    s_add_u32 m0, s28, 54912
    s_nop 0
    buffer_load_dwordx4 v6, s[12:15], s25 offen offset:0 lds
    s_waitcnt lgkmcnt(4)
    v_mfma_f32_16x16x32_bf16 v[144:147], a[168:171], a[88:91], v[144:147]
    ds_read_b64_tr_b16 a[164:165], v15 offset:29600
    v_mfma_f32_16x16x32_bf16 v[148:151], a[168:171], a[92:95], v[148:151]
    ds_read_b64_tr_b16 a[166:167], v15 offset:30112
    s_waitcnt lgkmcnt(4)
    v_mfma_f32_16x16x32_bf16 v[152:155], a[172:175], a[88:91], v[152:155]
    ds_read_b64_tr_b16 a[168:169], v15 offset:29632
    v_mfma_f32_16x16x32_bf16 v[156:159], a[172:175], a[92:95], v[156:159]
    ds_read_b64_tr_b16 a[170:171], v15 offset:30144
    buffer_load_dwordx4 v7, s[12:15], s25 offen offset:1056 lds
    s_waitcnt lgkmcnt(4)
    v_mfma_f32_16x16x32_bf16 v[160:163], a[160:163], a[88:91], v[160:163]
    ds_read_b64_tr_b16 a[172:173], v15 offset:29664
    v_mfma_f32_16x16x32_bf16 v[164:167], a[160:163], a[92:95], v[164:167]
    ds_read_b64_tr_b16 a[174:175], v15 offset:30176
    s_add_u32 m0, s28, 50688
    s_nop 0
    buffer_load_dwordx4 v8, s[12:15], s25 offen offset:0 lds
    s_waitcnt lgkmcnt(4)
    v_mfma_f32_16x16x32_bf16 v[168:171], a[164:167], a[88:91], v[168:171]
    s_waitcnt vmcnt(24)
    s_barrier
    ds_read_b64_tr_b16 a[160:161], v13 offset:0
    v_mfma_f32_16x16x32_bf16 v[172:175], a[164:167], a[92:95], v[172:175]
    ds_read_b64_tr_b16 a[162:163], v13 offset:512
    s_waitcnt lgkmcnt(4)
    v_mfma_f32_16x16x32_bf16 v[176:179], a[168:171], a[88:91], v[176:179]
    ds_read_b64_tr_b16 a[164:165], v13 offset:32
    v_mfma_f32_16x16x32_bf16 v[180:183], a[168:171], a[92:95], v[180:183]
    ds_read_b64_tr_b16 a[166:167], v13 offset:544
    buffer_load_dwordx4 v9, s[12:15], s25 offen offset:1056 lds
    s_waitcnt lgkmcnt(4)
    v_mfma_f32_16x16x32_bf16 v[184:187], a[172:175], a[88:91], v[184:187]
    ds_read_b64_tr_b16 a[168:169], v13 offset:64
    v_mfma_f32_16x16x32_bf16 v[188:191], a[172:175], a[92:95], v[188:191]
    ds_read_b64_tr_b16 a[170:171], v13 offset:576
    s_waitcnt vmcnt(23)
    s_waitcnt lgkmcnt(4)
    v_mfma_f32_16x16x32_bf16 v[128:131], a[160:163], a[96:99], v[128:131]
    ds_read_b64_tr_b16 a[172:173], v13 offset:96
    v_mfma_f32_16x16x32_bf16 v[132:135], a[160:163], a[100:103], v[132:135]
    ds_read_b64_tr_b16 a[174:175], v13 offset:608
    buffer_load_dwordx4 a[144:147], v2, s[8:11], s26 offen offset:2048 sc1
    s_waitcnt lgkmcnt(4)
    v_mfma_f32_16x16x32_bf16 v[136:139], a[164:167], a[96:99], v[136:139]
    ds_read_b64_tr_b16 a[160:161], v13 offset:4224
    v_mfma_f32_16x16x32_bf16 v[140:143], a[164:167], a[100:103], v[140:143]
    ds_read_b64_tr_b16 a[162:163], v13 offset:4736
    s_waitcnt lgkmcnt(4)
    v_mfma_f32_16x16x32_bf16 v[144:147], a[168:171], a[96:99], v[144:147]
    ds_read_b64_tr_b16 a[164:165], v13 offset:4256
    v_mfma_f32_16x16x32_bf16 v[148:151], a[168:171], a[100:103], v[148:151]
    ds_read_b64_tr_b16 a[166:167], v13 offset:4768
    buffer_load_dwordx4 a[148:151], v3, s[8:11], s26 offen offset:2048 sc1
    s_waitcnt lgkmcnt(4)
    v_mfma_f32_16x16x32_bf16 v[152:155], a[172:175], a[96:99], v[152:155]
    ds_read_b64_tr_b16 a[168:169], v13 offset:4288
    v_mfma_f32_16x16x32_bf16 v[156:159], a[172:175], a[100:103], v[156:159]
    ds_read_b64_tr_b16 a[170:171], v13 offset:4800
    s_waitcnt lgkmcnt(4)
    v_mfma_f32_16x16x32_bf16 v[160:163], a[160:163], a[96:99], v[160:163]
    ds_read_b64_tr_b16 a[172:173], v13 offset:4320
    v_mfma_f32_16x16x32_bf16 v[164:167], a[160:163], a[100:103], v[164:167]
    ds_read_b64_tr_b16 a[174:175], v13 offset:4832
    buffer_load_dwordx4 a[152:155], v2, s[8:11], s26 offen offset:3072 sc1
    s_waitcnt lgkmcnt(4)
    v_mfma_f32_16x16x32_bf16 v[168:171], a[164:167], a[96:99], v[168:171]
    ds_read_b64_tr_b16 a[160:161], v13 offset:8448
    v_mfma_f32_16x16x32_bf16 v[172:175], a[164:167], a[100:103], v[172:175]
    ds_read_b64_tr_b16 a[162:163], v13 offset:8960
    buffer_load_dwordx4 a[156:159], v3, s[8:11], s26 offen offset:3072 sc1
    s_add_u32 s26, s26, 4096
    s_waitcnt lgkmcnt(4)
    v_mfma_f32_16x16x32_bf16 v[176:179], a[168:171], a[96:99], v[176:179]
    ds_read_b64_tr_b16 a[164:165], v13 offset:8480
    v_mfma_f32_16x16x32_bf16 v[180:183], a[168:171], a[100:103], v[180:183]
    ds_read_b64_tr_b16 a[166:167], v13 offset:8992
    s_waitcnt lgkmcnt(4)
    v_mfma_f32_16x16x32_bf16 v[184:187], a[172:175], a[96:99], v[184:187]
    ds_read_b64_tr_b16 a[168:169], v13 offset:8512
    v_mfma_f32_16x16x32_bf16 v[188:191], a[172:175], a[100:103], v[188:191]
    ds_read_b64_tr_b16 a[170:171], v13 offset:9024
    s_add_u32 s25, s27, 983040
    s_add_u32 m0, s28, 71808
    s_nop 0
    buffer_load_dwordx4 v6, s[12:15], s25 offen offset:0 lds
    s_waitcnt vmcnt(26)
    s_waitcnt lgkmcnt(4)
    v_mfma_f32_16x16x32_bf16 v[128:131], a[160:163], a[104:107], v[128:131]
    ds_read_b64_tr_b16 a[172:173], v13 offset:8544
    v_mfma_f32_16x16x32_bf16 v[132:135], a[160:163], a[108:111], v[132:135]
    ds_read_b64_tr_b16 a[174:175], v13 offset:9056
    s_waitcnt lgkmcnt(4)
    v_mfma_f32_16x16x32_bf16 v[136:139], a[164:167], a[104:107], v[136:139]
    ds_read_b64_tr_b16 a[160:161], v13 offset:12672
    v_mfma_f32_16x16x32_bf16 v[140:143], a[164:167], a[108:111], v[140:143]
    ds_read_b64_tr_b16 a[162:163], v13 offset:13184
    buffer_load_dwordx4 v7, s[12:15], s25 offen offset:1056 lds
    s_waitcnt lgkmcnt(4)
    v_mfma_f32_16x16x32_bf16 v[144:147], a[168:171], a[104:107], v[144:147]
    ds_read_b64_tr_b16 a[164:165], v13 offset:12704
    v_mfma_f32_16x16x32_bf16 v[148:151], a[168:171], a[108:111], v[148:151]
    ds_read_b64_tr_b16 a[166:167], v13 offset:13216
    s_waitcnt lgkmcnt(4)
    v_mfma_f32_16x16x32_bf16 v[152:155], a[172:175], a[104:107], v[152:155]
    ds_read_b64_tr_b16 a[168:169], v13 offset:12736
    v_mfma_f32_16x16x32_bf16 v[156:159], a[172:175], a[108:111], v[156:159]
    ds_read_b64_tr_b16 a[170:171], v13 offset:13248
    s_add_u32 m0, s28, 67584
    s_nop 0
    buffer_load_dwordx4 v8, s[12:15], s25 offen offset:0 lds
    s_waitcnt lgkmcnt(4)
    v_mfma_f32_16x16x32_bf16 v[160:163], a[160:163], a[104:107], v[160:163]
    ds_read_b64_tr_b16 a[172:173], v13 offset:12768
    v_mfma_f32_16x16x32_bf16 v[164:167], a[160:163], a[108:111], v[164:167]
    ds_read_b64_tr_b16 a[174:175], v13 offset:13280
    buffer_load_dwordx4 v9, s[12:15], s25 offen offset:1056 lds
    s_waitcnt lgkmcnt(4)
    v_mfma_f32_16x16x32_bf16 v[168:171], a[164:167], a[104:107], v[168:171]
    s_waitcnt vmcnt(25)
    s_barrier
    ds_read_b64_tr_b16 a[160:161], v13 offset:16896
    v_mfma_f32_16x16x32_bf16 v[172:175], a[164:167], a[108:111], v[172:175]
    ds_read_b64_tr_b16 a[162:163], v13 offset:17408
    s_waitcnt lgkmcnt(4)
    v_mfma_f32_16x16x32_bf16 v[176:179], a[168:171], a[104:107], v[176:179]
    ds_read_b64_tr_b16 a[164:165], v13 offset:16928
    v_mfma_f32_16x16x32_bf16 v[180:183], a[168:171], a[108:111], v[180:183]
    ds_read_b64_tr_b16 a[166:167], v13 offset:17440
    buffer_load_dwordx4 a[0:3], v2, s[8:11], s26 offen offset:0 sc1
    s_waitcnt lgkmcnt(4)
    v_mfma_f32_16x16x32_bf16 v[184:187], a[172:175], a[104:107], v[184:187]
    ds_read_b64_tr_b16 a[168:169], v13 offset:16960
    v_mfma_f32_16x16x32_bf16 v[188:191], a[172:175], a[108:111], v[188:191]
    ds_read_b64_tr_b16 a[170:171], v13 offset:17472
    s_waitcnt vmcnt(23)
    s_waitcnt lgkmcnt(4)
    v_mfma_f32_16x16x32_bf16 v[128:131], a[160:163], a[112:115], v[128:131]
    ds_read_b64_tr_b16 a[172:173], v13 offset:16992
    v_mfma_f32_16x16x32_bf16 v[132:135], a[160:163], a[116:119], v[132:135]
    ds_read_b64_tr_b16 a[174:175], v13 offset:17504
    buffer_load_dwordx4 a[4:7], v3, s[8:11], s26 offen offset:0 sc1
    s_waitcnt lgkmcnt(4)
    v_mfma_f32_16x16x32_bf16 v[136:139], a[164:167], a[112:115], v[136:139]
    ds_read_b64_tr_b16 a[160:161], v13 offset:21120
    v_mfma_f32_16x16x32_bf16 v[140:143], a[164:167], a[116:119], v[140:143]
    ds_read_b64_tr_b16 a[162:163], v13 offset:21632
    s_waitcnt lgkmcnt(4)
    v_mfma_f32_16x16x32_bf16 v[144:147], a[168:171], a[112:115], v[144:147]
    ds_read_b64_tr_b16 a[164:165], v13 offset:21152
    v_mfma_f32_16x16x32_bf16 v[148:151], a[168:171], a[116:119], v[148:151]
    ds_read_b64_tr_b16 a[166:167], v13 offset:21664
    buffer_load_dwordx4 a[8:11], v2, s[8:11], s26 offen offset:1024 sc1
    s_waitcnt lgkmcnt(4)
    v_mfma_f32_16x16x32_bf16 v[152:155], a[172:175], a[112:115], v[152:155]
    ds_read_b64_tr_b16 a[168:169], v13 offset:21184
    v_mfma_f32_16x16x32_bf16 v[156:159], a[172:175], a[116:119], v[156:159]
    ds_read_b64_tr_b16 a[170:171], v13 offset:21696
    buffer_load_dwordx4 a[12:15], v3, s[8:11], s26 offen offset:1024 sc1
    s_waitcnt lgkmcnt(4)
    v_mfma_f32_16x16x32_bf16 v[160:163], a[160:163], a[112:115], v[160:163]
    ds_read_b64_tr_b16 a[172:173], v13 offset:21216
    v_mfma_f32_16x16x32_bf16 v[164:167], a[160:163], a[116:119], v[164:167]
    ds_read_b64_tr_b16 a[174:175], v13 offset:21728
    s_waitcnt lgkmcnt(4)
    v_mfma_f32_16x16x32_bf16 v[168:171], a[164:167], a[112:115], v[168:171]
    ds_read_b64_tr_b16 a[160:161], v13 offset:25344
    v_mfma_f32_16x16x32_bf16 v[172:175], a[164:167], a[116:119], v[172:175]
    ds_read_b64_tr_b16 a[162:163], v13 offset:25856
    s_add_u32 s25, s27, 1441792
    s_add_u32 m0, s28, 88704
    s_nop 0
    buffer_load_dwordx4 v6, s[12:15], s25 offen offset:0 lds
    s_waitcnt lgkmcnt(4)
    v_mfma_f32_16x16x32_bf16 v[176:179], a[168:171], a[112:115], v[176:179]
    ds_read_b64_tr_b16 a[164:165], v13 offset:25376
    v_mfma_f32_16x16x32_bf16 v[180:183], a[168:171], a[116:119], v[180:183]
    ds_read_b64_tr_b16 a[166:167], v13 offset:25888
    s_waitcnt lgkmcnt(4)
    v_mfma_f32_16x16x32_bf16 v[184:187], a[172:175], a[112:115], v[184:187]
    ds_read_b64_tr_b16 a[168:169], v13 offset:25408
    v_mfma_f32_16x16x32_bf16 v[188:191], a[172:175], a[116:119], v[188:191]
    ds_read_b64_tr_b16 a[170:171], v13 offset:25920
    buffer_load_dwordx4 v7, s[12:15], s25 offen offset:1056 lds
    s_waitcnt vmcnt(26)
    s_waitcnt lgkmcnt(4)
    v_mfma_f32_16x16x32_bf16 v[128:131], a[160:163], a[120:123], v[128:131]
    ds_read_b64_tr_b16 a[172:173], v13 offset:25440
    v_mfma_f32_16x16x32_bf16 v[132:135], a[160:163], a[124:127], v[132:135]
    ds_read_b64_tr_b16 a[174:175], v13 offset:25952
    s_waitcnt lgkmcnt(4)
    v_mfma_f32_16x16x32_bf16 v[136:139], a[164:167], a[120:123], v[136:139]
    ds_read_b64_tr_b16 a[160:161], v13 offset:29568
    v_mfma_f32_16x16x32_bf16 v[140:143], a[164:167], a[124:127], v[140:143]
    ds_read_b64_tr_b16 a[162:163], v13 offset:30080
    s_add_u32 m0, s28, 84480
    s_nop 0
    buffer_load_dwordx4 v8, s[12:15], s25 offen offset:0 lds
    s_waitcnt lgkmcnt(4)
    v_mfma_f32_16x16x32_bf16 v[144:147], a[168:171], a[120:123], v[144:147]
    ds_read_b64_tr_b16 a[164:165], v13 offset:29600
    v_mfma_f32_16x16x32_bf16 v[148:151], a[168:171], a[124:127], v[148:151]
    ds_read_b64_tr_b16 a[166:167], v13 offset:30112
    buffer_load_dwordx4 v9, s[12:15], s25 offen offset:1056 lds
    s_waitcnt lgkmcnt(4)
    v_mfma_f32_16x16x32_bf16 v[152:155], a[172:175], a[120:123], v[152:155]
    ds_read_b64_tr_b16 a[168:169], v13 offset:29632
    v_mfma_f32_16x16x32_bf16 v[156:159], a[172:175], a[124:127], v[156:159]
    ds_read_b64_tr_b16 a[170:171], v13 offset:30144
    s_waitcnt lgkmcnt(4)
    v_mfma_f32_16x16x32_bf16 v[160:163], a[160:163], a[120:123], v[160:163]
    ds_read_b64_tr_b16 a[172:173], v13 offset:29664
    v_mfma_f32_16x16x32_bf16 v[164:167], a[160:163], a[124:127], v[164:167]
    ds_read_b64_tr_b16 a[174:175], v13 offset:30176
    buffer_load_dwordx4 a[16:19], v2, s[8:11], s26 offen offset:2048 sc1
    s_waitcnt lgkmcnt(4)
    v_mfma_f32_16x16x32_bf16 v[168:171], a[164:167], a[120:123], v[168:171]
    s_waitcnt vmcnt(25)
    s_barrier
    ds_read_b64_tr_b16 a[160:161], v13 offset:33792
    v_mfma_f32_16x16x32_bf16 v[172:175], a[164:167], a[124:127], v[172:175]
    ds_read_b64_tr_b16 a[162:163], v13 offset:34304
    s_waitcnt lgkmcnt(4)
    v_mfma_f32_16x16x32_bf16 v[176:179], a[168:171], a[120:123], v[176:179]
    ds_read_b64_tr_b16 a[164:165], v13 offset:33824
    v_mfma_f32_16x16x32_bf16 v[180:183], a[168:171], a[124:127], v[180:183]
    ds_read_b64_tr_b16 a[166:167], v13 offset:34336
    buffer_load_dwordx4 a[20:23], v3, s[8:11], s26 offen offset:2048 sc1
    s_waitcnt lgkmcnt(4)
    v_mfma_f32_16x16x32_bf16 v[184:187], a[172:175], a[120:123], v[184:187]
    ds_read_b64_tr_b16 a[168:169], v13 offset:33856
    v_mfma_f32_16x16x32_bf16 v[188:191], a[172:175], a[124:127], v[188:191]
    ds_read_b64_tr_b16 a[170:171], v13 offset:34368
    s_waitcnt vmcnt(24)
    s_waitcnt lgkmcnt(4)
    v_mfma_f32_16x16x32_bf16 v[128:131], a[160:163], a[128:131], v[128:131]
    ds_read_b64_tr_b16 a[172:173], v13 offset:33888
    v_mfma_f32_16x16x32_bf16 v[132:135], a[160:163], a[132:135], v[132:135]
    ds_read_b64_tr_b16 a[174:175], v13 offset:34400
    buffer_load_dwordx4 a[24:27], v2, s[8:11], s26 offen offset:3072 sc1
    s_waitcnt lgkmcnt(4)
    v_mfma_f32_16x16x32_bf16 v[136:139], a[164:167], a[128:131], v[136:139]
    ds_read_b64_tr_b16 a[160:161], v13 offset:38016
    v_mfma_f32_16x16x32_bf16 v[140:143], a[164:167], a[132:135], v[140:143]
    ds_read_b64_tr_b16 a[162:163], v13 offset:38528
    buffer_load_dwordx4 a[28:31], v3, s[8:11], s26 offen offset:3072 sc1
    s_add_u32 s26, s26, 4096
    s_waitcnt lgkmcnt(4)
    v_mfma_f32_16x16x32_bf16 v[144:147], a[168:171], a[128:131], v[144:147]
    ds_read_b64_tr_b16 a[164:165], v13 offset:38048
    v_mfma_f32_16x16x32_bf16 v[148:151], a[168:171], a[132:135], v[148:151]
    ds_read_b64_tr_b16 a[166:167], v13 offset:38560
    s_waitcnt lgkmcnt(4)
    v_mfma_f32_16x16x32_bf16 v[152:155], a[172:175], a[128:131], v[152:155]
    ds_read_b64_tr_b16 a[168:169], v13 offset:38080
    v_mfma_f32_16x16x32_bf16 v[156:159], a[172:175], a[132:135], v[156:159]
    ds_read_b64_tr_b16 a[170:171], v13 offset:38592
    s_add_u32 s25, s27, 1900544
    s_add_u32 m0, s28, 105600
    s_nop 0
    buffer_load_dwordx4 v6, s[12:15], s25 offen offset:0 lds
    s_waitcnt lgkmcnt(4)
    v_mfma_f32_16x16x32_bf16 v[160:163], a[160:163], a[128:131], v[160:163]
    ds_read_b64_tr_b16 a[172:173], v13 offset:38112
    v_mfma_f32_16x16x32_bf16 v[164:167], a[160:163], a[132:135], v[164:167]
    ds_read_b64_tr_b16 a[174:175], v13 offset:38624
    s_waitcnt lgkmcnt(4)
    v_mfma_f32_16x16x32_bf16 v[168:171], a[164:167], a[128:131], v[168:171]
    ds_read_b64_tr_b16 a[160:161], v13 offset:42240
    v_mfma_f32_16x16x32_bf16 v[172:175], a[164:167], a[132:135], v[172:175]
    ds_read_b64_tr_b16 a[162:163], v13 offset:42752
    buffer_load_dwordx4 v7, s[12:15], s25 offen offset:1056 lds
    s_waitcnt lgkmcnt(4)
    v_mfma_f32_16x16x32_bf16 v[176:179], a[168:171], a[128:131], v[176:179]
    ds_read_b64_tr_b16 a[164:165], v13 offset:42272
    v_mfma_f32_16x16x32_bf16 v[180:183], a[168:171], a[132:135], v[180:183]
    ds_read_b64_tr_b16 a[166:167], v13 offset:42784
    s_waitcnt lgkmcnt(4)
    v_mfma_f32_16x16x32_bf16 v[184:187], a[172:175], a[128:131], v[184:187]
    ds_read_b64_tr_b16 a[168:169], v13 offset:42304
    v_mfma_f32_16x16x32_bf16 v[188:191], a[172:175], a[132:135], v[188:191]
    ds_read_b64_tr_b16 a[170:171], v13 offset:42816
    s_add_u32 m0, s28, 101376
    s_nop 0
    buffer_load_dwordx4 v8, s[12:15], s25 offen offset:0 lds
    s_waitcnt vmcnt(27)
    s_waitcnt lgkmcnt(4)
    v_mfma_f32_16x16x32_bf16 v[128:131], a[160:163], a[136:139], v[128:131]
    ds_read_b64_tr_b16 a[172:173], v13 offset:42336
    v_mfma_f32_16x16x32_bf16 v[132:135], a[160:163], a[140:143], v[132:135]
    ds_read_b64_tr_b16 a[174:175], v13 offset:42848
    buffer_load_dwordx4 v9, s[12:15], s25 offen offset:1056 lds
    s_waitcnt lgkmcnt(4)
    v_mfma_f32_16x16x32_bf16 v[136:139], a[164:167], a[136:139], v[136:139]
    ds_read_b64_tr_b16 a[160:161], v13 offset:46464
    v_mfma_f32_16x16x32_bf16 v[140:143], a[164:167], a[140:143], v[140:143]
    ds_read_b64_tr_b16 a[162:163], v13 offset:46976
    s_waitcnt lgkmcnt(4)
    v_mfma_f32_16x16x32_bf16 v[144:147], a[168:171], a[136:139], v[144:147]
    ds_read_b64_tr_b16 a[164:165], v13 offset:46496
    v_mfma_f32_16x16x32_bf16 v[148:151], a[168:171], a[140:143], v[148:151]
    ds_read_b64_tr_b16 a[166:167], v13 offset:47008
    buffer_load_dwordx4 a[32:35], v2, s[8:11], s26 offen offset:0 sc1
    s_waitcnt lgkmcnt(4)
    v_mfma_f32_16x16x32_bf16 v[152:155], a[172:175], a[136:139], v[152:155]
    ds_read_b64_tr_b16 a[168:169], v13 offset:46528
    v_mfma_f32_16x16x32_bf16 v[156:159], a[172:175], a[140:143], v[156:159]
    ds_read_b64_tr_b16 a[170:171], v13 offset:47040
    s_waitcnt lgkmcnt(4)
    v_mfma_f32_16x16x32_bf16 v[160:163], a[160:163], a[136:139], v[160:163]
    ds_read_b64_tr_b16 a[172:173], v13 offset:46560
    v_mfma_f32_16x16x32_bf16 v[164:167], a[160:163], a[140:143], v[164:167]
    ds_read_b64_tr_b16 a[174:175], v13 offset:47072
    buffer_load_dwordx4 a[36:39], v3, s[8:11], s26 offen offset:0 sc1
    s_waitcnt lgkmcnt(4)
    v_mfma_f32_16x16x32_bf16 v[168:171], a[164:167], a[136:139], v[168:171]
    s_waitcnt vmcnt(26)
    s_barrier
    ds_read_b64_tr_b16 a[160:161], v14 offset:0
    v_mfma_f32_16x16x32_bf16 v[172:175], a[164:167], a[140:143], v[172:175]
    ds_read_b64_tr_b16 a[162:163], v14 offset:512
    s_waitcnt lgkmcnt(4)
    v_mfma_f32_16x16x32_bf16 v[176:179], a[168:171], a[136:139], v[176:179]
    ds_read_b64_tr_b16 a[164:165], v14 offset:32
    v_mfma_f32_16x16x32_bf16 v[180:183], a[168:171], a[140:143], v[180:183]
    ds_read_b64_tr_b16 a[166:167], v14 offset:544
    buffer_load_dwordx4 a[40:43], v2, s[8:11], s26 offen offset:1024 sc1
    s_waitcnt lgkmcnt(4)
    v_mfma_f32_16x16x32_bf16 v[184:187], a[172:175], a[136:139], v[184:187]
    ds_read_b64_tr_b16 a[168:169], v14 offset:64
    v_mfma_f32_16x16x32_bf16 v[188:191], a[172:175], a[140:143], v[188:191]
    ds_read_b64_tr_b16 a[170:171], v14 offset:576
    buffer_load_dwordx4 a[44:47], v3, s[8:11], s26 offen offset:1024 sc1
    s_waitcnt vmcnt(26)
    s_waitcnt lgkmcnt(4)
    v_mfma_f32_16x16x32_bf16 v[128:131], a[160:163], a[144:147], v[128:131]
    ds_read_b64_tr_b16 a[172:173], v14 offset:96
    v_mfma_f32_16x16x32_bf16 v[132:135], a[160:163], a[148:151], v[132:135]
    ds_read_b64_tr_b16 a[174:175], v14 offset:608
    s_waitcnt lgkmcnt(4)
    v_mfma_f32_16x16x32_bf16 v[136:139], a[164:167], a[144:147], v[136:139]
    ds_read_b64_tr_b16 a[160:161], v14 offset:4224
    v_mfma_f32_16x16x32_bf16 v[140:143], a[164:167], a[148:151], v[140:143]
    ds_read_b64_tr_b16 a[162:163], v14 offset:4736
    s_add_u32 s25, s27, 2359296
    s_add_u32 m0, s28, 122496
    s_nop 0
    buffer_load_dwordx4 v6, s[12:15], s25 offen offset:0 lds
    s_waitcnt lgkmcnt(4)
    v_mfma_f32_16x16x32_bf16 v[144:147], a[168:171], a[144:147], v[144:147]
    ds_read_b64_tr_b16 a[164:165], v14 offset:4256
    v_mfma_f32_16x16x32_bf16 v[148:151], a[168:171], a[148:151], v[148:151]
    ds_read_b64_tr_b16 a[166:167], v14 offset:4768
    s_waitcnt lgkmcnt(4)
    v_mfma_f32_16x16x32_bf16 v[152:155], a[172:175], a[144:147], v[152:155]
    ds_read_b64_tr_b16 a[168:169], v14 offset:4288
    v_mfma_f32_16x16x32_bf16 v[156:159], a[172:175], a[148:151], v[156:159]
    ds_read_b64_tr_b16 a[170:171], v14 offset:4800
    buffer_load_dwordx4 v7, s[12:15], s25 offen offset:1056 lds
    s_waitcnt lgkmcnt(4)
    v_mfma_f32_16x16x32_bf16 v[160:163], a[160:163], a[144:147], v[160:163]
    ds_read_b64_tr_b16 a[172:173], v14 offset:4320
    v_mfma_f32_16x16x32_bf16 v[164:167], a[160:163], a[148:151], v[164:167]
    ds_read_b64_tr_b16 a[174:175], v14 offset:4832
    s_waitcnt lgkmcnt(4)
    v_mfma_f32_16x16x32_bf16 v[168:171], a[164:167], a[144:147], v[168:171]
    ds_read_b64_tr_b16 a[160:161], v14 offset:8448
    v_mfma_f32_16x16x32_bf16 v[172:175], a[164:167], a[148:151], v[172:175]
    ds_read_b64_tr_b16 a[162:163], v14 offset:8960
    s_add_u32 m0, s28, 118272
    s_nop 0
    buffer_load_dwordx4 v8, s[12:15], s25 offen offset:0 lds
    s_waitcnt lgkmcnt(4)
    v_mfma_f32_16x16x32_bf16 v[176:179], a[168:171], a[144:147], v[176:179]
    ds_read_b64_tr_b16 a[164:165], v14 offset:8480
    v_mfma_f32_16x16x32_bf16 v[180:183], a[168:171], a[148:151], v[180:183]
    ds_read_b64_tr_b16 a[166:167], v14 offset:8992
    buffer_load_dwordx4 v9, s[12:15], s25 offen offset:1056 lds
    s_waitcnt lgkmcnt(4)
    v_mfma_f32_16x16x32_bf16 v[184:187], a[172:175], a[144:147], v[184:187]
    ds_read_b64_tr_b16 a[168:169], v14 offset:8512
    v_mfma_f32_16x16x32_bf16 v[188:191], a[172:175], a[148:151], v[188:191]
    ds_read_b64_tr_b16 a[170:171], v14 offset:9024
    s_waitcnt vmcnt(28)
    s_waitcnt lgkmcnt(4)
    v_mfma_f32_16x16x32_bf16 v[128:131], a[160:163], a[152:155], v[128:131]
    ds_read_b64_tr_b16 a[172:173], v14 offset:8544
    v_mfma_f32_16x16x32_bf16 v[132:135], a[160:163], a[156:159], v[132:135]
    ds_read_b64_tr_b16 a[174:175], v14 offset:9056
    buffer_load_dwordx4 a[48:51], v2, s[8:11], s26 offen offset:2048 sc1
    s_waitcnt lgkmcnt(4)
    v_mfma_f32_16x16x32_bf16 v[136:139], a[164:167], a[152:155], v[136:139]
    ds_read_b64_tr_b16 a[160:161], v14 offset:12672
    v_mfma_f32_16x16x32_bf16 v[140:143], a[164:167], a[156:159], v[140:143]
    ds_read_b64_tr_b16 a[162:163], v14 offset:13184
    s_waitcnt lgkmcnt(4)
    v_mfma_f32_16x16x32_bf16 v[144:147], a[168:171], a[152:155], v[144:147]
    ds_read_b64_tr_b16 a[164:165], v14 offset:12704
    v_mfma_f32_16x16x32_bf16 v[148:151], a[168:171], a[156:159], v[148:151]
    ds_read_b64_tr_b16 a[166:167], v14 offset:13216
    buffer_load_dwordx4 a[52:55], v3, s[8:11], s26 offen offset:2048 sc1
    s_waitcnt lgkmcnt(4)
    v_mfma_f32_16x16x32_bf16 v[152:155], a[172:175], a[152:155], v[152:155]
    ds_read_b64_tr_b16 a[168:169], v14 offset:12736
    v_mfma_f32_16x16x32_bf16 v[156:159], a[172:175], a[156:159], v[156:159]
    ds_read_b64_tr_b16 a[170:171], v14 offset:13248
    s_waitcnt lgkmcnt(4)
    v_mfma_f32_16x16x32_bf16 v[160:163], a[160:163], a[152:155], v[160:163]
    ds_read_b64_tr_b16 a[172:173], v14 offset:12768
    v_mfma_f32_16x16x32_bf16 v[164:167], a[160:163], a[156:159], v[164:167]
    ds_read_b64_tr_b16 a[174:175], v14 offset:13280
    buffer_load_dwordx4 a[56:59], v2, s[8:11], s26 offen offset:3072 sc1
    s_waitcnt lgkmcnt(4)
    v_mfma_f32_16x16x32_bf16 v[168:171], a[164:167], a[152:155], v[168:171]
    s_waitcnt vmcnt(27)
    s_barrier
    ds_read_b64_tr_b16 a[160:161], v14 offset:16896
    v_mfma_f32_16x16x32_bf16 v[172:175], a[164:167], a[156:159], v[172:175]
    ds_read_b64_tr_b16 a[162:163], v14 offset:17408
    buffer_load_dwordx4 a[60:63], v3, s[8:11], s26 offen offset:3072 sc1
    s_add_u32 s26, s26, 4096
    s_waitcnt lgkmcnt(4)
    v_mfma_f32_16x16x32_bf16 v[176:179], a[168:171], a[152:155], v[176:179]
    ds_read_b64_tr_b16 a[164:165], v14 offset:16928
    v_mfma_f32_16x16x32_bf16 v[180:183], a[168:171], a[156:159], v[180:183]
    ds_read_b64_tr_b16 a[166:167], v14 offset:17440
    s_waitcnt lgkmcnt(4)
    v_mfma_f32_16x16x32_bf16 v[184:187], a[172:175], a[152:155], v[184:187]
    ds_read_b64_tr_b16 a[168:169], v14 offset:16960
    v_mfma_f32_16x16x32_bf16 v[188:191], a[172:175], a[156:159], v[188:191]
    ds_read_b64_tr_b16 a[170:171], v14 offset:17472
    s_add_u32 s25, s27, 2818048
    s_add_u32 m0, s28, 4224
    s_nop 0
    buffer_load_dwordx4 v6, s[12:15], s25 offen offset:0 lds
    s_waitcnt vmcnt(27)
    s_waitcnt lgkmcnt(4)
    v_mfma_f32_16x16x32_bf16 v[128:131], a[160:163], a[0:3], v[128:131]
    ds_read_b64_tr_b16 a[172:173], v14 offset:16992
    v_mfma_f32_16x16x32_bf16 v[132:135], a[160:163], a[4:7], v[132:135]
    ds_read_b64_tr_b16 a[174:175], v14 offset:17504
    s_waitcnt lgkmcnt(4)
    v_mfma_f32_16x16x32_bf16 v[136:139], a[164:167], a[0:3], v[136:139]
    ds_read_b64_tr_b16 a[160:161], v14 offset:21120
    v_mfma_f32_16x16x32_bf16 v[140:143], a[164:167], a[4:7], v[140:143]
    ds_read_b64_tr_b16 a[162:163], v14 offset:21632
    buffer_load_dwordx4 v7, s[12:15], s25 offen offset:1056 lds
    s_waitcnt lgkmcnt(4)
    v_mfma_f32_16x16x32_bf16 v[144:147], a[168:171], a[0:3], v[144:147]
    ds_read_b64_tr_b16 a[164:165], v14 offset:21152
    v_mfma_f32_16x16x32_bf16 v[148:151], a[168:171], a[4:7], v[148:151]
    ds_read_b64_tr_b16 a[166:167], v14 offset:21664
    s_waitcnt lgkmcnt(4)
    v_mfma_f32_16x16x32_bf16 v[152:155], a[172:175], a[0:3], v[152:155]
    ds_read_b64_tr_b16 a[168:169], v14 offset:21184
    v_mfma_f32_16x16x32_bf16 v[156:159], a[172:175], a[4:7], v[156:159]
    ds_read_b64_tr_b16 a[170:171], v14 offset:21696
    s_add_u32 m0, s28, 0
    s_nop 0
    buffer_load_dwordx4 v8, s[12:15], s25 offen offset:0 lds
    s_waitcnt lgkmcnt(4)
    v_mfma_f32_16x16x32_bf16 v[160:163], a[160:163], a[0:3], v[160:163]
    ds_read_b64_tr_b16 a[172:173], v14 offset:21216
    v_mfma_f32_16x16x32_bf16 v[164:167], a[160:163], a[4:7], v[164:167]
    ds_read_b64_tr_b16 a[174:175], v14 offset:21728
    buffer_load_dwordx4 v9, s[12:15], s25 offen offset:1056 lds
    s_waitcnt lgkmcnt(4)
    v_mfma_f32_16x16x32_bf16 v[168:171], a[164:167], a[0:3], v[168:171]
    ds_read_b64_tr_b16 a[160:161], v14 offset:25344
    v_mfma_f32_16x16x32_bf16 v[172:175], a[164:167], a[4:7], v[172:175]
    ds_read_b64_tr_b16 a[162:163], v14 offset:25856
    s_waitcnt lgkmcnt(4)
    v_mfma_f32_16x16x32_bf16 v[176:179], a[168:171], a[0:3], v[176:179]
    ds_read_b64_tr_b16 a[164:165], v14 offset:25376
    v_mfma_f32_16x16x32_bf16 v[180:183], a[168:171], a[4:7], v[180:183]
    ds_read_b64_tr_b16 a[166:167], v14 offset:25888
    buffer_load_dwordx4 a[64:67], v2, s[8:11], s26 offen offset:0 sc1
    s_waitcnt lgkmcnt(4)
    v_mfma_f32_16x16x32_bf16 v[184:187], a[172:175], a[0:3], v[184:187]
    ds_read_b64_tr_b16 a[168:169], v14 offset:25408
    v_mfma_f32_16x16x32_bf16 v[188:191], a[172:175], a[4:7], v[188:191]
    ds_read_b64_tr_b16 a[170:171], v14 offset:25920
    s_waitcnt vmcnt(29)
    s_waitcnt lgkmcnt(4)
    v_mfma_f32_16x16x32_bf16 v[128:131], a[160:163], a[8:11], v[128:131]
    ds_read_b64_tr_b16 a[172:173], v14 offset:25440
    v_mfma_f32_16x16x32_bf16 v[132:135], a[160:163], a[12:15], v[132:135]
    ds_read_b64_tr_b16 a[174:175], v14 offset:25952
    buffer_load_dwordx4 a[68:71], v3, s[8:11], s26 offen offset:0 sc1
    s_waitcnt lgkmcnt(4)
    v_mfma_f32_16x16x32_bf16 v[136:139], a[164:167], a[8:11], v[136:139]
    ds_read_b64_tr_b16 a[160:161], v14 offset:29568
    v_mfma_f32_16x16x32_bf16 v[140:143], a[164:167], a[12:15], v[140:143]
    ds_read_b64_tr_b16 a[162:163], v14 offset:30080
    s_waitcnt lgkmcnt(4)
    v_mfma_f32_16x16x32_bf16 v[144:147], a[168:171], a[8:11], v[144:147]
    ds_read_b64_tr_b16 a[164:165], v14 offset:29600
    v_mfma_f32_16x16x32_bf16 v[148:151], a[168:171], a[12:15], v[148:151]
    ds_read_b64_tr_b16 a[166:167], v14 offset:30112
    buffer_load_dwordx4 a[72:75], v2, s[8:11], s26 offen offset:1024 sc1
    s_waitcnt lgkmcnt(4)
    v_mfma_f32_16x16x32_bf16 v[152:155], a[172:175], a[8:11], v[152:155]
    ds_read_b64_tr_b16 a[168:169], v14 offset:29632
    v_mfma_f32_16x16x32_bf16 v[156:159], a[172:175], a[12:15], v[156:159]
    ds_read_b64_tr_b16 a[170:171], v14 offset:30144
    buffer_load_dwordx4 a[76:79], v3, s[8:11], s26 offen offset:1024 sc1
    s_waitcnt lgkmcnt(4)
    v_mfma_f32_16x16x32_bf16 v[160:163], a[160:163], a[8:11], v[160:163]
    ds_read_b64_tr_b16 a[172:173], v14 offset:29664
    v_mfma_f32_16x16x32_bf16 v[164:167], a[160:163], a[12:15], v[164:167]
    ds_read_b64_tr_b16 a[174:175], v14 offset:30176
    s_waitcnt lgkmcnt(4)
    v_mfma_f32_16x16x32_bf16 v[168:171], a[164:167], a[8:11], v[168:171]
    s_waitcnt vmcnt(28)
    s_barrier
    ds_read_b64_tr_b16 a[160:161], v14 offset:33792
    v_mfma_f32_16x16x32_bf16 v[172:175], a[164:167], a[12:15], v[172:175]
    ds_read_b64_tr_b16 a[162:163], v14 offset:34304
    s_add_u32 s25, s27, 3276800
    s_add_u32 m0, s28, 21120
    s_nop 0
    buffer_load_dwordx4 v6, s[12:15], s25 offen offset:0 lds
    s_waitcnt lgkmcnt(4)
    v_mfma_f32_16x16x32_bf16 v[176:179], a[168:171], a[8:11], v[176:179]
    ds_read_b64_tr_b16 a[164:165], v14 offset:33824
    v_mfma_f32_16x16x32_bf16 v[180:183], a[168:171], a[12:15], v[180:183]
    ds_read_b64_tr_b16 a[166:167], v14 offset:34336
    s_waitcnt lgkmcnt(4)
    v_mfma_f32_16x16x32_bf16 v[184:187], a[172:175], a[8:11], v[184:187]
    ds_read_b64_tr_b16 a[168:169], v14 offset:33856
    v_mfma_f32_16x16x32_bf16 v[188:191], a[172:175], a[12:15], v[188:191]
    ds_read_b64_tr_b16 a[170:171], v14 offset:34368
    buffer_load_dwordx4 v7, s[12:15], s25 offen offset:1056 lds
    s_waitcnt vmcnt(28)
    s_waitcnt lgkmcnt(4)
    v_mfma_f32_16x16x32_bf16 v[128:131], a[160:163], a[16:19], v[128:131]
    ds_read_b64_tr_b16 a[172:173], v14 offset:33888
    v_mfma_f32_16x16x32_bf16 v[132:135], a[160:163], a[20:23], v[132:135]
    ds_read_b64_tr_b16 a[174:175], v14 offset:34400
    s_waitcnt lgkmcnt(4)
    v_mfma_f32_16x16x32_bf16 v[136:139], a[164:167], a[16:19], v[136:139]
    ds_read_b64_tr_b16 a[160:161], v14 offset:38016
    v_mfma_f32_16x16x32_bf16 v[140:143], a[164:167], a[20:23], v[140:143]
    ds_read_b64_tr_b16 a[162:163], v14 offset:38528
    s_add_u32 m0, s28, 16896
    s_nop 0
    buffer_load_dwordx4 v8, s[12:15], s25 offen offset:0 lds
    s_waitcnt lgkmcnt(4)
    v_mfma_f32_16x16x32_bf16 v[144:147], a[168:171], a[16:19], v[144:147]
    ds_read_b64_tr_b16 a[164:165], v14 offset:38048
    v_mfma_f32_16x16x32_bf16 v[148:151], a[168:171], a[20:23], v[148:151]
    ds_read_b64_tr_b16 a[166:167], v14 offset:38560
    buffer_load_dwordx4 v9, s[12:15], s25 offen offset:1056 lds
    s_waitcnt lgkmcnt(4)
    v_mfma_f32_16x16x32_bf16 v[152:155], a[172:175], a[16:19], v[152:155]
    ds_read_b64_tr_b16 a[168:169], v14 offset:38080
    v_mfma_f32_16x16x32_bf16 v[156:159], a[172:175], a[20:23], v[156:159]
    ds_read_b64_tr_b16 a[170:171], v14 offset:38592
    buffer_load_dword v12, v10, s[4:7], 0 offen sc1
    s_waitcnt lgkmcnt(4)
    v_mfma_f32_16x16x32_bf16 v[160:163], a[160:163], a[16:19], v[160:163]
    ds_read_b64_tr_b16 a[172:173], v14 offset:38112
    v_mfma_f32_16x16x32_bf16 v[164:167], a[160:163], a[20:23], v[164:167]
    ds_read_b64_tr_b16 a[174:175], v14 offset:38624
    buffer_load_dwordx4 a[80:83], v2, s[8:11], s26 offen offset:2048 sc1
    s_waitcnt lgkmcnt(4)
    v_mfma_f32_16x16x32_bf16 v[168:171], a[164:167], a[16:19], v[168:171]
    ds_read_b64_tr_b16 a[160:161], v14 offset:42240
    v_mfma_f32_16x16x32_bf16 v[172:175], a[164:167], a[20:23], v[172:175]
    ds_read_b64_tr_b16 a[162:163], v14 offset:42752
    s_waitcnt lgkmcnt(4)
    v_mfma_f32_16x16x32_bf16 v[176:179], a[168:171], a[16:19], v[176:179]
    ds_read_b64_tr_b16 a[164:165], v14 offset:42272
    v_mfma_f32_16x16x32_bf16 v[180:183], a[168:171], a[20:23], v[180:183]
    ds_read_b64_tr_b16 a[166:167], v14 offset:42784
    buffer_load_dwordx4 a[84:87], v3, s[8:11], s26 offen offset:2048 sc1
    s_waitcnt lgkmcnt(4)
    v_mfma_f32_16x16x32_bf16 v[184:187], a[172:175], a[16:19], v[184:187]
    ds_read_b64_tr_b16 a[168:169], v14 offset:42304
    v_mfma_f32_16x16x32_bf16 v[188:191], a[172:175], a[20:23], v[188:191]
    ds_read_b64_tr_b16 a[170:171], v14 offset:42816
    s_waitcnt vmcnt(31)
    s_waitcnt lgkmcnt(4)
    v_mfma_f32_16x16x32_bf16 v[128:131], a[160:163], a[24:27], v[128:131]
    ds_read_b64_tr_b16 a[172:173], v14 offset:42336
    v_mfma_f32_16x16x32_bf16 v[132:135], a[160:163], a[28:31], v[132:135]
    ds_read_b64_tr_b16 a[174:175], v14 offset:42848
    buffer_load_dwordx4 a[88:91], v2, s[8:11], s26 offen offset:3072 sc1
    s_waitcnt lgkmcnt(4)
    v_mfma_f32_16x16x32_bf16 v[136:139], a[164:167], a[24:27], v[136:139]
    ds_read_b64_tr_b16 a[160:161], v14 offset:46464
    v_mfma_f32_16x16x32_bf16 v[140:143], a[164:167], a[28:31], v[140:143]
    ds_read_b64_tr_b16 a[162:163], v14 offset:46976
    buffer_load_dwordx4 a[92:95], v3, s[8:11], s26 offen offset:3072 sc1
    s_add_u32 s26, s26, 4096
    s_waitcnt lgkmcnt(4)
    v_mfma_f32_16x16x32_bf16 v[144:147], a[168:171], a[24:27], v[144:147]
    ds_read_b64_tr_b16 a[164:165], v14 offset:46496
    v_mfma_f32_16x16x32_bf16 v[148:151], a[168:171], a[28:31], v[148:151]
    ds_read_b64_tr_b16 a[166:167], v14 offset:47008
    s_waitcnt lgkmcnt(4)
    v_mfma_f32_16x16x32_bf16 v[152:155], a[172:175], a[24:27], v[152:155]
    ds_read_b64_tr_b16 a[168:169], v14 offset:46528
    v_mfma_f32_16x16x32_bf16 v[156:159], a[172:175], a[28:31], v[156:159]
    ds_read_b64_tr_b16 a[170:171], v14 offset:47040
    s_add_u32 s25, s27, 131072
    s_add_u32 m0, s28, 38016
    s_nop 0
    buffer_load_dwordx4 v6, s[12:15], s25 offen offset:0 lds
    s_waitcnt lgkmcnt(4)
    v_mfma_f32_16x16x32_bf16 v[160:163], a[160:163], a[24:27], v[160:163]
    ds_read_b64_tr_b16 a[172:173], v14 offset:46560
    v_mfma_f32_16x16x32_bf16 v[164:167], a[160:163], a[28:31], v[164:167]
    ds_read_b64_tr_b16 a[174:175], v14 offset:47072
    s_waitcnt lgkmcnt(4)
    v_mfma_f32_16x16x32_bf16 v[168:171], a[164:167], a[24:27], v[168:171]
    s_waitcnt vmcnt(30)
    s_barrier
    ds_read_b64_tr_b16 a[160:161], v15 offset:0
    v_mfma_f32_16x16x32_bf16 v[172:175], a[164:167], a[28:31], v[172:175]
    ds_read_b64_tr_b16 a[162:163], v15 offset:512
    buffer_load_dwordx4 v7, s[12:15], s25 offen offset:1056 lds
    s_waitcnt lgkmcnt(4)
    v_mfma_f32_16x16x32_bf16 v[176:179], a[168:171], a[24:27], v[176:179]
    ds_read_b64_tr_b16 a[164:165], v15 offset:32
    v_mfma_f32_16x16x32_bf16 v[180:183], a[168:171], a[28:31], v[180:183]
    ds_read_b64_tr_b16 a[166:167], v15 offset:544
    s_waitcnt lgkmcnt(4)
    v_mfma_f32_16x16x32_bf16 v[184:187], a[172:175], a[24:27], v[184:187]
    ds_read_b64_tr_b16 a[168:169], v15 offset:64
    v_mfma_f32_16x16x32_bf16 v[188:191], a[172:175], a[28:31], v[188:191]
    ds_read_b64_tr_b16 a[170:171], v15 offset:576
    s_add_u32 m0, s28, 33792
    s_nop 0
    buffer_load_dwordx4 v8, s[12:15], s25 offen offset:0 lds
    s_waitcnt vmcnt(30)
    s_waitcnt lgkmcnt(4)
    v_mfma_f32_16x16x32_bf16 v[128:131], a[160:163], a[32:35], v[128:131]
    ds_read_b64_tr_b16 a[172:173], v15 offset:96
    v_mfma_f32_16x16x32_bf16 v[132:135], a[160:163], a[36:39], v[132:135]
    ds_read_b64_tr_b16 a[174:175], v15 offset:608
    buffer_load_dwordx4 v9, s[12:15], s25 offen offset:1056 lds
    s_waitcnt lgkmcnt(4)
    v_mfma_f32_16x16x32_bf16 v[136:139], a[164:167], a[32:35], v[136:139]
    ds_read_b64_tr_b16 a[160:161], v15 offset:4224
    v_mfma_f32_16x16x32_bf16 v[140:143], a[164:167], a[36:39], v[140:143]
    ds_read_b64_tr_b16 a[162:163], v15 offset:4736
    s_waitcnt lgkmcnt(4)
    v_mfma_f32_16x16x32_bf16 v[144:147], a[168:171], a[32:35], v[144:147]
    ds_read_b64_tr_b16 a[164:165], v15 offset:4256
    v_mfma_f32_16x16x32_bf16 v[148:151], a[168:171], a[36:39], v[148:151]
    ds_read_b64_tr_b16 a[166:167], v15 offset:4768
    s_waitcnt vmcnt(8)
    v_cmp_gt_u32 vcc, 3, v12
    s_nop 1
    s_cbranch_vccnz g34_slow2
g34_cont2:
    s_nop 0
    buffer_load_dwordx4 a[96:99], v2, s[8:11], s26 offen offset:0 sc1
    s_waitcnt lgkmcnt(4)
    v_mfma_f32_16x16x32_bf16 v[152:155], a[172:175], a[32:35], v[152:155]
    ds_read_b64_tr_b16 a[168:169], v15 offset:4288
    v_mfma_f32_16x16x32_bf16 v[156:159], a[172:175], a[36:39], v[156:159]
    ds_read_b64_tr_b16 a[170:171], v15 offset:4800
    s_waitcnt lgkmcnt(4)
    v_mfma_f32_16x16x32_bf16 v[160:163], a[160:163], a[32:35], v[160:163]
    ds_read_b64_tr_b16 a[172:173], v15 offset:4320
    v_mfma_f32_16x16x32_bf16 v[164:167], a[160:163], a[36:39], v[164:167]
    ds_read_b64_tr_b16 a[174:175], v15 offset:4832
    buffer_load_dwordx4 a[100:103], v3, s[8:11], s26 offen offset:0 sc1
    s_waitcnt lgkmcnt(4)
    v_mfma_f32_16x16x32_bf16 v[168:171], a[164:167], a[32:35], v[168:171]
    ds_read_b64_tr_b16 a[160:161], v15 offset:8448
    v_mfma_f32_16x16x32_bf16 v[172:175], a[164:167], a[36:39], v[172:175]
    ds_read_b64_tr_b16 a[162:163], v15 offset:8960
    s_waitcnt lgkmcnt(4)
    v_mfma_f32_16x16x32_bf16 v[176:179], a[168:171], a[32:35], v[176:179]
    ds_read_b64_tr_b16 a[164:165], v15 offset:8480
    v_mfma_f32_16x16x32_bf16 v[180:183], a[168:171], a[36:39], v[180:183]
    ds_read_b64_tr_b16 a[166:167], v15 offset:8992
    buffer_load_dwordx4 a[104:107], v2, s[8:11], s26 offen offset:1024 sc1
    s_waitcnt lgkmcnt(4)
    v_mfma_f32_16x16x32_bf16 v[184:187], a[172:175], a[32:35], v[184:187]
    ds_read_b64_tr_b16 a[168:169], v15 offset:8512
    v_mfma_f32_16x16x32_bf16 v[188:191], a[172:175], a[36:39], v[188:191]
    ds_read_b64_tr_b16 a[170:171], v15 offset:9024
    s_waitcnt vmcnt(32)
    s_waitcnt lgkmcnt(4)
    v_mfma_f32_16x16x32_bf16 v[128:131], a[160:163], a[40:43], v[128:131]
    ds_read_b64_tr_b16 a[172:173], v15 offset:8544
    v_mfma_f32_16x16x32_bf16 v[132:135], a[160:163], a[44:47], v[132:135]
    ds_read_b64_tr_b16 a[174:175], v15 offset:9056
    buffer_load_dwordx4 a[108:111], v3, s[8:11], s26 offen offset:1024 sc1
    s_waitcnt lgkmcnt(4)
    v_mfma_f32_16x16x32_bf16 v[136:139], a[164:167], a[40:43], v[136:139]
    ds_read_b64_tr_b16 a[160:161], v15 offset:12672
    v_mfma_f32_16x16x32_bf16 v[140:143], a[164:167], a[44:47], v[140:143]
    ds_read_b64_tr_b16 a[162:163], v15 offset:13184
    s_add_u32 s25, s27, 589824
    s_add_u32 m0, s28, 54912
    s_nop 0
    buffer_load_dwordx4 v6, s[12:15], s25 offen offset:0 lds
    s_waitcnt lgkmcnt(4)
    v_mfma_f32_16x16x32_bf16 v[144:147], a[168:171], a[40:43], v[144:147]
    ds_read_b64_tr_b16 a[164:165], v15 offset:12704
    v_mfma_f32_16x16x32_bf16 v[148:151], a[168:171], a[44:47], v[148:151]
    ds_read_b64_tr_b16 a[166:167], v15 offset:13216
    s_waitcnt lgkmcnt(4)
    v_mfma_f32_16x16x32_bf16 v[152:155], a[172:175], a[40:43], v[152:155]
    ds_read_b64_tr_b16 a[168:169], v15 offset:12736
    v_mfma_f32_16x16x32_bf16 v[156:159], a[172:175], a[44:47], v[156:159]
    ds_read_b64_tr_b16 a[170:171], v15 offset:13248
    buffer_load_dwordx4 v7, s[12:15], s25 offen offset:1056 lds
    s_waitcnt lgkmcnt(4)
    v_mfma_f32_16x16x32_bf16 v[160:163], a[160:163], a[40:43], v[160:163]
    ds_read_b64_tr_b16 a[172:173], v15 offset:12768
    v_mfma_f32_16x16x32_bf16 v[164:167], a[160:163], a[44:47], v[164:167]
    ds_read_b64_tr_b16 a[174:175], v15 offset:13280
    s_waitcnt lgkmcnt(4)
    v_mfma_f32_16x16x32_bf16 v[168:171], a[164:167], a[40:43], v[168:171]
    s_waitcnt vmcnt(31)
    s_barrier
    ds_read_b64_tr_b16 a[160:161], v15 offset:16896
    v_mfma_f32_16x16x32_bf16 v[172:175], a[164:167], a[44:47], v[172:175]
    ds_read_b64_tr_b16 a[162:163], v15 offset:17408
    s_add_u32 m0, s28, 50688
    s_nop 0
    buffer_load_dwordx4 v8, s[12:15], s25 offen offset:0 lds
    s_waitcnt lgkmcnt(4)
    v_mfma_f32_16x16x32_bf16 v[176:179], a[168:171], a[40:43], v[176:179]
    ds_read_b64_tr_b16 a[164:165], v15 offset:16928
    v_mfma_f32_16x16x32_bf16 v[180:183], a[168:171], a[44:47], v[180:183]
    ds_read_b64_tr_b16 a[166:167], v15 offset:17440
    s_waitcnt lgkmcnt(4)
    v_mfma_f32_16x16x32_bf16 v[184:187], a[172:175], a[40:43], v[184:187]
    ds_read_b64_tr_b16 a[168:169], v15 offset:16960
    v_mfma_f32_16x16x32_bf16 v[188:191], a[172:175], a[44:47], v[188:191]
    ds_read_b64_tr_b16 a[170:171], v15 offset:17472
    buffer_load_dwordx4 v9, s[12:15], s25 offen offset:1056 lds
    s_waitcnt vmcnt(31)
    s_waitcnt lgkmcnt(4)
    v_mfma_f32_16x16x32_bf16 v[128:131], a[160:163], a[48:51], v[128:131]
    ds_read_b64_tr_b16 a[172:173], v15 offset:16992
    v_mfma_f32_16x16x32_bf16 v[132:135], a[160:163], a[52:55], v[132:135]
    ds_read_b64_tr_b16 a[174:175], v15 offset:17504
    buffer_load_dwordx4 a[112:115], v2, s[8:11], s26 offen offset:2048 sc1
    s_waitcnt lgkmcnt(4)
    v_mfma_f32_16x16x32_bf16 v[136:139], a[164:167], a[48:51], v[136:139]
    ds_read_b64_tr_b16 a[160:161], v15 offset:21120
    v_mfma_f32_16x16x32_bf16 v[140:143], a[164:167], a[52:55], v[140:143]
    ds_read_b64_tr_b16 a[162:163], v15 offset:21632
    s_waitcnt lgkmcnt(4)
    v_mfma_f32_16x16x32_bf16 v[144:147], a[168:171], a[48:51], v[144:147]
    ds_read_b64_tr_b16 a[164:165], v15 offset:21152
    v_mfma_f32_16x16x32_bf16 v[148:151], a[168:171], a[52:55], v[148:151]
    ds_read_b64_tr_b16 a[166:167], v15 offset:21664
    buffer_load_dwordx4 a[116:119], v3, s[8:11], s26 offen offset:2048 sc1
    s_waitcnt lgkmcnt(4)
    v_mfma_f32_16x16x32_bf16 v[152:155], a[172:175], a[48:51], v[152:155]
    ds_read_b64_tr_b16 a[168:169], v15 offset:21184
    v_mfma_f32_16x16x32_bf16 v[156:159], a[172:175], a[52:55], v[156:159]
    ds_read_b64_tr_b16 a[170:171], v15 offset:21696
    s_waitcnt lgkmcnt(4)
    v_mfma_f32_16x16x32_bf16 v[160:163], a[160:163], a[48:51], v[160:163]
    ds_read_b64_tr_b16 a[172:173], v15 offset:21216
    v_mfma_f32_16x16x32_bf16 v[164:167], a[160:163], a[52:55], v[164:167]
    ds_read_b64_tr_b16 a[174:175], v15 offset:21728
    buffer_load_dwordx4 a[120:123], v2, s[8:11], s26 offen offset:3072 sc1
    s_waitcnt lgkmcnt(4)
    v_mfma_f32_16x16x32_bf16 v[168:171], a[164:167], a[48:51], v[168:171]
    ds_read_b64_tr_b16 a[160:161], v15 offset:25344
    v_mfma_f32_16x16x32_bf16 v[172:175], a[164:167], a[52:55], v[172:175]
    ds_read_b64_tr_b16 a[162:163], v15 offset:25856
    s_waitcnt lgkmcnt(4)
    v_mfma_f32_16x16x32_bf16 v[176:179], a[168:171], a[48:51], v[176:179]
    ds_read_b64_tr_b16 a[164:165], v15 offset:25376
    v_mfma_f32_16x16x32_bf16 v[180:183], a[168:171], a[52:55], v[180:183]
    ds_read_b64_tr_b16 a[166:167], v15 offset:25888
    buffer_load_dwordx4 a[124:127], v3, s[8:11], s26 offen offset:3072 sc1
    s_add_u32 s26, s26, 4096
    s_waitcnt lgkmcnt(4)
    v_mfma_f32_16x16x32_bf16 v[184:187], a[172:175], a[48:51], v[184:187]
    ds_read_b64_tr_b16 a[168:169], v15 offset:25408
    v_mfma_f32_16x16x32_bf16 v[188:191], a[172:175], a[52:55], v[188:191]
    ds_read_b64_tr_b16 a[170:171], v15 offset:25920
    s_add_u32 s25, s27, 1048576
    s_add_u32 m0, s28, 71808
    s_nop 0
    buffer_load_dwordx4 v6, s[12:15], s25 offen offset:0 lds
    s_waitcnt vmcnt(34)
    s_waitcnt lgkmcnt(4)
    v_mfma_f32_16x16x32_bf16 v[128:131], a[160:163], a[56:59], v[128:131]
    ds_read_b64_tr_b16 a[172:173], v15 offset:25440
    v_mfma_f32_16x16x32_bf16 v[132:135], a[160:163], a[60:63], v[132:135]
    ds_read_b64_tr_b16 a[174:175], v15 offset:25952
    s_waitcnt lgkmcnt(4)
    v_mfma_f32_16x16x32_bf16 v[136:139], a[164:167], a[56:59], v[136:139]
    ds_read_b64_tr_b16 a[160:161], v15 offset:29568
    v_mfma_f32_16x16x32_bf16 v[140:143], a[164:167], a[60:63], v[140:143]
    ds_read_b64_tr_b16 a[162:163], v15 offset:30080
    buffer_load_dwordx4 v7, s[12:15], s25 offen offset:1056 lds
    s_waitcnt lgkmcnt(4)
    v_mfma_f32_16x16x32_bf16 v[144:147], a[168:171], a[56:59], v[144:147]
    ds_read_b64_tr_b16 a[164:165], v15 offset:29600
    v_mfma_f32_16x16x32_bf16 v[148:151], a[168:171], a[60:63], v[148:151]
    ds_read_b64_tr_b16 a[166:167], v15 offset:30112
    s_waitcnt lgkmcnt(4)
    v_mfma_f32_16x16x32_bf16 v[152:155], a[172:175], a[56:59], v[152:155]
    ds_read_b64_tr_b16 a[168:169], v15 offset:29632
    v_mfma_f32_16x16x32_bf16 v[156:159], a[172:175], a[60:63], v[156:159]
    ds_read_b64_tr_b16 a[170:171], v15 offset:30144
    s_add_u32 m0, s28, 67584
    s_nop 0
    buffer_load_dwordx4 v8, s[12:15], s25 offen offset:0 lds
    s_waitcnt lgkmcnt(4)
    v_mfma_f32_16x16x32_bf16 v[160:163], a[160:163], a[56:59], v[160:163]
    ds_read_b64_tr_b16 a[172:173], v15 offset:29664
    v_mfma_f32_16x16x32_bf16 v[164:167], a[160:163], a[60:63], v[164:167]
    ds_read_b64_tr_b16 a[174:175], v15 offset:30176
    s_waitcnt lgkmcnt(4)
    v_mfma_f32_16x16x32_bf16 v[168:171], a[164:167], a[56:59], v[168:171]
    s_waitcnt vmcnt(32)
    s_barrier
    ds_read_b64_tr_b16 a[160:161], v13 offset:0
    v_mfma_f32_16x16x32_bf16 v[172:175], a[164:167], a[60:63], v[172:175]
    ds_read_b64_tr_b16 a[162:163], v13 offset:512
    buffer_load_dwordx4 v9, s[12:15], s25 offen offset:1056 lds
    s_waitcnt lgkmcnt(4)
    v_mfma_f32_16x16x32_bf16 v[176:179], a[168:171], a[56:59], v[176:179]
    ds_read_b64_tr_b16 a[164:165], v13 offset:32
    v_mfma_f32_16x16x32_bf16 v[180:183], a[168:171], a[60:63], v[180:183]
    ds_read_b64_tr_b16 a[166:167], v13 offset:544
    buffer_load_dwordx4 a[128:131], v2, s[8:11], s26 offen offset:0 sc1
    s_waitcnt lgkmcnt(4)
    v_mfma_f32_16x16x32_bf16 v[184:187], a[172:175], a[56:59], v[184:187]
    ds_read_b64_tr_b16 a[168:169], v13 offset:64
    v_mfma_f32_16x16x32_bf16 v[188:191], a[172:175], a[60:63], v[188:191]
    ds_read_b64_tr_b16 a[170:171], v13 offset:576
    s_waitcnt vmcnt(32)
    s_waitcnt lgkmcnt(4)
    v_mfma_f32_16x16x32_bf16 v[128:131], a[160:163], a[64:67], v[128:131]
    ds_read_b64_tr_b16 a[172:173], v13 offset:96
    v_mfma_f32_16x16x32_bf16 v[132:135], a[160:163], a[68:71], v[132:135]
    ds_read_b64_tr_b16 a[174:175], v13 offset:608
    buffer_load_dwordx4 a[132:135], v3, s[8:11], s26 offen offset:0 sc1
    s_waitcnt lgkmcnt(4)
    v_mfma_f32_16x16x32_bf16 v[136:139], a[164:167], a[64:67], v[136:139]
    ds_read_b64_tr_b16 a[160:161], v13 offset:4224
    v_mfma_f32_16x16x32_bf16 v[140:143], a[164:167], a[68:71], v[140:143]
    ds_read_b64_tr_b16 a[162:163], v13 offset:4736
    s_waitcnt lgkmcnt(4)
    v_mfma_f32_16x16x32_bf16 v[144:147], a[168:171], a[64:67], v[144:147]
    ds_read_b64_tr_b16 a[164:165], v13 offset:4256
    v_mfma_f32_16x16x32_bf16 v[148:151], a[168:171], a[68:71], v[148:151]
    ds_read_b64_tr_b16 a[166:167], v13 offset:4768
    buffer_load_dwordx4 a[136:139], v2, s[8:11], s26 offen offset:1024 sc1
    s_waitcnt lgkmcnt(4)
    v_mfma_f32_16x16x32_bf16 v[152:155], a[172:175], a[64:67], v[152:155]
    ds_read_b64_tr_b16 a[168:169], v13 offset:4288
    v_mfma_f32_16x16x32_bf16 v[156:159], a[172:175], a[68:71], v[156:159]
    ds_read_b64_tr_b16 a[170:171], v13 offset:4800
    s_waitcnt lgkmcnt(4)
    v_mfma_f32_16x16x32_bf16 v[160:163], a[160:163], a[64:67], v[160:163]
    ds_read_b64_tr_b16 a[172:173], v13 offset:4320
    v_mfma_f32_16x16x32_bf16 v[164:167], a[160:163], a[68:71], v[164:167]
    ds_read_b64_tr_b16 a[174:175], v13 offset:4832
    buffer_load_dwordx4 a[140:143], v3, s[8:11], s26 offen offset:1024 sc1
    s_waitcnt lgkmcnt(4)
    v_mfma_f32_16x16x32_bf16 v[168:171], a[164:167], a[64:67], v[168:171]
    ds_read_b64_tr_b16 a[160:161], v13 offset:8448
    v_mfma_f32_16x16x32_bf16 v[172:175], a[164:167], a[68:71], v[172:175]
    ds_read_b64_tr_b16 a[162:163], v13 offset:8960
    s_add_u32 s25, s27, 1507328
    s_add_u32 m0, s28, 88704
    s_nop 0
    buffer_load_dwordx4 v6, s[12:15], s25 offen offset:0 lds
    s_waitcnt lgkmcnt(4)
    v_mfma_f32_16x16x32_bf16 v[176:179], a[168:171], a[64:67], v[176:179]
    ds_read_b64_tr_b16 a[164:165], v13 offset:8480
    v_mfma_f32_16x16x32_bf16 v[180:183], a[168:171], a[68:71], v[180:183]
    ds_read_b64_tr_b16 a[166:167], v13 offset:8992
    s_waitcnt lgkmcnt(4)
    v_mfma_f32_16x16x32_bf16 v[184:187], a[172:175], a[64:67], v[184:187]
    ds_read_b64_tr_b16 a[168:169], v13 offset:8512
    v_mfma_f32_16x16x32_bf16 v[188:191], a[172:175], a[68:71], v[188:191]
    ds_read_b64_tr_b16 a[170:171], v13 offset:9024
    buffer_load_dwordx4 v7, s[12:15], s25 offen offset:1056 lds
    s_waitcnt vmcnt(35)
    s_waitcnt lgkmcnt(4)
    v_mfma_f32_16x16x32_bf16 v[128:131], a[160:163], a[72:75], v[128:131]
    ds_read_b64_tr_b16 a[172:173], v13 offset:8544
    v_mfma_f32_16x16x32_bf16 v[132:135], a[160:163], a[76:79], v[132:135]
    ds_read_b64_tr_b16 a[174:175], v13 offset:9056
    s_waitcnt lgkmcnt(4)
    v_mfma_f32_16x16x32_bf16 v[136:139], a[164:167], a[72:75], v[136:139]
    ds_read_b64_tr_b16 a[160:161], v13 offset:12672
    v_mfma_f32_16x16x32_bf16 v[140:143], a[164:167], a[76:79], v[140:143]
    ds_read_b64_tr_b16 a[162:163], v13 offset:13184
    s_add_u32 m0, s28, 84480
    s_nop 0
    buffer_load_dwordx4 v8, s[12:15], s25 offen offset:0 lds
    s_waitcnt lgkmcnt(4)
    v_mfma_f32_16x16x32_bf16 v[144:147], a[168:171], a[72:75], v[144:147]
    ds_read_b64_tr_b16 a[164:165], v13 offset:12704
    v_mfma_f32_16x16x32_bf16 v[148:151], a[168:171], a[76:79], v[148:151]
    ds_read_b64_tr_b16 a[166:167], v13 offset:13216
    s_waitcnt lgkmcnt(4)
    v_mfma_f32_16x16x32_bf16 v[152:155], a[172:175], a[72:75], v[152:155]
    ds_read_b64_tr_b16 a[168:169], v13 offset:12736
    v_mfma_f32_16x16x32_bf16 v[156:159], a[172:175], a[76:79], v[156:159]
    ds_read_b64_tr_b16 a[170:171], v13 offset:13248
    buffer_load_dwordx4 v9, s[12:15], s25 offen offset:1056 lds
    s_waitcnt lgkmcnt(4)
    v_mfma_f32_16x16x32_bf16 v[160:163], a[160:163], a[72:75], v[160:163]
    ds_read_b64_tr_b16 a[172:173], v13 offset:12768
    v_mfma_f32_16x16x32_bf16 v[164:167], a[160:163], a[76:79], v[164:167]
    ds_read_b64_tr_b16 a[174:175], v13 offset:13280
    buffer_load_dwordx4 a[144:147], v2, s[8:11], s26 offen offset:2048 sc1
    s_waitcnt lgkmcnt(4)
    v_mfma_f32_16x16x32_bf16 v[168:171], a[164:167], a[72:75], v[168:171]
    s_waitcnt vmcnt(34)
    s_barrier
    ds_read_b64_tr_b16 a[160:161], v13 offset:16896
    v_mfma_f32_16x16x32_bf16 v[172:175], a[164:167], a[76:79], v[172:175]
    ds_read_b64_tr_b16 a[162:163], v13 offset:17408
    s_waitcnt lgkmcnt(4)
    v_mfma_f32_16x16x32_bf16 v[176:179], a[168:171], a[72:75], v[176:179]
    ds_read_b64_tr_b16 a[164:165], v13 offset:16928
    v_mfma_f32_16x16x32_bf16 v[180:183], a[168:171], a[76:79], v[180:183]
    ds_read_b64_tr_b16 a[166:167], v13 offset:17440
    buffer_load_dwordx4 a[148:151], v3, s[8:11], s26 offen offset:2048 sc1
    s_waitcnt lgkmcnt(4)
    v_mfma_f32_16x16x32_bf16 v[184:187], a[172:175], a[72:75], v[184:187]
    ds_read_b64_tr_b16 a[168:169], v13 offset:16960
    v_mfma_f32_16x16x32_bf16 v[188:191], a[172:175], a[76:79], v[188:191]
    ds_read_b64_tr_b16 a[170:171], v13 offset:17472
    s_waitcnt vmcnt(32)
    s_waitcnt lgkmcnt(4)
    v_mfma_f32_16x16x32_bf16 v[128:131], a[160:163], a[80:83], v[128:131]
    ds_read_b64_tr_b16 a[172:173], v13 offset:16992
    v_mfma_f32_16x16x32_bf16 v[132:135], a[160:163], a[84:87], v[132:135]
    ds_read_b64_tr_b16 a[174:175], v13 offset:17504
    buffer_load_dwordx4 a[152:155], v2, s[8:11], s26 offen offset:3072 sc1
    s_waitcnt lgkmcnt(4)
    v_mfma_f32_16x16x32_bf16 v[136:139], a[164:167], a[80:83], v[136:139]
    ds_read_b64_tr_b16 a[160:161], v13 offset:21120
    v_mfma_f32_16x16x32_bf16 v[140:143], a[164:167], a[84:87], v[140:143]
    ds_read_b64_tr_b16 a[162:163], v13 offset:21632
    s_waitcnt lgkmcnt(4)
    v_mfma_f32_16x16x32_bf16 v[144:147], a[168:171], a[80:83], v[144:147]
    ds_read_b64_tr_b16 a[164:165], v13 offset:21152
    v_mfma_f32_16x16x32_bf16 v[148:151], a[168:171], a[84:87], v[148:151]
    ds_read_b64_tr_b16 a[166:167], v13 offset:21664
    buffer_load_dwordx4 a[156:159], v3, s[8:11], s26 offen offset:3072 sc1
    s_add_u32 s26, s26, 4096
    s_waitcnt lgkmcnt(4)
    v_mfma_f32_16x16x32_bf16 v[152:155], a[172:175], a[80:83], v[152:155]
    ds_read_b64_tr_b16 a[168:169], v13 offset:21184
    v_mfma_f32_16x16x32_bf16 v[156:159], a[172:175], a[84:87], v[156:159]
    ds_read_b64_tr_b16 a[170:171], v13 offset:21696
    s_add_u32 s25, s27, 1966080
    s_add_u32 m0, s28, 105600
    s_nop 0
    buffer_load_dwordx4 v6, s[12:15], s25 offen offset:0 lds
    s_waitcnt lgkmcnt(4)
    v_mfma_f32_16x16x32_bf16 v[160:163], a[160:163], a[80:83], v[160:163]
    ds_read_b64_tr_b16 a[172:173], v13 offset:21216
    v_mfma_f32_16x16x32_bf16 v[164:167], a[160:163], a[84:87], v[164:167]
    ds_read_b64_tr_b16 a[174:175], v13 offset:21728
    s_waitcnt lgkmcnt(4)
    v_mfma_f32_16x16x32_bf16 v[168:171], a[164:167], a[80:83], v[168:171]
    ds_read_b64_tr_b16 a[160:161], v13 offset:25344
    v_mfma_f32_16x16x32_bf16 v[172:175], a[164:167], a[84:87], v[172:175]
    ds_read_b64_tr_b16 a[162:163], v13 offset:25856
    buffer_load_dwordx4 v7, s[12:15], s25 offen offset:1056 lds
    s_waitcnt lgkmcnt(4)
    v_mfma_f32_16x16x32_bf16 v[176:179], a[168:171], a[80:83], v[176:179]
    ds_read_b64_tr_b16 a[164:165], v13 offset:25376
    v_mfma_f32_16x16x32_bf16 v[180:183], a[168:171], a[84:87], v[180:183]
    ds_read_b64_tr_b16 a[166:167], v13 offset:25888
    s_waitcnt lgkmcnt(4)
    v_mfma_f32_16x16x32_bf16 v[184:187], a[172:175], a[80:83], v[184:187]
    ds_read_b64_tr_b16 a[168:169], v13 offset:25408
    v_mfma_f32_16x16x32_bf16 v[188:191], a[172:175], a[84:87], v[188:191]
    ds_read_b64_tr_b16 a[170:171], v13 offset:25920
    buffer_load_dwordx4 a[0:3], v2, s[8:11], s26 offen offset:0 sc1
    s_waitcnt vmcnt(35)
    s_waitcnt lgkmcnt(4)
    v_mfma_f32_16x16x32_bf16 v[128:131], a[160:163], a[88:91], v[128:131]
    ds_read_b64_tr_b16 a[172:173], v13 offset:25440
    v_mfma_f32_16x16x32_bf16 v[132:135], a[160:163], a[92:95], v[132:135]
    ds_read_b64_tr_b16 a[174:175], v13 offset:25952
    s_waitcnt lgkmcnt(4)
    v_mfma_f32_16x16x32_bf16 v[136:139], a[164:167], a[88:91], v[136:139]
    ds_read_b64_tr_b16 a[160:161], v13 offset:29568
    v_mfma_f32_16x16x32_bf16 v[140:143], a[164:167], a[92:95], v[140:143]
    ds_read_b64_tr_b16 a[162:163], v13 offset:30080
    buffer_load_dwordx4 a[4:7], v3, s[8:11], s26 offen offset:0 sc1
    s_waitcnt lgkmcnt(4)
    v_mfma_f32_16x16x32_bf16 v[144:147], a[168:171], a[88:91], v[144:147]
    ds_read_b64_tr_b16 a[164:165], v13 offset:29600
    v_mfma_f32_16x16x32_bf16 v[148:151], a[168:171], a[92:95], v[148:151]
    ds_read_b64_tr_b16 a[166:167], v13 offset:30112
    buffer_load_dwordx4 a[8:11], v2, s[8:11], s26 offen offset:1024 sc1
    s_waitcnt lgkmcnt(4)
    v_mfma_f32_16x16x32_bf16 v[152:155], a[172:175], a[88:91], v[152:155]
    ds_read_b64_tr_b16 a[168:169], v13 offset:29632
    v_mfma_f32_16x16x32_bf16 v[156:159], a[172:175], a[92:95], v[156:159]
    ds_read_b64_tr_b16 a[170:171], v13 offset:30144
    s_waitcnt lgkmcnt(4)
    v_mfma_f32_16x16x32_bf16 v[160:163], a[160:163], a[88:91], v[160:163]
    ds_read_b64_tr_b16 a[172:173], v13 offset:29664
    v_mfma_f32_16x16x32_bf16 v[164:167], a[160:163], a[92:95], v[164:167]
    ds_read_b64_tr_b16 a[174:175], v13 offset:30176
    buffer_load_dwordx4 a[12:15], v3, s[8:11], s26 offen offset:1024 sc1
    s_waitcnt lgkmcnt(4)
    v_mfma_f32_16x16x32_bf16 v[168:171], a[164:167], a[88:91], v[168:171]
    s_waitcnt vmcnt(34)
    s_barrier
    ds_read_b64_tr_b16 a[160:161], v13 offset:33792
    v_mfma_f32_16x16x32_bf16 v[172:175], a[164:167], a[92:95], v[172:175]
    ds_read_b64_tr_b16 a[162:163], v13 offset:34304
    s_waitcnt lgkmcnt(4)
    v_mfma_f32_16x16x32_bf16 v[176:179], a[168:171], a[88:91], v[176:179]
    ds_read_b64_tr_b16 a[164:165], v13 offset:33824
    v_mfma_f32_16x16x32_bf16 v[180:183], a[168:171], a[92:95], v[180:183]
    ds_read_b64_tr_b16 a[166:167], v13 offset:34336
    s_add_u32 s25, s27, 2424832
    s_add_u32 m0, s28, 122496
    s_nop 0
    buffer_load_dwordx4 v6, s[12:15], s25 offen offset:0 lds
    s_waitcnt lgkmcnt(4)
    v_mfma_f32_16x16x32_bf16 v[184:187], a[172:175], a[88:91], v[184:187]
    ds_read_b64_tr_b16 a[168:169], v13 offset:33856
    v_mfma_f32_16x16x32_bf16 v[188:191], a[172:175], a[92:95], v[188:191]
    ds_read_b64_tr_b16 a[170:171], v13 offset:34368
    s_waitcnt vmcnt(33)
    s_waitcnt lgkmcnt(4)
    v_mfma_f32_16x16x32_bf16 v[128:131], a[160:163], a[96:99], v[128:131]
    ds_read_b64_tr_b16 a[172:173], v13 offset:33888
    v_mfma_f32_16x16x32_bf16 v[132:135], a[160:163], a[100:103], v[132:135]
    ds_read_b64_tr_b16 a[174:175], v13 offset:34400
    buffer_load_dwordx4 v7, s[12:15], s25 offen offset:1056 lds
    s_waitcnt lgkmcnt(4)
    v_mfma_f32_16x16x32_bf16 v[136:139], a[164:167], a[96:99], v[136:139]
    ds_read_b64_tr_b16 a[160:161], v13 offset:38016
    v_mfma_f32_16x16x32_bf16 v[140:143], a[164:167], a[100:103], v[140:143]
    ds_read_b64_tr_b16 a[162:163], v13 offset:38528
    buffer_load_dwordx4 a[16:19], v2, s[8:11], s26 offen offset:2048 sc1
    s_waitcnt lgkmcnt(4)
    v_mfma_f32_16x16x32_bf16 v[144:147], a[168:171], a[96:99], v[144:147]
    ds_read_b64_tr_b16 a[164:165], v13 offset:38048
    v_mfma_f32_16x16x32_bf16 v[148:151], a[168:171], a[100:103], v[148:151]
    ds_read_b64_tr_b16 a[166:167], v13 offset:38560
    s_waitcnt lgkmcnt(4)
    v_mfma_f32_16x16x32_bf16 v[152:155], a[172:175], a[96:99], v[152:155]
    ds_read_b64_tr_b16 a[168:169], v13 offset:38080
    v_mfma_f32_16x16x32_bf16 v[156:159], a[172:175], a[100:103], v[156:159]
    ds_read_b64_tr_b16 a[170:171], v13 offset:38592
    buffer_load_dwordx4 a[20:23], v3, s[8:11], s26 offen offset:2048 sc1
    s_waitcnt lgkmcnt(4)
    v_mfma_f32_16x16x32_bf16 v[160:163], a[160:163], a[96:99], v[160:163]
    ds_read_b64_tr_b16 a[172:173], v13 offset:38112
    v_mfma_f32_16x16x32_bf16 v[164:167], a[160:163], a[100:103], v[164:167]
    ds_read_b64_tr_b16 a[174:175], v13 offset:38624
    s_waitcnt lgkmcnt(4)
    v_mfma_f32_16x16x32_bf16 v[168:171], a[164:167], a[96:99], v[168:171]
    ds_read_b64_tr_b16 a[160:161], v13 offset:42240
    v_mfma_f32_16x16x32_bf16 v[172:175], a[164:167], a[100:103], v[172:175]
    ds_read_b64_tr_b16 a[162:163], v13 offset:42752
    buffer_load_dwordx4 a[24:27], v2, s[8:11], s26 offen offset:3072 sc1
    s_waitcnt lgkmcnt(4)
    v_mfma_f32_16x16x32_bf16 v[176:179], a[168:171], a[96:99], v[176:179]
    ds_read_b64_tr_b16 a[164:165], v13 offset:42272
    v_mfma_f32_16x16x32_bf16 v[180:183], a[168:171], a[100:103], v[180:183]
    ds_read_b64_tr_b16 a[166:167], v13 offset:42784
    s_waitcnt lgkmcnt(4)
    v_mfma_f32_16x16x32_bf16 v[184:187], a[172:175], a[96:99], v[184:187]
    ds_read_b64_tr_b16 a[168:169], v13 offset:42304
    v_mfma_f32_16x16x32_bf16 v[188:191], a[172:175], a[100:103], v[188:191]
    ds_read_b64_tr_b16 a[170:171], v13 offset:42816
    buffer_load_dwordx4 a[28:31], v3, s[8:11], s26 offen offset:3072 sc1
    s_add_u32 s26, s26, 4096
    s_waitcnt vmcnt(36)
    s_waitcnt lgkmcnt(4)
    v_mfma_f32_16x16x32_bf16 v[128:131], a[160:163], a[104:107], v[128:131]
    ds_read_b64_tr_b16 a[172:173], v13 offset:42336
    v_mfma_f32_16x16x32_bf16 v[132:135], a[160:163], a[108:111], v[132:135]
    ds_read_b64_tr_b16 a[174:175], v13 offset:42848
    s_add_u32 s25, s27, 2883584
    s_add_u32 m0, s28, 4224
    s_nop 0
    buffer_load_dwordx4 v6, s[12:15], s25 offen offset:0 lds
    s_waitcnt lgkmcnt(4)
    v_mfma_f32_16x16x32_bf16 v[136:139], a[164:167], a[104:107], v[136:139]
    ds_read_b64_tr_b16 a[160:161], v13 offset:46464
    v_mfma_f32_16x16x32_bf16 v[140:143], a[164:167], a[108:111], v[140:143]
    ds_read_b64_tr_b16 a[162:163], v13 offset:46976
    s_waitcnt lgkmcnt(4)
    v_mfma_f32_16x16x32_bf16 v[144:147], a[168:171], a[104:107], v[144:147]
    ds_read_b64_tr_b16 a[164:165], v13 offset:46496
    v_mfma_f32_16x16x32_bf16 v[148:151], a[168:171], a[108:111], v[148:151]
    ds_read_b64_tr_b16 a[166:167], v13 offset:47008
    buffer_load_dwordx4 v7, s[12:15], s25 offen offset:1056 lds
    s_waitcnt lgkmcnt(4)
    v_mfma_f32_16x16x32_bf16 v[152:155], a[172:175], a[104:107], v[152:155]
    ds_read_b64_tr_b16 a[168:169], v13 offset:46528
    v_mfma_f32_16x16x32_bf16 v[156:159], a[172:175], a[108:111], v[156:159]
    ds_read_b64_tr_b16 a[170:171], v13 offset:47040
    s_waitcnt lgkmcnt(4)
    v_mfma_f32_16x16x32_bf16 v[160:163], a[160:163], a[104:107], v[160:163]
    ds_read_b64_tr_b16 a[172:173], v13 offset:46560
    v_mfma_f32_16x16x32_bf16 v[164:167], a[160:163], a[108:111], v[164:167]
    ds_read_b64_tr_b16 a[174:175], v13 offset:47072
    buffer_load_dwordx4 a[32:35], v2, s[8:11], s26 offen offset:0 sc1
    s_waitcnt lgkmcnt(4)
    v_mfma_f32_16x16x32_bf16 v[168:171], a[164:167], a[104:107], v[168:171]
    s_waitcnt vmcnt(35)
    s_barrier
    ds_read_b64_tr_b16 a[160:161], v14 offset:0
    v_mfma_f32_16x16x32_bf16 v[172:175], a[164:167], a[108:111], v[172:175]
    ds_read_b64_tr_b16 a[162:163], v14 offset:512
    s_waitcnt lgkmcnt(4)
    v_mfma_f32_16x16x32_bf16 v[176:179], a[168:171], a[104:107], v[176:179]
    ds_read_b64_tr_b16 a[164:165], v14 offset:32
    v_mfma_f32_16x16x32_bf16 v[180:183], a[168:171], a[108:111], v[180:183]
    ds_read_b64_tr_b16 a[166:167], v14 offset:544
    buffer_load_dwordx4 a[36:39], v3, s[8:11], s26 offen offset:0 sc1
    s_waitcnt lgkmcnt(4)
    v_mfma_f32_16x16x32_bf16 v[184:187], a[172:175], a[104:107], v[184:187]
    ds_read_b64_tr_b16 a[168:169], v14 offset:64
    v_mfma_f32_16x16x32_bf16 v[188:191], a[172:175], a[108:111], v[188:191]
    ds_read_b64_tr_b16 a[170:171], v14 offset:576
    buffer_load_dwordx4 a[40:43], v2, s[8:11], s26 offen offset:1024 sc1
    s_waitcnt vmcnt(35)
    s_waitcnt lgkmcnt(4)
    v_mfma_f32_16x16x32_bf16 v[128:131], a[160:163], a[112:115], v[128:131]
    ds_read_b64_tr_b16 a[172:173], v14 offset:96
    v_mfma_f32_16x16x32_bf16 v[132:135], a[160:163], a[116:119], v[132:135]
    ds_read_b64_tr_b16 a[174:175], v14 offset:608
    s_waitcnt lgkmcnt(4)
    v_mfma_f32_16x16x32_bf16 v[136:139], a[164:167], a[112:115], v[136:139]
    ds_read_b64_tr_b16 a[160:161], v14 offset:4224
    v_mfma_f32_16x16x32_bf16 v[140:143], a[164:167], a[116:119], v[140:143]
    ds_read_b64_tr_b16 a[162:163], v14 offset:4736
    buffer_load_dwordx4 a[44:47], v3, s[8:11], s26 offen offset:1024 sc1
    s_waitcnt lgkmcnt(4)
    v_mfma_f32_16x16x32_bf16 v[144:147], a[168:171], a[112:115], v[144:147]
    ds_read_b64_tr_b16 a[164:165], v14 offset:4256
    v_mfma_f32_16x16x32_bf16 v[148:151], a[168:171], a[116:119], v[148:151]
    ds_read_b64_tr_b16 a[166:167], v14 offset:4768
    s_waitcnt lgkmcnt(4)
    v_mfma_f32_16x16x32_bf16 v[152:155], a[172:175], a[112:115], v[152:155]
    ds_read_b64_tr_b16 a[168:169], v14 offset:4288
    v_mfma_f32_16x16x32_bf16 v[156:159], a[172:175], a[116:119], v[156:159]
    ds_read_b64_tr_b16 a[170:171], v14 offset:4800
    s_add_u32 s25, s27, 3342336
    s_add_u32 m0, s28, 21120
    s_nop 0
    buffer_load_dwordx4 v6, s[12:15], s25 offen offset:0 lds
    s_waitcnt lgkmcnt(4)
    v_mfma_f32_16x16x32_bf16 v[160:163], a[160:163], a[112:115], v[160:163]
    ds_read_b64_tr_b16 a[172:173], v14 offset:4320
    v_mfma_f32_16x16x32_bf16 v[164:167], a[160:163], a[116:119], v[164:167]
    ds_read_b64_tr_b16 a[174:175], v14 offset:4832
    s_waitcnt lgkmcnt(4)
    v_mfma_f32_16x16x32_bf16 v[168:171], a[164:167], a[112:115], v[168:171]
    ds_read_b64_tr_b16 a[160:161], v14 offset:8448
    v_mfma_f32_16x16x32_bf16 v[172:175], a[164:167], a[116:119], v[172:175]
    ds_read_b64_tr_b16 a[162:163], v14 offset:8960
    buffer_load_dwordx4 v7, s[12:15], s25 offen offset:1056 lds
    s_waitcnt lgkmcnt(4)
    v_mfma_f32_16x16x32_bf16 v[176:179], a[168:171], a[112:115], v[176:179]
    ds_read_b64_tr_b16 a[164:165], v14 offset:8480
    v_mfma_f32_16x16x32_bf16 v[180:183], a[168:171], a[116:119], v[180:183]
    ds_read_b64_tr_b16 a[166:167], v14 offset:8992
    buffer_load_dwordx4 a[48:51], v2, s[8:11], s26 offen offset:2048 sc1
    s_waitcnt lgkmcnt(4)
    v_mfma_f32_16x16x32_bf16 v[184:187], a[172:175], a[112:115], v[184:187]
    ds_read_b64_tr_b16 a[168:169], v14 offset:8512
    v_mfma_f32_16x16x32_bf16 v[188:191], a[172:175], a[116:119], v[188:191]
    ds_read_b64_tr_b16 a[170:171], v14 offset:9024
    s_waitcnt vmcnt(37)
    s_waitcnt lgkmcnt(4)
    v_mfma_f32_16x16x32_bf16 v[128:131], a[160:163], a[120:123], v[128:131]
    ds_read_b64_tr_b16 a[172:173], v14 offset:8544
    v_mfma_f32_16x16x32_bf16 v[132:135], a[160:163], a[124:127], v[132:135]
    ds_read_b64_tr_b16 a[174:175], v14 offset:9056
    buffer_load_dwordx4 a[52:55], v3, s[8:11], s26 offen offset:2048 sc1
    s_waitcnt lgkmcnt(4)
    v_mfma_f32_16x16x32_bf16 v[136:139], a[164:167], a[120:123], v[136:139]
    ds_read_b64_tr_b16 a[160:161], v14 offset:12672
    v_mfma_f32_16x16x32_bf16 v[140:143], a[164:167], a[124:127], v[140:143]
    ds_read_b64_tr_b16 a[162:163], v14 offset:13184
    s_waitcnt lgkmcnt(4)
    v_mfma_f32_16x16x32_bf16 v[144:147], a[168:171], a[120:123], v[144:147]
    ds_read_b64_tr_b16 a[164:165], v14 offset:12704
    v_mfma_f32_16x16x32_bf16 v[148:151], a[168:171], a[124:127], v[148:151]
    ds_read_b64_tr_b16 a[166:167], v14 offset:13216
    buffer_load_dwordx4 a[56:59], v2, s[8:11], s26 offen offset:3072 sc1
    s_waitcnt lgkmcnt(4)
    v_mfma_f32_16x16x32_bf16 v[152:155], a[172:175], a[120:123], v[152:155]
    ds_read_b64_tr_b16 a[168:169], v14 offset:12736
    v_mfma_f32_16x16x32_bf16 v[156:159], a[172:175], a[124:127], v[156:159]
    ds_read_b64_tr_b16 a[170:171], v14 offset:13248
    s_waitcnt lgkmcnt(4)
    v_mfma_f32_16x16x32_bf16 v[160:163], a[160:163], a[120:123], v[160:163]
    ds_read_b64_tr_b16 a[172:173], v14 offset:12768
    v_mfma_f32_16x16x32_bf16 v[164:167], a[160:163], a[124:127], v[164:167]
    ds_read_b64_tr_b16 a[174:175], v14 offset:13280
    buffer_load_dwordx4 a[60:63], v3, s[8:11], s26 offen offset:3072 sc1
    s_add_u32 s26, s26, 4096
    s_waitcnt lgkmcnt(4)
    v_mfma_f32_16x16x32_bf16 v[168:171], a[164:167], a[120:123], v[168:171]
    s_waitcnt vmcnt(36)
    s_barrier
    ds_read_b64_tr_b16 a[160:161], v14 offset:16896
    v_mfma_f32_16x16x32_bf16 v[172:175], a[164:167], a[124:127], v[172:175]
    ds_read_b64_tr_b16 a[162:163], v14 offset:17408
    s_add_u32 s25, s30, 196608
    s_add_u32 m0, s28, 38016
    s_nop 0
    buffer_load_dwordx4 v116, s[12:15], s25 offen offset:0 lds
    s_waitcnt lgkmcnt(4)
    v_mfma_f32_16x16x32_bf16 v[176:179], a[168:171], a[120:123], v[176:179]
    ds_read_b64_tr_b16 a[164:165], v14 offset:16928
    v_mfma_f32_16x16x32_bf16 v[180:183], a[168:171], a[124:127], v[180:183]
    ds_read_b64_tr_b16 a[166:167], v14 offset:17440
    s_waitcnt lgkmcnt(4)
    v_mfma_f32_16x16x32_bf16 v[184:187], a[172:175], a[120:123], v[184:187]
    ds_read_b64_tr_b16 a[168:169], v14 offset:16960
    v_mfma_f32_16x16x32_bf16 v[188:191], a[172:175], a[124:127], v[188:191]
    ds_read_b64_tr_b16 a[170:171], v14 offset:17472
    buffer_load_dwordx4 v117, s[12:15], s25 offen offset:1056 lds
    s_waitcnt vmcnt(36)
    s_waitcnt lgkmcnt(4)
    v_mfma_f32_16x16x32_bf16 v[128:131], a[160:163], a[128:131], v[128:131]
    ds_read_b64_tr_b16 a[172:173], v14 offset:16992
    v_mfma_f32_16x16x32_bf16 v[132:135], a[160:163], a[132:135], v[132:135]
    ds_read_b64_tr_b16 a[174:175], v14 offset:17504
    s_waitcnt lgkmcnt(4)
    v_mfma_f32_16x16x32_bf16 v[136:139], a[164:167], a[128:131], v[136:139]
    ds_read_b64_tr_b16 a[160:161], v14 offset:21120
    v_mfma_f32_16x16x32_bf16 v[140:143], a[164:167], a[132:135], v[140:143]
    ds_read_b64_tr_b16 a[162:163], v14 offset:21632
    buffer_load_dwordx4 v[52:55], v1, s[20:23], s47 offen offset:0 sc1
    s_waitcnt lgkmcnt(4)
    v_mfma_f32_16x16x32_bf16 v[144:147], a[168:171], a[128:131], v[144:147]
    ds_read_b64_tr_b16 a[164:165], v14 offset:21152
    v_mfma_f32_16x16x32_bf16 v[148:151], a[168:171], a[132:135], v[148:151]
    ds_read_b64_tr_b16 a[166:167], v14 offset:21664
    s_waitcnt lgkmcnt(4)
    v_mfma_f32_16x16x32_bf16 v[152:155], a[172:175], a[128:131], v[152:155]
    ds_read_b64_tr_b16 a[168:169], v14 offset:21184
    v_mfma_f32_16x16x32_bf16 v[156:159], a[172:175], a[132:135], v[156:159]
    ds_read_b64_tr_b16 a[170:171], v14 offset:21696
    buffer_load_dwordx4 v[36:39], v1, s[48:51], s45 offen offset:0 sc1
    s_waitcnt lgkmcnt(4)
    v_mfma_f32_16x16x32_bf16 v[160:163], a[160:163], a[128:131], v[160:163]
    ds_read_b64_tr_b16 a[172:173], v14 offset:21216
    v_mfma_f32_16x16x32_bf16 v[164:167], a[160:163], a[132:135], v[164:167]
    ds_read_b64_tr_b16 a[174:175], v14 offset:21728
    buffer_load_dwordx4 v[40:43], v1, s[48:51], s45 offen offset:1024 sc1
    s_add_u32 s45, s45, 0x8000
    s_waitcnt lgkmcnt(4)
    v_mfma_f32_16x16x32_bf16 v[168:171], a[164:167], a[128:131], v[168:171]
    ds_read_b64_tr_b16 a[160:161], v14 offset:25344
    v_mfma_f32_16x16x32_bf16 v[172:175], a[164:167], a[132:135], v[172:175]
    ds_read_b64_tr_b16 a[162:163], v14 offset:25856
    s_waitcnt lgkmcnt(4)
    v_mfma_f32_16x16x32_bf16 v[176:179], a[168:171], a[128:131], v[176:179]
    ds_read_b64_tr_b16 a[164:165], v14 offset:25376
    v_mfma_f32_16x16x32_bf16 v[180:183], a[168:171], a[132:135], v[180:183]
    ds_read_b64_tr_b16 a[166:167], v14 offset:25888
    buffer_load_dword v32, v30, s[52:55], 0 offen offset:0 sc1
    s_waitcnt lgkmcnt(4)
    v_mfma_f32_16x16x32_bf16 v[184:187], a[172:175], a[128:131], v[184:187]
    ds_read_b64_tr_b16 a[168:169], v14 offset:25408
    v_mfma_f32_16x16x32_bf16 v[188:191], a[172:175], a[132:135], v[188:191]
    ds_read_b64_tr_b16 a[170:171], v14 offset:25920
    s_waitcnt vmcnt(38)
    s_waitcnt lgkmcnt(4)
    v_mfma_f32_16x16x32_bf16 v[128:131], a[160:163], a[136:139], v[128:131]
    ds_read_b64_tr_b16 a[172:173], v14 offset:25440
    v_mfma_f32_16x16x32_bf16 v[132:135], a[160:163], a[140:143], v[132:135]
    ds_read_b64_tr_b16 a[174:175], v14 offset:25952
    buffer_load_dwordx4 v[56:59], v1, s[20:23], s47 offen offset:1024 sc1
    s_waitcnt lgkmcnt(4)
    v_mfma_f32_16x16x32_bf16 v[136:139], a[164:167], a[136:139], v[136:139]
    ds_read_b64_tr_b16 a[160:161], v14 offset:29568
    v_mfma_f32_16x16x32_bf16 v[140:143], a[164:167], a[140:143], v[140:143]
    ds_read_b64_tr_b16 a[162:163], v14 offset:30080
    s_waitcnt lgkmcnt(4)
    v_mfma_f32_16x16x32_bf16 v[144:147], a[168:171], a[136:139], v[144:147]
    ds_read_b64_tr_b16 a[164:165], v14 offset:29600
    v_mfma_f32_16x16x32_bf16 v[148:151], a[168:171], a[140:143], v[148:151]
    ds_read_b64_tr_b16 a[166:167], v14 offset:30112
    buffer_load_dwordx4 v[44:47], v1, s[48:51], s45 offen offset:0 sc1
    s_waitcnt lgkmcnt(4)
    v_mfma_f32_16x16x32_bf16 v[152:155], a[172:175], a[136:139], v[152:155]
    ds_read_b64_tr_b16 a[168:169], v14 offset:29632
    v_mfma_f32_16x16x32_bf16 v[156:159], a[172:175], a[140:143], v[156:159]
    ds_read_b64_tr_b16 a[170:171], v14 offset:30144
    s_waitcnt lgkmcnt(4)
    v_mfma_f32_16x16x32_bf16 v[160:163], a[160:163], a[136:139], v[160:163]
    ds_read_b64_tr_b16 a[172:173], v14 offset:29664
    v_mfma_f32_16x16x32_bf16 v[164:167], a[160:163], a[140:143], v[164:167]
    ds_read_b64_tr_b16 a[174:175], v14 offset:30176
    buffer_load_dwordx4 v[48:51], v1, s[48:51], s45 offen offset:1024 sc1
    s_add_u32 s45, s45, 0x8000
    s_waitcnt lgkmcnt(4)
    v_mfma_f32_16x16x32_bf16 v[168:171], a[164:167], a[136:139], v[168:171]
    s_waitcnt vmcnt(37)
    s_barrier
    ds_read_b64_tr_b16 a[160:161], v14 offset:33792
    v_mfma_f32_16x16x32_bf16 v[172:175], a[164:167], a[140:143], v[172:175]
    ds_read_b64_tr_b16 a[162:163], v14 offset:34304
    buffer_load_dword v33, v30, s[52:55], 0 offen offset:64 sc1
    s_waitcnt lgkmcnt(4)
    v_mfma_f32_16x16x32_bf16 v[176:179], a[168:171], a[136:139], v[176:179]
    ds_read_b64_tr_b16 a[164:165], v14 offset:33824
    v_mfma_f32_16x16x32_bf16 v[180:183], a[168:171], a[140:143], v[180:183]
    ds_read_b64_tr_b16 a[166:167], v14 offset:34336
    buffer_load_dword v12, v11, s[4:7], 0 offen sc1
    s_waitcnt lgkmcnt(4)
    v_mfma_f32_16x16x32_bf16 v[184:187], a[172:175], a[136:139], v[184:187]
    ds_read_b64_tr_b16 a[168:169], v14 offset:33856
    v_mfma_f32_16x16x32_bf16 v[188:191], a[172:175], a[140:143], v[188:191]
    ds_read_b64_tr_b16 a[170:171], v14 offset:34368
    s_waitcnt vmcnt(0)
    v_cmp_gt_u32 vcc, 4, v12
    s_nop 1
    s_cbranch_vccnz g34_slow3
g34_cont3:
    s_nop 0
    buffer_load_dwordx4 a[64:67], v2, s[8:11], s26 offen offset:0 sc1
    s_waitcnt vmcnt(38)
    s_waitcnt lgkmcnt(4)
    v_mfma_f32_16x16x32_bf16 v[128:131], a[160:163], a[144:147], v[128:131]
    ds_read_b64_tr_b16 a[172:173], v14 offset:33888
    v_mfma_f32_16x16x32_bf16 v[132:135], a[160:163], a[148:151], v[132:135]
    ds_read_b64_tr_b16 a[174:175], v14 offset:34400
    s_waitcnt lgkmcnt(4)
    v_mfma_f32_16x16x32_bf16 v[136:139], a[164:167], a[144:147], v[136:139]
    ds_read_b64_tr_b16 a[160:161], v14 offset:38016
    v_mfma_f32_16x16x32_bf16 v[140:143], a[164:167], a[148:151], v[140:143]
    ds_read_b64_tr_b16 a[162:163], v14 offset:38528
    buffer_load_dwordx4 a[68:71], v3, s[8:11], s26 offen offset:0 sc1
    s_waitcnt lgkmcnt(4)
    v_mfma_f32_16x16x32_bf16 v[144:147], a[168:171], a[144:147], v[144:147]
    ds_read_b64_tr_b16 a[164:165], v14 offset:38048
    v_mfma_f32_16x16x32_bf16 v[148:151], a[168:171], a[148:151], v[148:151]
    ds_read_b64_tr_b16 a[166:167], v14 offset:38560
    s_waitcnt lgkmcnt(4)
    v_mfma_f32_16x16x32_bf16 v[152:155], a[172:175], a[144:147], v[152:155]
    ds_read_b64_tr_b16 a[168:169], v14 offset:38080
    v_mfma_f32_16x16x32_bf16 v[156:159], a[172:175], a[148:151], v[156:159]
    ds_read_b64_tr_b16 a[170:171], v14 offset:38592
    buffer_load_dwordx4 a[72:75], v2, s[8:11], s26 offen offset:1024 sc1
    s_waitcnt lgkmcnt(4)
    v_mfma_f32_16x16x32_bf16 v[160:163], a[160:163], a[144:147], v[160:163]
    ds_read_b64_tr_b16 a[172:173], v14 offset:38112
    v_mfma_f32_16x16x32_bf16 v[164:167], a[160:163], a[148:151], v[164:167]
    ds_read_b64_tr_b16 a[174:175], v14 offset:38624
    buffer_load_dwordx4 a[76:79], v3, s[8:11], s26 offen offset:1024 sc1
    s_waitcnt lgkmcnt(4)
    v_mfma_f32_16x16x32_bf16 v[168:171], a[164:167], a[144:147], v[168:171]
    ds_read_b64_tr_b16 a[160:161], v14 offset:42240
    v_mfma_f32_16x16x32_bf16 v[172:175], a[164:167], a[148:151], v[172:175]
    ds_read_b64_tr_b16 a[162:163], v14 offset:42752
    s_waitcnt lgkmcnt(4)
    v_mfma_f32_16x16x32_bf16 v[176:179], a[168:171], a[144:147], v[176:179]
    ds_read_b64_tr_b16 a[164:165], v14 offset:42272
    v_mfma_f32_16x16x32_bf16 v[180:183], a[168:171], a[148:151], v[180:183]
    ds_read_b64_tr_b16 a[166:167], v14 offset:42784
    s_add_u32 s25, s30, 1114112
    s_add_u32 m0, s28, 54912
    s_nop 0
    buffer_load_dwordx4 v116, s[12:15], s25 offen offset:0 lds
    s_waitcnt lgkmcnt(4)
    v_mfma_f32_16x16x32_bf16 v[184:187], a[172:175], a[144:147], v[184:187]
    ds_read_b64_tr_b16 a[168:169], v14 offset:42304
    v_mfma_f32_16x16x32_bf16 v[188:191], a[172:175], a[148:151], v[188:191]
    ds_read_b64_tr_b16 a[170:171], v14 offset:42816
    s_waitcnt vmcnt(40)
    s_waitcnt lgkmcnt(4)
    v_mfma_f32_16x16x32_bf16 v[128:131], a[160:163], a[152:155], v[128:131]
    ds_read_b64_tr_b16 a[172:173], v14 offset:42336
    v_mfma_f32_16x16x32_bf16 v[132:135], a[160:163], a[156:159], v[132:135]
    ds_read_b64_tr_b16 a[174:175], v14 offset:42848
    buffer_load_dwordx4 v117, s[12:15], s25 offen offset:1056 lds
    s_waitcnt lgkmcnt(4)
    v_mfma_f32_16x16x32_bf16 v[136:139], a[164:167], a[152:155], v[136:139]
    ds_read_b64_tr_b16 a[160:161], v14 offset:46464
    v_mfma_f32_16x16x32_bf16 v[140:143], a[164:167], a[156:159], v[140:143]
    ds_read_b64_tr_b16 a[162:163], v14 offset:46976
    s_waitcnt lgkmcnt(4)
    v_mfma_f32_16x16x32_bf16 v[144:147], a[168:171], a[152:155], v[144:147]
    ds_read_b64_tr_b16 a[164:165], v14 offset:46496
    v_mfma_f32_16x16x32_bf16 v[148:151], a[168:171], a[156:159], v[148:151]
    ds_read_b64_tr_b16 a[166:167], v14 offset:47008
    buffer_load_dwordx4 a[80:83], v2, s[8:11], s26 offen offset:2048 sc1
    s_waitcnt lgkmcnt(4)
    v_mfma_f32_16x16x32_bf16 v[152:155], a[172:175], a[152:155], v[152:155]
    ds_read_b64_tr_b16 a[168:169], v14 offset:46528
    v_mfma_f32_16x16x32_bf16 v[156:159], a[172:175], a[156:159], v[156:159]
    ds_read_b64_tr_b16 a[170:171], v14 offset:47040
    buffer_load_dwordx4 a[84:87], v3, s[8:11], s26 offen offset:2048 sc1
    s_waitcnt lgkmcnt(4)
    v_mfma_f32_16x16x32_bf16 v[160:163], a[160:163], a[152:155], v[160:163]
    ds_read_b64_tr_b16 a[172:173], v14 offset:46560
    v_mfma_f32_16x16x32_bf16 v[164:167], a[160:163], a[156:159], v[164:167]
    ds_read_b64_tr_b16 a[174:175], v14 offset:47072
    s_waitcnt lgkmcnt(4)
    v_mfma_f32_16x16x32_bf16 v[168:171], a[164:167], a[152:155], v[168:171]
    s_waitcnt vmcnt(41)
    s_barrier
    ds_read_b64_tr_b16 a[160:161], v15 offset:4224
    v_mfma_f32_16x16x32_bf16 v[172:175], a[164:167], a[156:159], v[172:175]
    ds_read_b64_tr_b16 a[162:163], v15 offset:4736
    buffer_load_dwordx4 a[88:91], v2, s[8:11], s26 offen offset:3072 sc1
    s_waitcnt lgkmcnt(4)
    v_mfma_f32_16x16x32_bf16 v[176:179], a[168:171], a[152:155], v[176:179]
    ds_read_b64_tr_b16 a[164:165], v15 offset:4256
    v_mfma_f32_16x16x32_bf16 v[180:183], a[168:171], a[156:159], v[180:183]
    ds_read_b64_tr_b16 a[166:167], v15 offset:4768
    s_waitcnt lgkmcnt(4)
    v_mfma_f32_16x16x32_bf16 v[184:187], a[172:175], a[152:155], v[184:187]
    ds_read_b64_tr_b16 a[168:169], v15 offset:4288
    v_mfma_f32_16x16x32_bf16 v[188:191], a[172:175], a[156:159], v[188:191]
    ds_read_b64_tr_b16 a[170:171], v15 offset:4800
    buffer_load_dwordx4 a[92:95], v3, s[8:11], s26 offen offset:3072 sc1
    s_add_u32 s26, s26, 4096
    s_waitcnt vmcnt(41)
    s_waitcnt lgkmcnt(4)
    v_mfma_f32_16x16x32_bf16 v[160:163], a[160:163], a[0:3], v[160:163]
    ds_read_b64_tr_b16 a[172:173], v15 offset:4320
    v_mfma_f32_16x16x32_bf16 v[164:167], a[160:163], a[4:7], v[164:167]
    ds_read_b64_tr_b16 a[174:175], v15 offset:4832
    s_waitcnt lgkmcnt(4)
    v_mfma_f32_16x16x32_bf16 v[168:171], a[164:167], a[0:3], v[168:171]
    ds_read_b64_tr_b16 a[160:161], v15 offset:12672
    v_mfma_f32_16x16x32_bf16 v[172:175], a[164:167], a[4:7], v[172:175]
    ds_read_b64_tr_b16 a[162:163], v15 offset:13184
    s_add_u32 s25, s30, 2031616
    s_add_u32 m0, s28, 71808
    s_nop 0
    buffer_load_dwordx4 v116, s[12:15], s25 offen offset:0 lds
    s_waitcnt lgkmcnt(4)
    v_mfma_f32_16x16x32_bf16 v[176:179], a[168:171], a[0:3], v[176:179]
    ds_read_b64_tr_b16 a[164:165], v15 offset:12704
    v_mfma_f32_16x16x32_bf16 v[180:183], a[168:171], a[4:7], v[180:183]
    ds_read_b64_tr_b16 a[166:167], v15 offset:13216
    buffer_load_dwordx4 v117, s[12:15], s25 offen offset:1056 lds
    s_waitcnt lgkmcnt(4)
    v_mfma_f32_16x16x32_bf16 v[184:187], a[172:175], a[0:3], v[184:187]
    ds_read_b64_tr_b16 a[168:169], v15 offset:12736
    v_mfma_f32_16x16x32_bf16 v[188:191], a[172:175], a[4:7], v[188:191]
    ds_read_b64_tr_b16 a[170:171], v15 offset:13248
    s_waitcnt vmcnt(41)
    s_waitcnt lgkmcnt(4)
    v_mfma_f32_16x16x32_bf16 v[160:163], a[160:163], a[8:11], v[160:163]
    ds_read_b64_tr_b16 a[172:173], v15 offset:12768
    v_mfma_f32_16x16x32_bf16 v[164:167], a[160:163], a[12:15], v[164:167]
    ds_read_b64_tr_b16 a[174:175], v15 offset:13280
    buffer_load_dwordx4 a[96:99], v2, s[8:11], s26 offen offset:0 sc1
    s_waitcnt lgkmcnt(4)
    v_mfma_f32_16x16x32_bf16 v[168:171], a[164:167], a[8:11], v[168:171]
    s_waitcnt vmcnt(40)
    s_barrier
    ds_read_b64_tr_b16 a[160:161], v15 offset:21120
    v_mfma_f32_16x16x32_bf16 v[172:175], a[164:167], a[12:15], v[172:175]
    ds_read_b64_tr_b16 a[162:163], v15 offset:21632
    s_waitcnt lgkmcnt(4)
    v_mfma_f32_16x16x32_bf16 v[176:179], a[168:171], a[8:11], v[176:179]
    ds_read_b64_tr_b16 a[164:165], v15 offset:21152
    v_mfma_f32_16x16x32_bf16 v[180:183], a[168:171], a[12:15], v[180:183]
    ds_read_b64_tr_b16 a[166:167], v15 offset:21664
    buffer_load_dwordx4 a[100:103], v3, s[8:11], s26 offen offset:0 sc1
    s_waitcnt lgkmcnt(4)
    v_mfma_f32_16x16x32_bf16 v[184:187], a[172:175], a[8:11], v[184:187]
    ds_read_b64_tr_b16 a[168:169], v15 offset:21184
    v_mfma_f32_16x16x32_bf16 v[188:191], a[172:175], a[12:15], v[188:191]
    ds_read_b64_tr_b16 a[170:171], v15 offset:21696
    s_waitcnt vmcnt(39)
    s_waitcnt lgkmcnt(4)
    v_mfma_f32_16x16x32_bf16 v[160:163], a[160:163], a[16:19], v[160:163]
    ds_read_b64_tr_b16 a[172:173], v15 offset:21216
    v_mfma_f32_16x16x32_bf16 v[164:167], a[160:163], a[20:23], v[164:167]
    ds_read_b64_tr_b16 a[174:175], v15 offset:21728
    buffer_load_dwordx4 a[104:107], v2, s[8:11], s26 offen offset:1024 sc1
    s_waitcnt lgkmcnt(4)
    v_mfma_f32_16x16x32_bf16 v[168:171], a[164:167], a[16:19], v[168:171]
    ds_read_b64_tr_b16 a[160:161], v15 offset:29568
    v_mfma_f32_16x16x32_bf16 v[172:175], a[164:167], a[20:23], v[172:175]
    ds_read_b64_tr_b16 a[162:163], v15 offset:30080
    buffer_load_dwordx4 a[108:111], v3, s[8:11], s26 offen offset:1024 sc1
    s_waitcnt lgkmcnt(4)
    v_mfma_f32_16x16x32_bf16 v[176:179], a[168:171], a[16:19], v[176:179]
    ds_read_b64_tr_b16 a[164:165], v15 offset:29600
    v_mfma_f32_16x16x32_bf16 v[180:183], a[168:171], a[20:23], v[180:183]
    ds_read_b64_tr_b16 a[166:167], v15 offset:30112
    s_waitcnt lgkmcnt(4)
    v_mfma_f32_16x16x32_bf16 v[184:187], a[172:175], a[16:19], v[184:187]
    ds_read_b64_tr_b16 a[168:169], v15 offset:29632
    v_mfma_f32_16x16x32_bf16 v[188:191], a[172:175], a[20:23], v[188:191]
    ds_read_b64_tr_b16 a[170:171], v15 offset:30144
    s_add_u32 s25, s30, 2949120
    s_add_u32 m0, s28, 88704
    s_nop 0
    buffer_load_dwordx4 v116, s[12:15], s25 offen offset:0 lds
    s_waitcnt vmcnt(40)
    s_waitcnt lgkmcnt(4)
    v_mfma_f32_16x16x32_bf16 v[160:163], a[160:163], a[24:27], v[160:163]
    ds_read_b64_tr_b16 a[172:173], v15 offset:29664
    v_mfma_f32_16x16x32_bf16 v[164:167], a[160:163], a[28:31], v[164:167]
    ds_read_b64_tr_b16 a[174:175], v15 offset:30176
    s_waitcnt lgkmcnt(4)
    v_mfma_f32_16x16x32_bf16 v[168:171], a[164:167], a[24:27], v[168:171]
    s_waitcnt vmcnt(38)
    s_barrier
    ds_read_b64_tr_b16 a[160:161], v13 offset:4224
    v_mfma_f32_16x16x32_bf16 v[172:175], a[164:167], a[28:31], v[172:175]
    ds_read_b64_tr_b16 a[162:163], v13 offset:4736
    buffer_load_dwordx4 v117, s[12:15], s25 offen offset:1056 lds
    s_waitcnt lgkmcnt(4)
    v_mfma_f32_16x16x32_bf16 v[176:179], a[168:171], a[24:27], v[176:179]
    ds_read_b64_tr_b16 a[164:165], v13 offset:4256
    v_mfma_f32_16x16x32_bf16 v[180:183], a[168:171], a[28:31], v[180:183]
    ds_read_b64_tr_b16 a[166:167], v13 offset:4768
    s_waitcnt lgkmcnt(4)
    v_mfma_f32_16x16x32_bf16 v[184:187], a[172:175], a[24:27], v[184:187]
    ds_read_b64_tr_b16 a[168:169], v13 offset:4288
    v_mfma_f32_16x16x32_bf16 v[188:191], a[172:175], a[28:31], v[188:191]
    ds_read_b64_tr_b16 a[170:171], v13 offset:4800
    buffer_load_dwordx4 a[112:115], v2, s[8:11], s26 offen offset:2048 sc1
    s_waitcnt vmcnt(38)
    s_waitcnt lgkmcnt(4)
    v_mfma_f32_16x16x32_bf16 v[160:163], a[160:163], a[32:35], v[160:163]
    ds_read_b64_tr_b16 a[172:173], v13 offset:4320
    v_mfma_f32_16x16x32_bf16 v[164:167], a[160:163], a[36:39], v[164:167]
    ds_read_b64_tr_b16 a[174:175], v13 offset:4832
    buffer_load_dwordx4 a[116:119], v3, s[8:11], s26 offen offset:2048 sc1
    s_waitcnt lgkmcnt(4)
    v_mfma_f32_16x16x32_bf16 v[168:171], a[164:167], a[32:35], v[168:171]
    ds_read_b64_tr_b16 a[160:161], v13 offset:12672
    v_mfma_f32_16x16x32_bf16 v[172:175], a[164:167], a[36:39], v[172:175]
    ds_read_b64_tr_b16 a[162:163], v13 offset:13184
    s_waitcnt lgkmcnt(4)
    v_mfma_f32_16x16x32_bf16 v[176:179], a[168:171], a[32:35], v[176:179]
    ds_read_b64_tr_b16 a[164:165], v13 offset:12704
    v_mfma_f32_16x16x32_bf16 v[180:183], a[168:171], a[36:39], v[180:183]
    ds_read_b64_tr_b16 a[166:167], v13 offset:13216
    buffer_load_dwordx4 a[120:123], v2, s[8:11], s26 offen offset:3072 sc1
    s_waitcnt lgkmcnt(4)
    v_mfma_f32_16x16x32_bf16 v[184:187], a[172:175], a[32:35], v[184:187]
    ds_read_b64_tr_b16 a[168:169], v13 offset:12736
    v_mfma_f32_16x16x32_bf16 v[188:191], a[172:175], a[36:39], v[188:191]
    ds_read_b64_tr_b16 a[170:171], v13 offset:13248
    s_waitcnt vmcnt(38)
    s_waitcnt lgkmcnt(4)
    v_mfma_f32_16x16x32_bf16 v[160:163], a[160:163], a[40:43], v[160:163]
    ds_read_b64_tr_b16 a[172:173], v13 offset:12768
    v_mfma_f32_16x16x32_bf16 v[164:167], a[160:163], a[44:47], v[164:167]
    ds_read_b64_tr_b16 a[174:175], v13 offset:13280
    buffer_load_dwordx4 a[124:127], v3, s[8:11], s26 offen offset:3072 sc1
    s_add_u32 s26, s26, 4096
    s_waitcnt lgkmcnt(4)
    v_mfma_f32_16x16x32_bf16 v[168:171], a[164:167], a[40:43], v[168:171]
    s_waitcnt vmcnt(37)
    s_barrier
    ds_read_b64_tr_b16 a[160:161], v13 offset:21120
    v_mfma_f32_16x16x32_bf16 v[172:175], a[164:167], a[44:47], v[172:175]
    ds_read_b64_tr_b16 a[162:163], v13 offset:21632
    s_waitcnt lgkmcnt(4)
    v_mfma_f32_16x16x32_bf16 v[176:179], a[168:171], a[40:43], v[176:179]
    ds_read_b64_tr_b16 a[164:165], v13 offset:21152
    v_mfma_f32_16x16x32_bf16 v[180:183], a[168:171], a[44:47], v[180:183]
    ds_read_b64_tr_b16 a[166:167], v13 offset:21664
    s_add_u32 s25, s27, 1966080
    s_add_u32 m0, s28, 101376
    s_nop 0
    buffer_load_dwordx4 v8, s[12:15], s25 offen offset:0 lds
    s_waitcnt lgkmcnt(4)
    v_mfma_f32_16x16x32_bf16 v[184:187], a[172:175], a[40:43], v[184:187]
    ds_read_b64_tr_b16 a[168:169], v13 offset:21184
    v_mfma_f32_16x16x32_bf16 v[188:191], a[172:175], a[44:47], v[188:191]
    ds_read_b64_tr_b16 a[170:171], v13 offset:21696
    buffer_load_dwordx4 v9, s[12:15], s25 offen offset:1056 lds
    s_waitcnt vmcnt(37)
    s_waitcnt lgkmcnt(4)
    v_mfma_f32_16x16x32_bf16 v[160:163], a[160:163], a[48:51], v[160:163]
    ds_read_b64_tr_b16 a[172:173], v13 offset:21216
    v_mfma_f32_16x16x32_bf16 v[164:167], a[160:163], a[52:55], v[164:167]
    ds_read_b64_tr_b16 a[174:175], v13 offset:21728
    s_waitcnt lgkmcnt(4)
    v_mfma_f32_16x16x32_bf16 v[168:171], a[164:167], a[48:51], v[168:171]
    ds_read_b64_tr_b16 a[160:161], v13 offset:29568
    v_mfma_f32_16x16x32_bf16 v[172:175], a[164:167], a[52:55], v[172:175]
    ds_read_b64_tr_b16 a[162:163], v13 offset:30080
    s_add_u32 s25, s27, 2424832
    s_add_u32 m0, s28, 118272
    s_nop 0
    buffer_load_dwordx4 v8, s[12:15], s25 offen offset:0 lds
    s_waitcnt lgkmcnt(4)
    v_mfma_f32_16x16x32_bf16 v[176:179], a[168:171], a[48:51], v[176:179]
    ds_read_b64_tr_b16 a[164:165], v13 offset:29600
    v_mfma_f32_16x16x32_bf16 v[180:183], a[168:171], a[52:55], v[180:183]
    ds_read_b64_tr_b16 a[166:167], v13 offset:30112
    s_waitcnt lgkmcnt(4)
    v_mfma_f32_16x16x32_bf16 v[184:187], a[172:175], a[48:51], v[184:187]
    ds_read_b64_tr_b16 a[168:169], v13 offset:29632
    v_mfma_f32_16x16x32_bf16 v[188:191], a[172:175], a[52:55], v[188:191]
    ds_read_b64_tr_b16 a[170:171], v13 offset:30144
    buffer_load_dwordx4 v9, s[12:15], s25 offen offset:1056 lds
    s_waitcnt vmcnt(37)
    s_waitcnt lgkmcnt(4)
    v_mfma_f32_16x16x32_bf16 v[160:163], a[160:163], a[56:59], v[160:163]
    ds_read_b64_tr_b16 a[172:173], v13 offset:29664
    v_mfma_f32_16x16x32_bf16 v[164:167], a[160:163], a[60:63], v[164:167]
    ds_read_b64_tr_b16 a[174:175], v13 offset:30176
    s_waitcnt lgkmcnt(4)
    v_mfma_f32_16x16x32_bf16 v[168:171], a[164:167], a[56:59], v[168:171]
    s_waitcnt vmcnt(35)
    s_barrier
    ds_read_b64_tr_b16 a[160:161], v13 offset:38016
    v_mfma_f32_16x16x32_bf16 v[172:175], a[164:167], a[60:63], v[172:175]
    ds_read_b64_tr_b16 a[162:163], v13 offset:38528
    s_add_u32 s25, s27, 2883584
    s_add_u32 m0, s28, 0
    s_nop 0
    buffer_load_dwordx4 v8, s[12:15], s25 offen offset:0 lds
    s_waitcnt lgkmcnt(4)
    v_mfma_f32_16x16x32_bf16 v[176:179], a[168:171], a[56:59], v[176:179]
    ds_read_b64_tr_b16 a[164:165], v13 offset:38048
    v_mfma_f32_16x16x32_bf16 v[180:183], a[168:171], a[60:63], v[180:183]
    ds_read_b64_tr_b16 a[166:167], v13 offset:38560
    buffer_load_dwordx4 v9, s[12:15], s25 offen offset:1056 lds
    s_waitcnt lgkmcnt(4)
    v_mfma_f32_16x16x32_bf16 v[184:187], a[172:175], a[56:59], v[184:187]
    ds_read_b64_tr_b16 a[168:169], v13 offset:38080
    v_mfma_f32_16x16x32_bf16 v[188:191], a[172:175], a[60:63], v[188:191]
    ds_read_b64_tr_b16 a[170:171], v13 offset:38592
    s_waitcnt vmcnt(26)
    s_waitcnt lgkmcnt(4)
    v_mfma_f32_16x16x32_bf16 v[160:163], a[160:163], a[64:67], v[160:163]
    ds_read_b64_tr_b16 a[172:173], v13 offset:38112
    v_mfma_f32_16x16x32_bf16 v[164:167], a[160:163], a[68:71], v[164:167]
    ds_read_b64_tr_b16 a[174:175], v13 offset:38624
    s_add_u32 s25, s27, 3342336
    s_add_u32 m0, s28, 16896
    s_nop 0
    buffer_load_dwordx4 v8, s[12:15], s25 offen offset:0 lds
    s_waitcnt lgkmcnt(4)
    v_mfma_f32_16x16x32_bf16 v[168:171], a[164:167], a[64:67], v[168:171]
    ds_read_b64_tr_b16 a[160:161], v13 offset:46464
    v_mfma_f32_16x16x32_bf16 v[172:175], a[164:167], a[68:71], v[172:175]
    ds_read_b64_tr_b16 a[162:163], v13 offset:46976
    s_waitcnt lgkmcnt(4)
    v_mfma_f32_16x16x32_bf16 v[176:179], a[168:171], a[64:67], v[176:179]
    ds_read_b64_tr_b16 a[164:165], v13 offset:46496
    v_mfma_f32_16x16x32_bf16 v[180:183], a[168:171], a[68:71], v[180:183]
    ds_read_b64_tr_b16 a[166:167], v13 offset:47008
    buffer_load_dwordx4 v9, s[12:15], s25 offen offset:1056 lds
    s_waitcnt lgkmcnt(4)
    v_mfma_f32_16x16x32_bf16 v[184:187], a[172:175], a[64:67], v[184:187]
    ds_read_b64_tr_b16 a[168:169], v13 offset:46528
    v_mfma_f32_16x16x32_bf16 v[188:191], a[172:175], a[68:71], v[188:191]
    ds_read_b64_tr_b16 a[170:171], v13 offset:47040
    s_waitcnt vmcnt(26)
    s_waitcnt lgkmcnt(4)
    v_mfma_f32_16x16x32_bf16 v[160:163], a[160:163], a[72:75], v[160:163]
    ds_read_b64_tr_b16 a[172:173], v13 offset:46560
    v_mfma_f32_16x16x32_bf16 v[164:167], a[160:163], a[76:79], v[164:167]
    ds_read_b64_tr_b16 a[174:175], v13 offset:47072
    s_add_u32 s25, s30, 196608
    s_add_u32 m0, s28, 33792
    s_nop 0
    buffer_load_dwordx4 v118, s[12:15], s25 offen offset:0 lds
    s_waitcnt lgkmcnt(4)
    v_mfma_f32_16x16x32_bf16 v[168:171], a[164:167], a[72:75], v[168:171]
    s_waitcnt vmcnt(25)
    s_barrier
    ds_read_b64_tr_b16 a[160:161], v14 offset:4224
    v_mfma_f32_16x16x32_bf16 v[172:175], a[164:167], a[76:79], v[172:175]
    ds_read_b64_tr_b16 a[162:163], v14 offset:4736
    buffer_load_dwordx4 v119, s[12:15], s25 offen offset:1056 lds
    s_waitcnt lgkmcnt(4)
    v_mfma_f32_16x16x32_bf16 v[176:179], a[168:171], a[72:75], v[176:179]
    ds_read_b64_tr_b16 a[164:165], v14 offset:4256
    v_mfma_f32_16x16x32_bf16 v[180:183], a[168:171], a[76:79], v[180:183]
    ds_read_b64_tr_b16 a[166:167], v14 offset:4768
    s_waitcnt lgkmcnt(4)
    v_mfma_f32_16x16x32_bf16 v[184:187], a[172:175], a[72:75], v[184:187]
    ds_read_b64_tr_b16 a[168:169], v14 offset:4288
    v_mfma_f32_16x16x32_bf16 v[188:191], a[172:175], a[76:79], v[188:191]
    ds_read_b64_tr_b16 a[170:171], v14 offset:4800
    s_add_u32 s25, s30, 1114112
    s_add_u32 m0, s28, 50688
    s_nop 0
    buffer_load_dwordx4 v118, s[12:15], s25 offen offset:0 lds
    s_waitcnt vmcnt(25)
    s_waitcnt lgkmcnt(4)
    v_mfma_f32_16x16x32_bf16 v[160:163], a[160:163], a[80:83], v[160:163]
    ds_read_b64_tr_b16 a[172:173], v14 offset:4320
    v_mfma_f32_16x16x32_bf16 v[164:167], a[160:163], a[84:87], v[164:167]
    ds_read_b64_tr_b16 a[174:175], v14 offset:4832
    s_waitcnt lgkmcnt(4)
    v_mfma_f32_16x16x32_bf16 v[168:171], a[164:167], a[80:83], v[168:171]
    ds_read_b64_tr_b16 a[160:161], v14 offset:12672
    v_mfma_f32_16x16x32_bf16 v[172:175], a[164:167], a[84:87], v[172:175]
    ds_read_b64_tr_b16 a[162:163], v14 offset:13184
    buffer_load_dwordx4 v119, s[12:15], s25 offen offset:1056 lds
    s_waitcnt lgkmcnt(4)
    v_mfma_f32_16x16x32_bf16 v[176:179], a[168:171], a[80:83], v[176:179]
    ds_read_b64_tr_b16 a[164:165], v14 offset:12704
    v_mfma_f32_16x16x32_bf16 v[180:183], a[168:171], a[84:87], v[180:183]
    ds_read_b64_tr_b16 a[166:167], v14 offset:13216
    s_waitcnt lgkmcnt(4)
    v_mfma_f32_16x16x32_bf16 v[184:187], a[172:175], a[80:83], v[184:187]
    ds_read_b64_tr_b16 a[168:169], v14 offset:12736
    v_mfma_f32_16x16x32_bf16 v[188:191], a[172:175], a[84:87], v[188:191]
    ds_read_b64_tr_b16 a[170:171], v14 offset:13248
    s_add_u32 s25, s30, 2031616
    s_add_u32 m0, s28, 67584
    s_nop 0
    buffer_load_dwordx4 v118, s[12:15], s25 offen offset:0 lds
    s_waitcnt vmcnt(25)
    s_waitcnt lgkmcnt(4)
    v_mfma_f32_16x16x32_bf16 v[160:163], a[160:163], a[88:91], v[160:163]
    ds_read_b64_tr_b16 a[172:173], v14 offset:12768
    v_mfma_f32_16x16x32_bf16 v[164:167], a[160:163], a[92:95], v[164:167]
    ds_read_b64_tr_b16 a[174:175], v14 offset:13280
    buffer_load_dwordx4 v119, s[12:15], s25 offen offset:1056 lds
    s_waitcnt lgkmcnt(4)
    v_mfma_f32_16x16x32_bf16 v[168:171], a[164:167], a[88:91], v[168:171]
    s_waitcnt vmcnt(24)
    s_barrier
    ds_read_b64_tr_b16 a[160:161], v14 offset:21120
    v_mfma_f32_16x16x32_bf16 v[172:175], a[164:167], a[92:95], v[172:175]
    ds_read_b64_tr_b16 a[162:163], v14 offset:21632
    s_waitcnt lgkmcnt(4)
    v_mfma_f32_16x16x32_bf16 v[176:179], a[168:171], a[88:91], v[176:179]
    ds_read_b64_tr_b16 a[164:165], v14 offset:21152
    v_mfma_f32_16x16x32_bf16 v[180:183], a[168:171], a[92:95], v[180:183]
    ds_read_b64_tr_b16 a[166:167], v14 offset:21664
    s_add_u32 s25, s30, 2949120
    s_add_u32 m0, s28, 84480
    s_nop 0
    buffer_load_dwordx4 v118, s[12:15], s25 offen offset:0 lds
    s_waitcnt lgkmcnt(4)
    v_mfma_f32_16x16x32_bf16 v[184:187], a[172:175], a[88:91], v[184:187]
    ds_read_b64_tr_b16 a[168:169], v14 offset:21184
    v_mfma_f32_16x16x32_bf16 v[188:191], a[172:175], a[92:95], v[188:191]
    ds_read_b64_tr_b16 a[170:171], v14 offset:21696
    s_waitcnt vmcnt(23)
    s_waitcnt lgkmcnt(4)
    v_mfma_f32_16x16x32_bf16 v[160:163], a[160:163], a[96:99], v[160:163]
    ds_read_b64_tr_b16 a[172:173], v14 offset:21216
    v_mfma_f32_16x16x32_bf16 v[164:167], a[160:163], a[100:103], v[164:167]
    ds_read_b64_tr_b16 a[174:175], v14 offset:21728
    buffer_load_dwordx4 v119, s[12:15], s25 offen offset:1056 lds
    s_waitcnt lgkmcnt(4)
    v_mfma_f32_16x16x32_bf16 v[168:171], a[164:167], a[96:99], v[168:171]
    ds_read_b64_tr_b16 a[160:161], v14 offset:29568
    v_mfma_f32_16x16x32_bf16 v[172:175], a[164:167], a[100:103], v[172:175]
    ds_read_b64_tr_b16 a[162:163], v14 offset:30080
    s_waitcnt lgkmcnt(4)
    v_mfma_f32_16x16x32_bf16 v[176:179], a[168:171], a[96:99], v[176:179]
    ds_read_b64_tr_b16 a[164:165], v14 offset:29600
    v_mfma_f32_16x16x32_bf16 v[180:183], a[168:171], a[100:103], v[180:183]
    ds_read_b64_tr_b16 a[166:167], v14 offset:30112
    s_waitcnt lgkmcnt(4)
    v_mfma_f32_16x16x32_bf16 v[184:187], a[172:175], a[96:99], v[184:187]
    ds_read_b64_tr_b16 a[168:169], v14 offset:29632
    v_mfma_f32_16x16x32_bf16 v[188:191], a[172:175], a[100:103], v[188:191]
    ds_read_b64_tr_b16 a[170:171], v14 offset:30144
    s_waitcnt vmcnt(22)
    s_waitcnt lgkmcnt(4)
    v_mfma_f32_16x16x32_bf16 v[160:163], a[160:163], a[104:107], v[160:163]
    ds_read_b64_tr_b16 a[172:173], v14 offset:29664
    v_mfma_f32_16x16x32_bf16 v[164:167], a[160:163], a[108:111], v[164:167]
    ds_read_b64_tr_b16 a[174:175], v14 offset:30176
    s_waitcnt lgkmcnt(4)
    v_mfma_f32_16x16x32_bf16 v[168:171], a[164:167], a[104:107], v[168:171]
    s_waitcnt vmcnt(20)
    s_barrier
    ds_read_b64_tr_b16 a[160:161], v14 offset:38016
    v_mfma_f32_16x16x32_bf16 v[172:175], a[164:167], a[108:111], v[172:175]
    ds_read_b64_tr_b16 a[162:163], v14 offset:38528
    s_waitcnt lgkmcnt(4)
    v_mfma_f32_16x16x32_bf16 v[176:179], a[168:171], a[104:107], v[176:179]
    ds_read_b64_tr_b16 a[164:165], v14 offset:38048
    v_mfma_f32_16x16x32_bf16 v[180:183], a[168:171], a[108:111], v[180:183]
    ds_read_b64_tr_b16 a[166:167], v14 offset:38560
    s_waitcnt lgkmcnt(4)
    v_mfma_f32_16x16x32_bf16 v[184:187], a[172:175], a[104:107], v[184:187]
    ds_read_b64_tr_b16 a[168:169], v14 offset:46464
    v_mfma_f32_16x16x32_bf16 v[188:191], a[172:175], a[108:111], v[188:191]
    ds_read_b64_tr_b16 a[170:171], v14 offset:46976
    s_waitcnt vmcnt(18)
    s_waitcnt lgkmcnt(4)
    v_mfma_f32_16x16x32_bf16 v[160:163], a[160:163], a[112:115], v[160:163]
    ds_read_b64_tr_b16 a[172:173], v14 offset:46496
    v_mfma_f32_16x16x32_bf16 v[164:167], a[160:163], a[116:119], v[164:167]
    ds_read_b64_tr_b16 a[174:175], v14 offset:47008
    s_waitcnt lgkmcnt(4)
    v_mfma_f32_16x16x32_bf16 v[168:171], a[164:167], a[112:115], v[168:171]
    ds_read_b64_tr_b16 a[160:161], v14 offset:38080
    v_mfma_f32_16x16x32_bf16 v[172:175], a[164:167], a[116:119], v[172:175]
    ds_read_b64_tr_b16 a[162:163], v14 offset:38592
    s_waitcnt vmcnt(16)
    s_waitcnt lgkmcnt(4)
    v_mfma_f32_16x16x32_bf16 v[160:163], a[168:171], a[120:123], v[160:163]
    ds_read_b64_tr_b16 a[164:165], v14 offset:38112
    v_mfma_f32_16x16x32_bf16 v[164:167], a[168:171], a[124:127], v[164:167]
    ds_read_b64_tr_b16 a[166:167], v14 offset:38624
    s_waitcnt lgkmcnt(4)
    v_mfma_f32_16x16x32_bf16 v[168:171], a[172:175], a[120:123], v[168:171]
    ds_read_b64_tr_b16 a[168:169], v14 offset:46528
    v_mfma_f32_16x16x32_bf16 v[172:175], a[172:175], a[124:127], v[172:175]
    ds_read_b64_tr_b16 a[170:171], v14 offset:47040
    s_waitcnt lgkmcnt(4)
    v_mfma_f32_16x16x32_bf16 v[176:179], a[160:163], a[112:115], v[176:179]
    ds_read_b64_tr_b16 a[172:173], v14 offset:46560
    v_mfma_f32_16x16x32_bf16 v[180:183], a[160:163], a[116:119], v[180:183]
    ds_read_b64_tr_b16 a[174:175], v14 offset:47072
    s_waitcnt lgkmcnt(4)
    v_mfma_f32_16x16x32_bf16 v[184:187], a[164:167], a[112:115], v[184:187]
    s_waitcnt vmcnt(12)
    s_barrier
    ds_read_b64_tr_b16 a[160:161], v15 offset:0
    v_mfma_f32_16x16x32_bf16 v[188:191], a[164:167], a[116:119], v[188:191]
    ds_read_b64_tr_b16 a[162:163], v15 offset:512
    s_waitcnt lgkmcnt(4)
    v_mfma_f32_16x16x32_bf16 v[176:179], a[168:171], a[120:123], v[176:179]
    ds_read_b64_tr_b16 a[164:165], v15 offset:32
    v_mfma_f32_16x16x32_bf16 v[180:183], a[168:171], a[124:127], v[180:183]
    ds_read_b64_tr_b16 a[166:167], v15 offset:544
    s_waitcnt lgkmcnt(4)
    v_mfma_f32_16x16x32_bf16 v[184:187], a[172:175], a[120:123], v[184:187]
    ds_read_b64_tr_b16 a[168:169], v15 offset:64
    v_mfma_f32_16x16x32_bf16 v[188:191], a[172:175], a[124:127], v[188:191]
    ds_read_b64_tr_b16 a[170:171], v15 offset:576
    s_waitcnt lgkmcnt(4)
    v_mfma_f32_16x16x32_bf16 v[128:131], a[160:163], a[0:3], v[128:131]
    ds_read_b64_tr_b16 a[172:173], v15 offset:96
    v_cvt_pk_bf16_f32 v160, v160, v161
    v_mfma_f32_16x16x32_bf16 v[132:135], a[160:163], a[4:7], v[132:135]
    ds_read_b64_tr_b16 a[174:175], v15 offset:608
    v_cvt_pk_bf16_f32 v161, v162, v163
    s_waitcnt lgkmcnt(4)
    v_mfma_f32_16x16x32_bf16 v[136:139], a[164:167], a[0:3], v[136:139]
    ds_read_b64_tr_b16 a[160:161], v15 offset:8448
    v_cvt_pk_bf16_f32 v162, v168, v169
    v_mfma_f32_16x16x32_bf16 v[140:143], a[164:167], a[4:7], v[140:143]
    ds_read_b64_tr_b16 a[162:163], v15 offset:8960
    v_cvt_pk_bf16_f32 v163, v170, v171
    s_waitcnt lgkmcnt(4)
    v_mfma_f32_16x16x32_bf16 v[144:147], a[168:171], a[0:3], v[144:147]
    ds_read_b64_tr_b16 a[164:165], v15 offset:8480
    buffer_store_dwordx4 v[160:163], v1, s[56:59], s60 offen offset:0 sc1
    v_mfma_f32_16x16x32_bf16 v[148:151], a[168:171], a[4:7], v[148:151]
    ds_read_b64_tr_b16 a[166:167], v15 offset:8992
    v_cvt_pk_bf16_f32 v164, v164, v165
    s_waitcnt lgkmcnt(4)
    v_mfma_f32_16x16x32_bf16 v[152:155], a[172:175], a[0:3], v[152:155]
    ds_read_b64_tr_b16 a[168:169], v15 offset:8512
    v_cvt_pk_bf16_f32 v165, v166, v167
    v_mfma_f32_16x16x32_bf16 v[156:159], a[172:175], a[4:7], v[156:159]
    ds_read_b64_tr_b16 a[170:171], v15 offset:9024
    v_cvt_pk_bf16_f32 v166, v172, v173
    s_waitcnt lgkmcnt(4)
    v_mfma_f32_16x16x32_bf16 v[128:131], a[160:163], a[8:11], v[128:131]
    ds_read_b64_tr_b16 a[172:173], v15 offset:8544
    v_cvt_pk_bf16_f32 v167, v174, v175
    v_mfma_f32_16x16x32_bf16 v[132:135], a[160:163], a[12:15], v[132:135]
    ds_read_b64_tr_b16 a[174:175], v15 offset:9056
    buffer_store_dwordx4 v[164:167], v1, s[56:59], s60 offen offset:2048 sc1
    s_waitcnt lgkmcnt(4)
    v_mfma_f32_16x16x32_bf16 v[136:139], a[164:167], a[8:11], v[136:139]
    ds_read_b64_tr_b16 a[160:161], v15 offset:16896
    v_cvt_pk_bf16_f32 v176, v176, v177
    v_mfma_f32_16x16x32_bf16 v[140:143], a[164:167], a[12:15], v[140:143]
    ds_read_b64_tr_b16 a[162:163], v15 offset:17408
    v_cvt_pk_bf16_f32 v177, v178, v179
    s_waitcnt lgkmcnt(4)
    v_mfma_f32_16x16x32_bf16 v[144:147], a[168:171], a[8:11], v[144:147]
    ds_read_b64_tr_b16 a[164:165], v15 offset:16928
    v_cvt_pk_bf16_f32 v178, v184, v185
    v_mfma_f32_16x16x32_bf16 v[148:151], a[168:171], a[12:15], v[148:151]
    ds_read_b64_tr_b16 a[166:167], v15 offset:17440
    v_cvt_pk_bf16_f32 v179, v186, v187
    s_waitcnt lgkmcnt(4)
    v_mfma_f32_16x16x32_bf16 v[152:155], a[172:175], a[8:11], v[152:155]
    ds_read_b64_tr_b16 a[168:169], v15 offset:16960
    buffer_store_dwordx4 v[176:179], v1, s[56:59], s60 offen offset:1024 sc1
    v_mfma_f32_16x16x32_bf16 v[156:159], a[172:175], a[12:15], v[156:159]
    ds_read_b64_tr_b16 a[170:171], v15 offset:17472
    v_cvt_pk_bf16_f32 v180, v180, v181
    s_waitcnt lgkmcnt(4)
    v_mfma_f32_16x16x32_bf16 v[128:131], a[160:163], a[16:19], v[128:131]
    ds_read_b64_tr_b16 a[172:173], v15 offset:16992
    v_cvt_pk_bf16_f32 v181, v182, v183
    v_mfma_f32_16x16x32_bf16 v[132:135], a[160:163], a[20:23], v[132:135]
    ds_read_b64_tr_b16 a[174:175], v15 offset:17504
    v_cvt_pk_bf16_f32 v182, v188, v189
    s_waitcnt lgkmcnt(4)
    v_mfma_f32_16x16x32_bf16 v[136:139], a[164:167], a[16:19], v[136:139]
    ds_read_b64_tr_b16 a[160:161], v15 offset:25344
    v_cvt_pk_bf16_f32 v183, v190, v191
    v_mfma_f32_16x16x32_bf16 v[140:143], a[164:167], a[20:23], v[140:143]
    ds_read_b64_tr_b16 a[162:163], v15 offset:25856
    buffer_store_dwordx4 v[180:183], v1, s[56:59], s60 offen offset:3072 sc1
    s_waitcnt lgkmcnt(4)
    v_mfma_f32_16x16x32_bf16 v[144:147], a[168:171], a[16:19], v[144:147]
    ds_read_b64_tr_b16 a[164:165], v15 offset:25376
    s_waitcnt vmcnt(43)
    v_mfma_f32_16x16x32_bf16 v[148:151], a[168:171], a[20:23], v[148:151]
    ds_read_b64_tr_b16 a[166:167], v15 offset:25888
    v_add_f32 v52, v52, v53
    s_waitcnt lgkmcnt(4)
    v_mfma_f32_16x16x32_bf16 v[152:155], a[172:175], a[16:19], v[152:155]
    ds_read_b64_tr_b16 a[168:169], v15 offset:25408
    v_add_f32 v54, v54, v55
    v_mfma_f32_16x16x32_bf16 v[156:159], a[172:175], a[20:23], v[156:159]
    ds_read_b64_tr_b16 a[170:171], v15 offset:25920
    v_add_f32 v52, v52, v54
    s_waitcnt lgkmcnt(4)
    v_mfma_f32_16x16x32_bf16 v[128:131], a[160:163], a[24:27], v[128:131]
    ds_read_b64_tr_b16 a[172:173], v15 offset:25440
    v_mov_b32 v53, v52
    v_mfma_f32_16x16x32_bf16 v[132:135], a[160:163], a[28:31], v[132:135]
    ds_read_b64_tr_b16 a[174:175], v15 offset:25952
    s_nop 1
    s_waitcnt lgkmcnt(4)
    v_mfma_f32_16x16x32_bf16 v[136:139], a[164:167], a[24:27], v[136:139]
    s_waitcnt vmcnt(12)
    s_barrier
    ds_read_b64_tr_b16 a[160:161], v13 offset:0
    v_permlane32_swap_b32 v52, v53
    v_mfma_f32_16x16x32_bf16 v[140:143], a[164:167], a[28:31], v[140:143]
    ds_read_b64_tr_b16 a[162:163], v13 offset:512
    v_add_f32 v52, v52, v53
    s_waitcnt lgkmcnt(4)
    v_mfma_f32_16x16x32_bf16 v[144:147], a[168:171], a[24:27], v[144:147]
    ds_read_b64_tr_b16 a[164:165], v13 offset:32
    v_mov_b32 v53, v52
    v_mfma_f32_16x16x32_bf16 v[148:151], a[168:171], a[28:31], v[148:151]
    ds_read_b64_tr_b16 a[166:167], v13 offset:544
    s_nop 1
    s_waitcnt lgkmcnt(4)
    v_mfma_f32_16x16x32_bf16 v[152:155], a[172:175], a[24:27], v[152:155]
    ds_read_b64_tr_b16 a[168:169], v13 offset:64
    v_permlane16_swap_b32 v52, v53
    v_mfma_f32_16x16x32_bf16 v[156:159], a[172:175], a[28:31], v[156:159]
    ds_read_b64_tr_b16 a[170:171], v13 offset:576
    v_add_f32 v52, v52, v53
    s_waitcnt lgkmcnt(4)
    v_mfma_f32_16x16x32_bf16 v[128:131], a[160:163], a[32:35], v[128:131]
    ds_read_b64_tr_b16 a[172:173], v13 offset:96
    v_mov_b32 v53, 0x3727c5ac
    v_mfma_f32_16x16x32_bf16 v[132:135], a[160:163], a[36:39], v[132:135]
    ds_read_b64_tr_b16 a[174:175], v13 offset:608
    v_fmac_f32 v53, 0x3a800000, v52
    s_waitcnt lgkmcnt(4)
    v_mfma_f32_16x16x32_bf16 v[136:139], a[164:167], a[32:35], v[136:139]
    ds_read_b64_tr_b16 a[160:161], v13 offset:8448
    v_rcp_f32 v16, v53
    v_mfma_f32_16x16x32_bf16 v[140:143], a[164:167], a[36:39], v[140:143]
    ds_read_b64_tr_b16 a[162:163], v13 offset:8960
    v_add_f32 v56, v56, v57
    s_waitcnt lgkmcnt(4)
    v_mfma_f32_16x16x32_bf16 v[144:147], a[168:171], a[32:35], v[144:147]
    ds_read_b64_tr_b16 a[164:165], v13 offset:8480
    v_add_f32 v58, v58, v59
    v_mfma_f32_16x16x32_bf16 v[148:151], a[168:171], a[36:39], v[148:151]
    ds_read_b64_tr_b16 a[166:167], v13 offset:8992
    v_add_f32 v56, v56, v58
    s_waitcnt lgkmcnt(4)
    v_mfma_f32_16x16x32_bf16 v[152:155], a[172:175], a[32:35], v[152:155]
    ds_read_b64_tr_b16 a[168:169], v13 offset:8512
    v_mov_b32 v57, v56
    v_mfma_f32_16x16x32_bf16 v[156:159], a[172:175], a[36:39], v[156:159]
    ds_read_b64_tr_b16 a[170:171], v13 offset:9024
    s_nop 1
    s_waitcnt lgkmcnt(4)
    v_mfma_f32_16x16x32_bf16 v[128:131], a[160:163], a[40:43], v[128:131]
    ds_read_b64_tr_b16 a[172:173], v13 offset:8544
    v_permlane32_swap_b32 v56, v57
    v_mfma_f32_16x16x32_bf16 v[132:135], a[160:163], a[44:47], v[132:135]
    ds_read_b64_tr_b16 a[174:175], v13 offset:9056
    v_add_f32 v56, v56, v57
    s_waitcnt lgkmcnt(4)
    v_mfma_f32_16x16x32_bf16 v[136:139], a[164:167], a[40:43], v[136:139]
    ds_read_b64_tr_b16 a[160:161], v13 offset:16896
    v_mov_b32 v57, v56
    v_mfma_f32_16x16x32_bf16 v[140:143], a[164:167], a[44:47], v[140:143]
    ds_read_b64_tr_b16 a[162:163], v13 offset:17408
    s_nop 1
    s_waitcnt lgkmcnt(4)
    v_mfma_f32_16x16x32_bf16 v[144:147], a[168:171], a[40:43], v[144:147]
    ds_read_b64_tr_b16 a[164:165], v13 offset:16928
    v_permlane16_swap_b32 v56, v57
    v_mfma_f32_16x16x32_bf16 v[148:151], a[168:171], a[44:47], v[148:151]
    ds_read_b64_tr_b16 a[166:167], v13 offset:17440
    v_add_f32 v56, v56, v57
    s_waitcnt lgkmcnt(4)
    v_mfma_f32_16x16x32_bf16 v[152:155], a[172:175], a[40:43], v[152:155]
    ds_read_b64_tr_b16 a[168:169], v13 offset:16960
    v_mov_b32 v57, 0x3727c5ac
    v_mfma_f32_16x16x32_bf16 v[156:159], a[172:175], a[44:47], v[156:159]
    ds_read_b64_tr_b16 a[170:171], v13 offset:17472
    v_fmac_f32 v57, 0x3a800000, v56
    s_waitcnt lgkmcnt(4)
    v_mfma_f32_16x16x32_bf16 v[128:131], a[160:163], a[48:51], v[128:131]
    ds_read_b64_tr_b16 a[172:173], v13 offset:16992
    v_rcp_f32 v17, v57
    v_mfma_f32_16x16x32_bf16 v[132:135], a[160:163], a[52:55], v[132:135]
    ds_read_b64_tr_b16 a[174:175], v13 offset:17504
    v_lshlrev_b32 v84, 16, v36
    s_waitcnt lgkmcnt(4)
    v_mfma_f32_16x16x32_bf16 v[136:139], a[164:167], a[48:51], v[136:139]
    ds_read_b64_tr_b16 a[160:161], v13 offset:25344
    v_and_b32 v85, 0xffff0000, v36
    v_mfma_f32_16x16x32_bf16 v[140:143], a[164:167], a[52:55], v[140:143]
    ds_read_b64_tr_b16 a[162:163], v13 offset:25856
    v_lshlrev_b32 v86, 16, v37
    s_waitcnt lgkmcnt(4)
    v_mfma_f32_16x16x32_bf16 v[144:147], a[168:171], a[48:51], v[144:147]
    ds_read_b64_tr_b16 a[164:165], v13 offset:25376
    v_and_b32 v87, 0xffff0000, v37
    v_mfma_f32_16x16x32_bf16 v[148:151], a[168:171], a[52:55], v[148:151]
    ds_read_b64_tr_b16 a[166:167], v13 offset:25888
    v_add_f32 v84, v84, v32
    s_waitcnt lgkmcnt(4)
    v_mfma_f32_16x16x32_bf16 v[152:155], a[172:175], a[48:51], v[152:155]
    ds_read_b64_tr_b16 a[168:169], v13 offset:25408
    v_add_f32 v85, v85, v32
    v_mfma_f32_16x16x32_bf16 v[156:159], a[172:175], a[52:55], v[156:159]
    ds_read_b64_tr_b16 a[170:171], v13 offset:25920
    v_add_f32 v86, v86, v32
    s_waitcnt lgkmcnt(4)
    v_mfma_f32_16x16x32_bf16 v[128:131], a[160:163], a[56:59], v[128:131]
    ds_read_b64_tr_b16 a[172:173], v13 offset:25440
    v_add_f32 v87, v87, v32
    v_mfma_f32_16x16x32_bf16 v[132:135], a[160:163], a[60:63], v[132:135]
    ds_read_b64_tr_b16 a[174:175], v13 offset:25952
    v_lshlrev_b32 v88, 16, v38
    s_waitcnt lgkmcnt(4)
    v_mfma_f32_16x16x32_bf16 v[136:139], a[164:167], a[56:59], v[136:139]
    s_waitcnt vmcnt(8)
    s_barrier
    ds_read_b64_tr_b16 a[160:161], v13 offset:33792
    v_and_b32 v89, 0xffff0000, v38
    v_mfma_f32_16x16x32_bf16 v[140:143], a[164:167], a[60:63], v[140:143]
    ds_read_b64_tr_b16 a[162:163], v13 offset:34304
    v_lshlrev_b32 v90, 16, v39
    s_waitcnt lgkmcnt(4)
    v_mfma_f32_16x16x32_bf16 v[144:147], a[168:171], a[56:59], v[144:147]
    ds_read_b64_tr_b16 a[164:165], v13 offset:33824
    v_and_b32 v91, 0xffff0000, v39
    v_mfma_f32_16x16x32_bf16 v[148:151], a[168:171], a[60:63], v[148:151]
    ds_read_b64_tr_b16 a[166:167], v13 offset:34336
    v_add_f32 v88, v88, v32
    s_waitcnt lgkmcnt(4)
    v_mfma_f32_16x16x32_bf16 v[152:155], a[172:175], a[56:59], v[152:155]
    ds_read_b64_tr_b16 a[168:169], v13 offset:33856
    v_add_f32 v89, v89, v32
    v_mfma_f32_16x16x32_bf16 v[156:159], a[172:175], a[60:63], v[156:159]
    ds_read_b64_tr_b16 a[170:171], v13 offset:34368
    v_add_f32 v90, v90, v32
    s_waitcnt lgkmcnt(4)
    v_mfma_f32_16x16x32_bf16 v[128:131], a[160:163], a[64:67], v[128:131]
    ds_read_b64_tr_b16 a[172:173], v13 offset:33888
    v_add_f32 v91, v91, v32
    v_mfma_f32_16x16x32_bf16 v[132:135], a[160:163], a[68:71], v[132:135]
    ds_read_b64_tr_b16 a[174:175], v13 offset:34400
    v_lshlrev_b32 v92, 16, v40
    s_waitcnt lgkmcnt(4)
    v_mfma_f32_16x16x32_bf16 v[136:139], a[164:167], a[64:67], v[136:139]
    ds_read_b64_tr_b16 a[160:161], v13 offset:42240
    v_and_b32 v93, 0xffff0000, v40
    v_mfma_f32_16x16x32_bf16 v[140:143], a[164:167], a[68:71], v[140:143]
    ds_read_b64_tr_b16 a[162:163], v13 offset:42752
    v_lshlrev_b32 v94, 16, v41
    s_waitcnt lgkmcnt(4)
    v_mfma_f32_16x16x32_bf16 v[144:147], a[168:171], a[64:67], v[144:147]
    ds_read_b64_tr_b16 a[164:165], v13 offset:42272
    v_and_b32 v95, 0xffff0000, v41
    v_mfma_f32_16x16x32_bf16 v[148:151], a[168:171], a[68:71], v[148:151]
    ds_read_b64_tr_b16 a[166:167], v13 offset:42784
    v_add_f32 v92, v92, v32
    s_waitcnt lgkmcnt(4)
    v_mfma_f32_16x16x32_bf16 v[152:155], a[172:175], a[64:67], v[152:155]
    ds_read_b64_tr_b16 a[168:169], v13 offset:42304
    v_add_f32 v93, v93, v32
    v_mfma_f32_16x16x32_bf16 v[156:159], a[172:175], a[68:71], v[156:159]
    ds_read_b64_tr_b16 a[170:171], v13 offset:42816
    v_add_f32 v94, v94, v32
    s_waitcnt lgkmcnt(4)
    v_mfma_f32_16x16x32_bf16 v[128:131], a[160:163], a[72:75], v[128:131]
    ds_read_b64_tr_b16 a[172:173], v13 offset:42336
    v_add_f32 v95, v95, v32
    v_mfma_f32_16x16x32_bf16 v[132:135], a[160:163], a[76:79], v[132:135]
    ds_read_b64_tr_b16 a[174:175], v13 offset:42848
    buffer_load_dwordx4 v[68:71], v1, s[56:59], s63 offen offset:0 sc1
    v_lshlrev_b32 v96, 16, v42
    s_waitcnt lgkmcnt(4)
    v_mfma_f32_16x16x32_bf16 v[136:139], a[164:167], a[72:75], v[136:139]
    ds_read_b64_tr_b16 a[160:161], v14 offset:0
    v_and_b32 v97, 0xffff0000, v42
    v_mfma_f32_16x16x32_bf16 v[140:143], a[164:167], a[76:79], v[140:143]
    ds_read_b64_tr_b16 a[162:163], v14 offset:512
    buffer_load_dwordx4 v[72:75], v1, s[56:59], s63 offen offset:1024 sc1
    v_lshlrev_b32 v98, 16, v43
    s_waitcnt lgkmcnt(4)
    v_mfma_f32_16x16x32_bf16 v[144:147], a[168:171], a[72:75], v[144:147]
    ds_read_b64_tr_b16 a[164:165], v14 offset:32
    v_and_b32 v99, 0xffff0000, v43
    v_mfma_f32_16x16x32_bf16 v[148:151], a[168:171], a[76:79], v[148:151]
    ds_read_b64_tr_b16 a[166:167], v14 offset:544
    buffer_load_dwordx4 v[76:79], v1, s[56:59], s63 offen offset:2048 sc1
    v_add_f32 v96, v96, v32
    s_waitcnt lgkmcnt(4)
    v_mfma_f32_16x16x32_bf16 v[152:155], a[172:175], a[72:75], v[152:155]
    ds_read_b64_tr_b16 a[168:169], v14 offset:64
    v_add_f32 v97, v97, v32
    v_mfma_f32_16x16x32_bf16 v[156:159], a[172:175], a[76:79], v[156:159]
    ds_read_b64_tr_b16 a[170:171], v14 offset:576
    buffer_load_dwordx4 v[80:83], v1, s[56:59], s63 offen offset:3072 sc1
    v_add_f32 v98, v98, v32
    s_waitcnt lgkmcnt(4)
    v_mfma_f32_16x16x32_bf16 v[128:131], a[160:163], a[80:83], v[128:131]
    ds_read_b64_tr_b16 a[172:173], v14 offset:96
    v_add_f32 v99, v99, v32
    v_mfma_f32_16x16x32_bf16 v[132:135], a[160:163], a[84:87], v[132:135]
    ds_read_b64_tr_b16 a[174:175], v14 offset:608
    v_lshlrev_b32 v100, 16, v44
    s_waitcnt lgkmcnt(4)
    v_mfma_f32_16x16x32_bf16 v[136:139], a[164:167], a[80:83], v[136:139]
    ds_read_b64_tr_b16 a[160:161], v14 offset:8448
    v_and_b32 v101, 0xffff0000, v44
    v_mfma_f32_16x16x32_bf16 v[140:143], a[164:167], a[84:87], v[140:143]
    ds_read_b64_tr_b16 a[162:163], v14 offset:8960
    v_lshlrev_b32 v102, 16, v45
    s_waitcnt lgkmcnt(4)
    v_mfma_f32_16x16x32_bf16 v[144:147], a[168:171], a[80:83], v[144:147]
    ds_read_b64_tr_b16 a[164:165], v14 offset:8480
    v_and_b32 v103, 0xffff0000, v45
    v_mfma_f32_16x16x32_bf16 v[148:151], a[168:171], a[84:87], v[148:151]
    ds_read_b64_tr_b16 a[166:167], v14 offset:8992
    v_add_f32 v100, v100, v33
    s_waitcnt lgkmcnt(4)
    v_mfma_f32_16x16x32_bf16 v[152:155], a[172:175], a[80:83], v[152:155]
    ds_read_b64_tr_b16 a[168:169], v14 offset:8512
    v_add_f32 v101, v101, v33
    v_mfma_f32_16x16x32_bf16 v[156:159], a[172:175], a[84:87], v[156:159]
    ds_read_b64_tr_b16 a[170:171], v14 offset:9024
    v_add_f32 v102, v102, v33
    s_waitcnt lgkmcnt(4)
    v_mfma_f32_16x16x32_bf16 v[128:131], a[160:163], a[88:91], v[128:131]
    ds_read_b64_tr_b16 a[172:173], v14 offset:8544
    v_add_f32 v103, v103, v33
    v_mfma_f32_16x16x32_bf16 v[132:135], a[160:163], a[92:95], v[132:135]
    ds_read_b64_tr_b16 a[174:175], v14 offset:9056
    v_lshlrev_b32 v104, 16, v46
    s_waitcnt lgkmcnt(4)
    v_mfma_f32_16x16x32_bf16 v[136:139], a[164:167], a[88:91], v[136:139]
    s_waitcnt vmcnt(8)
    s_barrier
    ds_read_b64_tr_b16 a[160:161], v14 offset:16896
    v_and_b32 v105, 0xffff0000, v46
    v_mfma_f32_16x16x32_bf16 v[140:143], a[164:167], a[92:95], v[140:143]
    ds_read_b64_tr_b16 a[162:163], v14 offset:17408
    v_lshlrev_b32 v106, 16, v47
    s_waitcnt lgkmcnt(4)
    v_mfma_f32_16x16x32_bf16 v[144:147], a[168:171], a[88:91], v[144:147]
    ds_read_b64_tr_b16 a[164:165], v14 offset:16928
    v_and_b32 v107, 0xffff0000, v47
    v_mfma_f32_16x16x32_bf16 v[148:151], a[168:171], a[92:95], v[148:151]
    ds_read_b64_tr_b16 a[166:167], v14 offset:17440
    v_add_f32 v104, v104, v33
    s_waitcnt lgkmcnt(4)
    v_mfma_f32_16x16x32_bf16 v[152:155], a[172:175], a[88:91], v[152:155]
    ds_read_b64_tr_b16 a[168:169], v14 offset:16960
    v_add_f32 v105, v105, v33
    v_mfma_f32_16x16x32_bf16 v[156:159], a[172:175], a[92:95], v[156:159]
    ds_read_b64_tr_b16 a[170:171], v14 offset:17472
    v_add_f32 v106, v106, v33
    s_waitcnt lgkmcnt(4)
    v_mfma_f32_16x16x32_bf16 v[128:131], a[160:163], a[96:99], v[128:131]
    ds_read_b64_tr_b16 a[172:173], v14 offset:16992
    v_add_f32 v107, v107, v33
    v_mfma_f32_16x16x32_bf16 v[132:135], a[160:163], a[100:103], v[132:135]
    ds_read_b64_tr_b16 a[174:175], v14 offset:17504
    v_lshlrev_b32 v108, 16, v48
    s_waitcnt lgkmcnt(4)
    v_mfma_f32_16x16x32_bf16 v[136:139], a[164:167], a[96:99], v[136:139]
    ds_read_b64_tr_b16 a[160:161], v14 offset:25344
    v_and_b32 v109, 0xffff0000, v48
    v_mfma_f32_16x16x32_bf16 v[140:143], a[164:167], a[100:103], v[140:143]
    ds_read_b64_tr_b16 a[162:163], v14 offset:25856
    v_lshlrev_b32 v110, 16, v49
    s_waitcnt lgkmcnt(4)
    v_mfma_f32_16x16x32_bf16 v[144:147], a[168:171], a[96:99], v[144:147]
    ds_read_b64_tr_b16 a[164:165], v14 offset:25376
    v_and_b32 v111, 0xffff0000, v49
    v_mfma_f32_16x16x32_bf16 v[148:151], a[168:171], a[100:103], v[148:151]
    ds_read_b64_tr_b16 a[166:167], v14 offset:25888
    v_add_f32 v108, v108, v33
    s_waitcnt lgkmcnt(4)
    v_mfma_f32_16x16x32_bf16 v[152:155], a[172:175], a[96:99], v[152:155]
    ds_read_b64_tr_b16 a[168:169], v14 offset:25408
    v_add_f32 v109, v109, v33
    v_mfma_f32_16x16x32_bf16 v[156:159], a[172:175], a[100:103], v[156:159]
    ds_read_b64_tr_b16 a[170:171], v14 offset:25920
    v_add_f32 v110, v110, v33
    s_waitcnt lgkmcnt(4)
    v_mfma_f32_16x16x32_bf16 v[128:131], a[160:163], a[104:107], v[128:131]
    ds_read_b64_tr_b16 a[172:173], v14 offset:25440
    v_add_f32 v111, v111, v33
    v_mfma_f32_16x16x32_bf16 v[132:135], a[160:163], a[108:111], v[132:135]
    ds_read_b64_tr_b16 a[174:175], v14 offset:25952
    v_lshlrev_b32 v112, 16, v50
    s_waitcnt lgkmcnt(4)
    v_mfma_f32_16x16x32_bf16 v[136:139], a[164:167], a[104:107], v[136:139]
    ds_read_b64_tr_b16 a[160:161], v14 offset:33792
    v_and_b32 v113, 0xffff0000, v50
    v_mfma_f32_16x16x32_bf16 v[140:143], a[164:167], a[108:111], v[140:143]
    ds_read_b64_tr_b16 a[162:163], v14 offset:34304
    v_lshlrev_b32 v114, 16, v51
    s_waitcnt lgkmcnt(4)
    v_mfma_f32_16x16x32_bf16 v[144:147], a[168:171], a[104:107], v[144:147]
    ds_read_b64_tr_b16 a[164:165], v14 offset:33824
    v_and_b32 v115, 0xffff0000, v51
    v_mfma_f32_16x16x32_bf16 v[148:151], a[168:171], a[108:111], v[148:151]
    ds_read_b64_tr_b16 a[166:167], v14 offset:34336
    v_add_f32 v112, v112, v33
    s_waitcnt lgkmcnt(4)
    v_mfma_f32_16x16x32_bf16 v[152:155], a[172:175], a[104:107], v[152:155]
    ds_read_b64_tr_b16 a[168:169], v14 offset:33856
    v_add_f32 v113, v113, v33
    v_mfma_f32_16x16x32_bf16 v[156:159], a[172:175], a[108:111], v[156:159]
    ds_read_b64_tr_b16 a[170:171], v14 offset:34368
    v_add_f32 v114, v114, v33
    s_waitcnt lgkmcnt(4)
    v_mfma_f32_16x16x32_bf16 v[128:131], a[160:163], a[112:115], v[128:131]
    ds_read_b64_tr_b16 a[172:173], v14 offset:33888
    v_add_f32 v115, v115, v33
    v_mfma_f32_16x16x32_bf16 v[132:135], a[160:163], a[116:119], v[132:135]
    ds_read_b64_tr_b16 a[174:175], v14 offset:34400
    s_waitcnt lgkmcnt(4)
    v_mfma_f32_16x16x32_bf16 v[136:139], a[164:167], a[112:115], v[136:139]
    ds_read_b64_tr_b16 a[160:161], v14 offset:42240
    v_mfma_f32_16x16x32_bf16 v[140:143], a[164:167], a[116:119], v[140:143]
    ds_read_b64_tr_b16 a[162:163], v14 offset:42752
    s_waitcnt lgkmcnt(4)
    v_mfma_f32_16x16x32_bf16 v[144:147], a[168:171], a[112:115], v[144:147]
    ds_read_b64_tr_b16 a[164:165], v14 offset:42272
    v_mfma_f32_16x16x32_bf16 v[148:151], a[168:171], a[116:119], v[148:151]
    ds_read_b64_tr_b16 a[166:167], v14 offset:42784
    s_waitcnt lgkmcnt(4)
    v_mfma_f32_16x16x32_bf16 v[152:155], a[172:175], a[112:115], v[152:155]
    ds_read_b64_tr_b16 a[168:169], v14 offset:42304
    v_mfma_f32_16x16x32_bf16 v[156:159], a[172:175], a[116:119], v[156:159]
    ds_read_b64_tr_b16 a[170:171], v14 offset:42816
    s_waitcnt lgkmcnt(4)
    v_mfma_f32_16x16x32_bf16 v[128:131], a[160:163], a[120:123], v[128:131]
    ds_read_b64_tr_b16 a[172:173], v14 offset:42336
    v_mfma_f32_16x16x32_bf16 v[132:135], a[160:163], a[124:127], v[132:135]
    ds_read_b64_tr_b16 a[174:175], v14 offset:42848
    s_waitcnt lgkmcnt(4)
    v_mfma_f32_16x16x32_bf16 v[136:139], a[164:167], a[120:123], v[136:139]
    v_mfma_f32_16x16x32_bf16 v[140:143], a[164:167], a[124:127], v[140:143]
    s_waitcnt lgkmcnt(2)
    v_mfma_f32_16x16x32_bf16 v[144:147], a[168:171], a[120:123], v[144:147]
    v_mfma_f32_16x16x32_bf16 v[148:151], a[168:171], a[124:127], v[148:151]
    s_waitcnt lgkmcnt(0)
    v_mfma_f32_16x16x32_bf16 v[152:155], a[172:175], a[120:123], v[152:155]
    v_mfma_f32_16x16x32_bf16 v[156:159], a[172:175], a[124:127], v[156:159]
    s_nop 7
    v_fmac_f32 v84, v128, v16
    v_fmac_f32 v85, v129, v16
    v_fmac_f32 v86, v130, v16
    v_fmac_f32 v87, v131, v16
    v_fmac_f32 v88, v136, v16
    v_fmac_f32 v89, v137, v16
    v_fmac_f32 v90, v138, v16
    v_fmac_f32 v91, v139, v16
    v_fmac_f32 v92, v144, v16
    v_fmac_f32 v93, v145, v16
    v_fmac_f32 v94, v146, v16
    v_fmac_f32 v95, v147, v16
    v_fmac_f32 v96, v152, v16
    v_fmac_f32 v97, v153, v16
    v_fmac_f32 v98, v154, v16
    v_fmac_f32 v99, v155, v16
    v_fmac_f32 v100, v132, v17
    v_fmac_f32 v101, v133, v17
    v_fmac_f32 v102, v134, v17
    v_fmac_f32 v103, v135, v17
    v_fmac_f32 v104, v140, v17
    v_fmac_f32 v105, v141, v17
    v_fmac_f32 v106, v142, v17
    v_fmac_f32 v107, v143, v17
    v_fmac_f32 v108, v148, v17
    v_fmac_f32 v109, v149, v17
    v_fmac_f32 v110, v150, v17
    v_fmac_f32 v111, v151, v17
    v_fmac_f32 v112, v156, v17
    v_fmac_f32 v113, v157, v17
    v_fmac_f32 v114, v158, v17
    v_fmac_f32 v115, v159, v17
    s_branch g34_kernel_chk
g34_kernel_retry:
    buffer_load_dwordx4 v[68:71], v1, s[56:59], s63 offen offset:0 sc1
    buffer_load_dwordx4 v[72:75], v1, s[56:59], s63 offen offset:1024 sc1
    buffer_load_dwordx4 v[76:79], v1, s[56:59], s63 offen offset:2048 sc1
    buffer_load_dwordx4 v[80:83], v1, s[56:59], s63 offen offset:3072 sc1
g34_kernel_chk:
    s_waitcnt vmcnt(0)
    v_max_u32 v22, v68, v69
    v_max_u32 v23, v70, v71
    v_max3_u32 v22, v22, v72, v73
    v_max3_u32 v23, v23, v74, v75
    v_max3_u32 v22, v22, v76, v77
    v_max3_u32 v23, v23, v78, v79
    v_max3_u32 v22, v22, v80, v81
    v_max3_u32 v23, v23, v82, v83
    v_max_u32 v22, v22, v23
    v_cmp_eq_u32 vcc, -1, v22
    s_add_u32 s66, s66, 1
    s_cmp_lt_u32 s66, 0x20000
    s_cselect_b64 s[68:69], vcc, 0
    s_cmp_lg_u64 s[68:69], 0
    s_cbranch_scc1 g34_kernel_retry
    v_lshlrev_b32 v36, 16, v68
    v_and_b32 v37, 0xffff0000, v68
    v_lshlrev_b32 v38, 16, v69
    v_and_b32 v39, 0xffff0000, v69
    v_fmac_f32 v84, v36, v16
    v_fmac_f32 v85, v37, v16
    v_fmac_f32 v86, v38, v16
    v_fmac_f32 v87, v39, v16
    v_cvt_pk_bf16_f32 v84, v84, v85
    v_cvt_pk_bf16_f32 v85, v86, v87
    ds_write_b64 v24, v[84:85] offset:0
    v_lshlrev_b32 v40, 16, v70
    v_and_b32 v41, 0xffff0000, v70
    v_lshlrev_b32 v42, 16, v71
    v_and_b32 v43, 0xffff0000, v71
    v_fmac_f32 v88, v40, v16
    v_fmac_f32 v89, v41, v16
    v_fmac_f32 v90, v42, v16
    v_fmac_f32 v91, v43, v16
    v_cvt_pk_bf16_f32 v88, v88, v89
    v_cvt_pk_bf16_f32 v89, v90, v91
    ds_write_b64 v25, v[88:89] offset:0
    v_lshlrev_b32 v36, 16, v72
    v_and_b32 v37, 0xffff0000, v72
    v_lshlrev_b32 v38, 16, v73
    v_and_b32 v39, 0xffff0000, v73
    v_fmac_f32 v92, v36, v16
    v_fmac_f32 v93, v37, v16
    v_fmac_f32 v94, v38, v16
    v_fmac_f32 v95, v39, v16
    v_cvt_pk_bf16_f32 v92, v92, v93
    v_cvt_pk_bf16_f32 v93, v94, v95
    ds_write_b64 v26, v[92:93] offset:0
    v_lshlrev_b32 v40, 16, v74
    v_and_b32 v41, 0xffff0000, v74
    v_lshlrev_b32 v42, 16, v75
    v_and_b32 v43, 0xffff0000, v75
    v_fmac_f32 v96, v40, v16
    v_fmac_f32 v97, v41, v16
    v_fmac_f32 v98, v42, v16
    v_fmac_f32 v99, v43, v16
    v_cvt_pk_bf16_f32 v96, v96, v97
    v_cvt_pk_bf16_f32 v97, v98, v99
    ds_write_b64 v27, v[96:97] offset:0
    v_lshlrev_b32 v36, 16, v76
    v_and_b32 v37, 0xffff0000, v76
    v_lshlrev_b32 v38, 16, v77
    v_and_b32 v39, 0xffff0000, v77
    v_fmac_f32 v100, v36, v17
    v_fmac_f32 v101, v37, v17
    v_fmac_f32 v102, v38, v17
    v_fmac_f32 v103, v39, v17
    v_cvt_pk_bf16_f32 v100, v100, v101
    v_cvt_pk_bf16_f32 v101, v102, v103
    ds_write_b64 v24, v[100:101] offset:2048
    v_lshlrev_b32 v40, 16, v78
    v_and_b32 v41, 0xffff0000, v78
    v_lshlrev_b32 v42, 16, v79
    v_and_b32 v43, 0xffff0000, v79
    v_fmac_f32 v104, v40, v17
    v_fmac_f32 v105, v41, v17
    v_fmac_f32 v106, v42, v17
    v_fmac_f32 v107, v43, v17
    v_cvt_pk_bf16_f32 v104, v104, v105
    v_cvt_pk_bf16_f32 v105, v106, v107
    ds_write_b64 v25, v[104:105] offset:2048
    v_lshlrev_b32 v36, 16, v80
    v_and_b32 v37, 0xffff0000, v80
    v_lshlrev_b32 v38, 16, v81
    v_and_b32 v39, 0xffff0000, v81
    v_fmac_f32 v108, v36, v17
    v_fmac_f32 v109, v37, v17
    v_fmac_f32 v110, v38, v17
    v_fmac_f32 v111, v39, v17
    v_cvt_pk_bf16_f32 v108, v108, v109
    v_cvt_pk_bf16_f32 v109, v110, v111
    ds_write_b64 v26, v[108:109] offset:2048
    v_lshlrev_b32 v40, 16, v82
    v_and_b32 v41, 0xffff0000, v82
    v_lshlrev_b32 v42, 16, v83
    v_and_b32 v43, 0xffff0000, v83
    v_fmac_f32 v112, v40, v17
    v_fmac_f32 v113, v41, v17
    v_fmac_f32 v114, v42, v17
    v_fmac_f32 v115, v43, v17
    v_cvt_pk_bf16_f32 v112, v112, v113
    v_cvt_pk_bf16_f32 v113, v114, v115
    ds_write_b64 v27, v[112:113] offset:2048
    s_waitcnt lgkmcnt(0)
    ds_read_b128 v[68:71], v28 offset:0
    ds_read_b128 v[72:75], v28 offset:1024
    ds_read_b128 v[76:79], v28 offset:2048
    ds_read_b128 v[80:83], v28 offset:3072
    s_waitcnt lgkmcnt(3)
    buffer_store_dwordx4 v[68:71], v20, s[16:19], s44 offen
    s_add_u32 s44, s44, 131072
    s_waitcnt lgkmcnt(2)
    buffer_store_dwordx4 v[72:75], v20, s[16:19], s44 offen
    s_add_u32 s44, s44, 131072
    s_waitcnt lgkmcnt(1)
    buffer_store_dwordx4 v[76:79], v20, s[16:19], s44 offen
    s_add_u32 s44, s44, 131072
    s_waitcnt lgkmcnt(0)
    buffer_store_dwordx4 v[80:83], v20, s[16:19], s44 offen
    s_branch g34_kernel_end
g34_slow0:
    buffer_load_dword v12, v10, s[4:7], 0 offen sc1
    s_add_u32 s67, s67, 1
    s_waitcnt vmcnt(0)
    v_cmp_gt_u32 vcc, 1, v12
    s_cmp_lt_u32 s67, 0x40000
    s_cselect_b64 s[68:69], vcc, 0
    s_cmp_lg_u64 s[68:69], 0
    s_cbranch_scc1 g34_slow0
    s_branch g34_cont0
g34_slow1:
    buffer_load_dword v12, v10, s[4:7], 0 offen sc1
    s_add_u32 s67, s67, 1
    s_waitcnt vmcnt(0)
    v_cmp_gt_u32 vcc, 2, v12
    s_cmp_lt_u32 s67, 0x40000
    s_cselect_b64 s[68:69], vcc, 0
    s_cmp_lg_u64 s[68:69], 0
    s_cbranch_scc1 g34_slow1
    s_branch g34_cont1
g34_slow2:
    buffer_load_dword v12, v10, s[4:7], 0 offen sc1
    s_add_u32 s67, s67, 1
    s_waitcnt vmcnt(0)
    v_cmp_gt_u32 vcc, 3, v12
    s_cmp_lt_u32 s67, 0x40000
    s_cselect_b64 s[68:69], vcc, 0
    s_cmp_lg_u64 s[68:69], 0
    s_cbranch_scc1 g34_slow2
    s_branch g34_cont2
g34_slow3:
    buffer_load_dword v12, v11, s[4:7], 0 offen sc1
    s_add_u32 s67, s67, 1
    s_waitcnt vmcnt(0)
    v_cmp_gt_u32 vcc, 4, v12
    s_cmp_lt_u32 s67, 0x40000
    s_cselect_b64 s[68:69], vcc, 0
    s_cmp_lg_u64 s[68:69], 0
    s_cbranch_scc1 g34_slow3
    s_branch g34_cont3
g34_kernel_end:
    s_endpgm
code_end:
.section .rodata,"a"
.p2align 6
.amdhsa_kernel k1_kernel
  .amdhsa_next_free_vgpr 168
  .amdhsa_next_free_sgpr 102
  .amdhsa_accum_offset 168
  .amdhsa_group_segment_fixed_size 0
  .amdhsa_kernarg_size 96
  .amdhsa_user_sgpr_count 2
  .amdhsa_user_sgpr_kernarg_segment_ptr 1
  .amdhsa_system_sgpr_workgroup_id_x 1
.end_amdhsa_kernel
.p2align 6
.amdhsa_kernel k2_kernel
  .amdhsa_next_free_vgpr 176
  .amdhsa_next_free_sgpr 102
  .amdhsa_accum_offset 80
  .amdhsa_group_segment_fixed_size 0
  .amdhsa_kernarg_size 96
  .amdhsa_user_sgpr_count 2
  .amdhsa_user_sgpr_kernarg_segment_ptr 1
  .amdhsa_system_sgpr_workgroup_id_x 1
.end_amdhsa_kernel
.p2align 6
.amdhsa_kernel g34_kernel
  .amdhsa_next_free_vgpr 432
  .amdhsa_next_free_sgpr 102
  .amdhsa_accum_offset 256
  .amdhsa_group_segment_fixed_size 0
  .amdhsa_kernarg_size 96
  .amdhsa_user_sgpr_count 2
  .amdhsa_user_sgpr_kernarg_segment_ptr 1
  .amdhsa_system_sgpr_workgroup_id_x 1
.end_amdhsa_kernel
```
